```python
import torch

def _softmax(x, axis=-1):
    return torch.softmax(x, dim=axis)
def _gelu(x):
    return torch.nn.functional.gelu(x, approximate="tanh")
def _silu(x):
    return torch.nn.functional.silu(x)
def _sigmoid(x):
    return torch.sigmoid(x)
def _layernorm(x, axis=-1, eps=1e-5):
    m = x.mean(dim=axis, keepdim=True)
    v = x.var(dim=axis, keepdim=True, unbiased=False)
    return (x - m) / torch.sqrt(v + eps)
def _scatter_add(tgt, idx, src, axis=0):
    return tgt.clone().index_add_(axis, idx, src)
def _segment_sum(src, seg, n):
    out = torch.zeros((n,) + src.shape[1:], dtype=src.dtype)
    return out.index_add_(0, seg, src)
def _pad(x, pw):
    flat = tuple(v for pair in reversed(pw) for v in pair)
    return torch.nn.functional.pad(x, flat)

kernel_name = 'concat_heads__compressed_kv_cla__linear_kernel_hedgehog__prompt'

def setup_inputs():

    _w = (lambda a: (lambda t: t.to(torch.bfloat16) if t.is_floating_point() else t)(torch.as_tensor(a)))
    def _A_setup():
        B, H, Sq, Sk, D, M = 1, 32, 2048, 2048, 128, 512
        Dc = 4 * D
        return {
            "x": _w((lambda *s: torch.randn(*s, dtype=torch.bfloat16) * 0.8)(B, Sq, M)),
            "c_kv": _w((lambda *s: torch.randn(*s, dtype=torch.bfloat16) * 0.4)(B, Sk, Dc)),
            "w_q": _w((lambda *s: torch.randn(*s, dtype=torch.bfloat16) * 6.4)(M, H, D) * (M ** -0.5)),
            "w_uk": _w((lambda *s: torch.randn(*s, dtype=torch.bfloat16) * 6.4)(Dc, H, D) * (Dc ** -0.5)),
            "w_uv": _w((lambda *s: torch.randn(*s, dtype=torch.bfloat16) * 0.4)(Dc, H, D) * (Dc ** -0.5)),
            "w_o": _w((lambda *s: torch.randn(*s, dtype=torch.bfloat16) * 0.4)(H, D, M) * ((H * D) ** -0.5)),
        }
    _A_in = _A_setup()

    def _B_setup():
        B, S, D, H = 1, 2048, 512, 32
        Dh = D // H
        return {
            "x": _w((lambda *s: torch.randn(*s, dtype=torch.bfloat16) * 0.4)(B, S, D)),
            "wqkv": _w((lambda *s: torch.randn(*s, dtype=torch.bfloat16) * 0.4)(D, 3 * D)),
            "w_phi": _w((lambda *s: torch.randn(*s, dtype=torch.bfloat16) * 0.4)(H, Dh, Dh) * (Dh ** -0.5)),
            "wo": _w((lambda *s: torch.randn(*s, dtype=torch.bfloat16) * 0.05)(D, D)),
        }
    _B_in = _B_setup()

    return {
        "A_x": _A_in["x"],
        "A_c_kv": _A_in["c_kv"],
        "A_w_q": _A_in["w_q"],
        "A_w_uk": _A_in["w_uk"],
        "A_w_uv": _A_in["w_uv"],
        "A_w_o": _A_in["w_o"],
        "B_x": _B_in["x"],
        "B_wqkv": _B_in["wqkv"],
        "B_w_phi": _B_in["w_phi"],
        "B_wo": _B_in["wo"],
    }

def reference(A_x, A_c_kv, A_w_q, A_w_uk, A_w_uv, A_w_o, B_x, B_wqkv, B_w_phi, B_wo):
    def _A_ref(x, c_kv, w_q, w_uk, w_uv, w_o):
        B, Sq, M = x.shape[0], x.shape[1], x.shape[2]
        Sk = c_kv.shape[1]
        H, D = w_q.shape[1], w_q.shape[2]
        q = torch.einsum("bqm,mhd->bhqd", x, w_q)
        k = torch.einsum("bkc,chd->bhkd", c_kv, w_uk)
        v = torch.einsum("bkc,chd->bhkd", c_kv, w_uv)
        scores = torch.einsum("bhqd,bhkd->bhqk", q, k) * (D ** -0.5)
        off = Sk - Sq
        qi = torch.arange(Sq)[:, None]
        kj = torch.arange(Sk)[None, :]
        cmask = kj <= (qi + off)
        scores = torch.where(cmask[None, None], scores, -1e9)
        p = _softmax(scores, axis=-1)
        ctx = torch.einsum("bhqk,bhkd->bhqd", p, v)
        return torch.einsum("bhqd,hdm->bqm", ctx, w_o)

    def _B_ref(x, wqkv, w_phi, wo):
        B, S, D = x.shape
        H = 32; Dh = D // H
        qkv = (lambda x, *d: x.permute(*d))((x @ wqkv).reshape(B, S, 3, H, Dh), 2, 0, 3, 1, 4)
        q, k, v = qkv[0], qkv[1], qkv[2]
        pq = torch.einsum("bhsd,hdf->bhsf", q, w_phi)
        pk = torch.einsum("bhsd,hdf->bhsf", k, w_phi)
        phi_q = torch.concatenate([_softmax(pq, axis=-1), _softmax(-pq, axis=-1)], axis=-1)
        phi_k = torch.concatenate([_softmax(pk, axis=-1), _softmax(-pk, axis=-1)], axis=-1)
        kv = torch.einsum("bhsf,bhsd->bhfd", phi_k, v)
        z  = torch.einsum("bhsf->bhf", phi_k)
        num = torch.einsum("bhqf,bhfd->bhqd", phi_q, kv)
        den = torch.einsum("bhqf,bhf->bhq", phi_q, z)[..., None] + 1e-6
        o = num / den
        return (lambda x, *d: x.permute(*d))(o, 0, 2, 1, 3).reshape(B, S, D) @ wo

    a = _A_ref(A_x, A_c_kv, A_w_q, A_w_uk, A_w_uv, A_w_o)
    b = _B_ref(B_x, B_wqkv, B_w_phi, B_wo)
    return torch.concatenate([a, b], axis=-1)
```

```asm
; @launch kernel=k1_kernel grid=(256,1,1) block=(256,1,1) lds=163840
.amdgcn_target "amdgcn-amd-amdhsa--gfx950"
.text
.globl k1_kernel
.p2align 8
.type k1_kernel,@function
k1_kernel:
    s_cmp_ge_u32 s2, 256
    s_cbranch_scc1 K1_end_1
    s_load_dwordx4 s[44:47], s[0:1], 8
    s_load_dwordx4 s[48:51], s[0:1], 24
    s_load_dwordx4 s[52:55], s[0:1], 48
    s_load_dwordx2 s[56:57], s[0:1], 96
    s_load_dwordx2 s[58:59], s[0:1], 64
    v_lshrrev_b32 v241, 6, v0
    v_and_b32 v240, 63, v0
    v_readfirstlane_b32 s16, v241
    s_lshr_b32 s27, s2, 3
    s_and_b32 s17, s2, 1
    s_lshl_b32 s17, s17, 2
    s_and_b32 s26, s27, 3
    s_add_u32 s17, s17, s26
    s_lshr_b32 s27, s27, 2
    s_and_b32 s26, s2, 6
    s_mul_i32 s18, s26, 3
    s_add_u32 s18, s18, s27
    s_add_u32 s26, s26, s27
    s_add_u32 s26, s26, 18
    s_cmp_ge_u32 s27, 6
    s_cselect_b32 s18, s26, s18
    s_lshl_b32 s63, s18, 3
    s_add_u32 s63, s63, s17
    s_lshl_b32 s99, s63, 7
    s_lshl_b32 s32, s17, 16
    s_lshl_b32 s26, s16, 14
    s_add_u32 s32, s32, s26
    s_mov_b32 s14, 83886080
    s_mov_b32 s15, 0x20000
    s_mov_b32 s6, 0x200000
    s_mov_b32 s7, 0x20000
    s_mov_b32 s11, 0x20000
    s_mov_b32 s20, 0x3e0293ee
    s_cmp_ge_u32 s18, 12
    s_cselect_b32 s26, 12, 0
    s_cselect_b32 s28, 18874368, 0
    s_cselect_b32 s20, 0x5b800000, s20
    s_sub_u32 s19, s18, s26
    s_add_u32 s22, s32, s28
    s_mul_i32 s26, s19, 43
    s_lshr_b32 s26, s26, 7
    s_mul_i32 s28, s26, 3
    s_sub_u32 s28, s19, s28
    s_lshl_b32 s26, s26, 5
    s_lshl_b32 s28, s28, 3
    s_lshr_b32 s19, 0x160c00, s28
    s_and_b32 s19, s19, 0xff
    s_add_u32 s19, s19, s26
    s_lshr_b32 s97, 0x1f0b0a, s28
    s_and_b32 s97, s97, 0xff
    s_add_u32 s97, s97, s26
    s_lshl_b32 s23, s19, 6
    s_sub_u32 s26, s18, 24
    s_lshl_b32 s28, s26, 7
    s_add_u32 s28, s28, 1024
    s_mov_b32 s10, 0x400000
    s_mov_b32 s21, 8192
    s_cmp_ge_u32 s18, 24
    s_cselect_b32 s19, s26, s19
    s_cselect_b32 s23, s28, s23
    s_cselect_b32 s32, s32, s22
    s_cselect_b32 s10, 0x180000, s10
    s_cselect_b32 s21, 3072, s21
    s_cselect_b32 s39, 896, 0
    s_lshl_b32 s34, s21, 2
    s_lshr_b32 s35, s21, 1
    s_lshl_b32 s36, s21, 3
    s_lshl_b32 s92, s17, 1
    s_add_u32 s92, s92, s27
    s_and_b32 s92, s92, 7
    s_add_u32 s26, s92, s16
    s_and_b32 s26, s26, 7
    s_lshl_b32 s26, s26, 6
    s_mul_i32 s37, s26, s21
    s_xor_b32 s26, s26, 256
    s_mul_i32 s96, s26, s21
    s_lshl_b32 s92, s92, 7
    s_sub_u32 s92, s92, 128
    s_lshl_b32 s24, s17, 18
    s_lshl_b32 s26, s16, 16
    s_add_u32 s24, s24, s26
    s_add_u32 s25, s24, 32768
    s_lshl_b32 s30, s16, 14
    s_add_u32 s30, s30, 98304
    s_lshl_b32 s31, s16, 12
    s_add_u32 s31, s31, 0
    s_lshl_b32 s38, s16, 13
    s_mov_b32 s94, s38
    s_lshl_b32 s26, s16, 4
    s_mul_i32 s93, s26, s21
    s_add_u32 s93, s93, s23
    v_lshrrev_b32 v241, 3, v240
    v_lshlrev_b32 v241, 10, v241
    v_and_b32 v242, 7, v240
    v_lshrrev_b32 v243, 4, v240
    v_xor_b32 v242, v242, v243
    v_lshl_add_u32 v218, v242, 4, v241
    v_xor_b32 v219, 64, v218
    v_add_u32 v219, 7168, v219
    v_add_u32 v252, 14336, v218
    v_add_u32 v253, 14336, v219
    v_mul_lo_u32 v241, v243, s21
    v_and_b32 v242, 15, v240
    v_lshlrev_b32 v243, 1, v243
    v_xor_b32 v242, v242, v243
    v_lshl_add_u32 v220, v242, 4, v241
    v_xor_b32 v243, 8, v242
    v_lshl_add_u32 v254, v243, 4, v241
    v_lshrrev_b32 v242, 3, v242
    v_mul_lo_u32 v242, v242, s39
    v_add_u32 v220, v220, v242
    v_lshrrev_b32 v243, 3, v243
    v_mul_lo_u32 v243, v243, s39
    v_add_u32 v254, v254, v243
    s_sub_u32 s28, s34, 1024
    v_add_u32 v221, s28, v220
    v_add_u32 v254, s28, v254
    v_add_u32 v254, s28, v254
    v_add_u32 v255, s28, v254
    s_cmp_ge_u32 s18, 12
    s_waitcnt lgkmcnt(0)
    s_cselect_b64 s[8:9], s[50:51], s[48:49]
    s_cmp_ge_u32 s18, 24
    s_cselect_b64 s[8:9], s[54:55], s[8:9]
    s_cselect_b64 s[4:5], s[52:53], s[44:45]
    s_add_u32 s92, s92, 128
    s_and_b32 s92, s92, 0x3ff
    s_mul_i32 s33, s92, s35
    s_add_u32 m0, s31, 0
    s_add_u32 s33, s33, s93
    buffer_load_dwordx4 v220, s[8:11], s33 offen offset:0 lds
    buffer_load_dwordx4 v221, s[8:11], s33 offen offset:1024 lds
    buffer_load_dwordx4 v254, s[8:11], s33 offen offset:2048 lds
    buffer_load_dwordx4 v255, s[8:11], s33 offen offset:3072 lds
    s_add_u32 m0, s30, 0
    s_add_u32 s28, s24, s92
    buffer_load_dwordx4 v218, s[4:7], s28 offen offset:0 lds
    buffer_load_dwordx4 v219, s[4:7], s28 offen offset:1024 lds
    buffer_load_dwordx4 v252, s[4:7], s28 offen offset:2048 lds
    buffer_load_dwordx4 v253, s[4:7], s28 offen offset:3072 lds
    s_add_u32 m0, s30, 4096
    s_add_u32 s28, s25, s92
    buffer_load_dwordx4 v218, s[4:7], s28 offen offset:0 lds
    buffer_load_dwordx4 v219, s[4:7], s28 offen offset:1024 lds
    buffer_load_dwordx4 v252, s[4:7], s28 offen offset:2048 lds
    buffer_load_dwordx4 v253, s[4:7], s28 offen offset:3072 lds
    s_mov_b32 s12, s56
    s_mov_b32 s13, s57
    s_load_dwordx2 s[44:45], s[0:1], 0
    v_lshrrev_b32 v241, 4, v240
    v_bfe_u32 v242, v240, 2, 2
    v_lshl_add_u32 v243, v241, 3, v242
    v_lshlrev_b32 v243, 8, v243
    v_and_b32 v241, 1, v241
    v_lshl_add_u32 v242, v241, 2, v242
    v_and_b32 v241, 3, v240
    v_lshl_add_u32 v243, v241, 3, v243
    v_xor_b32 v241, 0, v242
    v_lshl_add_u32 v208, v241, 5, v243
    v_xor_b32 v241, 1, v242
    v_lshl_add_u32 v209, v241, 5, v243
    v_xor_b32 v241, 2, v242
    v_lshl_add_u32 v210, v241, 5, v243
    v_xor_b32 v241, 3, v242
    v_lshl_add_u32 v211, v241, 5, v243
    v_xor_b32 v241, 4, v242
    v_lshl_add_u32 v212, v241, 5, v243
    v_xor_b32 v241, 5, v242
    v_lshl_add_u32 v213, v241, 5, v243
    v_xor_b32 v241, 6, v242
    v_lshl_add_u32 v214, v241, 5, v243
    v_xor_b32 v241, 7, v242
    v_lshl_add_u32 v215, v241, 5, v243
    v_and_b32 v241, 15, v240
    v_lshlrev_b32 v241, 7, v241
    v_add_u32 v241, s30, v241
    v_bfe_u32 v242, v240, 1, 3
    v_lshrrev_b32 v243, 4, v240
    v_xor_b32 v242, v242, v243
    v_lshl_add_u32 v216, v242, 4, v241
    v_xor_b32 v242, 4, v242
    v_lshl_add_u32 v217, v242, 4, v241
    v_lshrrev_b32 v241, 3, v240
    v_mul_lo_u32 v241, v241, s21
    v_and_b32 v242, 7, v240
    v_bfe_u32 v243, v240, 4, 1
    v_lshlrev_b32 v243, 1, v243
    v_xor_b32 v242, v242, v243
    v_lshl_add_u32 v238, v242, 4, v241
    v_xor_b32 v242, 4, v242
    v_lshl_add_u32 v239, v242, 4, v241
    v_lshrrev_b32 v241, 4, v240
    v_bfe_u32 v242, v240, 2, 2
    v_lshl_add_u32 v243, v241, 3, v242
    v_lshlrev_b32 v243, 7, v243
    v_and_b32 v241, 1, v241
    v_lshrrev_b32 v242, 1, v242
    v_lshl_add_u32 v242, v241, 1, v242
    v_and_b32 v241, 3, v240
    v_lshl_add_u32 v243, v241, 3, v243
    v_xor_b32 v241, 0, v242
    v_lshl_add_u32 v222, v241, 5, v243
    v_add_u32 v226, 0x10000, v222
    v_xor_b32 v241, 1, v242
    v_lshl_add_u32 v223, v241, 5, v243
    v_add_u32 v227, 0x10000, v223
    v_xor_b32 v241, 2, v242
    v_lshl_add_u32 v224, v241, 5, v243
    v_add_u32 v228, 0x10000, v224
    v_xor_b32 v241, 3, v242
    v_lshl_add_u32 v225, v241, 5, v243
    v_add_u32 v229, 0x10000, v225
    v_lshlrev_b32 v234, 4, v240
    v_add_u32 v235, 4096, v234
    v_add_u32 v236, 8192, v234
    v_add_u32 v237, 12288, v234
    s_add_u32 s23, s23, 256
    s_cmp_lg_u32 s16, 0
    s_cbranch_scc1 K1_noclear
    s_lshl_b32 s26, s2, 7
    v_lshlrev_b32 v242, 15, v240
    v_add_u32 v243, s99, v242
    v_add_u32 v242, s26, v242
    v_cmp_eq_u32 vcc, 1, v240
    s_mov_b32 s26, 60293120
    v_mov_b32 v241, 0
    v_cndmask_b32 v242, v242, v243, vcc
    s_mov_b64 exec, 7
    buffer_store_dword v241, v242, s[12:15], s26 offen sc1
    s_mov_b64 exec, -1
K1_noclear:
    s_getpc_b64 s[62:63]
CPF_9:
    s_add_u32 s62, s62, K1_ktype_4 - CPF_9
    s_addc_u32 s63, s63, 0
    s_lshr_b32 s26, s2, 3
    s_lshl_b32 s26, s26, 2
    s_add_u32 s26, s26, s16
    s_lshl_b32 s26, s26, 10
    v_and_b32 v241, 7, v240
    v_lshlrev_b32 v241, 7, v241
    v_add_u32 v241, s26, v241
    v_min_u32 v241, K2_after - K1_ktype_4 - 4, v241
    global_load_dword v245, v241, s[62:63]
    s_cmp_ge_u32 s18, 24
    s_cbranch_scc1 K1_bkv_3
    s_cmp_ge_u32 s18, 12
    s_cbranch_scc1 K1_vtype_2
K1_ktype_4:
    s_add_u32 s92, s92, 128
    s_and_b32 s92, s92, 0x3ff
    s_mul_i32 s33, s92, s35
    s_add_u32 m0, s31, 16384
    s_add_u32 s33, s33, s93
    buffer_load_dwordx4 v220, s[8:11], s33 offen offset:0 lds
    buffer_load_dwordx4 v221, s[8:11], s33 offen offset:1024 lds
    buffer_load_dwordx4 v254, s[8:11], s33 offen offset:2048 lds
    buffer_load_dwordx4 v255, s[8:11], s33 offen offset:3072 lds
    s_waitcnt vmcnt(5)
    s_barrier
    ds_read_b128 a[0:3], v216 offset:0
    ds_read_b128 a[4:7], v216 offset:2048
    ds_read_b128 a[8:11], v216 offset:4096
    ds_read_b128 a[12:15], v216 offset:6144
    ds_read_b64_tr_b16 v[128:129], v208 offset:0
    ds_read_b64_tr_b16 v[130:131], v208 offset:1024
    ds_read_b64_tr_b16 v[132:133], v209 offset:0
    ds_read_b64_tr_b16 v[134:135], v209 offset:1024
    ds_read_b64_tr_b16 v[136:137], v210 offset:0
    ds_read_b64_tr_b16 v[138:139], v210 offset:1024
    ds_read_b64_tr_b16 v[140:141], v211 offset:0
    ds_read_b64_tr_b16 v[142:143], v211 offset:1024
    s_waitcnt lgkmcnt(4)
    v_mfma_f32_16x16x32_bf16 v[0:3], v[128:131], a[0:3], 0
    ds_read_b128 a[16:19], v217 offset:0
    ds_read_b128 a[20:23], v217 offset:2048
    ds_read_b64_tr_b16 v[144:145], v212 offset:0
    ds_read_b64_tr_b16 v[146:147], v212 offset:1024
    v_mfma_f32_16x16x32_bf16 v[4:7], v[128:131], a[4:7], 0
    s_add_u32 m0, s30, 8192
    ds_read_b128 a[24:27], v217 offset:4096
    ds_read_b128 a[28:31], v217 offset:6144
    v_mfma_f32_16x16x32_bf16 v[8:11], v[128:131], a[8:11], 0
    s_add_u32 s28, s24, s92
    v_mfma_f32_16x16x32_bf16 v[12:15], v[128:131], a[12:15], 0
    buffer_load_dwordx4 v218, s[4:7], s28 offen offset:0 lds
    v_mfma_f32_16x16x32_bf16 v[28:31], v[132:135], a[12:15], 0
    ds_read_b64_tr_b16 v[148:149], v213 offset:0
    ds_read_b64_tr_b16 v[150:151], v213 offset:1024
    v_mfma_f32_16x16x32_bf16 v[24:27], v[132:135], a[8:11], 0
    buffer_load_dwordx4 v219, s[4:7], s28 offen offset:1024 lds
    v_mfma_f32_16x16x32_bf16 v[20:23], v[132:135], a[4:7], 0
    buffer_load_dwordx4 v252, s[4:7], s28 offen offset:2048 lds
    v_mfma_f32_16x16x32_bf16 v[16:19], v[132:135], a[0:3], 0
    s_waitcnt lgkmcnt(8)
    v_mfma_f32_16x16x32_bf16 v[32:35], v[136:139], a[0:3], 0
    ds_read_b64_tr_b16 v[152:153], v214 offset:0
    ds_read_b64_tr_b16 v[154:155], v214 offset:1024
    v_mfma_f32_16x16x32_bf16 v[36:39], v[136:139], a[4:7], 0
    buffer_load_dwordx4 v253, s[4:7], s28 offen offset:3072 lds
    v_mfma_f32_16x16x32_bf16 v[40:43], v[136:139], a[8:11], 0
    s_add_u32 m0, s30, 12288
    s_add_u32 s28, s25, s92
    v_mfma_f32_16x16x32_bf16 v[44:47], v[136:139], a[12:15], 0
    buffer_load_dwordx4 v218, s[4:7], s28 offen offset:0 lds
    v_mfma_f32_16x16x32_bf16 v[60:63], v[140:143], a[12:15], 0
    ds_read_b64_tr_b16 v[156:157], v215 offset:0
    ds_read_b64_tr_b16 v[158:159], v215 offset:1024
    v_mfma_f32_16x16x32_bf16 v[56:59], v[140:143], a[8:11], 0
    buffer_load_dwordx4 v219, s[4:7], s28 offen offset:1024 lds
    v_mfma_f32_16x16x32_bf16 v[52:55], v[140:143], a[4:7], 0
    buffer_load_dwordx4 v252, s[4:7], s28 offen offset:2048 lds
    v_mfma_f32_16x16x32_bf16 v[48:51], v[140:143], a[0:3], 0
    s_waitcnt lgkmcnt(4)
    buffer_load_dwordx4 v253, s[4:7], s28 offen offset:3072 lds
    v_mfma_f32_16x16x32_bf16 v[64:67], v[144:147], a[0:3], 0
    s_add_u32 s92, s92, 128
    ds_read_b64_tr_b16 v[160:161], v208 offset:8192
    ds_read_b64_tr_b16 v[162:163], v208 offset:9216
    v_mfma_f32_16x16x32_bf16 v[68:71], v[144:147], a[4:7], 0
    s_and_b32 s92, s92, 0x3ff
    s_mul_i32 s33, s92, s35
    v_mfma_f32_16x16x32_bf16 v[72:75], v[144:147], a[8:11], 0
    s_add_u32 m0, s31, 32768
    v_mfma_f32_16x16x32_bf16 v[76:79], v[144:147], a[12:15], 0
    s_add_u32 s33, s33, s93
    v_mfma_f32_16x16x32_bf16 v[92:95], v[148:151], a[12:15], 0
    ds_read_b64_tr_b16 v[164:165], v209 offset:8192
    ds_read_b64_tr_b16 v[166:167], v209 offset:9216
    v_mfma_f32_16x16x32_bf16 v[88:91], v[148:151], a[8:11], 0
    buffer_load_dwordx4 v220, s[8:11], s33 offen offset:0 lds
    v_mfma_f32_16x16x32_bf16 v[84:87], v[148:151], a[4:7], 0
    buffer_load_dwordx4 v221, s[8:11], s33 offen offset:1024 lds
    v_mfma_f32_16x16x32_bf16 v[80:83], v[148:151], a[0:3], 0
    s_waitcnt lgkmcnt(4)
    v_mfma_f32_16x16x32_bf16 v[96:99], v[152:155], a[0:3], 0
    ds_read_b64_tr_b16 v[168:169], v210 offset:8192
    ds_read_b64_tr_b16 v[170:171], v210 offset:9216
    v_mfma_f32_16x16x32_bf16 v[100:103], v[152:155], a[4:7], 0
    buffer_load_dwordx4 v254, s[8:11], s33 offen offset:2048 lds
    buffer_load_dwordx4 v255, s[8:11], s33 offen offset:3072 lds
    v_mfma_f32_16x16x32_bf16 v[104:107], v[152:155], a[8:11], 0
    s_add_u32 m0, s30, 0
    s_add_u32 s28, s24, s92
    v_mfma_f32_16x16x32_bf16 v[108:111], v[152:155], a[12:15], 0
    buffer_load_dwordx4 v218, s[4:7], s28 offen offset:0 lds
    v_mfma_f32_16x16x32_bf16 v[124:127], v[156:159], a[12:15], 0
    ds_read_b64_tr_b16 v[172:173], v211 offset:8192
    ds_read_b64_tr_b16 v[174:175], v211 offset:9216
    v_mfma_f32_16x16x32_bf16 v[120:123], v[156:159], a[8:11], 0
    buffer_load_dwordx4 v219, s[4:7], s28 offen offset:1024 lds
    v_mfma_f32_16x16x32_bf16 v[116:119], v[156:159], a[4:7], 0
    v_mfma_f32_16x16x32_bf16 v[112:115], v[156:159], a[0:3], 0
    s_waitcnt lgkmcnt(4)
    v_mfma_f32_16x16x32_bf16 v[0:3], v[160:163], a[16:19], v[0:3]
    ds_read_b64_tr_b16 v[176:177], v212 offset:8192
    ds_read_b64_tr_b16 v[178:179], v212 offset:9216
    v_mfma_f32_16x16x32_bf16 v[4:7], v[160:163], a[20:23], v[4:7]
    buffer_load_dwordx4 v252, s[4:7], s28 offen offset:2048 lds
    v_mfma_f32_16x16x32_bf16 v[8:11], v[160:163], a[24:27], v[8:11]
    buffer_load_dwordx4 v253, s[4:7], s28 offen offset:3072 lds
    v_mfma_f32_16x16x32_bf16 v[12:15], v[160:163], a[28:31], v[12:15]
    s_add_u32 m0, s30, 4096
    s_add_u32 s28, s25, s92
    v_mfma_f32_16x16x32_bf16 v[28:31], v[164:167], a[28:31], v[28:31]
    ds_read_b64_tr_b16 v[180:181], v213 offset:8192
    ds_read_b64_tr_b16 v[182:183], v213 offset:9216
    v_mfma_f32_16x16x32_bf16 v[24:27], v[164:167], a[24:27], v[24:27]
    buffer_load_dwordx4 v218, s[4:7], s28 offen offset:0 lds
    v_mfma_f32_16x16x32_bf16 v[20:23], v[164:167], a[20:23], v[20:23]
    buffer_load_dwordx4 v219, s[4:7], s28 offen offset:1024 lds
    v_mfma_f32_16x16x32_bf16 v[16:19], v[164:167], a[16:19], v[16:19]
    s_waitcnt lgkmcnt(4)
    v_mfma_f32_16x16x32_bf16 v[32:35], v[168:171], a[16:19], v[32:35]
    ds_read_b64_tr_b16 v[184:185], v214 offset:8192
    ds_read_b64_tr_b16 v[186:187], v214 offset:9216
    v_mfma_f32_16x16x32_bf16 v[36:39], v[168:171], a[20:23], v[36:39]
    buffer_load_dwordx4 v252, s[4:7], s28 offen offset:2048 lds
    v_mfma_f32_16x16x32_bf16 v[40:43], v[168:171], a[24:27], v[40:43]
    buffer_load_dwordx4 v253, s[4:7], s28 offen offset:3072 lds
    v_mfma_f32_16x16x32_bf16 v[44:47], v[168:171], a[28:31], v[44:47]
    v_mfma_f32_16x16x32_bf16 v[60:63], v[172:175], a[28:31], v[60:63]
    s_waitcnt vmcnt(12)
    ds_read_b64_tr_b16 v[188:189], v215 offset:8192
    ds_read_b64_tr_b16 v[190:191], v215 offset:9216
    s_barrier
    v_mfma_f32_16x16x32_bf16 v[56:59], v[172:175], a[24:27], v[56:59]
    ds_read_b128 a[32:35], v216 offset:8192
    ds_read_b128 a[36:39], v216 offset:10240
    v_mfma_f32_16x16x32_bf16 v[52:55], v[172:175], a[20:23], v[52:55]
    ds_read_b128 a[40:43], v216 offset:12288
    ds_read_b128 a[44:47], v216 offset:14336
    v_mfma_f32_16x16x32_bf16 v[48:51], v[172:175], a[16:19], v[48:51]
    s_waitcnt lgkmcnt(8)
    s_add_u32 s92, s92, 128
    v_mfma_f32_16x16x32_bf16 v[64:67], v[176:179], a[16:19], v[64:67]
    ds_read_b64_tr_b16 v[128:129], v208 offset:16384
    ds_read_b64_tr_b16 v[130:131], v208 offset:17408
    v_mfma_f32_16x16x32_bf16 v[68:71], v[176:179], a[20:23], v[68:71]
    s_and_b32 s92, s92, 0x3ff
    v_mfma_f32_16x16x32_bf16 v[72:75], v[176:179], a[24:27], v[72:75]
    ds_read_b128 a[48:51], v217 offset:8192
    ds_read_b128 a[52:55], v217 offset:10240
    v_mfma_f32_16x16x32_bf16 v[76:79], v[176:179], a[28:31], v[76:79]
    s_mul_i32 s33, s92, s35
    v_mfma_f32_16x16x32_bf16 v[92:95], v[180:183], a[28:31], v[92:95]
    ds_read_b64_tr_b16 v[132:133], v209 offset:16384
    ds_read_b64_tr_b16 v[134:135], v209 offset:17408
    v_mfma_f32_16x16x32_bf16 v[88:91], v[180:183], a[24:27], v[88:91]
    s_add_u32 m0, s31, 49152
    v_mfma_f32_16x16x32_bf16 v[84:87], v[180:183], a[20:23], v[84:87]
    ds_read_b128 a[56:59], v217 offset:12288
    ds_read_b128 a[60:63], v217 offset:14336
    v_mfma_f32_16x16x32_bf16 v[80:83], v[180:183], a[16:19], v[80:83]
    s_waitcnt lgkmcnt(12)
    s_add_u32 s33, s33, s93
    v_mfma_f32_16x16x32_bf16 v[96:99], v[184:187], a[16:19], v[96:99]
    ds_read_b64_tr_b16 v[136:137], v210 offset:16384
    ds_read_b64_tr_b16 v[138:139], v210 offset:17408
    v_mfma_f32_16x16x32_bf16 v[100:103], v[184:187], a[20:23], v[100:103]
    buffer_load_dwordx4 v220, s[8:11], s33 offen offset:0 lds
    v_mfma_f32_16x16x32_bf16 v[104:107], v[184:187], a[24:27], v[104:107]
    v_mfma_f32_16x16x32_bf16 v[108:111], v[184:187], a[28:31], v[108:111]
    v_mfma_f32_16x16x32_bf16 v[124:127], v[188:191], a[28:31], v[124:127]
    ds_read_b64_tr_b16 v[140:141], v211 offset:16384
    ds_read_b64_tr_b16 v[142:143], v211 offset:17408
    v_mfma_f32_16x16x32_bf16 v[120:123], v[188:191], a[24:27], v[120:123]
    buffer_load_dwordx4 v221, s[8:11], s33 offen offset:1024 lds
    v_mfma_f32_16x16x32_bf16 v[116:119], v[188:191], a[20:23], v[116:119]
    v_mfma_f32_16x16x32_bf16 v[112:115], v[188:191], a[16:19], v[112:115]
    s_waitcnt lgkmcnt(6)
    v_mfma_f32_16x16x32_bf16 v[0:3], v[128:131], a[32:35], v[0:3]
    ds_read_b64_tr_b16 v[144:145], v212 offset:16384
    ds_read_b64_tr_b16 v[146:147], v212 offset:17408
    v_mfma_f32_16x16x32_bf16 v[4:7], v[128:131], a[36:39], v[4:7]
    buffer_load_dwordx4 v254, s[8:11], s33 offen offset:2048 lds
    v_mfma_f32_16x16x32_bf16 v[8:11], v[128:131], a[40:43], v[8:11]
    v_mfma_f32_16x16x32_bf16 v[12:15], v[128:131], a[44:47], v[12:15]
    v_mfma_f32_16x16x32_bf16 v[28:31], v[132:135], a[44:47], v[28:31]
    ds_read_b64_tr_b16 v[148:149], v213 offset:16384
    ds_read_b64_tr_b16 v[150:151], v213 offset:17408
    v_mfma_f32_16x16x32_bf16 v[24:27], v[132:135], a[40:43], v[24:27]
    buffer_load_dwordx4 v255, s[8:11], s33 offen offset:3072 lds
    v_mfma_f32_16x16x32_bf16 v[20:23], v[132:135], a[36:39], v[20:23]
    v_mfma_f32_16x16x32_bf16 v[16:19], v[132:135], a[32:35], v[16:19]
    s_waitcnt lgkmcnt(4)
    v_mfma_f32_16x16x32_bf16 v[32:35], v[136:139], a[32:35], v[32:35]
    ds_read_b64_tr_b16 v[152:153], v214 offset:16384
    ds_read_b64_tr_b16 v[154:155], v214 offset:17408
    v_mfma_f32_16x16x32_bf16 v[36:39], v[136:139], a[36:39], v[36:39]
    s_add_u32 m0, s30, 8192
    v_mfma_f32_16x16x32_bf16 v[40:43], v[136:139], a[40:43], v[40:43]
    s_add_u32 s28, s24, s92
    v_mfma_f32_16x16x32_bf16 v[44:47], v[136:139], a[44:47], v[44:47]
    v_mfma_f32_16x16x32_bf16 v[60:63], v[140:143], a[44:47], v[60:63]
    ds_read_b64_tr_b16 v[156:157], v215 offset:16384
    ds_read_b64_tr_b16 v[158:159], v215 offset:17408
    v_mfma_f32_16x16x32_bf16 v[56:59], v[140:143], a[40:43], v[56:59]
    buffer_load_dwordx4 v218, s[4:7], s28 offen offset:0 lds
    v_mfma_f32_16x16x32_bf16 v[52:55], v[140:143], a[36:39], v[52:55]
    v_mfma_f32_16x16x32_bf16 v[48:51], v[140:143], a[32:35], v[48:51]
    s_waitcnt lgkmcnt(4)
    v_mfma_f32_16x16x32_bf16 v[64:67], v[144:147], a[32:35], v[64:67]
    ds_read_b64_tr_b16 v[160:161], v208 offset:24576
    ds_read_b64_tr_b16 v[162:163], v208 offset:25600
    v_mfma_f32_16x16x32_bf16 v[68:71], v[144:147], a[36:39], v[68:71]
    buffer_load_dwordx4 v219, s[4:7], s28 offen offset:1024 lds
    v_mfma_f32_16x16x32_bf16 v[72:75], v[144:147], a[40:43], v[72:75]
    v_mfma_f32_16x16x32_bf16 v[76:79], v[144:147], a[44:47], v[76:79]
    buffer_load_dwordx4 v252, s[4:7], s28 offen offset:2048 lds
    v_mfma_f32_16x16x32_bf16 v[92:95], v[148:151], a[44:47], v[92:95]
    ds_read_b64_tr_b16 v[164:165], v209 offset:24576
    ds_read_b64_tr_b16 v[166:167], v209 offset:25600
    v_mfma_f32_16x16x32_bf16 v[88:91], v[148:151], a[40:43], v[88:91]
    v_mfma_f32_16x16x32_bf16 v[84:87], v[148:151], a[36:39], v[84:87]
    buffer_load_dwordx4 v253, s[4:7], s28 offen offset:3072 lds
    v_mfma_f32_16x16x32_bf16 v[80:83], v[148:151], a[32:35], v[80:83]
    s_waitcnt lgkmcnt(4)
    v_mfma_f32_16x16x32_bf16 v[96:99], v[152:155], a[32:35], v[96:99]
    ds_read_b64_tr_b16 v[168:169], v210 offset:24576
    ds_read_b64_tr_b16 v[170:171], v210 offset:25600
    v_mfma_f32_16x16x32_bf16 v[100:103], v[152:155], a[36:39], v[100:103]
    v_mfma_f32_16x16x32_bf16 v[104:107], v[152:155], a[40:43], v[104:107]
    s_add_u32 m0, s30, 12288
    v_mfma_f32_16x16x32_bf16 v[108:111], v[152:155], a[44:47], v[108:111]
    s_add_u32 s28, s25, s92
    v_mfma_f32_16x16x32_bf16 v[124:127], v[156:159], a[44:47], v[124:127]
    ds_read_b64_tr_b16 v[172:173], v211 offset:24576
    ds_read_b64_tr_b16 v[174:175], v211 offset:25600
    v_mfma_f32_16x16x32_bf16 v[120:123], v[156:159], a[40:43], v[120:123]
    buffer_load_dwordx4 v218, s[4:7], s28 offen offset:0 lds
    v_mfma_f32_16x16x32_bf16 v[116:119], v[156:159], a[36:39], v[116:119]
    v_mfma_f32_16x16x32_bf16 v[112:115], v[156:159], a[32:35], v[112:115]
    s_waitcnt lgkmcnt(4)
    v_mfma_f32_16x16x32_bf16 v[0:3], v[160:163], a[48:51], v[0:3]
    ds_read_b64_tr_b16 v[176:177], v212 offset:24576
    ds_read_b64_tr_b16 v[178:179], v212 offset:25600
    v_mfma_f32_16x16x32_bf16 v[4:7], v[160:163], a[52:55], v[4:7]
    buffer_load_dwordx4 v219, s[4:7], s28 offen offset:1024 lds
    v_mfma_f32_16x16x32_bf16 v[8:11], v[160:163], a[56:59], v[8:11]
    v_mfma_f32_16x16x32_bf16 v[12:15], v[160:163], a[60:63], v[12:15]
    v_mfma_f32_16x16x32_bf16 v[28:31], v[164:167], a[60:63], v[28:31]
    ds_read_b64_tr_b16 v[180:181], v213 offset:24576
    ds_read_b64_tr_b16 v[182:183], v213 offset:25600
    v_mfma_f32_16x16x32_bf16 v[24:27], v[164:167], a[56:59], v[24:27]
    buffer_load_dwordx4 v252, s[4:7], s28 offen offset:2048 lds
    v_mfma_f32_16x16x32_bf16 v[20:23], v[164:167], a[52:55], v[20:23]
    v_mfma_f32_16x16x32_bf16 v[16:19], v[164:167], a[48:51], v[16:19]
    s_waitcnt lgkmcnt(4)
    v_mfma_f32_16x16x32_bf16 v[32:35], v[168:171], a[48:51], v[32:35]
    ds_read_b64_tr_b16 v[184:185], v214 offset:24576
    ds_read_b64_tr_b16 v[186:187], v214 offset:25600
    v_mfma_f32_16x16x32_bf16 v[36:39], v[168:171], a[52:55], v[36:39]
    buffer_load_dwordx4 v253, s[4:7], s28 offen offset:3072 lds
    v_mfma_f32_16x16x32_bf16 v[40:43], v[168:171], a[56:59], v[40:43]
    v_mfma_f32_16x16x32_bf16 v[44:47], v[168:171], a[60:63], v[44:47]
    v_mfma_f32_16x16x32_bf16 v[60:63], v[172:175], a[60:63], v[60:63]
    s_waitcnt vmcnt(12)
    ds_read_b64_tr_b16 v[188:189], v215 offset:24576
    ds_read_b64_tr_b16 v[190:191], v215 offset:25600
    s_barrier
    v_mfma_f32_16x16x32_bf16 v[56:59], v[172:175], a[56:59], v[56:59]
    ds_read_b128 a[64:67], v216 offset:0
    ds_read_b128 a[68:71], v216 offset:2048
    v_mfma_f32_16x16x32_bf16 v[52:55], v[172:175], a[52:55], v[52:55]
    ds_read_b128 a[72:75], v216 offset:4096
    ds_read_b128 a[76:79], v216 offset:6144
    v_mfma_f32_16x16x32_bf16 v[48:51], v[172:175], a[48:51], v[48:51]
    s_waitcnt lgkmcnt(8)
    s_add_u32 s92, s92, 128
    v_mfma_f32_16x16x32_bf16 v[64:67], v[176:179], a[48:51], v[64:67]
    ds_read_b64_tr_b16 v[128:129], v208 offset:32768
    ds_read_b64_tr_b16 v[130:131], v208 offset:33792
    v_mfma_f32_16x16x32_bf16 v[68:71], v[176:179], a[52:55], v[68:71]
    s_and_b32 s92, s92, 0x3ff
    v_mfma_f32_16x16x32_bf16 v[72:75], v[176:179], a[56:59], v[72:75]
    ds_read_b128 a[80:83], v217 offset:0
    ds_read_b128 a[84:87], v217 offset:2048
    v_mfma_f32_16x16x32_bf16 v[76:79], v[176:179], a[60:63], v[76:79]
    s_mul_i32 s33, s92, s35
    v_mfma_f32_16x16x32_bf16 v[92:95], v[180:183], a[60:63], v[92:95]
    ds_read_b64_tr_b16 v[132:133], v209 offset:32768
    ds_read_b64_tr_b16 v[134:135], v209 offset:33792
    v_mfma_f32_16x16x32_bf16 v[88:91], v[180:183], a[56:59], v[88:91]
    s_add_u32 m0, s31, 0
    v_mfma_f32_16x16x32_bf16 v[84:87], v[180:183], a[52:55], v[84:87]
    ds_read_b128 a[88:91], v217 offset:4096
    ds_read_b128 a[92:95], v217 offset:6144
    v_mfma_f32_16x16x32_bf16 v[80:83], v[180:183], a[48:51], v[80:83]
    s_waitcnt lgkmcnt(12)
    s_add_u32 s33, s33, s93
    v_mfma_f32_16x16x32_bf16 v[96:99], v[184:187], a[48:51], v[96:99]
    ds_read_b64_tr_b16 v[136:137], v210 offset:32768
    ds_read_b64_tr_b16 v[138:139], v210 offset:33792
    v_mfma_f32_16x16x32_bf16 v[100:103], v[184:187], a[52:55], v[100:103]
    buffer_load_dwordx4 v220, s[8:11], s33 offen offset:0 lds
    v_mfma_f32_16x16x32_bf16 v[104:107], v[184:187], a[56:59], v[104:107]
    v_mfma_f32_16x16x32_bf16 v[108:111], v[184:187], a[60:63], v[108:111]
    v_mfma_f32_16x16x32_bf16 v[124:127], v[188:191], a[60:63], v[124:127]
    ds_read_b64_tr_b16 v[140:141], v211 offset:32768
    ds_read_b64_tr_b16 v[142:143], v211 offset:33792
    v_mfma_f32_16x16x32_bf16 v[120:123], v[188:191], a[56:59], v[120:123]
    buffer_load_dwordx4 v221, s[8:11], s33 offen offset:1024 lds
    v_mfma_f32_16x16x32_bf16 v[116:119], v[188:191], a[52:55], v[116:119]
    v_mfma_f32_16x16x32_bf16 v[112:115], v[188:191], a[48:51], v[112:115]
    s_waitcnt lgkmcnt(6)
    v_mfma_f32_16x16x32_bf16 v[0:3], v[128:131], a[64:67], v[0:3]
    ds_read_b64_tr_b16 v[144:145], v212 offset:32768
    ds_read_b64_tr_b16 v[146:147], v212 offset:33792
    v_mfma_f32_16x16x32_bf16 v[4:7], v[128:131], a[68:71], v[4:7]
    buffer_load_dwordx4 v254, s[8:11], s33 offen offset:2048 lds
    v_mfma_f32_16x16x32_bf16 v[8:11], v[128:131], a[72:75], v[8:11]
    v_mfma_f32_16x16x32_bf16 v[12:15], v[128:131], a[76:79], v[12:15]
    v_mfma_f32_16x16x32_bf16 v[28:31], v[132:135], a[76:79], v[28:31]
    ds_read_b64_tr_b16 v[148:149], v213 offset:32768
    ds_read_b64_tr_b16 v[150:151], v213 offset:33792
    v_mfma_f32_16x16x32_bf16 v[24:27], v[132:135], a[72:75], v[24:27]
    buffer_load_dwordx4 v255, s[8:11], s33 offen offset:3072 lds
    v_mfma_f32_16x16x32_bf16 v[20:23], v[132:135], a[68:71], v[20:23]
    v_mfma_f32_16x16x32_bf16 v[16:19], v[132:135], a[64:67], v[16:19]
    s_waitcnt lgkmcnt(4)
    v_mfma_f32_16x16x32_bf16 v[32:35], v[136:139], a[64:67], v[32:35]
    ds_read_b64_tr_b16 v[152:153], v214 offset:32768
    ds_read_b64_tr_b16 v[154:155], v214 offset:33792
    v_mfma_f32_16x16x32_bf16 v[36:39], v[136:139], a[68:71], v[36:39]
    s_add_u32 m0, s30, 0
    v_mfma_f32_16x16x32_bf16 v[40:43], v[136:139], a[72:75], v[40:43]
    s_add_u32 s28, s24, s92
    v_mfma_f32_16x16x32_bf16 v[44:47], v[136:139], a[76:79], v[44:47]
    v_mfma_f32_16x16x32_bf16 v[60:63], v[140:143], a[76:79], v[60:63]
    ds_read_b64_tr_b16 v[156:157], v215 offset:32768
    ds_read_b64_tr_b16 v[158:159], v215 offset:33792
    v_mfma_f32_16x16x32_bf16 v[56:59], v[140:143], a[72:75], v[56:59]
    buffer_load_dwordx4 v218, s[4:7], s28 offen offset:0 lds
    v_mfma_f32_16x16x32_bf16 v[52:55], v[140:143], a[68:71], v[52:55]
    v_mfma_f32_16x16x32_bf16 v[48:51], v[140:143], a[64:67], v[48:51]
    s_waitcnt lgkmcnt(4)
    v_mfma_f32_16x16x32_bf16 v[64:67], v[144:147], a[64:67], v[64:67]
    ds_read_b64_tr_b16 v[160:161], v208 offset:40960
    ds_read_b64_tr_b16 v[162:163], v208 offset:41984
    v_mfma_f32_16x16x32_bf16 v[68:71], v[144:147], a[68:71], v[68:71]
    buffer_load_dwordx4 v219, s[4:7], s28 offen offset:1024 lds
    v_mfma_f32_16x16x32_bf16 v[72:75], v[144:147], a[72:75], v[72:75]
    v_mfma_f32_16x16x32_bf16 v[76:79], v[144:147], a[76:79], v[76:79]
    buffer_load_dwordx4 v252, s[4:7], s28 offen offset:2048 lds
    v_mfma_f32_16x16x32_bf16 v[92:95], v[148:151], a[76:79], v[92:95]
    ds_read_b64_tr_b16 v[164:165], v209 offset:40960
    ds_read_b64_tr_b16 v[166:167], v209 offset:41984
    v_mfma_f32_16x16x32_bf16 v[88:91], v[148:151], a[72:75], v[88:91]
    v_mfma_f32_16x16x32_bf16 v[84:87], v[148:151], a[68:71], v[84:87]
    buffer_load_dwordx4 v253, s[4:7], s28 offen offset:3072 lds
    v_mfma_f32_16x16x32_bf16 v[80:83], v[148:151], a[64:67], v[80:83]
    s_waitcnt lgkmcnt(4)
    v_mfma_f32_16x16x32_bf16 v[96:99], v[152:155], a[64:67], v[96:99]
    ds_read_b64_tr_b16 v[168:169], v210 offset:40960
    ds_read_b64_tr_b16 v[170:171], v210 offset:41984
    v_mfma_f32_16x16x32_bf16 v[100:103], v[152:155], a[68:71], v[100:103]
    v_mfma_f32_16x16x32_bf16 v[104:107], v[152:155], a[72:75], v[104:107]
    s_add_u32 m0, s30, 4096
    v_mfma_f32_16x16x32_bf16 v[108:111], v[152:155], a[76:79], v[108:111]
    s_add_u32 s28, s25, s92
    v_mfma_f32_16x16x32_bf16 v[124:127], v[156:159], a[76:79], v[124:127]
    ds_read_b64_tr_b16 v[172:173], v211 offset:40960
    ds_read_b64_tr_b16 v[174:175], v211 offset:41984
    v_mfma_f32_16x16x32_bf16 v[120:123], v[156:159], a[72:75], v[120:123]
    buffer_load_dwordx4 v218, s[4:7], s28 offen offset:0 lds
    v_mfma_f32_16x16x32_bf16 v[116:119], v[156:159], a[68:71], v[116:119]
    v_mfma_f32_16x16x32_bf16 v[112:115], v[156:159], a[64:67], v[112:115]
    s_waitcnt lgkmcnt(4)
    v_mfma_f32_16x16x32_bf16 v[0:3], v[160:163], a[80:83], v[0:3]
    ds_read_b64_tr_b16 v[176:177], v212 offset:40960
    ds_read_b64_tr_b16 v[178:179], v212 offset:41984
    v_mfma_f32_16x16x32_bf16 v[4:7], v[160:163], a[84:87], v[4:7]
    buffer_load_dwordx4 v219, s[4:7], s28 offen offset:1024 lds
    v_mfma_f32_16x16x32_bf16 v[8:11], v[160:163], a[88:91], v[8:11]
    v_mfma_f32_16x16x32_bf16 v[12:15], v[160:163], a[92:95], v[12:15]
    v_mfma_f32_16x16x32_bf16 v[28:31], v[164:167], a[92:95], v[28:31]
    ds_read_b64_tr_b16 v[180:181], v213 offset:40960
    ds_read_b64_tr_b16 v[182:183], v213 offset:41984
    v_mfma_f32_16x16x32_bf16 v[24:27], v[164:167], a[88:91], v[24:27]
    buffer_load_dwordx4 v252, s[4:7], s28 offen offset:2048 lds
    v_mfma_f32_16x16x32_bf16 v[20:23], v[164:167], a[84:87], v[20:23]
    v_mfma_f32_16x16x32_bf16 v[16:19], v[164:167], a[80:83], v[16:19]
    s_waitcnt lgkmcnt(4)
    v_mfma_f32_16x16x32_bf16 v[32:35], v[168:171], a[80:83], v[32:35]
    ds_read_b64_tr_b16 v[184:185], v214 offset:40960
    ds_read_b64_tr_b16 v[186:187], v214 offset:41984
    v_mfma_f32_16x16x32_bf16 v[36:39], v[168:171], a[84:87], v[36:39]
    buffer_load_dwordx4 v253, s[4:7], s28 offen offset:3072 lds
    v_mfma_f32_16x16x32_bf16 v[40:43], v[168:171], a[88:91], v[40:43]
    v_mfma_f32_16x16x32_bf16 v[44:47], v[168:171], a[92:95], v[44:47]
    v_mfma_f32_16x16x32_bf16 v[60:63], v[172:175], a[92:95], v[60:63]
    s_waitcnt vmcnt(12)
    ds_read_b64_tr_b16 v[188:189], v215 offset:40960
    ds_read_b64_tr_b16 v[190:191], v215 offset:41984
    s_barrier
    v_mfma_f32_16x16x32_bf16 v[56:59], v[172:175], a[88:91], v[56:59]
    ds_read_b128 a[96:99], v216 offset:8192
    ds_read_b128 a[100:103], v216 offset:10240
    v_mfma_f32_16x16x32_bf16 v[52:55], v[172:175], a[84:87], v[52:55]
    ds_read_b128 a[104:107], v216 offset:12288
    ds_read_b128 a[108:111], v216 offset:14336
    v_mfma_f32_16x16x32_bf16 v[48:51], v[172:175], a[80:83], v[48:51]
    s_waitcnt lgkmcnt(8)
    s_add_u32 s92, s92, 128
    v_mfma_f32_16x16x32_bf16 v[64:67], v[176:179], a[80:83], v[64:67]
    ds_read_b64_tr_b16 v[128:129], v208 offset:49152
    ds_read_b64_tr_b16 v[130:131], v208 offset:50176
    v_mfma_f32_16x16x32_bf16 v[68:71], v[176:179], a[84:87], v[68:71]
    s_and_b32 s92, s92, 0x3ff
    v_mfma_f32_16x16x32_bf16 v[72:75], v[176:179], a[88:91], v[72:75]
    ds_read_b128 a[112:115], v217 offset:8192
    ds_read_b128 a[116:119], v217 offset:10240
    v_mfma_f32_16x16x32_bf16 v[76:79], v[176:179], a[92:95], v[76:79]
    s_mul_i32 s33, s92, s35
    v_mfma_f32_16x16x32_bf16 v[92:95], v[180:183], a[92:95], v[92:95]
    ds_read_b64_tr_b16 v[132:133], v209 offset:49152
    ds_read_b64_tr_b16 v[134:135], v209 offset:50176
    v_mfma_f32_16x16x32_bf16 v[88:91], v[180:183], a[88:91], v[88:91]
    s_add_u32 m0, s31, 16384
    v_mfma_f32_16x16x32_bf16 v[84:87], v[180:183], a[84:87], v[84:87]
    ds_read_b128 a[120:123], v217 offset:12288
    ds_read_b128 a[124:127], v217 offset:14336
    v_mfma_f32_16x16x32_bf16 v[80:83], v[180:183], a[80:83], v[80:83]
    s_waitcnt lgkmcnt(12)
    s_add_u32 s33, s33, s93
    v_mfma_f32_16x16x32_bf16 v[96:99], v[184:187], a[80:83], v[96:99]
    ds_read_b64_tr_b16 v[136:137], v210 offset:49152
    ds_read_b64_tr_b16 v[138:139], v210 offset:50176
    v_mfma_f32_16x16x32_bf16 v[100:103], v[184:187], a[84:87], v[100:103]
    buffer_load_dwordx4 v220, s[8:11], s33 offen offset:0 lds
    v_mfma_f32_16x16x32_bf16 v[104:107], v[184:187], a[88:91], v[104:107]
    v_mfma_f32_16x16x32_bf16 v[108:111], v[184:187], a[92:95], v[108:111]
    v_mfma_f32_16x16x32_bf16 v[124:127], v[188:191], a[92:95], v[124:127]
    ds_read_b64_tr_b16 v[140:141], v211 offset:49152
    ds_read_b64_tr_b16 v[142:143], v211 offset:50176
    v_mfma_f32_16x16x32_bf16 v[120:123], v[188:191], a[88:91], v[120:123]
    buffer_load_dwordx4 v221, s[8:11], s33 offen offset:1024 lds
    v_mfma_f32_16x16x32_bf16 v[116:119], v[188:191], a[84:87], v[116:119]
    v_mfma_f32_16x16x32_bf16 v[112:115], v[188:191], a[80:83], v[112:115]
    s_waitcnt lgkmcnt(6)
    v_mfma_f32_16x16x32_bf16 v[0:3], v[128:131], a[96:99], v[0:3]
    ds_read_b64_tr_b16 v[144:145], v212 offset:49152
    ds_read_b64_tr_b16 v[146:147], v212 offset:50176
    v_mfma_f32_16x16x32_bf16 v[4:7], v[128:131], a[100:103], v[4:7]
    buffer_load_dwordx4 v254, s[8:11], s33 offen offset:2048 lds
    v_mfma_f32_16x16x32_bf16 v[8:11], v[128:131], a[104:107], v[8:11]
    v_mfma_f32_16x16x32_bf16 v[12:15], v[128:131], a[108:111], v[12:15]
    v_mfma_f32_16x16x32_bf16 v[28:31], v[132:135], a[108:111], v[28:31]
    ds_read_b64_tr_b16 v[148:149], v213 offset:49152
    ds_read_b64_tr_b16 v[150:151], v213 offset:50176
    v_mfma_f32_16x16x32_bf16 v[24:27], v[132:135], a[104:107], v[24:27]
    buffer_load_dwordx4 v255, s[8:11], s33 offen offset:3072 lds
    v_mfma_f32_16x16x32_bf16 v[20:23], v[132:135], a[100:103], v[20:23]
    v_mfma_f32_16x16x32_bf16 v[16:19], v[132:135], a[96:99], v[16:19]
    s_waitcnt lgkmcnt(4)
    v_mfma_f32_16x16x32_bf16 v[32:35], v[136:139], a[96:99], v[32:35]
    ds_read_b64_tr_b16 v[152:153], v214 offset:49152
    ds_read_b64_tr_b16 v[154:155], v214 offset:50176
    v_mfma_f32_16x16x32_bf16 v[36:39], v[136:139], a[100:103], v[36:39]
    s_add_u32 m0, s30, 8192
    v_mfma_f32_16x16x32_bf16 v[40:43], v[136:139], a[104:107], v[40:43]
    s_add_u32 s28, s24, s92
    v_mfma_f32_16x16x32_bf16 v[44:47], v[136:139], a[108:111], v[44:47]
    v_mfma_f32_16x16x32_bf16 v[60:63], v[140:143], a[108:111], v[60:63]
    ds_read_b64_tr_b16 v[156:157], v215 offset:49152
    ds_read_b64_tr_b16 v[158:159], v215 offset:50176
    v_mfma_f32_16x16x32_bf16 v[56:59], v[140:143], a[104:107], v[56:59]
    buffer_load_dwordx4 v218, s[4:7], s28 offen offset:0 lds
    v_mfma_f32_16x16x32_bf16 v[52:55], v[140:143], a[100:103], v[52:55]
    v_mfma_f32_16x16x32_bf16 v[48:51], v[140:143], a[96:99], v[48:51]
    s_waitcnt lgkmcnt(4)
    v_mfma_f32_16x16x32_bf16 v[64:67], v[144:147], a[96:99], v[64:67]
    ds_read_b64_tr_b16 v[160:161], v208 offset:57344
    ds_read_b64_tr_b16 v[162:163], v208 offset:58368
    v_mfma_f32_16x16x32_bf16 v[68:71], v[144:147], a[100:103], v[68:71]
    buffer_load_dwordx4 v219, s[4:7], s28 offen offset:1024 lds
    v_mfma_f32_16x16x32_bf16 v[72:75], v[144:147], a[104:107], v[72:75]
    v_mfma_f32_16x16x32_bf16 v[76:79], v[144:147], a[108:111], v[76:79]
    buffer_load_dwordx4 v252, s[4:7], s28 offen offset:2048 lds
    v_mfma_f32_16x16x32_bf16 v[92:95], v[148:151], a[108:111], v[92:95]
    ds_read_b64_tr_b16 v[164:165], v209 offset:57344
    ds_read_b64_tr_b16 v[166:167], v209 offset:58368
    v_mfma_f32_16x16x32_bf16 v[88:91], v[148:151], a[104:107], v[88:91]
    v_mfma_f32_16x16x32_bf16 v[84:87], v[148:151], a[100:103], v[84:87]
    buffer_load_dwordx4 v253, s[4:7], s28 offen offset:3072 lds
    v_mfma_f32_16x16x32_bf16 v[80:83], v[148:151], a[96:99], v[80:83]
    s_waitcnt lgkmcnt(4)
    v_mfma_f32_16x16x32_bf16 v[96:99], v[152:155], a[96:99], v[96:99]
    ds_read_b64_tr_b16 v[168:169], v210 offset:57344
    ds_read_b64_tr_b16 v[170:171], v210 offset:58368
    v_mfma_f32_16x16x32_bf16 v[100:103], v[152:155], a[100:103], v[100:103]
    v_mfma_f32_16x16x32_bf16 v[104:107], v[152:155], a[104:107], v[104:107]
    s_add_u32 m0, s30, 12288
    v_mfma_f32_16x16x32_bf16 v[108:111], v[152:155], a[108:111], v[108:111]
    s_add_u32 s28, s25, s92
    v_mfma_f32_16x16x32_bf16 v[124:127], v[156:159], a[108:111], v[124:127]
    ds_read_b64_tr_b16 v[172:173], v211 offset:57344
    ds_read_b64_tr_b16 v[174:175], v211 offset:58368
    v_mfma_f32_16x16x32_bf16 v[120:123], v[156:159], a[104:107], v[120:123]
    buffer_load_dwordx4 v218, s[4:7], s28 offen offset:0 lds
    v_mfma_f32_16x16x32_bf16 v[116:119], v[156:159], a[100:103], v[116:119]
    v_mfma_f32_16x16x32_bf16 v[112:115], v[156:159], a[96:99], v[112:115]
    s_waitcnt lgkmcnt(4)
    v_mfma_f32_16x16x32_bf16 v[0:3], v[160:163], a[112:115], v[0:3]
    ds_read_b64_tr_b16 v[176:177], v212 offset:57344
    ds_read_b64_tr_b16 v[178:179], v212 offset:58368
    v_mfma_f32_16x16x32_bf16 v[4:7], v[160:163], a[116:119], v[4:7]
    buffer_load_dwordx4 v219, s[4:7], s28 offen offset:1024 lds
    v_mfma_f32_16x16x32_bf16 v[8:11], v[160:163], a[120:123], v[8:11]
    v_mfma_f32_16x16x32_bf16 v[12:15], v[160:163], a[124:127], v[12:15]
    v_mfma_f32_16x16x32_bf16 v[28:31], v[164:167], a[124:127], v[28:31]
    ds_read_b64_tr_b16 v[180:181], v213 offset:57344
    ds_read_b64_tr_b16 v[182:183], v213 offset:58368
    v_mfma_f32_16x16x32_bf16 v[24:27], v[164:167], a[120:123], v[24:27]
    buffer_load_dwordx4 v252, s[4:7], s28 offen offset:2048 lds
    v_mfma_f32_16x16x32_bf16 v[20:23], v[164:167], a[116:119], v[20:23]
    v_mfma_f32_16x16x32_bf16 v[16:19], v[164:167], a[112:115], v[16:19]
    s_waitcnt lgkmcnt(4)
    v_mfma_f32_16x16x32_bf16 v[32:35], v[168:171], a[112:115], v[32:35]
    ds_read_b64_tr_b16 v[184:185], v214 offset:57344
    ds_read_b64_tr_b16 v[186:187], v214 offset:58368
    v_mfma_f32_16x16x32_bf16 v[36:39], v[168:171], a[116:119], v[36:39]
    buffer_load_dwordx4 v253, s[4:7], s28 offen offset:3072 lds
    v_mfma_f32_16x16x32_bf16 v[40:43], v[168:171], a[120:123], v[40:43]
    v_mfma_f32_16x16x32_bf16 v[44:47], v[168:171], a[124:127], v[44:47]
    v_mfma_f32_16x16x32_bf16 v[60:63], v[172:175], a[124:127], v[60:63]
    s_waitcnt vmcnt(12)
    ds_read_b64_tr_b16 v[188:189], v215 offset:57344
    ds_read_b64_tr_b16 v[190:191], v215 offset:58368
    s_barrier
    v_mfma_f32_16x16x32_bf16 v[56:59], v[172:175], a[120:123], v[56:59]
    ds_read_b128 a[128:131], v216 offset:0
    ds_read_b128 a[132:135], v216 offset:2048
    v_mfma_f32_16x16x32_bf16 v[52:55], v[172:175], a[116:119], v[52:55]
    ds_read_b128 a[136:139], v216 offset:4096
    ds_read_b128 a[140:143], v216 offset:6144
    v_mfma_f32_16x16x32_bf16 v[48:51], v[172:175], a[112:115], v[48:51]
    s_waitcnt lgkmcnt(8)
    s_add_u32 s92, s92, 128
    v_mfma_f32_16x16x32_bf16 v[64:67], v[176:179], a[112:115], v[64:67]
    ds_read_b64_tr_b16 v[128:129], v208 offset:0
    ds_read_b64_tr_b16 v[130:131], v208 offset:1024
    v_mfma_f32_16x16x32_bf16 v[68:71], v[176:179], a[116:119], v[68:71]
    s_and_b32 s92, s92, 0x3ff
    v_mfma_f32_16x16x32_bf16 v[72:75], v[176:179], a[120:123], v[72:75]
    ds_read_b128 a[144:147], v217 offset:0
    ds_read_b128 a[148:151], v217 offset:2048
    v_mfma_f32_16x16x32_bf16 v[76:79], v[176:179], a[124:127], v[76:79]
    s_mul_i32 s33, s92, s35
    v_mfma_f32_16x16x32_bf16 v[92:95], v[180:183], a[124:127], v[92:95]
    ds_read_b64_tr_b16 v[132:133], v209 offset:0
    ds_read_b64_tr_b16 v[134:135], v209 offset:1024
    v_mfma_f32_16x16x32_bf16 v[88:91], v[180:183], a[120:123], v[88:91]
    s_add_u32 m0, s31, 32768
    v_mfma_f32_16x16x32_bf16 v[84:87], v[180:183], a[116:119], v[84:87]
    ds_read_b128 a[152:155], v217 offset:4096
    ds_read_b128 a[156:159], v217 offset:6144
    v_mfma_f32_16x16x32_bf16 v[80:83], v[180:183], a[112:115], v[80:83]
    s_waitcnt lgkmcnt(12)
    s_add_u32 s33, s33, s93
    v_mfma_f32_16x16x32_bf16 v[96:99], v[184:187], a[112:115], v[96:99]
    ds_read_b64_tr_b16 v[136:137], v210 offset:0
    ds_read_b64_tr_b16 v[138:139], v210 offset:1024
    v_mfma_f32_16x16x32_bf16 v[100:103], v[184:187], a[116:119], v[100:103]
    buffer_load_dwordx4 v220, s[8:11], s33 offen offset:0 lds
    v_mfma_f32_16x16x32_bf16 v[104:107], v[184:187], a[120:123], v[104:107]
    v_mfma_f32_16x16x32_bf16 v[108:111], v[184:187], a[124:127], v[108:111]
    v_mfma_f32_16x16x32_bf16 v[124:127], v[188:191], a[124:127], v[124:127]
    ds_read_b64_tr_b16 v[140:141], v211 offset:0
    ds_read_b64_tr_b16 v[142:143], v211 offset:1024
    v_mfma_f32_16x16x32_bf16 v[120:123], v[188:191], a[120:123], v[120:123]
    buffer_load_dwordx4 v221, s[8:11], s33 offen offset:1024 lds
    v_mfma_f32_16x16x32_bf16 v[116:119], v[188:191], a[116:119], v[116:119]
    v_mfma_f32_16x16x32_bf16 v[112:115], v[188:191], a[112:115], v[112:115]
    s_waitcnt lgkmcnt(6)
    v_mfma_f32_16x16x32_bf16 v[0:3], v[128:131], a[128:131], v[0:3]
    ds_read_b64_tr_b16 v[144:145], v212 offset:0
    ds_read_b64_tr_b16 v[146:147], v212 offset:1024
    v_mfma_f32_16x16x32_bf16 v[4:7], v[128:131], a[132:135], v[4:7]
    buffer_load_dwordx4 v254, s[8:11], s33 offen offset:2048 lds
    v_mfma_f32_16x16x32_bf16 v[8:11], v[128:131], a[136:139], v[8:11]
    v_mfma_f32_16x16x32_bf16 v[12:15], v[128:131], a[140:143], v[12:15]
    v_mfma_f32_16x16x32_bf16 v[28:31], v[132:135], a[140:143], v[28:31]
    ds_read_b64_tr_b16 v[148:149], v213 offset:0
    ds_read_b64_tr_b16 v[150:151], v213 offset:1024
    v_mfma_f32_16x16x32_bf16 v[24:27], v[132:135], a[136:139], v[24:27]
    buffer_load_dwordx4 v255, s[8:11], s33 offen offset:3072 lds
    v_mfma_f32_16x16x32_bf16 v[20:23], v[132:135], a[132:135], v[20:23]
    v_mfma_f32_16x16x32_bf16 v[16:19], v[132:135], a[128:131], v[16:19]
    s_waitcnt lgkmcnt(4)
    v_mfma_f32_16x16x32_bf16 v[32:35], v[136:139], a[128:131], v[32:35]
    ds_read_b64_tr_b16 v[152:153], v214 offset:0
    ds_read_b64_tr_b16 v[154:155], v214 offset:1024
    v_mfma_f32_16x16x32_bf16 v[36:39], v[136:139], a[132:135], v[36:39]
    s_add_u32 m0, s30, 0
    v_mfma_f32_16x16x32_bf16 v[40:43], v[136:139], a[136:139], v[40:43]
    s_add_u32 s28, s24, s92
    v_mfma_f32_16x16x32_bf16 v[44:47], v[136:139], a[140:143], v[44:47]
    v_mfma_f32_16x16x32_bf16 v[60:63], v[140:143], a[140:143], v[60:63]
    ds_read_b64_tr_b16 v[156:157], v215 offset:0
    ds_read_b64_tr_b16 v[158:159], v215 offset:1024
    v_mfma_f32_16x16x32_bf16 v[56:59], v[140:143], a[136:139], v[56:59]
    buffer_load_dwordx4 v218, s[4:7], s28 offen offset:0 lds
    v_mfma_f32_16x16x32_bf16 v[52:55], v[140:143], a[132:135], v[52:55]
    v_mfma_f32_16x16x32_bf16 v[48:51], v[140:143], a[128:131], v[48:51]
    s_waitcnt lgkmcnt(4)
    v_mfma_f32_16x16x32_bf16 v[64:67], v[144:147], a[128:131], v[64:67]
    ds_read_b64_tr_b16 v[160:161], v208 offset:8192
    ds_read_b64_tr_b16 v[162:163], v208 offset:9216
    v_mfma_f32_16x16x32_bf16 v[68:71], v[144:147], a[132:135], v[68:71]
    buffer_load_dwordx4 v219, s[4:7], s28 offen offset:1024 lds
    v_mfma_f32_16x16x32_bf16 v[72:75], v[144:147], a[136:139], v[72:75]
    v_mfma_f32_16x16x32_bf16 v[76:79], v[144:147], a[140:143], v[76:79]
    buffer_load_dwordx4 v252, s[4:7], s28 offen offset:2048 lds
    v_mfma_f32_16x16x32_bf16 v[92:95], v[148:151], a[140:143], v[92:95]
    ds_read_b64_tr_b16 v[164:165], v209 offset:8192
    ds_read_b64_tr_b16 v[166:167], v209 offset:9216
    v_mfma_f32_16x16x32_bf16 v[88:91], v[148:151], a[136:139], v[88:91]
    v_mfma_f32_16x16x32_bf16 v[84:87], v[148:151], a[132:135], v[84:87]
    buffer_load_dwordx4 v253, s[4:7], s28 offen offset:3072 lds
    v_mfma_f32_16x16x32_bf16 v[80:83], v[148:151], a[128:131], v[80:83]
    s_waitcnt lgkmcnt(4)
    v_mfma_f32_16x16x32_bf16 v[96:99], v[152:155], a[128:131], v[96:99]
    ds_read_b64_tr_b16 v[168:169], v210 offset:8192
    ds_read_b64_tr_b16 v[170:171], v210 offset:9216
    v_mfma_f32_16x16x32_bf16 v[100:103], v[152:155], a[132:135], v[100:103]
    v_mfma_f32_16x16x32_bf16 v[104:107], v[152:155], a[136:139], v[104:107]
    s_add_u32 m0, s30, 4096
    v_mfma_f32_16x16x32_bf16 v[108:111], v[152:155], a[140:143], v[108:111]
    s_add_u32 s28, s25, s92
    v_mfma_f32_16x16x32_bf16 v[124:127], v[156:159], a[140:143], v[124:127]
    ds_read_b64_tr_b16 v[172:173], v211 offset:8192
    ds_read_b64_tr_b16 v[174:175], v211 offset:9216
    v_mfma_f32_16x16x32_bf16 v[120:123], v[156:159], a[136:139], v[120:123]
    buffer_load_dwordx4 v218, s[4:7], s28 offen offset:0 lds
    v_mfma_f32_16x16x32_bf16 v[116:119], v[156:159], a[132:135], v[116:119]
    v_mfma_f32_16x16x32_bf16 v[112:115], v[156:159], a[128:131], v[112:115]
    s_waitcnt lgkmcnt(4)
    v_mfma_f32_16x16x32_bf16 v[0:3], v[160:163], a[144:147], v[0:3]
    ds_read_b64_tr_b16 v[176:177], v212 offset:8192
    ds_read_b64_tr_b16 v[178:179], v212 offset:9216
    v_mfma_f32_16x16x32_bf16 v[4:7], v[160:163], a[148:151], v[4:7]
    buffer_load_dwordx4 v219, s[4:7], s28 offen offset:1024 lds
    v_mfma_f32_16x16x32_bf16 v[8:11], v[160:163], a[152:155], v[8:11]
    v_mfma_f32_16x16x32_bf16 v[12:15], v[160:163], a[156:159], v[12:15]
    v_mfma_f32_16x16x32_bf16 v[28:31], v[164:167], a[156:159], v[28:31]
    ds_read_b64_tr_b16 v[180:181], v213 offset:8192
    ds_read_b64_tr_b16 v[182:183], v213 offset:9216
    v_mfma_f32_16x16x32_bf16 v[24:27], v[164:167], a[152:155], v[24:27]
    buffer_load_dwordx4 v252, s[4:7], s28 offen offset:2048 lds
    v_mfma_f32_16x16x32_bf16 v[20:23], v[164:167], a[148:151], v[20:23]
    v_mfma_f32_16x16x32_bf16 v[16:19], v[164:167], a[144:147], v[16:19]
    s_waitcnt lgkmcnt(4)
    v_mfma_f32_16x16x32_bf16 v[32:35], v[168:171], a[144:147], v[32:35]
    ds_read_b64_tr_b16 v[184:185], v214 offset:8192
    ds_read_b64_tr_b16 v[186:187], v214 offset:9216
    v_mfma_f32_16x16x32_bf16 v[36:39], v[168:171], a[148:151], v[36:39]
    buffer_load_dwordx4 v253, s[4:7], s28 offen offset:3072 lds
    v_mfma_f32_16x16x32_bf16 v[40:43], v[168:171], a[152:155], v[40:43]
    v_mfma_f32_16x16x32_bf16 v[44:47], v[168:171], a[156:159], v[44:47]
    v_mfma_f32_16x16x32_bf16 v[60:63], v[172:175], a[156:159], v[60:63]
    s_waitcnt vmcnt(12)
    ds_read_b64_tr_b16 v[188:189], v215 offset:8192
    ds_read_b64_tr_b16 v[190:191], v215 offset:9216
    s_barrier
    v_mfma_f32_16x16x32_bf16 v[56:59], v[172:175], a[152:155], v[56:59]
    ds_read_b128 a[160:163], v216 offset:8192
    ds_read_b128 a[164:167], v216 offset:10240
    v_mfma_f32_16x16x32_bf16 v[52:55], v[172:175], a[148:151], v[52:55]
    ds_read_b128 a[168:171], v216 offset:12288
    ds_read_b128 a[172:175], v216 offset:14336
    v_mfma_f32_16x16x32_bf16 v[48:51], v[172:175], a[144:147], v[48:51]
    s_waitcnt lgkmcnt(8)
    s_add_u32 s92, s92, 128
    v_mfma_f32_16x16x32_bf16 v[64:67], v[176:179], a[144:147], v[64:67]
    ds_read_b64_tr_b16 v[128:129], v208 offset:16384
    ds_read_b64_tr_b16 v[130:131], v208 offset:17408
    v_mfma_f32_16x16x32_bf16 v[68:71], v[176:179], a[148:151], v[68:71]
    s_and_b32 s92, s92, 0x3ff
    v_mfma_f32_16x16x32_bf16 v[72:75], v[176:179], a[152:155], v[72:75]
    ds_read_b128 a[176:179], v217 offset:8192
    ds_read_b128 a[180:183], v217 offset:10240
    v_mfma_f32_16x16x32_bf16 v[76:79], v[176:179], a[156:159], v[76:79]
    s_mul_i32 s33, s92, s35
    v_mfma_f32_16x16x32_bf16 v[92:95], v[180:183], a[156:159], v[92:95]
    ds_read_b64_tr_b16 v[132:133], v209 offset:16384
    ds_read_b64_tr_b16 v[134:135], v209 offset:17408
    v_mfma_f32_16x16x32_bf16 v[88:91], v[180:183], a[152:155], v[88:91]
    s_add_u32 m0, s31, 49152
    v_mfma_f32_16x16x32_bf16 v[84:87], v[180:183], a[148:151], v[84:87]
    ds_read_b128 a[184:187], v217 offset:12288
    ds_read_b128 a[188:191], v217 offset:14336
    v_mfma_f32_16x16x32_bf16 v[80:83], v[180:183], a[144:147], v[80:83]
    s_waitcnt lgkmcnt(12)
    s_add_u32 s33, s33, s93
    v_mfma_f32_16x16x32_bf16 v[96:99], v[184:187], a[144:147], v[96:99]
    ds_read_b64_tr_b16 v[136:137], v210 offset:16384
    ds_read_b64_tr_b16 v[138:139], v210 offset:17408
    v_mfma_f32_16x16x32_bf16 v[100:103], v[184:187], a[148:151], v[100:103]
    buffer_load_dwordx4 v220, s[8:11], s33 offen offset:0 lds
    v_mfma_f32_16x16x32_bf16 v[104:107], v[184:187], a[152:155], v[104:107]
    v_mfma_f32_16x16x32_bf16 v[108:111], v[184:187], a[156:159], v[108:111]
    v_mfma_f32_16x16x32_bf16 v[124:127], v[188:191], a[156:159], v[124:127]
    ds_read_b64_tr_b16 v[140:141], v211 offset:16384
    ds_read_b64_tr_b16 v[142:143], v211 offset:17408
    v_mfma_f32_16x16x32_bf16 v[120:123], v[188:191], a[152:155], v[120:123]
    buffer_load_dwordx4 v221, s[8:11], s33 offen offset:1024 lds
    v_mfma_f32_16x16x32_bf16 v[116:119], v[188:191], a[148:151], v[116:119]
    v_mfma_f32_16x16x32_bf16 v[112:115], v[188:191], a[144:147], v[112:115]
    s_waitcnt lgkmcnt(6)
    v_mfma_f32_16x16x32_bf16 v[0:3], v[128:131], a[160:163], v[0:3]
    ds_read_b64_tr_b16 v[144:145], v212 offset:16384
    ds_read_b64_tr_b16 v[146:147], v212 offset:17408
    v_mfma_f32_16x16x32_bf16 v[4:7], v[128:131], a[164:167], v[4:7]
    buffer_load_dwordx4 v254, s[8:11], s33 offen offset:2048 lds
    v_mfma_f32_16x16x32_bf16 v[8:11], v[128:131], a[168:171], v[8:11]
    v_mfma_f32_16x16x32_bf16 v[12:15], v[128:131], a[172:175], v[12:15]
    v_mfma_f32_16x16x32_bf16 v[28:31], v[132:135], a[172:175], v[28:31]
    ds_read_b64_tr_b16 v[148:149], v213 offset:16384
    ds_read_b64_tr_b16 v[150:151], v213 offset:17408
    v_mfma_f32_16x16x32_bf16 v[24:27], v[132:135], a[168:171], v[24:27]
    buffer_load_dwordx4 v255, s[8:11], s33 offen offset:3072 lds
    v_mfma_f32_16x16x32_bf16 v[20:23], v[132:135], a[164:167], v[20:23]
    v_mfma_f32_16x16x32_bf16 v[16:19], v[132:135], a[160:163], v[16:19]
    s_waitcnt lgkmcnt(4)
    v_mfma_f32_16x16x32_bf16 v[32:35], v[136:139], a[160:163], v[32:35]
    ds_read_b64_tr_b16 v[152:153], v214 offset:16384
    ds_read_b64_tr_b16 v[154:155], v214 offset:17408
    v_mfma_f32_16x16x32_bf16 v[36:39], v[136:139], a[164:167], v[36:39]
    s_add_u32 m0, s30, 8192
    v_mfma_f32_16x16x32_bf16 v[40:43], v[136:139], a[168:171], v[40:43]
    s_add_u32 s28, s24, s92
    v_mfma_f32_16x16x32_bf16 v[44:47], v[136:139], a[172:175], v[44:47]
    v_mfma_f32_16x16x32_bf16 v[60:63], v[140:143], a[172:175], v[60:63]
    ds_read_b64_tr_b16 v[156:157], v215 offset:16384
    ds_read_b64_tr_b16 v[158:159], v215 offset:17408
    v_mfma_f32_16x16x32_bf16 v[56:59], v[140:143], a[168:171], v[56:59]
    buffer_load_dwordx4 v218, s[4:7], s28 offen offset:0 lds
    v_mfma_f32_16x16x32_bf16 v[52:55], v[140:143], a[164:167], v[52:55]
    v_mfma_f32_16x16x32_bf16 v[48:51], v[140:143], a[160:163], v[48:51]
    s_waitcnt lgkmcnt(4)
    v_mfma_f32_16x16x32_bf16 v[64:67], v[144:147], a[160:163], v[64:67]
    ds_read_b64_tr_b16 v[160:161], v208 offset:24576
    ds_read_b64_tr_b16 v[162:163], v208 offset:25600
    v_mfma_f32_16x16x32_bf16 v[68:71], v[144:147], a[164:167], v[68:71]
    buffer_load_dwordx4 v219, s[4:7], s28 offen offset:1024 lds
    v_mfma_f32_16x16x32_bf16 v[72:75], v[144:147], a[168:171], v[72:75]
    v_mfma_f32_16x16x32_bf16 v[76:79], v[144:147], a[172:175], v[76:79]
    buffer_load_dwordx4 v252, s[4:7], s28 offen offset:2048 lds
    v_mfma_f32_16x16x32_bf16 v[92:95], v[148:151], a[172:175], v[92:95]
    ds_read_b64_tr_b16 v[164:165], v209 offset:24576
    ds_read_b64_tr_b16 v[166:167], v209 offset:25600
    v_mfma_f32_16x16x32_bf16 v[88:91], v[148:151], a[168:171], v[88:91]
    v_mfma_f32_16x16x32_bf16 v[84:87], v[148:151], a[164:167], v[84:87]
    buffer_load_dwordx4 v253, s[4:7], s28 offen offset:3072 lds
    v_mfma_f32_16x16x32_bf16 v[80:83], v[148:151], a[160:163], v[80:83]
    s_waitcnt lgkmcnt(4)
    v_mfma_f32_16x16x32_bf16 v[96:99], v[152:155], a[160:163], v[96:99]
    ds_read_b64_tr_b16 v[168:169], v210 offset:24576
    ds_read_b64_tr_b16 v[170:171], v210 offset:25600
    v_mfma_f32_16x16x32_bf16 v[100:103], v[152:155], a[164:167], v[100:103]
    v_mfma_f32_16x16x32_bf16 v[104:107], v[152:155], a[168:171], v[104:107]
    s_add_u32 m0, s30, 12288
    v_mfma_f32_16x16x32_bf16 v[108:111], v[152:155], a[172:175], v[108:111]
    s_add_u32 s28, s25, s92
    v_mfma_f32_16x16x32_bf16 v[124:127], v[156:159], a[172:175], v[124:127]
    ds_read_b64_tr_b16 v[172:173], v211 offset:24576
    ds_read_b64_tr_b16 v[174:175], v211 offset:25600
    v_mfma_f32_16x16x32_bf16 v[120:123], v[156:159], a[168:171], v[120:123]
    buffer_load_dwordx4 v218, s[4:7], s28 offen offset:0 lds
    v_mfma_f32_16x16x32_bf16 v[116:119], v[156:159], a[164:167], v[116:119]
    v_mfma_f32_16x16x32_bf16 v[112:115], v[156:159], a[160:163], v[112:115]
    s_waitcnt lgkmcnt(4)
    v_mfma_f32_16x16x32_bf16 v[0:3], v[160:163], a[176:179], v[0:3]
    ds_read_b64_tr_b16 v[176:177], v212 offset:24576
    ds_read_b64_tr_b16 v[178:179], v212 offset:25600
    v_mfma_f32_16x16x32_bf16 v[4:7], v[160:163], a[180:183], v[4:7]
    buffer_load_dwordx4 v219, s[4:7], s28 offen offset:1024 lds
    v_mfma_f32_16x16x32_bf16 v[8:11], v[160:163], a[184:187], v[8:11]
    v_mfma_f32_16x16x32_bf16 v[12:15], v[160:163], a[188:191], v[12:15]
    v_mfma_f32_16x16x32_bf16 v[28:31], v[164:167], a[188:191], v[28:31]
    ds_read_b64_tr_b16 v[180:181], v213 offset:24576
    ds_read_b64_tr_b16 v[182:183], v213 offset:25600
    v_mfma_f32_16x16x32_bf16 v[24:27], v[164:167], a[184:187], v[24:27]
    buffer_load_dwordx4 v252, s[4:7], s28 offen offset:2048 lds
    v_mfma_f32_16x16x32_bf16 v[20:23], v[164:167], a[180:183], v[20:23]
    v_mfma_f32_16x16x32_bf16 v[16:19], v[164:167], a[176:179], v[16:19]
    s_waitcnt lgkmcnt(4)
    v_mfma_f32_16x16x32_bf16 v[32:35], v[168:171], a[176:179], v[32:35]
    ds_read_b64_tr_b16 v[184:185], v214 offset:24576
    ds_read_b64_tr_b16 v[186:187], v214 offset:25600
    v_mfma_f32_16x16x32_bf16 v[36:39], v[168:171], a[180:183], v[36:39]
    buffer_load_dwordx4 v253, s[4:7], s28 offen offset:3072 lds
    v_mfma_f32_16x16x32_bf16 v[40:43], v[168:171], a[184:187], v[40:43]
    v_mfma_f32_16x16x32_bf16 v[44:47], v[168:171], a[188:191], v[44:47]
    v_mfma_f32_16x16x32_bf16 v[60:63], v[172:175], a[188:191], v[60:63]
    s_waitcnt vmcnt(12)
    ds_read_b64_tr_b16 v[188:189], v215 offset:24576
    ds_read_b64_tr_b16 v[190:191], v215 offset:25600
    s_barrier
    v_mfma_f32_16x16x32_bf16 v[56:59], v[172:175], a[184:187], v[56:59]
    ds_read_b128 a[192:195], v216 offset:0
    ds_read_b128 a[196:199], v216 offset:2048
    v_mfma_f32_16x16x32_bf16 v[52:55], v[172:175], a[180:183], v[52:55]
    ds_read_b128 a[200:203], v216 offset:4096
    ds_read_b128 a[204:207], v216 offset:6144
    v_mfma_f32_16x16x32_bf16 v[48:51], v[172:175], a[176:179], v[48:51]
    s_waitcnt lgkmcnt(8)
    s_add_u32 m0, s38, 65536
    v_mfma_f32_16x16x32_bf16 v[64:67], v[176:179], a[176:179], v[64:67]
    s_add_u32 s27, s23, s37
    ds_read_b64_tr_b16 v[128:129], v208 offset:32768
    ds_read_b64_tr_b16 v[130:131], v208 offset:33792
    v_mfma_f32_16x16x32_bf16 v[68:71], v[176:179], a[180:183], v[68:71]
    buffer_load_dwordx4 v238, s[8:11], s27 offen lds
    v_mfma_f32_16x16x32_bf16 v[72:75], v[176:179], a[184:187], v[72:75]
    ds_read_b128 a[208:211], v217 offset:0
    ds_read_b128 a[212:215], v217 offset:2048
    v_mfma_f32_16x16x32_bf16 v[76:79], v[176:179], a[188:191], v[76:79]
    v_mfma_f32_16x16x32_bf16 v[92:95], v[180:183], a[188:191], v[92:95]
    s_add_u32 m0, s38, 66560
    ds_read_b64_tr_b16 v[132:133], v209 offset:32768
    ds_read_b64_tr_b16 v[134:135], v209 offset:33792
    v_mfma_f32_16x16x32_bf16 v[88:91], v[180:183], a[184:187], v[88:91]
    v_mfma_f32_16x16x32_bf16 v[84:87], v[180:183], a[180:183], v[84:87]
    s_add_u32 s27, s27, s36
    ds_read_b128 a[216:219], v217 offset:4096
    ds_read_b128 a[220:223], v217 offset:6144
    v_mfma_f32_16x16x32_bf16 v[80:83], v[180:183], a[176:179], v[80:83]
    s_waitcnt lgkmcnt(12)
    v_mfma_f32_16x16x32_bf16 v[96:99], v[184:187], a[176:179], v[96:99]
    ds_read_b64_tr_b16 v[136:137], v210 offset:32768
    ds_read_b64_tr_b16 v[138:139], v210 offset:33792
    v_mfma_f32_16x16x32_bf16 v[100:103], v[184:187], a[180:183], v[100:103]
    buffer_load_dwordx4 v239, s[8:11], s27 offen lds
    v_mfma_f32_16x16x32_bf16 v[104:107], v[184:187], a[184:187], v[104:107]
    s_add_u32 m0, s38, 67584
    v_mfma_f32_16x16x32_bf16 v[108:111], v[184:187], a[188:191], v[108:111]
    v_mfma_f32_16x16x32_bf16 v[124:127], v[188:191], a[188:191], v[124:127]
    s_add_u32 s27, s27, s36
    ds_read_b64_tr_b16 v[140:141], v211 offset:32768
    ds_read_b64_tr_b16 v[142:143], v211 offset:33792
    v_mfma_f32_16x16x32_bf16 v[120:123], v[188:191], a[184:187], v[120:123]
    buffer_load_dwordx4 v238, s[8:11], s27 offen lds
    v_mfma_f32_16x16x32_bf16 v[116:119], v[188:191], a[180:183], v[116:119]
    v_mfma_f32_16x16x32_bf16 v[112:115], v[188:191], a[176:179], v[112:115]
    s_waitcnt lgkmcnt(6)
    v_mfma_f32_16x16x32_bf16 v[0:3], v[128:131], a[192:195], v[0:3]
    s_add_u32 m0, s38, 68608
    ds_read_b64_tr_b16 v[144:145], v212 offset:32768
    ds_read_b64_tr_b16 v[146:147], v212 offset:33792
    v_mfma_f32_16x16x32_bf16 v[4:7], v[128:131], a[196:199], v[4:7]
    v_mfma_f32_16x16x32_bf16 v[8:11], v[128:131], a[200:203], v[8:11]
    s_add_u32 s27, s27, s36
    v_mfma_f32_16x16x32_bf16 v[12:15], v[128:131], a[204:207], v[12:15]
    buffer_load_dwordx4 v239, s[8:11], s27 offen lds
    v_mfma_f32_16x16x32_bf16 v[28:31], v[132:135], a[204:207], v[28:31]
    ds_read_b64_tr_b16 v[148:149], v213 offset:32768
    ds_read_b64_tr_b16 v[150:151], v213 offset:33792
    v_mfma_f32_16x16x32_bf16 v[24:27], v[132:135], a[200:203], v[24:27]
    v_mfma_f32_16x16x32_bf16 v[20:23], v[132:135], a[196:199], v[20:23]
    s_add_u32 m0, s38, 69632
    v_mfma_f32_16x16x32_bf16 v[16:19], v[132:135], a[192:195], v[16:19]
    s_waitcnt lgkmcnt(4)
    s_add_u32 s27, s27, s36
    v_mfma_f32_16x16x32_bf16 v[32:35], v[136:139], a[192:195], v[32:35]
    ds_read_b64_tr_b16 v[152:153], v214 offset:32768
    ds_read_b64_tr_b16 v[154:155], v214 offset:33792
    v_mfma_f32_16x16x32_bf16 v[36:39], v[136:139], a[196:199], v[36:39]
    buffer_load_dwordx4 v238, s[8:11], s27 offen lds
    v_mfma_f32_16x16x32_bf16 v[40:43], v[136:139], a[200:203], v[40:43]
    v_mfma_f32_16x16x32_bf16 v[44:47], v[136:139], a[204:207], v[44:47]
    v_mfma_f32_16x16x32_bf16 v[60:63], v[140:143], a[204:207], v[60:63]
    s_add_u32 m0, s38, 70656
    ds_read_b64_tr_b16 v[156:157], v215 offset:32768
    ds_read_b64_tr_b16 v[158:159], v215 offset:33792
    v_mfma_f32_16x16x32_bf16 v[56:59], v[140:143], a[200:203], v[56:59]
    s_add_u32 s27, s27, s36
    v_mfma_f32_16x16x32_bf16 v[52:55], v[140:143], a[196:199], v[52:55]
    v_mfma_f32_16x16x32_bf16 v[48:51], v[140:143], a[192:195], v[48:51]
    s_waitcnt lgkmcnt(4)
    v_mfma_f32_16x16x32_bf16 v[64:67], v[144:147], a[192:195], v[64:67]
    ds_read_b64_tr_b16 v[160:161], v208 offset:40960
    ds_read_b64_tr_b16 v[162:163], v208 offset:41984
    v_mfma_f32_16x16x32_bf16 v[68:71], v[144:147], a[196:199], v[68:71]
    buffer_load_dwordx4 v239, s[8:11], s27 offen lds
    v_mfma_f32_16x16x32_bf16 v[72:75], v[144:147], a[200:203], v[72:75]
    s_add_u32 m0, s38, 71680
    v_mfma_f32_16x16x32_bf16 v[76:79], v[144:147], a[204:207], v[76:79]
    s_add_u32 s27, s27, s36
    v_mfma_f32_16x16x32_bf16 v[92:95], v[148:151], a[204:207], v[92:95]
    ds_read_b64_tr_b16 v[164:165], v209 offset:40960
    ds_read_b64_tr_b16 v[166:167], v209 offset:41984
    v_mfma_f32_16x16x32_bf16 v[88:91], v[148:151], a[200:203], v[88:91]
    buffer_load_dwordx4 v238, s[8:11], s27 offen lds
    v_mfma_f32_16x16x32_bf16 v[84:87], v[148:151], a[196:199], v[84:87]
    v_mfma_f32_16x16x32_bf16 v[80:83], v[148:151], a[192:195], v[80:83]
    s_waitcnt lgkmcnt(4)
    v_mfma_f32_16x16x32_bf16 v[96:99], v[152:155], a[192:195], v[96:99]
    s_add_u32 m0, s38, 72704
    ds_read_b64_tr_b16 v[168:169], v210 offset:40960
    ds_read_b64_tr_b16 v[170:171], v210 offset:41984
    v_mfma_f32_16x16x32_bf16 v[100:103], v[152:155], a[196:199], v[100:103]
    s_add_u32 s27, s27, s36
    v_mfma_f32_16x16x32_bf16 v[104:107], v[152:155], a[200:203], v[104:107]
    v_mfma_f32_16x16x32_bf16 v[108:111], v[152:155], a[204:207], v[108:111]
    buffer_load_dwordx4 v239, s[8:11], s27 offen lds
    v_mfma_f32_16x16x32_bf16 v[124:127], v[156:159], a[204:207], v[124:127]
    ds_read_b64_tr_b16 v[172:173], v211 offset:40960
    ds_read_b64_tr_b16 v[174:175], v211 offset:41984
    v_mfma_f32_16x16x32_bf16 v[120:123], v[156:159], a[200:203], v[120:123]
    v_mfma_f32_16x16x32_bf16 v[116:119], v[156:159], a[196:199], v[116:119]
    v_mfma_f32_16x16x32_bf16 v[112:115], v[156:159], a[192:195], v[112:115]
    s_waitcnt lgkmcnt(4)
    v_mfma_f32_16x16x32_bf16 v[0:3], v[160:163], a[208:211], v[0:3]
    ds_read_b64_tr_b16 v[176:177], v212 offset:40960
    ds_read_b64_tr_b16 v[178:179], v212 offset:41984
    v_mfma_f32_16x16x32_bf16 v[4:7], v[160:163], a[212:215], v[4:7]
    v_mfma_f32_16x16x32_bf16 v[8:11], v[160:163], a[216:219], v[8:11]
    v_mfma_f32_16x16x32_bf16 v[12:15], v[160:163], a[220:223], v[12:15]
    v_mfma_f32_16x16x32_bf16 v[28:31], v[164:167], a[220:223], v[28:31]
    ds_read_b64_tr_b16 v[180:181], v213 offset:40960
    ds_read_b64_tr_b16 v[182:183], v213 offset:41984
    v_mfma_f32_16x16x32_bf16 v[24:27], v[164:167], a[216:219], v[24:27]
    v_mfma_f32_16x16x32_bf16 v[20:23], v[164:167], a[212:215], v[20:23]
    v_mfma_f32_16x16x32_bf16 v[16:19], v[164:167], a[208:211], v[16:19]
    s_waitcnt lgkmcnt(4)
    v_mfma_f32_16x16x32_bf16 v[32:35], v[168:171], a[208:211], v[32:35]
    ds_read_b64_tr_b16 v[184:185], v214 offset:40960
    ds_read_b64_tr_b16 v[186:187], v214 offset:41984
    v_mfma_f32_16x16x32_bf16 v[36:39], v[168:171], a[212:215], v[36:39]
    v_mfma_f32_16x16x32_bf16 v[40:43], v[168:171], a[216:219], v[40:43]
    v_mfma_f32_16x16x32_bf16 v[44:47], v[168:171], a[220:223], v[44:47]
    v_mfma_f32_16x16x32_bf16 v[60:63], v[172:175], a[220:223], v[60:63]
    s_waitcnt vmcnt(8)
    ds_read_b64_tr_b16 v[188:189], v215 offset:40960
    ds_read_b64_tr_b16 v[190:191], v215 offset:41984
    s_barrier
    v_mfma_f32_16x16x32_bf16 v[56:59], v[172:175], a[216:219], v[56:59]
    ds_read_b128 a[224:227], v216 offset:8192
    ds_read_b128 a[228:231], v216 offset:10240
    v_mfma_f32_16x16x32_bf16 v[52:55], v[172:175], a[212:215], v[52:55]
    ds_read_b128 a[232:235], v216 offset:12288
    ds_read_b128 a[236:239], v216 offset:14336
    v_mfma_f32_16x16x32_bf16 v[48:51], v[172:175], a[208:211], v[48:51]
    s_waitcnt lgkmcnt(8)
    s_add_u32 m0, s38, 0
    v_mfma_f32_16x16x32_bf16 v[64:67], v[176:179], a[208:211], v[64:67]
    s_add_u32 s27, s23, s96
    ds_read_b64_tr_b16 v[128:129], v208 offset:49152
    ds_read_b64_tr_b16 v[130:131], v208 offset:50176
    v_mfma_f32_16x16x32_bf16 v[68:71], v[176:179], a[212:215], v[68:71]
    buffer_load_dwordx4 v238, s[8:11], s27 offen lds
    v_mfma_f32_16x16x32_bf16 v[72:75], v[176:179], a[216:219], v[72:75]
    ds_read_b128 a[240:243], v217 offset:8192
    ds_read_b128 a[244:247], v217 offset:10240
    v_mfma_f32_16x16x32_bf16 v[76:79], v[176:179], a[220:223], v[76:79]
    v_mfma_f32_16x16x32_bf16 v[92:95], v[180:183], a[220:223], v[92:95]
    s_add_u32 m0, s38, 1024
    ds_read_b64_tr_b16 v[132:133], v209 offset:49152
    ds_read_b64_tr_b16 v[134:135], v209 offset:50176
    v_mfma_f32_16x16x32_bf16 v[88:91], v[180:183], a[216:219], v[88:91]
    v_mfma_f32_16x16x32_bf16 v[84:87], v[180:183], a[212:215], v[84:87]
    s_add_u32 s27, s27, s36
    ds_read_b128 a[248:251], v217 offset:12288
    ds_read_b128 a[252:255], v217 offset:14336
    v_mfma_f32_16x16x32_bf16 v[80:83], v[180:183], a[208:211], v[80:83]
    s_waitcnt lgkmcnt(12)
    v_mfma_f32_16x16x32_bf16 v[96:99], v[184:187], a[208:211], v[96:99]
    ds_read_b64_tr_b16 v[136:137], v210 offset:49152
    ds_read_b64_tr_b16 v[138:139], v210 offset:50176
    v_mfma_f32_16x16x32_bf16 v[100:103], v[184:187], a[212:215], v[100:103]
    buffer_load_dwordx4 v239, s[8:11], s27 offen lds
    v_mfma_f32_16x16x32_bf16 v[104:107], v[184:187], a[216:219], v[104:107]
    s_add_u32 m0, s38, 2048
    v_mfma_f32_16x16x32_bf16 v[108:111], v[184:187], a[220:223], v[108:111]
    s_add_u32 s27, s27, s36
    v_mfma_f32_16x16x32_bf16 v[124:127], v[188:191], a[220:223], v[124:127]
    ds_read_b64_tr_b16 v[140:141], v211 offset:49152
    ds_read_b64_tr_b16 v[142:143], v211 offset:50176
    v_mfma_f32_16x16x32_bf16 v[120:123], v[188:191], a[216:219], v[120:123]
    buffer_load_dwordx4 v238, s[8:11], s27 offen lds
    v_mfma_f32_16x16x32_bf16 v[116:119], v[188:191], a[212:215], v[116:119]
    v_mfma_f32_16x16x32_bf16 v[112:115], v[188:191], a[208:211], v[112:115]
    s_waitcnt lgkmcnt(6)
    v_mfma_f32_16x16x32_bf16 v[0:3], v[128:131], a[224:227], v[0:3]
    s_add_u32 m0, s38, 3072
    ds_read_b64_tr_b16 v[144:145], v212 offset:49152
    ds_read_b64_tr_b16 v[146:147], v212 offset:50176
    v_mfma_f32_16x16x32_bf16 v[4:7], v[128:131], a[228:231], v[4:7]
    s_add_u32 s27, s27, s36
    v_mfma_f32_16x16x32_bf16 v[8:11], v[128:131], a[232:235], v[8:11]
    buffer_load_dwordx4 v239, s[8:11], s27 offen lds
    v_mfma_f32_16x16x32_bf16 v[12:15], v[128:131], a[236:239], v[12:15]
    v_mfma_f32_16x16x32_bf16 v[28:31], v[132:135], a[236:239], v[28:31]
    ds_read_b64_tr_b16 v[148:149], v213 offset:49152
    ds_read_b64_tr_b16 v[150:151], v213 offset:50176
    v_mfma_f32_16x16x32_bf16 v[24:27], v[132:135], a[232:235], v[24:27]
    s_add_u32 m0, s38, 4096
    v_mfma_f32_16x16x32_bf16 v[20:23], v[132:135], a[228:231], v[20:23]
    v_mfma_f32_16x16x32_bf16 v[16:19], v[132:135], a[224:227], v[16:19]
    s_waitcnt lgkmcnt(4)
    s_add_u32 s27, s27, s36
    v_mfma_f32_16x16x32_bf16 v[32:35], v[136:139], a[224:227], v[32:35]
    ds_read_b64_tr_b16 v[152:153], v214 offset:49152
    ds_read_b64_tr_b16 v[154:155], v214 offset:50176
    v_mfma_f32_16x16x32_bf16 v[36:39], v[136:139], a[228:231], v[36:39]
    buffer_load_dwordx4 v238, s[8:11], s27 offen lds
    v_mfma_f32_16x16x32_bf16 v[40:43], v[136:139], a[232:235], v[40:43]
    v_mfma_f32_16x16x32_bf16 v[44:47], v[136:139], a[236:239], v[44:47]
    s_add_u32 m0, s38, 5120
    v_mfma_f32_16x16x32_bf16 v[60:63], v[140:143], a[236:239], v[60:63]
    s_add_u32 s27, s27, s36
    ds_read_b64_tr_b16 v[156:157], v215 offset:49152
    ds_read_b64_tr_b16 v[158:159], v215 offset:50176
    v_mfma_f32_16x16x32_bf16 v[56:59], v[140:143], a[232:235], v[56:59]
    v_mfma_f32_16x16x32_bf16 v[52:55], v[140:143], a[228:231], v[52:55]
    buffer_load_dwordx4 v239, s[8:11], s27 offen lds
    v_mfma_f32_16x16x32_bf16 v[48:51], v[140:143], a[224:227], v[48:51]
    s_waitcnt lgkmcnt(4)
    v_mfma_f32_16x16x32_bf16 v[64:67], v[144:147], a[224:227], v[64:67]
    ds_read_b64_tr_b16 v[160:161], v208 offset:57344
    ds_read_b64_tr_b16 v[162:163], v208 offset:58368
    v_mfma_f32_16x16x32_bf16 v[68:71], v[144:147], a[228:231], v[68:71]
    s_add_u32 m0, s38, 6144
    v_mfma_f32_16x16x32_bf16 v[72:75], v[144:147], a[232:235], v[72:75]
    s_add_u32 s27, s27, s36
    v_mfma_f32_16x16x32_bf16 v[76:79], v[144:147], a[236:239], v[76:79]
    v_mfma_f32_16x16x32_bf16 v[92:95], v[148:151], a[236:239], v[92:95]
    ds_read_b64_tr_b16 v[164:165], v209 offset:57344
    ds_read_b64_tr_b16 v[166:167], v209 offset:58368
    v_mfma_f32_16x16x32_bf16 v[88:91], v[148:151], a[232:235], v[88:91]
    buffer_load_dwordx4 v238, s[8:11], s27 offen lds
    v_mfma_f32_16x16x32_bf16 v[84:87], v[148:151], a[228:231], v[84:87]
    s_add_u32 m0, s38, 7168
    v_mfma_f32_16x16x32_bf16 v[80:83], v[148:151], a[224:227], v[80:83]
    s_waitcnt lgkmcnt(4)
    v_mfma_f32_16x16x32_bf16 v[96:99], v[152:155], a[224:227], v[96:99]
    s_add_u32 s27, s27, s36
    ds_read_b64_tr_b16 v[168:169], v210 offset:57344
    ds_read_b64_tr_b16 v[170:171], v210 offset:58368
    v_mfma_f32_16x16x32_bf16 v[100:103], v[152:155], a[228:231], v[100:103]
    buffer_load_dwordx4 v239, s[8:11], s27 offen lds
    v_mfma_f32_16x16x32_bf16 v[104:107], v[152:155], a[232:235], v[104:107]
    v_mfma_f32_16x16x32_bf16 v[108:111], v[152:155], a[236:239], v[108:111]
    v_mfma_f32_16x16x32_bf16 v[124:127], v[156:159], a[236:239], v[124:127]
    s_add_u32 s23, s23, 128
    ds_read_b64_tr_b16 v[172:173], v211 offset:57344
    ds_read_b64_tr_b16 v[174:175], v211 offset:58368
    v_mfma_f32_16x16x32_bf16 v[120:123], v[156:159], a[232:235], v[120:123]
    v_mfma_f32_16x16x32_bf16 v[116:119], v[156:159], a[228:231], v[116:119]
    v_mfma_f32_16x16x32_bf16 v[112:115], v[156:159], a[224:227], v[112:115]
    s_waitcnt lgkmcnt(4)
    v_mfma_f32_16x16x32_bf16 v[0:3], v[160:163], a[240:243], v[0:3]
    ds_read_b64_tr_b16 v[176:177], v212 offset:57344
    ds_read_b64_tr_b16 v[178:179], v212 offset:58368
    v_mfma_f32_16x16x32_bf16 v[4:7], v[160:163], a[244:247], v[4:7]
    v_mfma_f32_16x16x32_bf16 v[8:11], v[160:163], a[248:251], v[8:11]
    v_mfma_f32_16x16x32_bf16 v[12:15], v[160:163], a[252:255], v[12:15]
    v_mfma_f32_16x16x32_bf16 v[28:31], v[164:167], a[252:255], v[28:31]
    ds_read_b64_tr_b16 v[180:181], v213 offset:57344
    ds_read_b64_tr_b16 v[182:183], v213 offset:58368
    v_mfma_f32_16x16x32_bf16 v[24:27], v[164:167], a[248:251], v[24:27]
    v_mfma_f32_16x16x32_bf16 v[20:23], v[164:167], a[244:247], v[20:23]
    v_mfma_f32_16x16x32_bf16 v[16:19], v[164:167], a[240:243], v[16:19]
    s_waitcnt lgkmcnt(4)
    v_mfma_f32_16x16x32_bf16 v[32:35], v[168:171], a[240:243], v[32:35]
    ds_read_b64_tr_b16 v[184:185], v214 offset:57344
    ds_read_b64_tr_b16 v[186:187], v214 offset:58368
    v_mfma_f32_16x16x32_bf16 v[36:39], v[168:171], a[244:247], v[36:39]
    v_mfma_f32_16x16x32_bf16 v[40:43], v[168:171], a[248:251], v[40:43]
    v_mfma_f32_16x16x32_bf16 v[44:47], v[168:171], a[252:255], v[44:47]
    v_mfma_f32_16x16x32_bf16 v[60:63], v[172:175], a[252:255], v[60:63]
    ds_read_b64_tr_b16 v[188:189], v215 offset:57344
    ds_read_b64_tr_b16 v[190:191], v215 offset:58368
    v_mfma_f32_16x16x32_bf16 v[56:59], v[172:175], a[248:251], v[56:59]
    v_mfma_f32_16x16x32_bf16 v[52:55], v[172:175], a[244:247], v[52:55]
    v_mfma_f32_16x16x32_bf16 v[48:51], v[172:175], a[240:243], v[48:51]
    s_waitcnt lgkmcnt(4)
    v_mfma_f32_16x16x32_bf16 v[64:67], v[176:179], a[240:243], v[64:67]
    v_mfma_f32_16x16x32_bf16 v[68:71], v[176:179], a[244:247], v[68:71]
    v_mfma_f32_16x16x32_bf16 v[72:75], v[176:179], a[248:251], v[72:75]
    v_mfma_f32_16x16x32_bf16 v[76:79], v[176:179], a[252:255], v[76:79]
    v_mfma_f32_16x16x32_bf16 v[92:95], v[180:183], a[252:255], v[92:95]
    v_mfma_f32_16x16x32_bf16 v[88:91], v[180:183], a[248:251], v[88:91]
    v_mfma_f32_16x16x32_bf16 v[84:87], v[180:183], a[244:247], v[84:87]
    v_mfma_f32_16x16x32_bf16 v[80:83], v[180:183], a[240:243], v[80:83]
    s_waitcnt lgkmcnt(0)
    v_mfma_f32_16x16x32_bf16 v[96:99], v[184:187], a[240:243], v[96:99]
    v_mfma_f32_16x16x32_bf16 v[100:103], v[184:187], a[244:247], v[100:103]
    v_mfma_f32_16x16x32_bf16 v[104:107], v[184:187], a[248:251], v[104:107]
    v_mfma_f32_16x16x32_bf16 v[108:111], v[184:187], a[252:255], v[108:111]
    v_mfma_f32_16x16x32_bf16 v[124:127], v[188:191], a[252:255], v[124:127]
    v_mfma_f32_16x16x32_bf16 v[120:123], v[188:191], a[248:251], v[120:123]
    v_mfma_f32_16x16x32_bf16 v[116:119], v[188:191], a[244:247], v[116:119]
    v_mfma_f32_16x16x32_bf16 v[112:115], v[188:191], a[240:243], v[112:115]
    s_cmp_lg_u32 s16, 0
    s_cbranch_scc1 K1_cnt_10
    s_load_dwordx2 s[88:89], s[0:1], 88
    s_mov_b32 s90, 256
    s_mov_b32 s91, 0x20000
    v_mov_b32 v241, 1
    v_mov_b32 v242, 0
    s_waitcnt lgkmcnt(0)
    s_mov_b64 exec, 1
    buffer_atomic_add v241, v242, s[88:91], 0 offen sc1
    s_mov_b64 exec, -1
K1_cnt_10:
    s_nop 3
    s_lshr_b32 s22, s19, 2
    s_lshl_b32 s22, s22, 19
    s_and_b32 s26, s19, 3
    s_lshl_b32 s26, s26, 12
    s_add_u32 s22, s22, s26
    s_add_u32 s22, s22, s32
    s_add_u32 s19, s19, 1
    v_pk_mul_f32 v[192:193], v[0:1], s[20:21] op_sel_hi:[1,0]
    v_cvt_pk_bf16_f32 v160, v192, v193
    v_pk_mul_f32 v[194:195], v[2:3], s[20:21] op_sel_hi:[1,0]
    v_cvt_pk_bf16_f32 v161, v194, v195
    v_pk_mul_f32 v[196:197], v[16:17], s[20:21] op_sel_hi:[1,0]
    v_cvt_pk_bf16_f32 v162, v196, v197
    v_pk_mul_f32 v[198:199], v[18:19], s[20:21] op_sel_hi:[1,0]
    v_cvt_pk_bf16_f32 v163, v198, v199
    buffer_store_dwordx4 v[160:163], v234, s[12:15], s22 offen offset:0 sc1
    v_pk_mul_f32 v[200:201], v[4:5], s[20:21] op_sel_hi:[1,0]
    v_cvt_pk_bf16_f32 v164, v200, v201
    v_pk_mul_f32 v[202:203], v[6:7], s[20:21] op_sel_hi:[1,0]
    v_cvt_pk_bf16_f32 v165, v202, v203
    v_pk_mul_f32 v[204:205], v[20:21], s[20:21] op_sel_hi:[1,0]
    v_cvt_pk_bf16_f32 v166, v204, v205
    v_pk_mul_f32 v[206:207], v[22:23], s[20:21] op_sel_hi:[1,0]
    v_cvt_pk_bf16_f32 v167, v206, v207
    buffer_store_dwordx4 v[164:167], v234, s[12:15], s22 offen offset:1024 sc1
    v_pk_mul_f32 v[192:193], v[8:9], s[20:21] op_sel_hi:[1,0]
    v_cvt_pk_bf16_f32 v168, v192, v193
    v_pk_mul_f32 v[194:195], v[10:11], s[20:21] op_sel_hi:[1,0]
    v_cvt_pk_bf16_f32 v169, v194, v195
    v_pk_mul_f32 v[196:197], v[24:25], s[20:21] op_sel_hi:[1,0]
    v_cvt_pk_bf16_f32 v170, v196, v197
    v_pk_mul_f32 v[198:199], v[26:27], s[20:21] op_sel_hi:[1,0]
    v_cvt_pk_bf16_f32 v171, v198, v199
    buffer_store_dwordx4 v[168:171], v234, s[12:15], s22 offen offset:2048 sc1
    v_pk_mul_f32 v[200:201], v[12:13], s[20:21] op_sel_hi:[1,0]
    v_cvt_pk_bf16_f32 v172, v200, v201
    v_pk_mul_f32 v[202:203], v[14:15], s[20:21] op_sel_hi:[1,0]
    v_cvt_pk_bf16_f32 v173, v202, v203
    v_pk_mul_f32 v[204:205], v[28:29], s[20:21] op_sel_hi:[1,0]
    v_cvt_pk_bf16_f32 v174, v204, v205
    v_pk_mul_f32 v[206:207], v[30:31], s[20:21] op_sel_hi:[1,0]
    v_cvt_pk_bf16_f32 v175, v206, v207
    buffer_store_dwordx4 v[172:175], v234, s[12:15], s22 offen offset:3072 sc1
    s_lshr_b32 s22, s19, 2
    s_lshl_b32 s22, s22, 19
    s_and_b32 s26, s19, 3
    s_lshl_b32 s26, s26, 12
    s_add_u32 s22, s22, s26
    s_add_u32 s22, s22, s32
    s_add_u32 s19, s19, 1
    v_pk_mul_f32 v[192:193], v[32:33], s[20:21] op_sel_hi:[1,0]
    v_cvt_pk_bf16_f32 v176, v192, v193
    v_pk_mul_f32 v[194:195], v[34:35], s[20:21] op_sel_hi:[1,0]
    v_cvt_pk_bf16_f32 v177, v194, v195
    v_pk_mul_f32 v[196:197], v[48:49], s[20:21] op_sel_hi:[1,0]
    v_cvt_pk_bf16_f32 v178, v196, v197
    v_pk_mul_f32 v[198:199], v[50:51], s[20:21] op_sel_hi:[1,0]
    v_cvt_pk_bf16_f32 v179, v198, v199
    buffer_store_dwordx4 v[176:179], v234, s[12:15], s22 offen offset:0 sc1
    v_pk_mul_f32 v[200:201], v[36:37], s[20:21] op_sel_hi:[1,0]
    v_cvt_pk_bf16_f32 v180, v200, v201
    v_pk_mul_f32 v[202:203], v[38:39], s[20:21] op_sel_hi:[1,0]
    v_cvt_pk_bf16_f32 v181, v202, v203
    v_pk_mul_f32 v[204:205], v[52:53], s[20:21] op_sel_hi:[1,0]
    v_cvt_pk_bf16_f32 v182, v204, v205
    v_pk_mul_f32 v[206:207], v[54:55], s[20:21] op_sel_hi:[1,0]
    v_cvt_pk_bf16_f32 v183, v206, v207
    buffer_store_dwordx4 v[180:183], v234, s[12:15], s22 offen offset:1024 sc1
    v_pk_mul_f32 v[192:193], v[40:41], s[20:21] op_sel_hi:[1,0]
    v_cvt_pk_bf16_f32 v184, v192, v193
    v_pk_mul_f32 v[194:195], v[42:43], s[20:21] op_sel_hi:[1,0]
    v_cvt_pk_bf16_f32 v185, v194, v195
    v_pk_mul_f32 v[196:197], v[56:57], s[20:21] op_sel_hi:[1,0]
    v_cvt_pk_bf16_f32 v186, v196, v197
    v_pk_mul_f32 v[198:199], v[58:59], s[20:21] op_sel_hi:[1,0]
    v_cvt_pk_bf16_f32 v187, v198, v199
    buffer_store_dwordx4 v[184:187], v234, s[12:15], s22 offen offset:2048 sc1
    v_pk_mul_f32 v[200:201], v[44:45], s[20:21] op_sel_hi:[1,0]
    v_cvt_pk_bf16_f32 v188, v200, v201
    v_pk_mul_f32 v[202:203], v[46:47], s[20:21] op_sel_hi:[1,0]
    v_cvt_pk_bf16_f32 v189, v202, v203
    v_pk_mul_f32 v[204:205], v[60:61], s[20:21] op_sel_hi:[1,0]
    v_cvt_pk_bf16_f32 v190, v204, v205
    v_pk_mul_f32 v[206:207], v[62:63], s[20:21] op_sel_hi:[1,0]
    v_cvt_pk_bf16_f32 v191, v206, v207
    buffer_store_dwordx4 v[188:191], v234, s[12:15], s22 offen offset:3072 sc1
    s_waitcnt vmcnt(16)
    s_barrier
    ds_read_b64_tr_b16 v[128:129], v226 offset:0
    ds_read_b64_tr_b16 v[130:131], v226 offset:512
    ds_read_b64_tr_b16 v[132:133], v227 offset:0
    ds_read_b64_tr_b16 v[134:135], v227 offset:512
    ds_read_b64_tr_b16 v[136:137], v228 offset:0
    ds_read_b64_tr_b16 v[138:139], v228 offset:512
    s_mov_b32 s29, 0
K1_loop_11:
    s_waitcnt lgkmcnt(2)
    v_mfma_f32_16x16x32_bf16 v[0:3], v[128:131], a[0:3], 0
    s_add_u32 m0, s38, 32768
    ds_read_b64_tr_b16 v[140:141], v229 offset:0
    ds_read_b64_tr_b16 v[142:143], v229 offset:512
    v_mfma_f32_16x16x32_bf16 v[4:7], v[128:131], a[4:7], 0
    s_add_u32 s27, s23, s37
    v_mfma_f32_16x16x32_bf16 v[8:11], v[128:131], a[8:11], 0
    buffer_load_dwordx4 v238, s[8:11], s27 offen lds
    v_mfma_f32_16x16x32_bf16 v[12:15], v[128:131], a[12:15], 0
    s_add_u32 m0, s38, 33792
    v_mfma_f32_16x16x32_bf16 v[28:31], v[132:135], a[12:15], 0
    s_add_u32 s27, s27, s36
    ds_read_b64_tr_b16 v[144:145], v226 offset:4096
    ds_read_b64_tr_b16 v[146:147], v226 offset:4608
    v_mfma_f32_16x16x32_bf16 v[24:27], v[132:135], a[8:11], 0
    buffer_load_dwordx4 v239, s[8:11], s27 offen lds
    v_mfma_f32_16x16x32_bf16 v[20:23], v[132:135], a[4:7], 0
    s_add_u32 m0, s38, 34816
    v_mfma_f32_16x16x32_bf16 v[16:19], v[132:135], a[0:3], 0
    s_waitcnt lgkmcnt(2)
    s_add_u32 s27, s27, s36
    v_mfma_f32_16x16x32_bf16 v[32:35], v[136:139], a[0:3], 0
    ds_read_b64_tr_b16 v[148:149], v227 offset:4096
    ds_read_b64_tr_b16 v[150:151], v227 offset:4608
    v_mfma_f32_16x16x32_bf16 v[36:39], v[136:139], a[4:7], 0
    buffer_load_dwordx4 v238, s[8:11], s27 offen lds
    v_mfma_f32_16x16x32_bf16 v[40:43], v[136:139], a[8:11], 0
    s_add_u32 m0, s38, 35840
    s_add_u32 s27, s27, s36
    v_mfma_f32_16x16x32_bf16 v[44:47], v[136:139], a[12:15], 0
    buffer_load_dwordx4 v239, s[8:11], s27 offen lds
    v_mfma_f32_16x16x32_bf16 v[60:63], v[140:143], a[12:15], 0
    ds_read_b64_tr_b16 v[152:153], v228 offset:4096
    ds_read_b64_tr_b16 v[154:155], v228 offset:4608
    v_mfma_f32_16x16x32_bf16 v[56:59], v[140:143], a[8:11], 0
    s_add_u32 m0, s38, 36864
    s_add_u32 s27, s27, s36
    v_mfma_f32_16x16x32_bf16 v[52:55], v[140:143], a[4:7], 0
    buffer_load_dwordx4 v238, s[8:11], s27 offen lds
    v_mfma_f32_16x16x32_bf16 v[48:51], v[140:143], a[0:3], 0
    s_waitcnt lgkmcnt(2)
    s_lshr_b32 s22, s19, 2
    s_lshl_b32 s22, s22, 19
    v_mfma_f32_16x16x32_bf16 v[0:3], v[144:147], a[16:19], v[0:3]
    s_add_u32 m0, s38, 37888
    ds_read_b64_tr_b16 v[156:157], v229 offset:4096
    ds_read_b64_tr_b16 v[158:159], v229 offset:4608
    v_mfma_f32_16x16x32_bf16 v[4:7], v[144:147], a[20:23], v[4:7]
    s_add_u32 s27, s27, s36
    s_and_b32 s26, s19, 3
    v_mfma_f32_16x16x32_bf16 v[8:11], v[144:147], a[24:27], v[8:11]
    buffer_load_dwordx4 v239, s[8:11], s27 offen lds
    v_mfma_f32_16x16x32_bf16 v[12:15], v[144:147], a[28:31], v[12:15]
    s_add_u32 m0, s38, 38912
    s_lshl_b32 s26, s26, 12
    v_mfma_f32_16x16x32_bf16 v[28:31], v[148:151], a[28:31], v[28:31]
    s_add_u32 s27, s27, s36
    ds_read_b64_tr_b16 v[128:129], v226 offset:8192
    ds_read_b64_tr_b16 v[130:131], v226 offset:8704
    v_mfma_f32_16x16x32_bf16 v[24:27], v[148:151], a[24:27], v[24:27]
    buffer_load_dwordx4 v238, s[8:11], s27 offen lds
    v_mfma_f32_16x16x32_bf16 v[20:23], v[148:151], a[20:23], v[20:23]
    s_add_u32 m0, s38, 39936
    s_add_u32 s22, s22, s26
    s_add_u32 s22, s22, s32
    v_mfma_f32_16x16x32_bf16 v[16:19], v[148:151], a[16:19], v[16:19]
    s_waitcnt lgkmcnt(2)
    s_add_u32 s27, s27, s36
    s_add_u32 s19, s19, 1
    v_mfma_f32_16x16x32_bf16 v[32:35], v[152:155], a[16:19], v[32:35]
    ds_read_b64_tr_b16 v[132:133], v227 offset:8192
    ds_read_b64_tr_b16 v[134:135], v227 offset:8704
    v_mfma_f32_16x16x32_bf16 v[36:39], v[152:155], a[20:23], v[36:39]
    buffer_load_dwordx4 v239, s[8:11], s27 offen lds
    v_mfma_f32_16x16x32_bf16 v[40:43], v[152:155], a[24:27], v[40:43]
    v_mul_f32 v192, s20, v64
    v_mul_f32 v193, s20, v65
    v_mfma_f32_16x16x32_bf16 v[44:47], v[152:155], a[28:31], v[44:47]
    v_cvt_pk_bf16_f32 v160, v192, v193
    v_mfma_f32_16x16x32_bf16 v[60:63], v[156:159], a[28:31], v[60:63]
    ds_read_b64_tr_b16 v[136:137], v228 offset:8192
    ds_read_b64_tr_b16 v[138:139], v228 offset:8704
    v_mfma_f32_16x16x32_bf16 v[56:59], v[156:159], a[24:27], v[56:59]
    v_mul_f32 v194, s20, v66
    v_mfma_f32_16x16x32_bf16 v[52:55], v[156:159], a[20:23], v[52:55]
    v_mul_f32 v195, s20, v67
    v_mfma_f32_16x16x32_bf16 v[48:51], v[156:159], a[16:19], v[48:51]
    s_waitcnt lgkmcnt(2)
    v_mfma_f32_16x16x32_bf16 v[0:3], v[128:131], a[32:35], v[0:3]
    ds_read_b64_tr_b16 v[140:141], v229 offset:8192
    ds_read_b64_tr_b16 v[142:143], v229 offset:8704
    v_mfma_f32_16x16x32_bf16 v[4:7], v[128:131], a[36:39], v[4:7]
    v_cvt_pk_bf16_f32 v161, v194, v195
    v_mul_f32 v196, s20, v80
    v_mfma_f32_16x16x32_bf16 v[8:11], v[128:131], a[40:43], v[8:11]
    v_mfma_f32_16x16x32_bf16 v[12:15], v[128:131], a[44:47], v[12:15]
    v_mul_f32 v197, s20, v81
    v_mfma_f32_16x16x32_bf16 v[28:31], v[132:135], a[44:47], v[28:31]
    ds_read_b64_tr_b16 v[144:145], v226 offset:12288
    ds_read_b64_tr_b16 v[146:147], v226 offset:12800
    v_mfma_f32_16x16x32_bf16 v[24:27], v[132:135], a[40:43], v[24:27]
    v_cvt_pk_bf16_f32 v162, v196, v197
    v_mfma_f32_16x16x32_bf16 v[20:23], v[132:135], a[36:39], v[20:23]
    v_mul_f32 v198, s20, v82
    v_mfma_f32_16x16x32_bf16 v[16:19], v[132:135], a[32:35], v[16:19]
    s_waitcnt lgkmcnt(2)
    v_mul_f32 v199, s20, v83
    v_mfma_f32_16x16x32_bf16 v[32:35], v[136:139], a[32:35], v[32:35]
    ds_read_b64_tr_b16 v[148:149], v227 offset:12288
    ds_read_b64_tr_b16 v[150:151], v227 offset:12800
    v_mfma_f32_16x16x32_bf16 v[36:39], v[136:139], a[36:39], v[36:39]
    v_cvt_pk_bf16_f32 v163, v198, v199
    v_mfma_f32_16x16x32_bf16 v[40:43], v[136:139], a[40:43], v[40:43]
    buffer_store_dwordx4 v[160:163], v234, s[12:15], s22 offen offset:0 sc1
    v_mfma_f32_16x16x32_bf16 v[44:47], v[136:139], a[44:47], v[44:47]
    v_mfma_f32_16x16x32_bf16 v[60:63], v[140:143], a[44:47], v[60:63]
    ds_read_b64_tr_b16 v[152:153], v228 offset:12288
    ds_read_b64_tr_b16 v[154:155], v228 offset:12800
    v_mfma_f32_16x16x32_bf16 v[56:59], v[140:143], a[40:43], v[56:59]
    v_mfma_f32_16x16x32_bf16 v[52:55], v[140:143], a[36:39], v[52:55]
    v_mul_f32 v200, s20, v68
    v_mfma_f32_16x16x32_bf16 v[48:51], v[140:143], a[32:35], v[48:51]
    s_waitcnt lgkmcnt(2)
    v_mul_f32 v201, s20, v69
    v_mfma_f32_16x16x32_bf16 v[0:3], v[144:147], a[48:51], v[0:3]
    ds_read_b64_tr_b16 v[156:157], v229 offset:12288
    ds_read_b64_tr_b16 v[158:159], v229 offset:12800
    v_mfma_f32_16x16x32_bf16 v[4:7], v[144:147], a[52:55], v[4:7]
    v_cvt_pk_bf16_f32 v164, v200, v201
    v_mfma_f32_16x16x32_bf16 v[8:11], v[144:147], a[56:59], v[8:11]
    v_mul_f32 v202, s20, v70
    v_mfma_f32_16x16x32_bf16 v[12:15], v[144:147], a[60:63], v[12:15]
    v_mfma_f32_16x16x32_bf16 v[28:31], v[148:151], a[60:63], v[28:31]
    ds_read_b64_tr_b16 v[128:129], v226 offset:16384
    ds_read_b64_tr_b16 v[130:131], v226 offset:16896
    v_mfma_f32_16x16x32_bf16 v[24:27], v[148:151], a[56:59], v[24:27]
    v_mul_f32 v203, s20, v71
    v_cvt_pk_bf16_f32 v165, v202, v203
    v_mfma_f32_16x16x32_bf16 v[20:23], v[148:151], a[52:55], v[20:23]
    v_mfma_f32_16x16x32_bf16 v[16:19], v[148:151], a[48:51], v[16:19]
    s_waitcnt lgkmcnt(2)
    v_mul_f32 v204, s20, v84
    v_mfma_f32_16x16x32_bf16 v[32:35], v[152:155], a[48:51], v[32:35]
    ds_read_b64_tr_b16 v[132:133], v227 offset:16384
    ds_read_b64_tr_b16 v[134:135], v227 offset:16896
    v_mfma_f32_16x16x32_bf16 v[36:39], v[152:155], a[52:55], v[36:39]
    v_mul_f32 v205, s20, v85
    v_mfma_f32_16x16x32_bf16 v[40:43], v[152:155], a[56:59], v[40:43]
    v_cvt_pk_bf16_f32 v166, v204, v205
    v_mfma_f32_16x16x32_bf16 v[44:47], v[152:155], a[60:63], v[44:47]
    v_mul_f32 v206, s20, v86
    v_mfma_f32_16x16x32_bf16 v[60:63], v[156:159], a[60:63], v[60:63]
    ds_read_b64_tr_b16 v[136:137], v228 offset:16384
    ds_read_b64_tr_b16 v[138:139], v228 offset:16896
    v_mfma_f32_16x16x32_bf16 v[56:59], v[156:159], a[56:59], v[56:59]
    v_mul_f32 v207, s20, v87
    v_mfma_f32_16x16x32_bf16 v[52:55], v[156:159], a[52:55], v[52:55]
    v_cvt_pk_bf16_f32 v167, v206, v207
    v_mfma_f32_16x16x32_bf16 v[48:51], v[156:159], a[48:51], v[48:51]
    s_waitcnt lgkmcnt(2)
    v_mfma_f32_16x16x32_bf16 v[0:3], v[128:131], a[64:67], v[0:3]
    ds_read_b64_tr_b16 v[140:141], v229 offset:16384
    ds_read_b64_tr_b16 v[142:143], v229 offset:16896
    v_mfma_f32_16x16x32_bf16 v[4:7], v[128:131], a[68:71], v[4:7]
    buffer_store_dwordx4 v[164:167], v234, s[12:15], s22 offen offset:1024 sc1
    v_mfma_f32_16x16x32_bf16 v[8:11], v[128:131], a[72:75], v[8:11]
    v_mfma_f32_16x16x32_bf16 v[12:15], v[128:131], a[76:79], v[12:15]
    v_mul_f32 v192, s20, v72
    v_mfma_f32_16x16x32_bf16 v[28:31], v[132:135], a[76:79], v[28:31]
    ds_read_b64_tr_b16 v[144:145], v226 offset:20480
    ds_read_b64_tr_b16 v[146:147], v226 offset:20992
    v_mfma_f32_16x16x32_bf16 v[24:27], v[132:135], a[72:75], v[24:27]
    v_mul_f32 v193, s20, v73
    v_mfma_f32_16x16x32_bf16 v[20:23], v[132:135], a[68:71], v[20:23]
    v_cvt_pk_bf16_f32 v168, v192, v193
    v_mfma_f32_16x16x32_bf16 v[16:19], v[132:135], a[64:67], v[16:19]
    s_waitcnt lgkmcnt(2)
    v_mul_f32 v194, s20, v74
    v_mfma_f32_16x16x32_bf16 v[32:35], v[136:139], a[64:67], v[32:35]
    ds_read_b64_tr_b16 v[148:149], v227 offset:20480
    ds_read_b64_tr_b16 v[150:151], v227 offset:20992
    v_mfma_f32_16x16x32_bf16 v[36:39], v[136:139], a[68:71], v[36:39]
    v_mul_f32 v195, s20, v75
    v_mfma_f32_16x16x32_bf16 v[40:43], v[136:139], a[72:75], v[40:43]
    v_cvt_pk_bf16_f32 v169, v194, v195
    v_mfma_f32_16x16x32_bf16 v[44:47], v[136:139], a[76:79], v[44:47]
    v_mfma_f32_16x16x32_bf16 v[60:63], v[140:143], a[76:79], v[60:63]
    ds_read_b64_tr_b16 v[152:153], v228 offset:20480
    ds_read_b64_tr_b16 v[154:155], v228 offset:20992
    v_mfma_f32_16x16x32_bf16 v[56:59], v[140:143], a[72:75], v[56:59]
    v_mul_f32 v196, s20, v88
    v_mfma_f32_16x16x32_bf16 v[52:55], v[140:143], a[68:71], v[52:55]
    v_mul_f32 v197, s20, v89
    v_mfma_f32_16x16x32_bf16 v[48:51], v[140:143], a[64:67], v[48:51]
    s_waitcnt lgkmcnt(2)
    v_cvt_pk_bf16_f32 v170, v196, v197
    v_mfma_f32_16x16x32_bf16 v[0:3], v[144:147], a[80:83], v[0:3]
    ds_read_b64_tr_b16 v[156:157], v229 offset:20480
    ds_read_b64_tr_b16 v[158:159], v229 offset:20992
    v_mfma_f32_16x16x32_bf16 v[4:7], v[144:147], a[84:87], v[4:7]
    v_mul_f32 v198, s20, v90
    v_mfma_f32_16x16x32_bf16 v[8:11], v[144:147], a[88:91], v[8:11]
    v_mul_f32 v199, s20, v91
    v_mfma_f32_16x16x32_bf16 v[12:15], v[144:147], a[92:95], v[12:15]
    v_mfma_f32_16x16x32_bf16 v[28:31], v[148:151], a[92:95], v[28:31]
    ds_read_b64_tr_b16 v[128:129], v226 offset:24576
    ds_read_b64_tr_b16 v[130:131], v226 offset:25088
    v_mfma_f32_16x16x32_bf16 v[24:27], v[148:151], a[88:91], v[24:27]
    v_cvt_pk_bf16_f32 v171, v198, v199
    v_mfma_f32_16x16x32_bf16 v[20:23], v[148:151], a[84:87], v[20:23]
    buffer_store_dwordx4 v[168:171], v234, s[12:15], s22 offen offset:2048 sc1
    v_mfma_f32_16x16x32_bf16 v[16:19], v[148:151], a[80:83], v[16:19]
    s_waitcnt lgkmcnt(2)
    v_mfma_f32_16x16x32_bf16 v[32:35], v[152:155], a[80:83], v[32:35]
    ds_read_b64_tr_b16 v[132:133], v227 offset:24576
    ds_read_b64_tr_b16 v[134:135], v227 offset:25088
    v_mfma_f32_16x16x32_bf16 v[36:39], v[152:155], a[84:87], v[36:39]
    v_mul_f32 v200, s20, v76
    v_mfma_f32_16x16x32_bf16 v[40:43], v[152:155], a[88:91], v[40:43]
    v_mul_f32 v201, s20, v77
    v_mfma_f32_16x16x32_bf16 v[44:47], v[152:155], a[92:95], v[44:47]
    v_cvt_pk_bf16_f32 v172, v200, v201
    v_mfma_f32_16x16x32_bf16 v[60:63], v[156:159], a[92:95], v[60:63]
    ds_read_b64_tr_b16 v[136:137], v228 offset:24576
    ds_read_b64_tr_b16 v[138:139], v228 offset:25088
    v_mfma_f32_16x16x32_bf16 v[56:59], v[156:159], a[88:91], v[56:59]
    v_mul_f32 v202, s20, v78
    v_mfma_f32_16x16x32_bf16 v[52:55], v[156:159], a[84:87], v[52:55]
    v_mul_f32 v203, s20, v79
    v_mfma_f32_16x16x32_bf16 v[48:51], v[156:159], a[80:83], v[48:51]
    s_waitcnt lgkmcnt(2)
    v_mfma_f32_16x16x32_bf16 v[0:3], v[128:131], a[96:99], v[0:3]
    ds_read_b64_tr_b16 v[140:141], v229 offset:24576
    ds_read_b64_tr_b16 v[142:143], v229 offset:25088
    v_mfma_f32_16x16x32_bf16 v[4:7], v[128:131], a[100:103], v[4:7]
    v_cvt_pk_bf16_f32 v173, v202, v203
    v_mul_f32 v204, s20, v92
    v_mfma_f32_16x16x32_bf16 v[8:11], v[128:131], a[104:107], v[8:11]
    v_mfma_f32_16x16x32_bf16 v[12:15], v[128:131], a[108:111], v[12:15]
    v_mul_f32 v205, s20, v93
    v_mfma_f32_16x16x32_bf16 v[28:31], v[132:135], a[108:111], v[28:31]
    ds_read_b64_tr_b16 v[144:145], v226 offset:28672
    ds_read_b64_tr_b16 v[146:147], v226 offset:29184
    v_mfma_f32_16x16x32_bf16 v[24:27], v[132:135], a[104:107], v[24:27]
    v_cvt_pk_bf16_f32 v174, v204, v205
    v_mfma_f32_16x16x32_bf16 v[20:23], v[132:135], a[100:103], v[20:23]
    v_mul_f32 v206, s20, v94
    v_mfma_f32_16x16x32_bf16 v[16:19], v[132:135], a[96:99], v[16:19]
    s_waitcnt lgkmcnt(2)
    v_mul_f32 v207, s20, v95
    v_mfma_f32_16x16x32_bf16 v[32:35], v[136:139], a[96:99], v[32:35]
    ds_read_b64_tr_b16 v[148:149], v227 offset:28672
    ds_read_b64_tr_b16 v[150:151], v227 offset:29184
    v_mfma_f32_16x16x32_bf16 v[36:39], v[136:139], a[100:103], v[36:39]
    v_cvt_pk_bf16_f32 v175, v206, v207
    v_mfma_f32_16x16x32_bf16 v[40:43], v[136:139], a[104:107], v[40:43]
    buffer_store_dwordx4 v[172:175], v234, s[12:15], s22 offen offset:3072 sc1
    v_mfma_f32_16x16x32_bf16 v[44:47], v[136:139], a[108:111], v[44:47]
    v_mfma_f32_16x16x32_bf16 v[60:63], v[140:143], a[108:111], v[60:63]
    ds_read_b64_tr_b16 v[152:153], v228 offset:28672
    ds_read_b64_tr_b16 v[154:155], v228 offset:29184
    v_mfma_f32_16x16x32_bf16 v[56:59], v[140:143], a[104:107], v[56:59]
    v_mfma_f32_16x16x32_bf16 v[52:55], v[140:143], a[100:103], v[52:55]
    v_mfma_f32_16x16x32_bf16 v[48:51], v[140:143], a[96:99], v[48:51]
    s_waitcnt lgkmcnt(2)
    v_mfma_f32_16x16x32_bf16 v[0:3], v[144:147], a[112:115], v[0:3]
    ds_read_b64_tr_b16 v[156:157], v229 offset:28672
    ds_read_b64_tr_b16 v[158:159], v229 offset:29184
    v_mfma_f32_16x16x32_bf16 v[4:7], v[144:147], a[116:119], v[4:7]
    v_mfma_f32_16x16x32_bf16 v[8:11], v[144:147], a[120:123], v[8:11]
    s_waitcnt vmcnt(16)
    s_barrier
    v_mfma_f32_16x16x32_bf16 v[12:15], v[144:147], a[124:127], v[12:15]
    v_mfma_f32_16x16x32_bf16 v[28:31], v[148:151], a[124:127], v[28:31]
    s_add_u32 m0, s94, 98304
    ds_read_b64_tr_b16 v[128:129], v222 offset:0
    ds_read_b64_tr_b16 v[130:131], v222 offset:512
    v_mfma_f32_16x16x32_bf16 v[24:27], v[148:151], a[120:123], v[24:27]
    s_add_u32 s27, s23, s96
    v_mfma_f32_16x16x32_bf16 v[20:23], v[148:151], a[116:119], v[20:23]
    buffer_load_dwordx4 v238, s[8:11], s27 offen lds
    v_mfma_f32_16x16x32_bf16 v[16:19], v[148:151], a[112:115], v[16:19]
    s_waitcnt lgkmcnt(2)
    s_add_u32 m0, s94, 99328
    s_add_u32 s27, s27, s36
    v_mfma_f32_16x16x32_bf16 v[32:35], v[152:155], a[112:115], v[32:35]
    ds_read_b64_tr_b16 v[132:133], v223 offset:0
    ds_read_b64_tr_b16 v[134:135], v223 offset:512
    v_mfma_f32_16x16x32_bf16 v[36:39], v[152:155], a[116:119], v[36:39]
    buffer_load_dwordx4 v239, s[8:11], s27 offen lds
    v_mfma_f32_16x16x32_bf16 v[40:43], v[152:155], a[120:123], v[40:43]
    s_add_u32 m0, s94, 100352
    v_mfma_f32_16x16x32_bf16 v[44:47], v[152:155], a[124:127], v[44:47]
    s_add_u32 s27, s27, s36
    v_mfma_f32_16x16x32_bf16 v[60:63], v[156:159], a[124:127], v[60:63]
    ds_read_b64_tr_b16 v[136:137], v224 offset:0
    ds_read_b64_tr_b16 v[138:139], v224 offset:512
    v_mfma_f32_16x16x32_bf16 v[56:59], v[156:159], a[120:123], v[56:59]
    buffer_load_dwordx4 v238, s[8:11], s27 offen lds
    v_mfma_f32_16x16x32_bf16 v[52:55], v[156:159], a[116:119], v[52:55]
    s_add_u32 m0, s94, 101376
    s_add_u32 s27, s27, s36
    v_mfma_f32_16x16x32_bf16 v[48:51], v[156:159], a[112:115], v[48:51]
    s_waitcnt lgkmcnt(2)
    v_mfma_f32_16x16x32_bf16 v[0:3], v[128:131], a[128:131], v[0:3]
    ds_read_b64_tr_b16 v[140:141], v225 offset:0
    ds_read_b64_tr_b16 v[142:143], v225 offset:512
    v_mfma_f32_16x16x32_bf16 v[4:7], v[128:131], a[132:135], v[4:7]
    buffer_load_dwordx4 v239, s[8:11], s27 offen lds
    v_mfma_f32_16x16x32_bf16 v[8:11], v[128:131], a[136:139], v[8:11]
    s_add_u32 m0, s94, 102400
    s_add_u32 s27, s27, s36
    v_mfma_f32_16x16x32_bf16 v[12:15], v[128:131], a[140:143], v[12:15]
    buffer_load_dwordx4 v238, s[8:11], s27 offen lds
    v_mfma_f32_16x16x32_bf16 v[28:31], v[132:135], a[140:143], v[28:31]
    s_add_u32 m0, s94, 103424
    ds_read_b64_tr_b16 v[144:145], v222 offset:4096
    ds_read_b64_tr_b16 v[146:147], v222 offset:4608
    v_mfma_f32_16x16x32_bf16 v[24:27], v[132:135], a[136:139], v[24:27]
    s_add_u32 s27, s27, s36
    s_lshr_b32 s22, s19, 2
    s_lshl_b32 s22, s22, 19
    v_mfma_f32_16x16x32_bf16 v[20:23], v[132:135], a[132:135], v[20:23]
    buffer_load_dwordx4 v239, s[8:11], s27 offen lds
    v_mfma_f32_16x16x32_bf16 v[16:19], v[132:135], a[128:131], v[16:19]
    s_waitcnt lgkmcnt(2)
    s_add_u32 m0, s94, 104448
    s_add_u32 s27, s27, s36
    v_mfma_f32_16x16x32_bf16 v[32:35], v[136:139], a[128:131], v[32:35]
    s_and_b32 s26, s19, 3
    ds_read_b64_tr_b16 v[148:149], v223 offset:4096
    ds_read_b64_tr_b16 v[150:151], v223 offset:4608
    v_mfma_f32_16x16x32_bf16 v[36:39], v[136:139], a[132:135], v[36:39]
    buffer_load_dwordx4 v238, s[8:11], s27 offen lds
    v_mfma_f32_16x16x32_bf16 v[40:43], v[136:139], a[136:139], v[40:43]
    s_add_u32 m0, s94, 105472
    s_add_u32 s27, s27, s36
    s_lshl_b32 s26, s26, 12
    v_mfma_f32_16x16x32_bf16 v[44:47], v[136:139], a[140:143], v[44:47]
    buffer_load_dwordx4 v239, s[8:11], s27 offen lds
    v_mfma_f32_16x16x32_bf16 v[60:63], v[140:143], a[140:143], v[60:63]
    s_add_u32 s22, s22, s26
    ds_read_b64_tr_b16 v[152:153], v224 offset:4096
    ds_read_b64_tr_b16 v[154:155], v224 offset:4608
    v_mfma_f32_16x16x32_bf16 v[56:59], v[140:143], a[136:139], v[56:59]
    s_add_u32 s23, s23, 128
    s_add_u32 s22, s22, s32
    s_add_u32 s19, s19, 1
    v_mfma_f32_16x16x32_bf16 v[52:55], v[140:143], a[132:135], v[52:55]
    v_mfma_f32_16x16x32_bf16 v[48:51], v[140:143], a[128:131], v[48:51]
    s_waitcnt lgkmcnt(2)
    v_mul_f32 v192, s20, v96
    v_mfma_f32_16x16x32_bf16 v[0:3], v[144:147], a[144:147], v[0:3]
    ds_read_b64_tr_b16 v[156:157], v225 offset:4096
    ds_read_b64_tr_b16 v[158:159], v225 offset:4608
    v_mfma_f32_16x16x32_bf16 v[4:7], v[144:147], a[148:151], v[4:7]
    v_mul_f32 v193, s20, v97
    v_mfma_f32_16x16x32_bf16 v[8:11], v[144:147], a[152:155], v[8:11]
    v_cvt_pk_bf16_f32 v176, v192, v193
    v_mfma_f32_16x16x32_bf16 v[12:15], v[144:147], a[156:159], v[12:15]
    v_mfma_f32_16x16x32_bf16 v[28:31], v[148:151], a[156:159], v[28:31]
    ds_read_b64_tr_b16 v[128:129], v222 offset:8192
    ds_read_b64_tr_b16 v[130:131], v222 offset:8704
    v_mfma_f32_16x16x32_bf16 v[24:27], v[148:151], a[152:155], v[24:27]
    v_mul_f32 v194, s20, v98
    v_mfma_f32_16x16x32_bf16 v[20:23], v[148:151], a[148:151], v[20:23]
    v_mul_f32 v195, s20, v99
    v_mfma_f32_16x16x32_bf16 v[16:19], v[148:151], a[144:147], v[16:19]
    s_waitcnt lgkmcnt(2)
    v_cvt_pk_bf16_f32 v177, v194, v195
    v_mfma_f32_16x16x32_bf16 v[32:35], v[152:155], a[144:147], v[32:35]
    ds_read_b64_tr_b16 v[132:133], v223 offset:8192
    ds_read_b64_tr_b16 v[134:135], v223 offset:8704
    v_mfma_f32_16x16x32_bf16 v[36:39], v[152:155], a[148:151], v[36:39]
    v_mul_f32 v196, s20, v112
    v_mfma_f32_16x16x32_bf16 v[40:43], v[152:155], a[152:155], v[40:43]
    v_mfma_f32_16x16x32_bf16 v[44:47], v[152:155], a[156:159], v[44:47]
    v_mul_f32 v197, s20, v113
    v_mfma_f32_16x16x32_bf16 v[60:63], v[156:159], a[156:159], v[60:63]
    ds_read_b64_tr_b16 v[136:137], v224 offset:8192
    ds_read_b64_tr_b16 v[138:139], v224 offset:8704
    v_mfma_f32_16x16x32_bf16 v[56:59], v[156:159], a[152:155], v[56:59]
    v_cvt_pk_bf16_f32 v178, v196, v197
    v_mfma_f32_16x16x32_bf16 v[52:55], v[156:159], a[148:151], v[52:55]
    v_mul_f32 v198, s20, v114
    v_mfma_f32_16x16x32_bf16 v[48:51], v[156:159], a[144:147], v[48:51]
    s_waitcnt lgkmcnt(2)
    v_mfma_f32_16x16x32_bf16 v[0:3], v[128:131], a[160:163], v[0:3]
    ds_read_b64_tr_b16 v[140:141], v225 offset:8192
    ds_read_b64_tr_b16 v[142:143], v225 offset:8704
    v_mfma_f32_16x16x32_bf16 v[4:7], v[128:131], a[164:167], v[4:7]
    v_mul_f32 v199, s20, v115
    v_cvt_pk_bf16_f32 v179, v198, v199
    v_mfma_f32_16x16x32_bf16 v[8:11], v[128:131], a[168:171], v[8:11]
    v_mfma_f32_16x16x32_bf16 v[12:15], v[128:131], a[172:175], v[12:15]
    buffer_store_dwordx4 v[176:179], v234, s[12:15], s22 offen offset:0 sc1
    v_mfma_f32_16x16x32_bf16 v[28:31], v[132:135], a[172:175], v[28:31]
    ds_read_b64_tr_b16 v[144:145], v222 offset:12288
    ds_read_b64_tr_b16 v[146:147], v222 offset:12800
    v_mfma_f32_16x16x32_bf16 v[24:27], v[132:135], a[168:171], v[24:27]
    v_mfma_f32_16x16x32_bf16 v[20:23], v[132:135], a[164:167], v[20:23]
    v_mul_f32 v200, s20, v100
    v_mfma_f32_16x16x32_bf16 v[16:19], v[132:135], a[160:163], v[16:19]
    s_waitcnt lgkmcnt(2)
    v_mfma_f32_16x16x32_bf16 v[32:35], v[136:139], a[160:163], v[32:35]
    ds_read_b64_tr_b16 v[148:149], v223 offset:12288
    ds_read_b64_tr_b16 v[150:151], v223 offset:12800
    v_mfma_f32_16x16x32_bf16 v[36:39], v[136:139], a[164:167], v[36:39]
    v_mul_f32 v201, s20, v101
    v_cvt_pk_bf16_f32 v180, v200, v201
    v_mfma_f32_16x16x32_bf16 v[40:43], v[136:139], a[168:171], v[40:43]
    v_mfma_f32_16x16x32_bf16 v[44:47], v[136:139], a[172:175], v[44:47]
    v_mul_f32 v202, s20, v102
    v_mfma_f32_16x16x32_bf16 v[60:63], v[140:143], a[172:175], v[60:63]
    ds_read_b64_tr_b16 v[152:153], v224 offset:12288
    ds_read_b64_tr_b16 v[154:155], v224 offset:12800
    v_mfma_f32_16x16x32_bf16 v[56:59], v[140:143], a[168:171], v[56:59]
    v_mul_f32 v203, s20, v103
    v_mfma_f32_16x16x32_bf16 v[52:55], v[140:143], a[164:167], v[52:55]
    v_cvt_pk_bf16_f32 v181, v202, v203
    v_mfma_f32_16x16x32_bf16 v[48:51], v[140:143], a[160:163], v[48:51]
    s_waitcnt lgkmcnt(2)
    v_mfma_f32_16x16x32_bf16 v[0:3], v[144:147], a[176:179], v[0:3]
    ds_read_b64_tr_b16 v[156:157], v225 offset:12288
    ds_read_b64_tr_b16 v[158:159], v225 offset:12800
    v_mfma_f32_16x16x32_bf16 v[4:7], v[144:147], a[180:183], v[4:7]
    v_mul_f32 v204, s20, v116
    v_mfma_f32_16x16x32_bf16 v[8:11], v[144:147], a[184:187], v[8:11]
    v_mul_f32 v205, s20, v117
    v_mfma_f32_16x16x32_bf16 v[12:15], v[144:147], a[188:191], v[12:15]
    v_cvt_pk_bf16_f32 v182, v204, v205
    v_mfma_f32_16x16x32_bf16 v[28:31], v[148:151], a[188:191], v[28:31]
    ds_read_b64_tr_b16 v[128:129], v222 offset:16384
    ds_read_b64_tr_b16 v[130:131], v222 offset:16896
    v_mfma_f32_16x16x32_bf16 v[24:27], v[148:151], a[184:187], v[24:27]
    v_mul_f32 v206, s20, v118
    v_mfma_f32_16x16x32_bf16 v[20:23], v[148:151], a[180:183], v[20:23]
    v_mfma_f32_16x16x32_bf16 v[16:19], v[148:151], a[176:179], v[16:19]
    s_waitcnt lgkmcnt(2)
    v_mul_f32 v207, s20, v119
    v_mfma_f32_16x16x32_bf16 v[32:35], v[152:155], a[176:179], v[32:35]
    ds_read_b64_tr_b16 v[132:133], v223 offset:16384
    ds_read_b64_tr_b16 v[134:135], v223 offset:16896
    v_mfma_f32_16x16x32_bf16 v[36:39], v[152:155], a[180:183], v[36:39]
    v_cvt_pk_bf16_f32 v183, v206, v207
    v_mfma_f32_16x16x32_bf16 v[40:43], v[152:155], a[184:187], v[40:43]
    buffer_store_dwordx4 v[180:183], v234, s[12:15], s22 offen offset:1024 sc1
    v_mfma_f32_16x16x32_bf16 v[44:47], v[152:155], a[188:191], v[44:47]
    v_mfma_f32_16x16x32_bf16 v[60:63], v[156:159], a[188:191], v[60:63]
    ds_read_b64_tr_b16 v[136:137], v224 offset:16384
    ds_read_b64_tr_b16 v[138:139], v224 offset:16896
    v_mfma_f32_16x16x32_bf16 v[56:59], v[156:159], a[184:187], v[56:59]
    v_mul_f32 v192, s20, v104
    v_mfma_f32_16x16x32_bf16 v[52:55], v[156:159], a[180:183], v[52:55]
    v_mfma_f32_16x16x32_bf16 v[48:51], v[156:159], a[176:179], v[48:51]
    s_waitcnt lgkmcnt(2)
    v_mul_f32 v193, s20, v105
    v_mfma_f32_16x16x32_bf16 v[0:3], v[128:131], a[192:195], v[0:3]
    ds_read_b64_tr_b16 v[140:141], v225 offset:16384
    ds_read_b64_tr_b16 v[142:143], v225 offset:16896
    v_mfma_f32_16x16x32_bf16 v[4:7], v[128:131], a[196:199], v[4:7]
    v_cvt_pk_bf16_f32 v184, v192, v193
    v_mfma_f32_16x16x32_bf16 v[8:11], v[128:131], a[200:203], v[8:11]
    v_mul_f32 v194, s20, v106
    v_mfma_f32_16x16x32_bf16 v[12:15], v[128:131], a[204:207], v[12:15]
    v_mfma_f32_16x16x32_bf16 v[28:31], v[132:135], a[204:207], v[28:31]
    ds_read_b64_tr_b16 v[144:145], v222 offset:20480
    ds_read_b64_tr_b16 v[146:147], v222 offset:20992
    v_mfma_f32_16x16x32_bf16 v[24:27], v[132:135], a[200:203], v[24:27]
    v_mul_f32 v195, s20, v107
    v_mfma_f32_16x16x32_bf16 v[20:23], v[132:135], a[196:199], v[20:23]
    v_cvt_pk_bf16_f32 v185, v194, v195
    v_mfma_f32_16x16x32_bf16 v[16:19], v[132:135], a[192:195], v[16:19]
    s_waitcnt lgkmcnt(2)
    v_mul_f32 v196, s20, v120
    v_mfma_f32_16x16x32_bf16 v[32:35], v[136:139], a[192:195], v[32:35]
    ds_read_b64_tr_b16 v[148:149], v223 offset:20480
    ds_read_b64_tr_b16 v[150:151], v223 offset:20992
    v_mfma_f32_16x16x32_bf16 v[36:39], v[136:139], a[196:199], v[36:39]
    v_mul_f32 v197, s20, v121
    v_mfma_f32_16x16x32_bf16 v[40:43], v[136:139], a[200:203], v[40:43]
    v_cvt_pk_bf16_f32 v186, v196, v197
    v_mfma_f32_16x16x32_bf16 v[44:47], v[136:139], a[204:207], v[44:47]
    v_mfma_f32_16x16x32_bf16 v[60:63], v[140:143], a[204:207], v[60:63]
    ds_read_b64_tr_b16 v[152:153], v224 offset:20480
    ds_read_b64_tr_b16 v[154:155], v224 offset:20992
    v_mfma_f32_16x16x32_bf16 v[56:59], v[140:143], a[200:203], v[56:59]
    v_mul_f32 v198, s20, v122
    v_mfma_f32_16x16x32_bf16 v[52:55], v[140:143], a[196:199], v[52:55]
    v_mul_f32 v199, s20, v123
    v_mfma_f32_16x16x32_bf16 v[48:51], v[140:143], a[192:195], v[48:51]
    s_waitcnt lgkmcnt(2)
    v_cvt_pk_bf16_f32 v187, v198, v199
    v_mfma_f32_16x16x32_bf16 v[0:3], v[144:147], a[208:211], v[0:3]
    ds_read_b64_tr_b16 v[156:157], v225 offset:20480
    ds_read_b64_tr_b16 v[158:159], v225 offset:20992
    v_mfma_f32_16x16x32_bf16 v[4:7], v[144:147], a[212:215], v[4:7]
    buffer_store_dwordx4 v[184:187], v234, s[12:15], s22 offen offset:2048 sc1
    v_mfma_f32_16x16x32_bf16 v[8:11], v[144:147], a[216:219], v[8:11]
    v_mfma_f32_16x16x32_bf16 v[12:15], v[144:147], a[220:223], v[12:15]
    v_mfma_f32_16x16x32_bf16 v[28:31], v[148:151], a[220:223], v[28:31]
    ds_read_b64_tr_b16 v[128:129], v222 offset:24576
    ds_read_b64_tr_b16 v[130:131], v222 offset:25088
    v_mfma_f32_16x16x32_bf16 v[24:27], v[148:151], a[216:219], v[24:27]
    v_mul_f32 v200, s20, v108
    v_mfma_f32_16x16x32_bf16 v[20:23], v[148:151], a[212:215], v[20:23]
    v_mul_f32 v201, s20, v109
    v_mfma_f32_16x16x32_bf16 v[16:19], v[148:151], a[208:211], v[16:19]
    s_waitcnt lgkmcnt(2)
    v_mfma_f32_16x16x32_bf16 v[32:35], v[152:155], a[208:211], v[32:35]
    ds_read_b64_tr_b16 v[132:133], v223 offset:24576
    ds_read_b64_tr_b16 v[134:135], v223 offset:25088
    v_mfma_f32_16x16x32_bf16 v[36:39], v[152:155], a[212:215], v[36:39]
    v_cvt_pk_bf16_f32 v188, v200, v201
    v_mul_f32 v202, s20, v110
    v_mfma_f32_16x16x32_bf16 v[40:43], v[152:155], a[216:219], v[40:43]
    v_mfma_f32_16x16x32_bf16 v[44:47], v[152:155], a[220:223], v[44:47]
    v_mul_f32 v203, s20, v111
    v_mfma_f32_16x16x32_bf16 v[60:63], v[156:159], a[220:223], v[60:63]
    ds_read_b64_tr_b16 v[136:137], v224 offset:24576
    ds_read_b64_tr_b16 v[138:139], v224 offset:25088
    v_mfma_f32_16x16x32_bf16 v[56:59], v[156:159], a[216:219], v[56:59]
    v_cvt_pk_bf16_f32 v189, v202, v203
    v_mfma_f32_16x16x32_bf16 v[52:55], v[156:159], a[212:215], v[52:55]
    v_mul_f32 v204, s20, v124
    v_mfma_f32_16x16x32_bf16 v[48:51], v[156:159], a[208:211], v[48:51]
    s_waitcnt lgkmcnt(2)
    v_mfma_f32_16x16x32_bf16 v[0:3], v[128:131], a[224:227], v[0:3]
    ds_read_b64_tr_b16 v[140:141], v225 offset:24576
    ds_read_b64_tr_b16 v[142:143], v225 offset:25088
    v_mfma_f32_16x16x32_bf16 v[4:7], v[128:131], a[228:231], v[4:7]
    v_mul_f32 v205, s20, v125
    v_mfma_f32_16x16x32_bf16 v[8:11], v[128:131], a[232:235], v[8:11]
    v_cvt_pk_bf16_f32 v190, v204, v205
    v_mfma_f32_16x16x32_bf16 v[12:15], v[128:131], a[236:239], v[12:15]
    v_mul_f32 v206, s20, v126
    v_mfma_f32_16x16x32_bf16 v[28:31], v[132:135], a[236:239], v[28:31]
    ds_read_b64_tr_b16 v[144:145], v222 offset:28672
    ds_read_b64_tr_b16 v[146:147], v222 offset:29184
    v_mfma_f32_16x16x32_bf16 v[24:27], v[132:135], a[232:235], v[24:27]
    v_mul_f32 v207, s20, v127
    v_mfma_f32_16x16x32_bf16 v[20:23], v[132:135], a[228:231], v[20:23]
    v_mfma_f32_16x16x32_bf16 v[16:19], v[132:135], a[224:227], v[16:19]
    s_waitcnt lgkmcnt(2)
    v_cvt_pk_bf16_f32 v191, v206, v207
    v_mfma_f32_16x16x32_bf16 v[32:35], v[136:139], a[224:227], v[32:35]
    ds_read_b64_tr_b16 v[148:149], v223 offset:28672
    ds_read_b64_tr_b16 v[150:151], v223 offset:29184
    v_mfma_f32_16x16x32_bf16 v[36:39], v[136:139], a[228:231], v[36:39]
    buffer_store_dwordx4 v[188:191], v234, s[12:15], s22 offen offset:3072 sc1
    v_mfma_f32_16x16x32_bf16 v[40:43], v[136:139], a[232:235], v[40:43]
    v_mfma_f32_16x16x32_bf16 v[44:47], v[136:139], a[236:239], v[44:47]
    v_mfma_f32_16x16x32_bf16 v[60:63], v[140:143], a[236:239], v[60:63]
    ds_read_b64_tr_b16 v[152:153], v224 offset:28672
    ds_read_b64_tr_b16 v[154:155], v224 offset:29184
    v_mfma_f32_16x16x32_bf16 v[56:59], v[140:143], a[232:235], v[56:59]
    v_mfma_f32_16x16x32_bf16 v[52:55], v[140:143], a[228:231], v[52:55]
    v_mfma_f32_16x16x32_bf16 v[48:51], v[140:143], a[224:227], v[48:51]
    s_waitcnt lgkmcnt(2)
    v_mfma_f32_16x16x32_bf16 v[0:3], v[144:147], a[240:243], v[0:3]
    ds_read_b64_tr_b16 v[156:157], v225 offset:28672
    ds_read_b64_tr_b16 v[158:159], v225 offset:29184
    v_mfma_f32_16x16x32_bf16 v[4:7], v[144:147], a[244:247], v[4:7]
    v_mfma_f32_16x16x32_bf16 v[8:11], v[144:147], a[248:251], v[8:11]
    s_waitcnt vmcnt(16)
    s_barrier
    v_mfma_f32_16x16x32_bf16 v[12:15], v[144:147], a[252:255], v[12:15]
    v_mfma_f32_16x16x32_bf16 v[28:31], v[148:151], a[252:255], v[28:31]
    ds_read_b64_tr_b16 v[128:129], v222 offset:32768
    ds_read_b64_tr_b16 v[130:131], v222 offset:33280
    v_mfma_f32_16x16x32_bf16 v[24:27], v[148:151], a[248:251], v[24:27]
    v_mfma_f32_16x16x32_bf16 v[20:23], v[148:151], a[244:247], v[20:23]
    v_mfma_f32_16x16x32_bf16 v[16:19], v[148:151], a[240:243], v[16:19]
    s_waitcnt lgkmcnt(2)
    v_mfma_f32_16x16x32_bf16 v[32:35], v[152:155], a[240:243], v[32:35]
    ds_read_b64_tr_b16 v[132:133], v223 offset:32768
    ds_read_b64_tr_b16 v[134:135], v223 offset:33280
    v_mfma_f32_16x16x32_bf16 v[36:39], v[152:155], a[244:247], v[36:39]
    v_mfma_f32_16x16x32_bf16 v[40:43], v[152:155], a[248:251], v[40:43]
    v_mfma_f32_16x16x32_bf16 v[44:47], v[152:155], a[252:255], v[44:47]
    v_mfma_f32_16x16x32_bf16 v[60:63], v[156:159], a[252:255], v[60:63]
    ds_read_b64_tr_b16 v[136:137], v224 offset:32768
    ds_read_b64_tr_b16 v[138:139], v224 offset:33280
    v_mfma_f32_16x16x32_bf16 v[56:59], v[156:159], a[248:251], v[56:59]
    v_mfma_f32_16x16x32_bf16 v[52:55], v[156:159], a[244:247], v[52:55]
    v_mfma_f32_16x16x32_bf16 v[48:51], v[156:159], a[240:243], v[48:51]
    s_cmp_eq_u32 s29, 1
    s_cbranch_scc1 K1_done_12
    s_waitcnt lgkmcnt(2)
    v_mfma_f32_16x16x32_bf16 v[64:67], v[128:131], a[0:3], 0
    s_add_u32 m0, s38, 65536
    ds_read_b64_tr_b16 v[140:141], v225 offset:32768
    ds_read_b64_tr_b16 v[142:143], v225 offset:33280
    v_mfma_f32_16x16x32_bf16 v[68:71], v[128:131], a[4:7], 0
    s_add_u32 s27, s23, s37
    v_mfma_f32_16x16x32_bf16 v[72:75], v[128:131], a[8:11], 0
    buffer_load_dwordx4 v238, s[8:11], s27 offen lds
    v_mfma_f32_16x16x32_bf16 v[76:79], v[128:131], a[12:15], 0
    s_add_u32 m0, s38, 66560
    v_mfma_f32_16x16x32_bf16 v[92:95], v[132:135], a[12:15], 0
    s_add_u32 s27, s27, s36
    ds_read_b64_tr_b16 v[144:145], v222 offset:36864
    ds_read_b64_tr_b16 v[146:147], v222 offset:37376
    v_mfma_f32_16x16x32_bf16 v[88:91], v[132:135], a[8:11], 0
    buffer_load_dwordx4 v239, s[8:11], s27 offen lds
    v_mfma_f32_16x16x32_bf16 v[84:87], v[132:135], a[4:7], 0
    s_add_u32 m0, s38, 67584
    v_mfma_f32_16x16x32_bf16 v[80:83], v[132:135], a[0:3], 0
    s_waitcnt lgkmcnt(2)
    s_add_u32 s27, s27, s36
    v_mfma_f32_16x16x32_bf16 v[96:99], v[136:139], a[0:3], 0
    ds_read_b64_tr_b16 v[148:149], v223 offset:36864
    ds_read_b64_tr_b16 v[150:151], v223 offset:37376
    v_mfma_f32_16x16x32_bf16 v[100:103], v[136:139], a[4:7], 0
    buffer_load_dwordx4 v238, s[8:11], s27 offen lds
    v_mfma_f32_16x16x32_bf16 v[104:107], v[136:139], a[8:11], 0
    s_add_u32 m0, s38, 68608
    s_add_u32 s27, s27, s36
    v_mfma_f32_16x16x32_bf16 v[108:111], v[136:139], a[12:15], 0
    buffer_load_dwordx4 v239, s[8:11], s27 offen lds
    v_mfma_f32_16x16x32_bf16 v[124:127], v[140:143], a[12:15], 0
    ds_read_b64_tr_b16 v[152:153], v224 offset:36864
    ds_read_b64_tr_b16 v[154:155], v224 offset:37376
    v_mfma_f32_16x16x32_bf16 v[120:123], v[140:143], a[8:11], 0
    s_add_u32 m0, s38, 69632
    s_add_u32 s27, s27, s36
    v_mfma_f32_16x16x32_bf16 v[116:119], v[140:143], a[4:7], 0
    buffer_load_dwordx4 v238, s[8:11], s27 offen lds
    v_mfma_f32_16x16x32_bf16 v[112:115], v[140:143], a[0:3], 0
    s_waitcnt lgkmcnt(2)
    s_lshr_b32 s22, s19, 2
    s_lshl_b32 s22, s22, 19
    v_mfma_f32_16x16x32_bf16 v[64:67], v[144:147], a[16:19], v[64:67]
    s_add_u32 m0, s38, 70656
    ds_read_b64_tr_b16 v[156:157], v225 offset:36864
    ds_read_b64_tr_b16 v[158:159], v225 offset:37376
    v_mfma_f32_16x16x32_bf16 v[68:71], v[144:147], a[20:23], v[68:71]
    s_add_u32 s27, s27, s36
    s_and_b32 s26, s19, 3
    v_mfma_f32_16x16x32_bf16 v[72:75], v[144:147], a[24:27], v[72:75]
    buffer_load_dwordx4 v239, s[8:11], s27 offen lds
    v_mfma_f32_16x16x32_bf16 v[76:79], v[144:147], a[28:31], v[76:79]
    s_add_u32 m0, s38, 71680
    s_lshl_b32 s26, s26, 12
    v_mfma_f32_16x16x32_bf16 v[92:95], v[148:151], a[28:31], v[92:95]
    s_add_u32 s27, s27, s36
    ds_read_b64_tr_b16 v[128:129], v222 offset:40960
    ds_read_b64_tr_b16 v[130:131], v222 offset:41472
    v_mfma_f32_16x16x32_bf16 v[88:91], v[148:151], a[24:27], v[88:91]
    buffer_load_dwordx4 v238, s[8:11], s27 offen lds
    v_mfma_f32_16x16x32_bf16 v[84:87], v[148:151], a[20:23], v[84:87]
    s_add_u32 m0, s38, 72704
    s_add_u32 s22, s22, s26
    s_add_u32 s22, s22, s32
    v_mfma_f32_16x16x32_bf16 v[80:83], v[148:151], a[16:19], v[80:83]
    s_waitcnt lgkmcnt(2)
    s_add_u32 s27, s27, s36
    s_add_u32 s19, s19, 1
    v_mfma_f32_16x16x32_bf16 v[96:99], v[152:155], a[16:19], v[96:99]
    ds_read_b64_tr_b16 v[132:133], v223 offset:40960
    ds_read_b64_tr_b16 v[134:135], v223 offset:41472
    v_mfma_f32_16x16x32_bf16 v[100:103], v[152:155], a[20:23], v[100:103]
    buffer_load_dwordx4 v239, s[8:11], s27 offen lds
    v_mfma_f32_16x16x32_bf16 v[104:107], v[152:155], a[24:27], v[104:107]
    v_mul_f32 v192, s20, v0
    v_mul_f32 v193, s20, v1
    v_mfma_f32_16x16x32_bf16 v[108:111], v[152:155], a[28:31], v[108:111]
    v_cvt_pk_bf16_f32 v160, v192, v193
    v_mfma_f32_16x16x32_bf16 v[124:127], v[156:159], a[28:31], v[124:127]
    ds_read_b64_tr_b16 v[136:137], v224 offset:40960
    ds_read_b64_tr_b16 v[138:139], v224 offset:41472
    v_mfma_f32_16x16x32_bf16 v[120:123], v[156:159], a[24:27], v[120:123]
    v_mul_f32 v194, s20, v2
    v_mfma_f32_16x16x32_bf16 v[116:119], v[156:159], a[20:23], v[116:119]
    v_mul_f32 v195, s20, v3
    v_mfma_f32_16x16x32_bf16 v[112:115], v[156:159], a[16:19], v[112:115]
    s_waitcnt lgkmcnt(2)
    v_mfma_f32_16x16x32_bf16 v[64:67], v[128:131], a[32:35], v[64:67]
    ds_read_b64_tr_b16 v[140:141], v225 offset:40960
    ds_read_b64_tr_b16 v[142:143], v225 offset:41472
    v_mfma_f32_16x16x32_bf16 v[68:71], v[128:131], a[36:39], v[68:71]
    v_cvt_pk_bf16_f32 v161, v194, v195
    v_mul_f32 v196, s20, v16
    v_mfma_f32_16x16x32_bf16 v[72:75], v[128:131], a[40:43], v[72:75]
    v_mfma_f32_16x16x32_bf16 v[76:79], v[128:131], a[44:47], v[76:79]
    v_mul_f32 v197, s20, v17
    v_mfma_f32_16x16x32_bf16 v[92:95], v[132:135], a[44:47], v[92:95]
    ds_read_b64_tr_b16 v[144:145], v222 offset:45056
    ds_read_b64_tr_b16 v[146:147], v222 offset:45568
    v_mfma_f32_16x16x32_bf16 v[88:91], v[132:135], a[40:43], v[88:91]
    v_cvt_pk_bf16_f32 v162, v196, v197
    v_mfma_f32_16x16x32_bf16 v[84:87], v[132:135], a[36:39], v[84:87]
    v_mul_f32 v198, s20, v18
    v_mfma_f32_16x16x32_bf16 v[80:83], v[132:135], a[32:35], v[80:83]
    s_waitcnt lgkmcnt(2)
    v_mul_f32 v199, s20, v19
    v_mfma_f32_16x16x32_bf16 v[96:99], v[136:139], a[32:35], v[96:99]
    ds_read_b64_tr_b16 v[148:149], v223 offset:45056
    ds_read_b64_tr_b16 v[150:151], v223 offset:45568
    v_mfma_f32_16x16x32_bf16 v[100:103], v[136:139], a[36:39], v[100:103]
    v_cvt_pk_bf16_f32 v163, v198, v199
    v_mfma_f32_16x16x32_bf16 v[104:107], v[136:139], a[40:43], v[104:107]
    buffer_store_dwordx4 v[160:163], v234, s[12:15], s22 offen offset:0 sc1
    v_mfma_f32_16x16x32_bf16 v[108:111], v[136:139], a[44:47], v[108:111]
    v_mfma_f32_16x16x32_bf16 v[124:127], v[140:143], a[44:47], v[124:127]
    ds_read_b64_tr_b16 v[152:153], v224 offset:45056
    ds_read_b64_tr_b16 v[154:155], v224 offset:45568
    v_mfma_f32_16x16x32_bf16 v[120:123], v[140:143], a[40:43], v[120:123]
    v_mfma_f32_16x16x32_bf16 v[116:119], v[140:143], a[36:39], v[116:119]
    v_mul_f32 v200, s20, v4
    v_mfma_f32_16x16x32_bf16 v[112:115], v[140:143], a[32:35], v[112:115]
    s_waitcnt lgkmcnt(2)
    v_mul_f32 v201, s20, v5
    v_mfma_f32_16x16x32_bf16 v[64:67], v[144:147], a[48:51], v[64:67]
    ds_read_b64_tr_b16 v[156:157], v225 offset:45056
    ds_read_b64_tr_b16 v[158:159], v225 offset:45568
    v_mfma_f32_16x16x32_bf16 v[68:71], v[144:147], a[52:55], v[68:71]
    v_cvt_pk_bf16_f32 v164, v200, v201
    v_mfma_f32_16x16x32_bf16 v[72:75], v[144:147], a[56:59], v[72:75]
    v_mul_f32 v202, s20, v6
    v_mfma_f32_16x16x32_bf16 v[76:79], v[144:147], a[60:63], v[76:79]
    v_mfma_f32_16x16x32_bf16 v[92:95], v[148:151], a[60:63], v[92:95]
    ds_read_b64_tr_b16 v[128:129], v222 offset:49152
    ds_read_b64_tr_b16 v[130:131], v222 offset:49664
    v_mfma_f32_16x16x32_bf16 v[88:91], v[148:151], a[56:59], v[88:91]
    v_mul_f32 v203, s20, v7
    v_cvt_pk_bf16_f32 v165, v202, v203
    v_mfma_f32_16x16x32_bf16 v[84:87], v[148:151], a[52:55], v[84:87]
    v_mfma_f32_16x16x32_bf16 v[80:83], v[148:151], a[48:51], v[80:83]
    s_waitcnt lgkmcnt(2)
    v_mul_f32 v204, s20, v20
    v_mfma_f32_16x16x32_bf16 v[96:99], v[152:155], a[48:51], v[96:99]
    ds_read_b64_tr_b16 v[132:133], v223 offset:49152
    ds_read_b64_tr_b16 v[134:135], v223 offset:49664
    v_mfma_f32_16x16x32_bf16 v[100:103], v[152:155], a[52:55], v[100:103]
    v_mul_f32 v205, s20, v21
    v_mfma_f32_16x16x32_bf16 v[104:107], v[152:155], a[56:59], v[104:107]
    v_cvt_pk_bf16_f32 v166, v204, v205
    v_mfma_f32_16x16x32_bf16 v[108:111], v[152:155], a[60:63], v[108:111]
    v_mul_f32 v206, s20, v22
    v_mfma_f32_16x16x32_bf16 v[124:127], v[156:159], a[60:63], v[124:127]
    ds_read_b64_tr_b16 v[136:137], v224 offset:49152
    ds_read_b64_tr_b16 v[138:139], v224 offset:49664
    v_mfma_f32_16x16x32_bf16 v[120:123], v[156:159], a[56:59], v[120:123]
    v_mul_f32 v207, s20, v23
    v_mfma_f32_16x16x32_bf16 v[116:119], v[156:159], a[52:55], v[116:119]
    v_cvt_pk_bf16_f32 v167, v206, v207
    v_mfma_f32_16x16x32_bf16 v[112:115], v[156:159], a[48:51], v[112:115]
    s_waitcnt lgkmcnt(2)
    v_mfma_f32_16x16x32_bf16 v[64:67], v[128:131], a[64:67], v[64:67]
    ds_read_b64_tr_b16 v[140:141], v225 offset:49152
    ds_read_b64_tr_b16 v[142:143], v225 offset:49664
    v_mfma_f32_16x16x32_bf16 v[68:71], v[128:131], a[68:71], v[68:71]
    buffer_store_dwordx4 v[164:167], v234, s[12:15], s22 offen offset:1024 sc1
    v_mfma_f32_16x16x32_bf16 v[72:75], v[128:131], a[72:75], v[72:75]
    v_mfma_f32_16x16x32_bf16 v[76:79], v[128:131], a[76:79], v[76:79]
    v_mul_f32 v192, s20, v8
    v_mfma_f32_16x16x32_bf16 v[92:95], v[132:135], a[76:79], v[92:95]
    ds_read_b64_tr_b16 v[144:145], v222 offset:53248
    ds_read_b64_tr_b16 v[146:147], v222 offset:53760
    v_mfma_f32_16x16x32_bf16 v[88:91], v[132:135], a[72:75], v[88:91]
    v_mul_f32 v193, s20, v9
    v_mfma_f32_16x16x32_bf16 v[84:87], v[132:135], a[68:71], v[84:87]
    v_cvt_pk_bf16_f32 v168, v192, v193
    v_mfma_f32_16x16x32_bf16 v[80:83], v[132:135], a[64:67], v[80:83]
    s_waitcnt lgkmcnt(2)
    v_mul_f32 v194, s20, v10
    v_mfma_f32_16x16x32_bf16 v[96:99], v[136:139], a[64:67], v[96:99]
    ds_read_b64_tr_b16 v[148:149], v223 offset:53248
    ds_read_b64_tr_b16 v[150:151], v223 offset:53760
    v_mfma_f32_16x16x32_bf16 v[100:103], v[136:139], a[68:71], v[100:103]
    v_mul_f32 v195, s20, v11
    v_mfma_f32_16x16x32_bf16 v[104:107], v[136:139], a[72:75], v[104:107]
    v_cvt_pk_bf16_f32 v169, v194, v195
    v_mfma_f32_16x16x32_bf16 v[108:111], v[136:139], a[76:79], v[108:111]
    v_mfma_f32_16x16x32_bf16 v[124:127], v[140:143], a[76:79], v[124:127]
    ds_read_b64_tr_b16 v[152:153], v224 offset:53248
    ds_read_b64_tr_b16 v[154:155], v224 offset:53760
    v_mfma_f32_16x16x32_bf16 v[120:123], v[140:143], a[72:75], v[120:123]
    v_mul_f32 v196, s20, v24
    v_mfma_f32_16x16x32_bf16 v[116:119], v[140:143], a[68:71], v[116:119]
    v_mul_f32 v197, s20, v25
    v_mfma_f32_16x16x32_bf16 v[112:115], v[140:143], a[64:67], v[112:115]
    s_waitcnt lgkmcnt(2)
    v_cvt_pk_bf16_f32 v170, v196, v197
    v_mfma_f32_16x16x32_bf16 v[64:67], v[144:147], a[80:83], v[64:67]
    ds_read_b64_tr_b16 v[156:157], v225 offset:53248
    ds_read_b64_tr_b16 v[158:159], v225 offset:53760
    v_mfma_f32_16x16x32_bf16 v[68:71], v[144:147], a[84:87], v[68:71]
    v_mul_f32 v198, s20, v26
    v_mfma_f32_16x16x32_bf16 v[72:75], v[144:147], a[88:91], v[72:75]
    v_mul_f32 v199, s20, v27
    v_mfma_f32_16x16x32_bf16 v[76:79], v[144:147], a[92:95], v[76:79]
    v_mfma_f32_16x16x32_bf16 v[92:95], v[148:151], a[92:95], v[92:95]
    ds_read_b64_tr_b16 v[128:129], v222 offset:57344
    ds_read_b64_tr_b16 v[130:131], v222 offset:57856
    v_mfma_f32_16x16x32_bf16 v[88:91], v[148:151], a[88:91], v[88:91]
    v_cvt_pk_bf16_f32 v171, v198, v199
    v_mfma_f32_16x16x32_bf16 v[84:87], v[148:151], a[84:87], v[84:87]
    buffer_store_dwordx4 v[168:171], v234, s[12:15], s22 offen offset:2048 sc1
    v_mfma_f32_16x16x32_bf16 v[80:83], v[148:151], a[80:83], v[80:83]
    s_waitcnt lgkmcnt(2)
    v_mfma_f32_16x16x32_bf16 v[96:99], v[152:155], a[80:83], v[96:99]
    ds_read_b64_tr_b16 v[132:133], v223 offset:57344
    ds_read_b64_tr_b16 v[134:135], v223 offset:57856
    v_mfma_f32_16x16x32_bf16 v[100:103], v[152:155], a[84:87], v[100:103]
    v_mul_f32 v200, s20, v12
    v_mfma_f32_16x16x32_bf16 v[104:107], v[152:155], a[88:91], v[104:107]
    v_mul_f32 v201, s20, v13
    v_mfma_f32_16x16x32_bf16 v[108:111], v[152:155], a[92:95], v[108:111]
    v_cvt_pk_bf16_f32 v172, v200, v201
    v_mfma_f32_16x16x32_bf16 v[124:127], v[156:159], a[92:95], v[124:127]
    ds_read_b64_tr_b16 v[136:137], v224 offset:57344
    ds_read_b64_tr_b16 v[138:139], v224 offset:57856
    v_mfma_f32_16x16x32_bf16 v[120:123], v[156:159], a[88:91], v[120:123]
    v_mul_f32 v202, s20, v14
    v_mfma_f32_16x16x32_bf16 v[116:119], v[156:159], a[84:87], v[116:119]
    v_mul_f32 v203, s20, v15
    v_mfma_f32_16x16x32_bf16 v[112:115], v[156:159], a[80:83], v[112:115]
    s_waitcnt lgkmcnt(2)
    v_mfma_f32_16x16x32_bf16 v[64:67], v[128:131], a[96:99], v[64:67]
    ds_read_b64_tr_b16 v[140:141], v225 offset:57344
    ds_read_b64_tr_b16 v[142:143], v225 offset:57856
    v_mfma_f32_16x16x32_bf16 v[68:71], v[128:131], a[100:103], v[68:71]
    v_cvt_pk_bf16_f32 v173, v202, v203
    v_mul_f32 v204, s20, v28
    v_mfma_f32_16x16x32_bf16 v[72:75], v[128:131], a[104:107], v[72:75]
    v_mfma_f32_16x16x32_bf16 v[76:79], v[128:131], a[108:111], v[76:79]
    v_mul_f32 v205, s20, v29
    v_mfma_f32_16x16x32_bf16 v[92:95], v[132:135], a[108:111], v[92:95]
    ds_read_b64_tr_b16 v[144:145], v222 offset:61440
    ds_read_b64_tr_b16 v[146:147], v222 offset:61952
    v_mfma_f32_16x16x32_bf16 v[88:91], v[132:135], a[104:107], v[88:91]
    v_cvt_pk_bf16_f32 v174, v204, v205
    v_mfma_f32_16x16x32_bf16 v[84:87], v[132:135], a[100:103], v[84:87]
    v_mul_f32 v206, s20, v30
    v_mfma_f32_16x16x32_bf16 v[80:83], v[132:135], a[96:99], v[80:83]
    s_waitcnt lgkmcnt(2)
    v_mul_f32 v207, s20, v31
    v_mfma_f32_16x16x32_bf16 v[96:99], v[136:139], a[96:99], v[96:99]
    ds_read_b64_tr_b16 v[148:149], v223 offset:61440
    ds_read_b64_tr_b16 v[150:151], v223 offset:61952
    v_mfma_f32_16x16x32_bf16 v[100:103], v[136:139], a[100:103], v[100:103]
    v_cvt_pk_bf16_f32 v175, v206, v207
    v_mfma_f32_16x16x32_bf16 v[104:107], v[136:139], a[104:107], v[104:107]
    buffer_store_dwordx4 v[172:175], v234, s[12:15], s22 offen offset:3072 sc1
    v_mfma_f32_16x16x32_bf16 v[108:111], v[136:139], a[108:111], v[108:111]
    v_mfma_f32_16x16x32_bf16 v[124:127], v[140:143], a[108:111], v[124:127]
    ds_read_b64_tr_b16 v[152:153], v224 offset:61440
    ds_read_b64_tr_b16 v[154:155], v224 offset:61952
    v_mfma_f32_16x16x32_bf16 v[120:123], v[140:143], a[104:107], v[120:123]
    v_mfma_f32_16x16x32_bf16 v[116:119], v[140:143], a[100:103], v[116:119]
    v_mfma_f32_16x16x32_bf16 v[112:115], v[140:143], a[96:99], v[112:115]
    s_waitcnt lgkmcnt(2)
    v_mfma_f32_16x16x32_bf16 v[64:67], v[144:147], a[112:115], v[64:67]
    ds_read_b64_tr_b16 v[156:157], v225 offset:61440
    ds_read_b64_tr_b16 v[158:159], v225 offset:61952
    v_mfma_f32_16x16x32_bf16 v[68:71], v[144:147], a[116:119], v[68:71]
    v_mfma_f32_16x16x32_bf16 v[72:75], v[144:147], a[120:123], v[72:75]
    s_waitcnt vmcnt(16)
    s_barrier
    v_mfma_f32_16x16x32_bf16 v[76:79], v[144:147], a[124:127], v[76:79]
    v_mfma_f32_16x16x32_bf16 v[92:95], v[148:151], a[124:127], v[92:95]
    s_add_u32 m0, s38, 0
    ds_read_b64_tr_b16 v[128:129], v226 offset:32768
    ds_read_b64_tr_b16 v[130:131], v226 offset:33280
    v_mfma_f32_16x16x32_bf16 v[88:91], v[148:151], a[120:123], v[88:91]
    s_add_u32 s27, s23, s96
    v_mfma_f32_16x16x32_bf16 v[84:87], v[148:151], a[116:119], v[84:87]
    buffer_load_dwordx4 v238, s[8:11], s27 offen lds
    v_mfma_f32_16x16x32_bf16 v[80:83], v[148:151], a[112:115], v[80:83]
    s_waitcnt lgkmcnt(2)
    s_add_u32 m0, s38, 1024
    s_add_u32 s27, s27, s36
    v_mfma_f32_16x16x32_bf16 v[96:99], v[152:155], a[112:115], v[96:99]
    ds_read_b64_tr_b16 v[132:133], v227 offset:32768
    ds_read_b64_tr_b16 v[134:135], v227 offset:33280
    v_mfma_f32_16x16x32_bf16 v[100:103], v[152:155], a[116:119], v[100:103]
    buffer_load_dwordx4 v239, s[8:11], s27 offen lds
    v_mfma_f32_16x16x32_bf16 v[104:107], v[152:155], a[120:123], v[104:107]
    s_add_u32 m0, s38, 2048
    v_mfma_f32_16x16x32_bf16 v[108:111], v[152:155], a[124:127], v[108:111]
    s_add_u32 s27, s27, s36
    v_mfma_f32_16x16x32_bf16 v[124:127], v[156:159], a[124:127], v[124:127]
    ds_read_b64_tr_b16 v[136:137], v228 offset:32768
    ds_read_b64_tr_b16 v[138:139], v228 offset:33280
    v_mfma_f32_16x16x32_bf16 v[120:123], v[156:159], a[120:123], v[120:123]
    buffer_load_dwordx4 v238, s[8:11], s27 offen lds
    v_mfma_f32_16x16x32_bf16 v[116:119], v[156:159], a[116:119], v[116:119]
    s_add_u32 m0, s38, 3072
    s_add_u32 s27, s27, s36
    v_mfma_f32_16x16x32_bf16 v[112:115], v[156:159], a[112:115], v[112:115]
    s_waitcnt lgkmcnt(2)
    v_mfma_f32_16x16x32_bf16 v[64:67], v[128:131], a[128:131], v[64:67]
    ds_read_b64_tr_b16 v[140:141], v229 offset:32768
    ds_read_b64_tr_b16 v[142:143], v229 offset:33280
    v_mfma_f32_16x16x32_bf16 v[68:71], v[128:131], a[132:135], v[68:71]
    buffer_load_dwordx4 v239, s[8:11], s27 offen lds
    v_mfma_f32_16x16x32_bf16 v[72:75], v[128:131], a[136:139], v[72:75]
    s_add_u32 m0, s38, 4096
    s_add_u32 s27, s27, s36
    v_mfma_f32_16x16x32_bf16 v[76:79], v[128:131], a[140:143], v[76:79]
    buffer_load_dwordx4 v238, s[8:11], s27 offen lds
    v_mfma_f32_16x16x32_bf16 v[92:95], v[132:135], a[140:143], v[92:95]
    s_add_u32 m0, s38, 5120
    ds_read_b64_tr_b16 v[144:145], v226 offset:36864
    ds_read_b64_tr_b16 v[146:147], v226 offset:37376
    v_mfma_f32_16x16x32_bf16 v[88:91], v[132:135], a[136:139], v[88:91]
    s_add_u32 s27, s27, s36
    s_lshr_b32 s22, s19, 2
    s_lshl_b32 s22, s22, 19
    v_mfma_f32_16x16x32_bf16 v[84:87], v[132:135], a[132:135], v[84:87]
    buffer_load_dwordx4 v239, s[8:11], s27 offen lds
    v_mfma_f32_16x16x32_bf16 v[80:83], v[132:135], a[128:131], v[80:83]
    s_waitcnt lgkmcnt(2)
    s_add_u32 m0, s38, 6144
    s_add_u32 s27, s27, s36
    v_mfma_f32_16x16x32_bf16 v[96:99], v[136:139], a[128:131], v[96:99]
    s_and_b32 s26, s19, 3
    ds_read_b64_tr_b16 v[148:149], v227 offset:36864
    ds_read_b64_tr_b16 v[150:151], v227 offset:37376
    v_mfma_f32_16x16x32_bf16 v[100:103], v[136:139], a[132:135], v[100:103]
    buffer_load_dwordx4 v238, s[8:11], s27 offen lds
    v_mfma_f32_16x16x32_bf16 v[104:107], v[136:139], a[136:139], v[104:107]
    s_add_u32 m0, s38, 7168
    s_add_u32 s27, s27, s36
    s_lshl_b32 s26, s26, 12
    v_mfma_f32_16x16x32_bf16 v[108:111], v[136:139], a[140:143], v[108:111]
    buffer_load_dwordx4 v239, s[8:11], s27 offen lds
    v_mfma_f32_16x16x32_bf16 v[124:127], v[140:143], a[140:143], v[124:127]
    s_add_u32 s22, s22, s26
    ds_read_b64_tr_b16 v[152:153], v228 offset:36864
    ds_read_b64_tr_b16 v[154:155], v228 offset:37376
    v_mfma_f32_16x16x32_bf16 v[120:123], v[140:143], a[136:139], v[120:123]
    s_add_u32 s23, s23, 128
    s_add_u32 s22, s22, s32
    s_add_u32 s19, s19, 1
    v_mfma_f32_16x16x32_bf16 v[116:119], v[140:143], a[132:135], v[116:119]
    v_mfma_f32_16x16x32_bf16 v[112:115], v[140:143], a[128:131], v[112:115]
    s_waitcnt lgkmcnt(2)
    v_mul_f32 v192, s20, v32
    v_mfma_f32_16x16x32_bf16 v[64:67], v[144:147], a[144:147], v[64:67]
    ds_read_b64_tr_b16 v[156:157], v229 offset:36864
    ds_read_b64_tr_b16 v[158:159], v229 offset:37376
    v_mfma_f32_16x16x32_bf16 v[68:71], v[144:147], a[148:151], v[68:71]
    v_mul_f32 v193, s20, v33
    v_mfma_f32_16x16x32_bf16 v[72:75], v[144:147], a[152:155], v[72:75]
    v_cvt_pk_bf16_f32 v176, v192, v193
    v_mfma_f32_16x16x32_bf16 v[76:79], v[144:147], a[156:159], v[76:79]
    v_mfma_f32_16x16x32_bf16 v[92:95], v[148:151], a[156:159], v[92:95]
    ds_read_b64_tr_b16 v[128:129], v226 offset:40960
    ds_read_b64_tr_b16 v[130:131], v226 offset:41472
    v_mfma_f32_16x16x32_bf16 v[88:91], v[148:151], a[152:155], v[88:91]
    v_mul_f32 v194, s20, v34
    v_mfma_f32_16x16x32_bf16 v[84:87], v[148:151], a[148:151], v[84:87]
    v_mul_f32 v195, s20, v35
    v_mfma_f32_16x16x32_bf16 v[80:83], v[148:151], a[144:147], v[80:83]
    s_waitcnt lgkmcnt(2)
    v_cvt_pk_bf16_f32 v177, v194, v195
    v_mfma_f32_16x16x32_bf16 v[96:99], v[152:155], a[144:147], v[96:99]
    ds_read_b64_tr_b16 v[132:133], v227 offset:40960
    ds_read_b64_tr_b16 v[134:135], v227 offset:41472
    v_mfma_f32_16x16x32_bf16 v[100:103], v[152:155], a[148:151], v[100:103]
    v_mul_f32 v196, s20, v48
    v_mfma_f32_16x16x32_bf16 v[104:107], v[152:155], a[152:155], v[104:107]
    v_mfma_f32_16x16x32_bf16 v[108:111], v[152:155], a[156:159], v[108:111]
    v_mul_f32 v197, s20, v49
    v_mfma_f32_16x16x32_bf16 v[124:127], v[156:159], a[156:159], v[124:127]
    ds_read_b64_tr_b16 v[136:137], v228 offset:40960
    ds_read_b64_tr_b16 v[138:139], v228 offset:41472
    v_mfma_f32_16x16x32_bf16 v[120:123], v[156:159], a[152:155], v[120:123]
    v_cvt_pk_bf16_f32 v178, v196, v197
    v_mfma_f32_16x16x32_bf16 v[116:119], v[156:159], a[148:151], v[116:119]
    v_mul_f32 v198, s20, v50
    v_mfma_f32_16x16x32_bf16 v[112:115], v[156:159], a[144:147], v[112:115]
    s_waitcnt lgkmcnt(2)
    v_mfma_f32_16x16x32_bf16 v[64:67], v[128:131], a[160:163], v[64:67]
    ds_read_b64_tr_b16 v[140:141], v229 offset:40960
    ds_read_b64_tr_b16 v[142:143], v229 offset:41472
    v_mfma_f32_16x16x32_bf16 v[68:71], v[128:131], a[164:167], v[68:71]
    v_mul_f32 v199, s20, v51
    v_cvt_pk_bf16_f32 v179, v198, v199
    v_mfma_f32_16x16x32_bf16 v[72:75], v[128:131], a[168:171], v[72:75]
    v_mfma_f32_16x16x32_bf16 v[76:79], v[128:131], a[172:175], v[76:79]
    buffer_store_dwordx4 v[176:179], v234, s[12:15], s22 offen offset:0 sc1
    v_mfma_f32_16x16x32_bf16 v[92:95], v[132:135], a[172:175], v[92:95]
    ds_read_b64_tr_b16 v[144:145], v226 offset:45056
    ds_read_b64_tr_b16 v[146:147], v226 offset:45568
    v_mfma_f32_16x16x32_bf16 v[88:91], v[132:135], a[168:171], v[88:91]
    v_mfma_f32_16x16x32_bf16 v[84:87], v[132:135], a[164:167], v[84:87]
    v_mul_f32 v200, s20, v36
    v_mfma_f32_16x16x32_bf16 v[80:83], v[132:135], a[160:163], v[80:83]
    s_waitcnt lgkmcnt(2)
    v_mfma_f32_16x16x32_bf16 v[96:99], v[136:139], a[160:163], v[96:99]
    ds_read_b64_tr_b16 v[148:149], v227 offset:45056
    ds_read_b64_tr_b16 v[150:151], v227 offset:45568
    v_mfma_f32_16x16x32_bf16 v[100:103], v[136:139], a[164:167], v[100:103]
    v_mul_f32 v201, s20, v37
    v_cvt_pk_bf16_f32 v180, v200, v201
    v_mfma_f32_16x16x32_bf16 v[104:107], v[136:139], a[168:171], v[104:107]
    v_mfma_f32_16x16x32_bf16 v[108:111], v[136:139], a[172:175], v[108:111]
    v_mul_f32 v202, s20, v38
    v_mfma_f32_16x16x32_bf16 v[124:127], v[140:143], a[172:175], v[124:127]
    ds_read_b64_tr_b16 v[152:153], v228 offset:45056
    ds_read_b64_tr_b16 v[154:155], v228 offset:45568
    v_mfma_f32_16x16x32_bf16 v[120:123], v[140:143], a[168:171], v[120:123]
    v_mul_f32 v203, s20, v39
    v_mfma_f32_16x16x32_bf16 v[116:119], v[140:143], a[164:167], v[116:119]
    v_cvt_pk_bf16_f32 v181, v202, v203
    v_mfma_f32_16x16x32_bf16 v[112:115], v[140:143], a[160:163], v[112:115]
    s_waitcnt lgkmcnt(2)
    v_mfma_f32_16x16x32_bf16 v[64:67], v[144:147], a[176:179], v[64:67]
    ds_read_b64_tr_b16 v[156:157], v229 offset:45056
    ds_read_b64_tr_b16 v[158:159], v229 offset:45568
    v_mfma_f32_16x16x32_bf16 v[68:71], v[144:147], a[180:183], v[68:71]
    v_mul_f32 v204, s20, v52
    v_mfma_f32_16x16x32_bf16 v[72:75], v[144:147], a[184:187], v[72:75]
    v_mul_f32 v205, s20, v53
    v_mfma_f32_16x16x32_bf16 v[76:79], v[144:147], a[188:191], v[76:79]
    v_cvt_pk_bf16_f32 v182, v204, v205
    v_mfma_f32_16x16x32_bf16 v[92:95], v[148:151], a[188:191], v[92:95]
    ds_read_b64_tr_b16 v[128:129], v226 offset:49152
    ds_read_b64_tr_b16 v[130:131], v226 offset:49664
    v_mfma_f32_16x16x32_bf16 v[88:91], v[148:151], a[184:187], v[88:91]
    v_mul_f32 v206, s20, v54
    v_mfma_f32_16x16x32_bf16 v[84:87], v[148:151], a[180:183], v[84:87]
    v_mfma_f32_16x16x32_bf16 v[80:83], v[148:151], a[176:179], v[80:83]
    s_waitcnt lgkmcnt(2)
    v_mul_f32 v207, s20, v55
    v_mfma_f32_16x16x32_bf16 v[96:99], v[152:155], a[176:179], v[96:99]
    ds_read_b64_tr_b16 v[132:133], v227 offset:49152
    ds_read_b64_tr_b16 v[134:135], v227 offset:49664
    v_mfma_f32_16x16x32_bf16 v[100:103], v[152:155], a[180:183], v[100:103]
    v_cvt_pk_bf16_f32 v183, v206, v207
    v_mfma_f32_16x16x32_bf16 v[104:107], v[152:155], a[184:187], v[104:107]
    buffer_store_dwordx4 v[180:183], v234, s[12:15], s22 offen offset:1024 sc1
    v_mfma_f32_16x16x32_bf16 v[108:111], v[152:155], a[188:191], v[108:111]
    v_mfma_f32_16x16x32_bf16 v[124:127], v[156:159], a[188:191], v[124:127]
    ds_read_b64_tr_b16 v[136:137], v228 offset:49152
    ds_read_b64_tr_b16 v[138:139], v228 offset:49664
    v_mfma_f32_16x16x32_bf16 v[120:123], v[156:159], a[184:187], v[120:123]
    v_mul_f32 v192, s20, v40
    v_mfma_f32_16x16x32_bf16 v[116:119], v[156:159], a[180:183], v[116:119]
    v_mfma_f32_16x16x32_bf16 v[112:115], v[156:159], a[176:179], v[112:115]
    s_waitcnt lgkmcnt(2)
    v_mul_f32 v193, s20, v41
    v_mfma_f32_16x16x32_bf16 v[64:67], v[128:131], a[192:195], v[64:67]
    ds_read_b64_tr_b16 v[140:141], v229 offset:49152
    ds_read_b64_tr_b16 v[142:143], v229 offset:49664
    v_mfma_f32_16x16x32_bf16 v[68:71], v[128:131], a[196:199], v[68:71]
    v_cvt_pk_bf16_f32 v184, v192, v193
    v_mfma_f32_16x16x32_bf16 v[72:75], v[128:131], a[200:203], v[72:75]
    v_mul_f32 v194, s20, v42
    v_mfma_f32_16x16x32_bf16 v[76:79], v[128:131], a[204:207], v[76:79]
    v_mfma_f32_16x16x32_bf16 v[92:95], v[132:135], a[204:207], v[92:95]
    ds_read_b64_tr_b16 v[144:145], v226 offset:53248
    ds_read_b64_tr_b16 v[146:147], v226 offset:53760
    v_mfma_f32_16x16x32_bf16 v[88:91], v[132:135], a[200:203], v[88:91]
    v_mul_f32 v195, s20, v43
    v_mfma_f32_16x16x32_bf16 v[84:87], v[132:135], a[196:199], v[84:87]
    v_cvt_pk_bf16_f32 v185, v194, v195
    v_mfma_f32_16x16x32_bf16 v[80:83], v[132:135], a[192:195], v[80:83]
    s_waitcnt lgkmcnt(2)
    v_mul_f32 v196, s20, v56
    v_mfma_f32_16x16x32_bf16 v[96:99], v[136:139], a[192:195], v[96:99]
    ds_read_b64_tr_b16 v[148:149], v227 offset:53248
    ds_read_b64_tr_b16 v[150:151], v227 offset:53760
    v_mfma_f32_16x16x32_bf16 v[100:103], v[136:139], a[196:199], v[100:103]
    v_mul_f32 v197, s20, v57
    v_mfma_f32_16x16x32_bf16 v[104:107], v[136:139], a[200:203], v[104:107]
    v_cvt_pk_bf16_f32 v186, v196, v197
    v_mfma_f32_16x16x32_bf16 v[108:111], v[136:139], a[204:207], v[108:111]
    v_mfma_f32_16x16x32_bf16 v[124:127], v[140:143], a[204:207], v[124:127]
    ds_read_b64_tr_b16 v[152:153], v228 offset:53248
    ds_read_b64_tr_b16 v[154:155], v228 offset:53760
    v_mfma_f32_16x16x32_bf16 v[120:123], v[140:143], a[200:203], v[120:123]
    v_mul_f32 v198, s20, v58
    v_mfma_f32_16x16x32_bf16 v[116:119], v[140:143], a[196:199], v[116:119]
    v_mul_f32 v199, s20, v59
    v_mfma_f32_16x16x32_bf16 v[112:115], v[140:143], a[192:195], v[112:115]
    s_waitcnt lgkmcnt(2)
    v_cvt_pk_bf16_f32 v187, v198, v199
    v_mfma_f32_16x16x32_bf16 v[64:67], v[144:147], a[208:211], v[64:67]
    ds_read_b64_tr_b16 v[156:157], v229 offset:53248
    ds_read_b64_tr_b16 v[158:159], v229 offset:53760
    v_mfma_f32_16x16x32_bf16 v[68:71], v[144:147], a[212:215], v[68:71]
    buffer_store_dwordx4 v[184:187], v234, s[12:15], s22 offen offset:2048 sc1
    v_mfma_f32_16x16x32_bf16 v[72:75], v[144:147], a[216:219], v[72:75]
    v_mfma_f32_16x16x32_bf16 v[76:79], v[144:147], a[220:223], v[76:79]
    v_mfma_f32_16x16x32_bf16 v[92:95], v[148:151], a[220:223], v[92:95]
    ds_read_b64_tr_b16 v[128:129], v226 offset:57344
    ds_read_b64_tr_b16 v[130:131], v226 offset:57856
    v_mfma_f32_16x16x32_bf16 v[88:91], v[148:151], a[216:219], v[88:91]
    v_mul_f32 v200, s20, v44
    v_mfma_f32_16x16x32_bf16 v[84:87], v[148:151], a[212:215], v[84:87]
    v_mul_f32 v201, s20, v45
    v_mfma_f32_16x16x32_bf16 v[80:83], v[148:151], a[208:211], v[80:83]
    s_waitcnt lgkmcnt(2)
    v_mfma_f32_16x16x32_bf16 v[96:99], v[152:155], a[208:211], v[96:99]
    ds_read_b64_tr_b16 v[132:133], v227 offset:57344
    ds_read_b64_tr_b16 v[134:135], v227 offset:57856
    v_mfma_f32_16x16x32_bf16 v[100:103], v[152:155], a[212:215], v[100:103]
    v_cvt_pk_bf16_f32 v188, v200, v201
    v_mul_f32 v202, s20, v46
    v_mfma_f32_16x16x32_bf16 v[104:107], v[152:155], a[216:219], v[104:107]
    v_mfma_f32_16x16x32_bf16 v[108:111], v[152:155], a[220:223], v[108:111]
    v_mul_f32 v203, s20, v47
    v_mfma_f32_16x16x32_bf16 v[124:127], v[156:159], a[220:223], v[124:127]
    ds_read_b64_tr_b16 v[136:137], v228 offset:57344
    ds_read_b64_tr_b16 v[138:139], v228 offset:57856
    v_mfma_f32_16x16x32_bf16 v[120:123], v[156:159], a[216:219], v[120:123]
    v_cvt_pk_bf16_f32 v189, v202, v203
    v_mfma_f32_16x16x32_bf16 v[116:119], v[156:159], a[212:215], v[116:119]
    v_mul_f32 v204, s20, v60
    v_mfma_f32_16x16x32_bf16 v[112:115], v[156:159], a[208:211], v[112:115]
    s_waitcnt lgkmcnt(2)
    v_mfma_f32_16x16x32_bf16 v[64:67], v[128:131], a[224:227], v[64:67]
    ds_read_b64_tr_b16 v[140:141], v229 offset:57344
    ds_read_b64_tr_b16 v[142:143], v229 offset:57856
    v_mfma_f32_16x16x32_bf16 v[68:71], v[128:131], a[228:231], v[68:71]
    v_mul_f32 v205, s20, v61
    v_mfma_f32_16x16x32_bf16 v[72:75], v[128:131], a[232:235], v[72:75]
    v_cvt_pk_bf16_f32 v190, v204, v205
    v_mfma_f32_16x16x32_bf16 v[76:79], v[128:131], a[236:239], v[76:79]
    v_mul_f32 v206, s20, v62
    v_mfma_f32_16x16x32_bf16 v[92:95], v[132:135], a[236:239], v[92:95]
    ds_read_b64_tr_b16 v[144:145], v226 offset:61440
    ds_read_b64_tr_b16 v[146:147], v226 offset:61952
    v_mfma_f32_16x16x32_bf16 v[88:91], v[132:135], a[232:235], v[88:91]
    v_mul_f32 v207, s20, v63
    v_mfma_f32_16x16x32_bf16 v[84:87], v[132:135], a[228:231], v[84:87]
    v_mfma_f32_16x16x32_bf16 v[80:83], v[132:135], a[224:227], v[80:83]
    s_waitcnt lgkmcnt(2)
    v_cvt_pk_bf16_f32 v191, v206, v207
    v_mfma_f32_16x16x32_bf16 v[96:99], v[136:139], a[224:227], v[96:99]
    ds_read_b64_tr_b16 v[148:149], v227 offset:61440
    ds_read_b64_tr_b16 v[150:151], v227 offset:61952
    v_mfma_f32_16x16x32_bf16 v[100:103], v[136:139], a[228:231], v[100:103]
    buffer_store_dwordx4 v[188:191], v234, s[12:15], s22 offen offset:3072 sc1
    v_mfma_f32_16x16x32_bf16 v[104:107], v[136:139], a[232:235], v[104:107]
    v_mfma_f32_16x16x32_bf16 v[108:111], v[136:139], a[236:239], v[108:111]
    v_mfma_f32_16x16x32_bf16 v[124:127], v[140:143], a[236:239], v[124:127]
    ds_read_b64_tr_b16 v[152:153], v228 offset:61440
    ds_read_b64_tr_b16 v[154:155], v228 offset:61952
    v_mfma_f32_16x16x32_bf16 v[120:123], v[140:143], a[232:235], v[120:123]
    v_mfma_f32_16x16x32_bf16 v[116:119], v[140:143], a[228:231], v[116:119]
    v_mfma_f32_16x16x32_bf16 v[112:115], v[140:143], a[224:227], v[112:115]
    s_waitcnt lgkmcnt(2)
    v_mfma_f32_16x16x32_bf16 v[64:67], v[144:147], a[240:243], v[64:67]
    ds_read_b64_tr_b16 v[156:157], v229 offset:61440
    ds_read_b64_tr_b16 v[158:159], v229 offset:61952
    v_mfma_f32_16x16x32_bf16 v[68:71], v[144:147], a[244:247], v[68:71]
    v_mfma_f32_16x16x32_bf16 v[72:75], v[144:147], a[248:251], v[72:75]
    s_waitcnt vmcnt(16)
    s_barrier
    v_mfma_f32_16x16x32_bf16 v[76:79], v[144:147], a[252:255], v[76:79]
    v_mfma_f32_16x16x32_bf16 v[92:95], v[148:151], a[252:255], v[92:95]
    ds_read_b64_tr_b16 v[128:129], v226 offset:0
    ds_read_b64_tr_b16 v[130:131], v226 offset:512
    v_mfma_f32_16x16x32_bf16 v[88:91], v[148:151], a[248:251], v[88:91]
    v_mfma_f32_16x16x32_bf16 v[84:87], v[148:151], a[244:247], v[84:87]
    v_mfma_f32_16x16x32_bf16 v[80:83], v[148:151], a[240:243], v[80:83]
    s_waitcnt lgkmcnt(2)
    v_mfma_f32_16x16x32_bf16 v[96:99], v[152:155], a[240:243], v[96:99]
    ds_read_b64_tr_b16 v[132:133], v227 offset:0
    ds_read_b64_tr_b16 v[134:135], v227 offset:512
    v_mfma_f32_16x16x32_bf16 v[100:103], v[152:155], a[244:247], v[100:103]
    v_mfma_f32_16x16x32_bf16 v[104:107], v[152:155], a[248:251], v[104:107]
    v_mfma_f32_16x16x32_bf16 v[108:111], v[152:155], a[252:255], v[108:111]
    v_mfma_f32_16x16x32_bf16 v[124:127], v[156:159], a[252:255], v[124:127]
    ds_read_b64_tr_b16 v[136:137], v228 offset:0
    ds_read_b64_tr_b16 v[138:139], v228 offset:512
    v_mfma_f32_16x16x32_bf16 v[120:123], v[156:159], a[248:251], v[120:123]
    v_mfma_f32_16x16x32_bf16 v[116:119], v[156:159], a[244:247], v[116:119]
    v_mfma_f32_16x16x32_bf16 v[112:115], v[156:159], a[240:243], v[112:115]
    s_mov_b32 s29, 1
    s_lshl_b32 s23, s97, 6
    v_and_b32 v238, 0xffffffbf, v238
    v_and_b32 v239, 0xffffffbf, v239
    s_branch K1_loop_11
K1_done_12:
    ds_read_b64_tr_b16 v[144:145], v222 offset:36864
    ds_read_b64_tr_b16 v[146:147], v222 offset:37376
    s_waitcnt lgkmcnt(6)
    v_mfma_f32_16x16x32_bf16 v[64:67], v[128:131], a[0:3], 0
    ds_read_b64_tr_b16 v[148:149], v223 offset:36864
    ds_read_b64_tr_b16 v[150:151], v223 offset:37376
    v_mfma_f32_16x16x32_bf16 v[68:71], v[128:131], a[4:7], 0
    v_mfma_f32_16x16x32_bf16 v[72:75], v[128:131], a[8:11], 0
    v_mfma_f32_16x16x32_bf16 v[76:79], v[128:131], a[12:15], 0
    s_waitcnt lgkmcnt(6)
    v_mfma_f32_16x16x32_bf16 v[92:95], v[132:135], a[12:15], 0
    ds_read_b64_tr_b16 v[128:129], v222 offset:40960
    ds_read_b64_tr_b16 v[130:131], v222 offset:41472
    v_mfma_f32_16x16x32_bf16 v[88:91], v[132:135], a[8:11], 0
    v_mfma_f32_16x16x32_bf16 v[84:87], v[132:135], a[4:7], 0
    v_mfma_f32_16x16x32_bf16 v[80:83], v[132:135], a[0:3], 0
    s_waitcnt lgkmcnt(4)
    v_mfma_f32_16x16x32_bf16 v[64:67], v[144:147], a[16:19], v[64:67]
    s_lshr_b32 s22, s19, 2
    ds_read_b64_tr_b16 v[132:133], v223 offset:40960
    ds_read_b64_tr_b16 v[134:135], v223 offset:41472
    v_mfma_f32_16x16x32_bf16 v[68:71], v[144:147], a[20:23], v[68:71]
    s_lshl_b32 s22, s22, 19
    s_and_b32 s26, s19, 3
    v_mfma_f32_16x16x32_bf16 v[72:75], v[144:147], a[24:27], v[72:75]
    s_lshl_b32 s26, s26, 12
    v_mfma_f32_16x16x32_bf16 v[76:79], v[144:147], a[28:31], v[76:79]
    s_waitcnt lgkmcnt(4)
    s_add_u32 s22, s22, s26
    v_mfma_f32_16x16x32_bf16 v[92:95], v[148:151], a[28:31], v[92:95]
    s_add_u32 s22, s22, s32
    ds_read_b64_tr_b16 v[144:145], v222 offset:45056
    ds_read_b64_tr_b16 v[146:147], v222 offset:45568
    v_mfma_f32_16x16x32_bf16 v[88:91], v[148:151], a[24:27], v[88:91]
    s_add_u32 s19, s19, 1
    v_mfma_f32_16x16x32_bf16 v[84:87], v[148:151], a[20:23], v[84:87]
    v_mul_f32 v192, s20, v0
    v_mfma_f32_16x16x32_bf16 v[80:83], v[148:151], a[16:19], v[80:83]
    s_waitcnt lgkmcnt(4)
    v_mul_f32 v193, s20, v1
    v_mfma_f32_16x16x32_bf16 v[64:67], v[128:131], a[32:35], v[64:67]
    ds_read_b64_tr_b16 v[148:149], v223 offset:45056
    ds_read_b64_tr_b16 v[150:151], v223 offset:45568
    v_mfma_f32_16x16x32_bf16 v[68:71], v[128:131], a[36:39], v[68:71]
    v_cvt_pk_bf16_f32 v160, v192, v193
    v_mul_f32 v194, s20, v2
    v_mfma_f32_16x16x32_bf16 v[72:75], v[128:131], a[40:43], v[72:75]
    v_mul_f32 v195, s20, v3
    v_mfma_f32_16x16x32_bf16 v[76:79], v[128:131], a[44:47], v[76:79]
    s_waitcnt lgkmcnt(4)
    v_cvt_pk_bf16_f32 v161, v194, v195
    v_mul_f32 v196, s20, v16
    v_mfma_f32_16x16x32_bf16 v[92:95], v[132:135], a[44:47], v[92:95]
    ds_read_b64_tr_b16 v[128:129], v222 offset:49152
    ds_read_b64_tr_b16 v[130:131], v222 offset:49664
    v_mfma_f32_16x16x32_bf16 v[88:91], v[132:135], a[40:43], v[88:91]
    v_mul_f32 v197, s20, v17
    v_cvt_pk_bf16_f32 v162, v196, v197
    v_mfma_f32_16x16x32_bf16 v[84:87], v[132:135], a[36:39], v[84:87]
    v_mul_f32 v198, s20, v18
    v_mfma_f32_16x16x32_bf16 v[80:83], v[132:135], a[32:35], v[80:83]
    s_waitcnt lgkmcnt(4)
    v_mul_f32 v199, s20, v19
    v_mfma_f32_16x16x32_bf16 v[64:67], v[144:147], a[48:51], v[64:67]
    ds_read_b64_tr_b16 v[132:133], v223 offset:49152
    ds_read_b64_tr_b16 v[134:135], v223 offset:49664
    v_mfma_f32_16x16x32_bf16 v[68:71], v[144:147], a[52:55], v[68:71]
    v_cvt_pk_bf16_f32 v163, v198, v199
    v_mfma_f32_16x16x32_bf16 v[72:75], v[144:147], a[56:59], v[72:75]
    buffer_store_dwordx4 v[160:163], v234, s[12:15], s22 offen offset:0 sc1
    v_mfma_f32_16x16x32_bf16 v[76:79], v[144:147], a[60:63], v[76:79]
    s_waitcnt lgkmcnt(4)
    v_mul_f32 v200, s20, v4
    v_mfma_f32_16x16x32_bf16 v[92:95], v[148:151], a[60:63], v[92:95]
    ds_read_b64_tr_b16 v[144:145], v222 offset:53248
    ds_read_b64_tr_b16 v[146:147], v222 offset:53760
    v_mfma_f32_16x16x32_bf16 v[88:91], v[148:151], a[56:59], v[88:91]
    v_mul_f32 v201, s20, v5
    v_cvt_pk_bf16_f32 v164, v200, v201
    v_mfma_f32_16x16x32_bf16 v[84:87], v[148:151], a[52:55], v[84:87]
    v_mul_f32 v202, s20, v6
    v_mfma_f32_16x16x32_bf16 v[80:83], v[148:151], a[48:51], v[80:83]
    s_waitcnt lgkmcnt(4)
    v_mul_f32 v203, s20, v7
    v_cvt_pk_bf16_f32 v165, v202, v203
    v_mfma_f32_16x16x32_bf16 v[64:67], v[128:131], a[64:67], v[64:67]
    ds_read_b64_tr_b16 v[148:149], v223 offset:53248
    ds_read_b64_tr_b16 v[150:151], v223 offset:53760
    v_mfma_f32_16x16x32_bf16 v[68:71], v[128:131], a[68:71], v[68:71]
    v_mul_f32 v204, s20, v20
    v_mul_f32 v205, s20, v21
    v_mfma_f32_16x16x32_bf16 v[72:75], v[128:131], a[72:75], v[72:75]
    v_cvt_pk_bf16_f32 v166, v204, v205
    v_mfma_f32_16x16x32_bf16 v[76:79], v[128:131], a[76:79], v[76:79]
    s_waitcnt lgkmcnt(4)
    v_mul_f32 v206, s20, v22
    v_mfma_f32_16x16x32_bf16 v[92:95], v[132:135], a[76:79], v[92:95]
    ds_read_b64_tr_b16 v[128:129], v222 offset:57344
    ds_read_b64_tr_b16 v[130:131], v222 offset:57856
    v_mfma_f32_16x16x32_bf16 v[88:91], v[132:135], a[72:75], v[88:91]
    v_mul_f32 v207, s20, v23
    v_cvt_pk_bf16_f32 v167, v206, v207
    v_mfma_f32_16x16x32_bf16 v[84:87], v[132:135], a[68:71], v[84:87]
    buffer_store_dwordx4 v[164:167], v234, s[12:15], s22 offen offset:1024 sc1
    v_mfma_f32_16x16x32_bf16 v[80:83], v[132:135], a[64:67], v[80:83]
    s_waitcnt lgkmcnt(4)
    v_mfma_f32_16x16x32_bf16 v[64:67], v[144:147], a[80:83], v[64:67]
    ds_read_b64_tr_b16 v[132:133], v223 offset:57344
    ds_read_b64_tr_b16 v[134:135], v223 offset:57856
    v_mfma_f32_16x16x32_bf16 v[68:71], v[144:147], a[84:87], v[68:71]
    v_mul_f32 v192, s20, v8
    v_mul_f32 v193, s20, v9
    v_mfma_f32_16x16x32_bf16 v[72:75], v[144:147], a[88:91], v[72:75]
    v_cvt_pk_bf16_f32 v168, v192, v193
    v_mul_f32 v194, s20, v10
    v_mfma_f32_16x16x32_bf16 v[76:79], v[144:147], a[92:95], v[76:79]
    s_waitcnt lgkmcnt(4)
    v_mul_f32 v195, s20, v11
    v_mfma_f32_16x16x32_bf16 v[92:95], v[148:151], a[92:95], v[92:95]
    ds_read_b64_tr_b16 v[144:145], v222 offset:61440
    ds_read_b64_tr_b16 v[146:147], v222 offset:61952
    v_mfma_f32_16x16x32_bf16 v[88:91], v[148:151], a[88:91], v[88:91]
    v_cvt_pk_bf16_f32 v169, v194, v195
    v_mul_f32 v196, s20, v24
    v_mfma_f32_16x16x32_bf16 v[84:87], v[148:151], a[84:87], v[84:87]
    v_mul_f32 v197, s20, v25
    v_mfma_f32_16x16x32_bf16 v[80:83], v[148:151], a[80:83], v[80:83]
    s_waitcnt lgkmcnt(4)
    v_cvt_pk_bf16_f32 v170, v196, v197
    v_mfma_f32_16x16x32_bf16 v[64:67], v[128:131], a[96:99], v[64:67]
    ds_read_b64_tr_b16 v[148:149], v223 offset:61440
    ds_read_b64_tr_b16 v[150:151], v223 offset:61952
    v_mfma_f32_16x16x32_bf16 v[68:71], v[128:131], a[100:103], v[68:71]
    v_mul_f32 v198, s20, v26
    v_mul_f32 v199, s20, v27
    v_mfma_f32_16x16x32_bf16 v[72:75], v[128:131], a[104:107], v[72:75]
    s_waitcnt vmcnt(6)
    v_cvt_pk_bf16_f32 v171, v198, v199
    s_barrier
    v_mfma_f32_16x16x32_bf16 v[76:79], v[128:131], a[108:111], v[76:79]
    s_waitcnt lgkmcnt(4)
    v_mfma_f32_16x16x32_bf16 v[92:95], v[132:135], a[108:111], v[92:95]
    ds_read_b64_tr_b16 v[128:129], v226 offset:32768
    ds_read_b64_tr_b16 v[130:131], v226 offset:33280
    v_mfma_f32_16x16x32_bf16 v[88:91], v[132:135], a[104:107], v[88:91]
    buffer_store_dwordx4 v[168:171], v234, s[12:15], s22 offen offset:2048 sc1
    v_mfma_f32_16x16x32_bf16 v[84:87], v[132:135], a[100:103], v[84:87]
    v_mul_f32 v200, s20, v12
    v_mul_f32 v201, s20, v13
    v_mfma_f32_16x16x32_bf16 v[80:83], v[132:135], a[96:99], v[80:83]
    s_waitcnt lgkmcnt(4)
    v_cvt_pk_bf16_f32 v172, v200, v201
    v_mul_f32 v202, s20, v14
    v_mfma_f32_16x16x32_bf16 v[64:67], v[144:147], a[112:115], v[64:67]
    ds_read_b64_tr_b16 v[132:133], v227 offset:32768
    ds_read_b64_tr_b16 v[134:135], v227 offset:33280
    v_mfma_f32_16x16x32_bf16 v[68:71], v[144:147], a[116:119], v[68:71]
    v_mul_f32 v203, s20, v15
    v_cvt_pk_bf16_f32 v173, v202, v203
    v_mfma_f32_16x16x32_bf16 v[72:75], v[144:147], a[120:123], v[72:75]
    v_mul_f32 v204, s20, v28
    v_mfma_f32_16x16x32_bf16 v[76:79], v[144:147], a[124:127], v[76:79]
    s_waitcnt lgkmcnt(4)
    v_mul_f32 v205, s20, v29
    v_mfma_f32_16x16x32_bf16 v[92:95], v[148:151], a[124:127], v[92:95]
    ds_read_b64_tr_b16 v[144:145], v226 offset:36864
    ds_read_b64_tr_b16 v[146:147], v226 offset:37376
    v_mfma_f32_16x16x32_bf16 v[88:91], v[148:151], a[120:123], v[88:91]
    v_cvt_pk_bf16_f32 v174, v204, v205
    v_mul_f32 v206, s20, v30
    v_mfma_f32_16x16x32_bf16 v[84:87], v[148:151], a[116:119], v[84:87]
    v_mul_f32 v207, s20, v31
    v_mfma_f32_16x16x32_bf16 v[80:83], v[148:151], a[112:115], v[80:83]
    s_waitcnt lgkmcnt(4)
    v_cvt_pk_bf16_f32 v175, v206, v207
    v_mfma_f32_16x16x32_bf16 v[64:67], v[128:131], a[128:131], v[64:67]
    ds_read_b64_tr_b16 v[148:149], v227 offset:36864
    ds_read_b64_tr_b16 v[150:151], v227 offset:37376
    v_mfma_f32_16x16x32_bf16 v[68:71], v[128:131], a[132:135], v[68:71]
    buffer_store_dwordx4 v[172:175], v234, s[12:15], s22 offen offset:3072 sc1
    v_mfma_f32_16x16x32_bf16 v[72:75], v[128:131], a[136:139], v[72:75]
    s_lshr_b32 s22, s19, 2
    s_lshl_b32 s22, s22, 19
    v_mfma_f32_16x16x32_bf16 v[76:79], v[128:131], a[140:143], v[76:79]
    s_waitcnt lgkmcnt(4)
    s_and_b32 s26, s19, 3
    v_mfma_f32_16x16x32_bf16 v[92:95], v[132:135], a[140:143], v[92:95]
    s_lshl_b32 s26, s26, 12
    ds_read_b64_tr_b16 v[128:129], v226 offset:40960
    ds_read_b64_tr_b16 v[130:131], v226 offset:41472
    v_mfma_f32_16x16x32_bf16 v[88:91], v[132:135], a[136:139], v[88:91]
    s_add_u32 s22, s22, s26
    v_mfma_f32_16x16x32_bf16 v[84:87], v[132:135], a[132:135], v[84:87]
    s_add_u32 s22, s22, s32
    v_mfma_f32_16x16x32_bf16 v[80:83], v[132:135], a[128:131], v[80:83]
    s_waitcnt lgkmcnt(4)
    s_add_u32 s19, s19, 1
    v_mfma_f32_16x16x32_bf16 v[64:67], v[144:147], a[144:147], v[64:67]
    ds_read_b64_tr_b16 v[132:133], v227 offset:40960
    ds_read_b64_tr_b16 v[134:135], v227 offset:41472
    v_mfma_f32_16x16x32_bf16 v[68:71], v[144:147], a[148:151], v[68:71]
    v_mul_f32 v192, s20, v32
    v_mul_f32 v193, s20, v33
    v_mfma_f32_16x16x32_bf16 v[72:75], v[144:147], a[152:155], v[72:75]
    v_cvt_pk_bf16_f32 v176, v192, v193
    v_mfma_f32_16x16x32_bf16 v[76:79], v[144:147], a[156:159], v[76:79]
    s_waitcnt lgkmcnt(4)
    v_mul_f32 v194, s20, v34
    v_mfma_f32_16x16x32_bf16 v[92:95], v[148:151], a[156:159], v[92:95]
    ds_read_b64_tr_b16 v[144:145], v226 offset:45056
    ds_read_b64_tr_b16 v[146:147], v226 offset:45568
    v_mfma_f32_16x16x32_bf16 v[88:91], v[148:151], a[152:155], v[88:91]
    v_mul_f32 v195, s20, v35
    v_cvt_pk_bf16_f32 v177, v194, v195
    v_mfma_f32_16x16x32_bf16 v[84:87], v[148:151], a[148:151], v[84:87]
    v_mul_f32 v196, s20, v48
    v_mul_f32 v197, s20, v49
    v_mfma_f32_16x16x32_bf16 v[80:83], v[148:151], a[144:147], v[80:83]
    s_waitcnt lgkmcnt(4)
    v_cvt_pk_bf16_f32 v178, v196, v197
    v_mfma_f32_16x16x32_bf16 v[64:67], v[128:131], a[160:163], v[64:67]
    ds_read_b64_tr_b16 v[148:149], v227 offset:45056
    ds_read_b64_tr_b16 v[150:151], v227 offset:45568
    v_mfma_f32_16x16x32_bf16 v[68:71], v[128:131], a[164:167], v[68:71]
    v_mul_f32 v198, s20, v50
    v_mul_f32 v199, s20, v51
    v_mfma_f32_16x16x32_bf16 v[72:75], v[128:131], a[168:171], v[72:75]
    v_cvt_pk_bf16_f32 v179, v198, v199
    v_mfma_f32_16x16x32_bf16 v[76:79], v[128:131], a[172:175], v[76:79]
    s_waitcnt lgkmcnt(4)
    v_mfma_f32_16x16x32_bf16 v[92:95], v[132:135], a[172:175], v[92:95]
    ds_read_b64_tr_b16 v[128:129], v226 offset:49152
    ds_read_b64_tr_b16 v[130:131], v226 offset:49664
    v_mfma_f32_16x16x32_bf16 v[88:91], v[132:135], a[168:171], v[88:91]
    buffer_store_dwordx4 v[176:179], v234, s[12:15], s22 offen offset:0 sc1
    v_mfma_f32_16x16x32_bf16 v[84:87], v[132:135], a[164:167], v[84:87]
    v_mul_f32 v200, s20, v36
    v_mul_f32 v201, s20, v37
    v_mfma_f32_16x16x32_bf16 v[80:83], v[132:135], a[160:163], v[80:83]
    s_waitcnt lgkmcnt(4)
    v_cvt_pk_bf16_f32 v180, v200, v201
    v_mfma_f32_16x16x32_bf16 v[64:67], v[144:147], a[176:179], v[64:67]
    ds_read_b64_tr_b16 v[132:133], v227 offset:49152
    ds_read_b64_tr_b16 v[134:135], v227 offset:49664
    v_mfma_f32_16x16x32_bf16 v[68:71], v[144:147], a[180:183], v[68:71]
    v_mul_f32 v202, s20, v38
    v_mul_f32 v203, s20, v39
    v_mfma_f32_16x16x32_bf16 v[72:75], v[144:147], a[184:187], v[72:75]
    v_cvt_pk_bf16_f32 v181, v202, v203
    v_mul_f32 v204, s20, v52
    v_mfma_f32_16x16x32_bf16 v[76:79], v[144:147], a[188:191], v[76:79]
    s_waitcnt lgkmcnt(4)
    v_mul_f32 v205, s20, v53
    v_mfma_f32_16x16x32_bf16 v[92:95], v[148:151], a[188:191], v[92:95]
    ds_read_b64_tr_b16 v[144:145], v226 offset:53248
    ds_read_b64_tr_b16 v[146:147], v226 offset:53760
    v_mfma_f32_16x16x32_bf16 v[88:91], v[148:151], a[184:187], v[88:91]
    v_cvt_pk_bf16_f32 v182, v204, v205
    v_mul_f32 v206, s20, v54
    v_mfma_f32_16x16x32_bf16 v[84:87], v[148:151], a[180:183], v[84:87]
    v_mul_f32 v207, s20, v55
    v_mfma_f32_16x16x32_bf16 v[80:83], v[148:151], a[176:179], v[80:83]
    s_waitcnt lgkmcnt(4)
    v_cvt_pk_bf16_f32 v183, v206, v207
    v_mfma_f32_16x16x32_bf16 v[64:67], v[128:131], a[192:195], v[64:67]
    ds_read_b64_tr_b16 v[148:149], v227 offset:53248
    ds_read_b64_tr_b16 v[150:151], v227 offset:53760
    v_mfma_f32_16x16x32_bf16 v[68:71], v[128:131], a[196:199], v[68:71]
    buffer_store_dwordx4 v[180:183], v234, s[12:15], s22 offen offset:1024 sc1
    v_mfma_f32_16x16x32_bf16 v[72:75], v[128:131], a[200:203], v[72:75]
    v_mul_f32 v192, s20, v40
    v_mfma_f32_16x16x32_bf16 v[76:79], v[128:131], a[204:207], v[76:79]
    s_waitcnt lgkmcnt(4)
    v_mul_f32 v193, s20, v41
    v_mfma_f32_16x16x32_bf16 v[92:95], v[132:135], a[204:207], v[92:95]
    ds_read_b64_tr_b16 v[128:129], v226 offset:57344
    ds_read_b64_tr_b16 v[130:131], v226 offset:57856
    v_mfma_f32_16x16x32_bf16 v[88:91], v[132:135], a[200:203], v[88:91]
    v_cvt_pk_bf16_f32 v184, v192, v193
    v_mul_f32 v194, s20, v42
    v_mfma_f32_16x16x32_bf16 v[84:87], v[132:135], a[196:199], v[84:87]
    v_mul_f32 v195, s20, v43
    v_cvt_pk_bf16_f32 v185, v194, v195
    v_mfma_f32_16x16x32_bf16 v[80:83], v[132:135], a[192:195], v[80:83]
    s_waitcnt lgkmcnt(4)
    v_mul_f32 v196, s20, v56
    v_mfma_f32_16x16x32_bf16 v[64:67], v[144:147], a[208:211], v[64:67]
    ds_read_b64_tr_b16 v[132:133], v227 offset:57344
    ds_read_b64_tr_b16 v[134:135], v227 offset:57856
    v_mfma_f32_16x16x32_bf16 v[68:71], v[144:147], a[212:215], v[68:71]
    v_mul_f32 v197, s20, v57
    v_cvt_pk_bf16_f32 v186, v196, v197
    v_mfma_f32_16x16x32_bf16 v[72:75], v[144:147], a[216:219], v[72:75]
    v_mul_f32 v198, s20, v58
    v_mfma_f32_16x16x32_bf16 v[76:79], v[144:147], a[220:223], v[76:79]
    s_waitcnt lgkmcnt(4)
    v_mul_f32 v199, s20, v59
    v_mfma_f32_16x16x32_bf16 v[92:95], v[148:151], a[220:223], v[92:95]
    ds_read_b64_tr_b16 v[144:145], v226 offset:61440
    ds_read_b64_tr_b16 v[146:147], v226 offset:61952
    v_mfma_f32_16x16x32_bf16 v[88:91], v[148:151], a[216:219], v[88:91]
    v_cvt_pk_bf16_f32 v187, v198, v199
    v_mfma_f32_16x16x32_bf16 v[84:87], v[148:151], a[212:215], v[84:87]
    buffer_store_dwordx4 v[184:187], v234, s[12:15], s22 offen offset:2048 sc1
    v_mfma_f32_16x16x32_bf16 v[80:83], v[148:151], a[208:211], v[80:83]
    s_waitcnt lgkmcnt(4)
    v_mul_f32 v200, s20, v44
    v_mfma_f32_16x16x32_bf16 v[64:67], v[128:131], a[224:227], v[64:67]
    ds_read_b64_tr_b16 v[148:149], v227 offset:61440
    ds_read_b64_tr_b16 v[150:151], v227 offset:61952
    v_mfma_f32_16x16x32_bf16 v[68:71], v[128:131], a[228:231], v[68:71]
    v_mul_f32 v201, s20, v45
    v_cvt_pk_bf16_f32 v188, v200, v201
    v_mfma_f32_16x16x32_bf16 v[72:75], v[128:131], a[232:235], v[72:75]
    v_mul_f32 v202, s20, v46
    v_mul_f32 v203, s20, v47
    v_mfma_f32_16x16x32_bf16 v[76:79], v[128:131], a[236:239], v[76:79]
    s_waitcnt lgkmcnt(4)
    v_cvt_pk_bf16_f32 v189, v202, v203
    v_mfma_f32_16x16x32_bf16 v[92:95], v[132:135], a[236:239], v[92:95]
    v_mul_f32 v204, s20, v60
    v_mfma_f32_16x16x32_bf16 v[88:91], v[132:135], a[232:235], v[88:91]
    v_mul_f32 v205, s20, v61
    v_mfma_f32_16x16x32_bf16 v[84:87], v[132:135], a[228:231], v[84:87]
    v_cvt_pk_bf16_f32 v190, v204, v205
    v_mfma_f32_16x16x32_bf16 v[80:83], v[132:135], a[224:227], v[80:83]
    s_waitcnt lgkmcnt(2)
    v_mul_f32 v206, s20, v62
    v_mfma_f32_16x16x32_bf16 v[64:67], v[144:147], a[240:243], v[64:67]
    v_mul_f32 v207, s20, v63
    v_mfma_f32_16x16x32_bf16 v[68:71], v[144:147], a[244:247], v[68:71]
    v_cvt_pk_bf16_f32 v191, v206, v207
    v_mfma_f32_16x16x32_bf16 v[72:75], v[144:147], a[248:251], v[72:75]
    buffer_store_dwordx4 v[188:191], v234, s[12:15], s22 offen offset:3072 sc1
    v_mfma_f32_16x16x32_bf16 v[76:79], v[144:147], a[252:255], v[76:79]
    s_waitcnt lgkmcnt(0)
    v_mfma_f32_16x16x32_bf16 v[92:95], v[148:151], a[252:255], v[92:95]
    v_mfma_f32_16x16x32_bf16 v[88:91], v[148:151], a[248:251], v[88:91]
    v_mfma_f32_16x16x32_bf16 v[84:87], v[148:151], a[244:247], v[84:87]
    v_mfma_f32_16x16x32_bf16 v[80:83], v[148:151], a[240:243], v[80:83]
    s_mov_b32 s19, s97
    s_nop 3
    s_lshr_b32 s22, s19, 2
    s_lshl_b32 s22, s22, 19
    s_and_b32 s26, s19, 3
    s_lshl_b32 s26, s26, 12
    s_add_u32 s22, s22, s26
    s_add_u32 s22, s22, s32
    s_add_u32 s19, s19, 1
    v_pk_mul_f32 v[192:193], v[64:65], s[20:21] op_sel_hi:[1,0]
    v_cvt_pk_bf16_f32 v160, v192, v193
    v_pk_mul_f32 v[194:195], v[66:67], s[20:21] op_sel_hi:[1,0]
    v_cvt_pk_bf16_f32 v161, v194, v195
    v_pk_mul_f32 v[196:197], v[80:81], s[20:21] op_sel_hi:[1,0]
    v_cvt_pk_bf16_f32 v162, v196, v197
    v_pk_mul_f32 v[198:199], v[82:83], s[20:21] op_sel_hi:[1,0]
    v_cvt_pk_bf16_f32 v163, v198, v199
    buffer_store_dwordx4 v[160:163], v234, s[12:15], s22 offen offset:0 sc1
    v_pk_mul_f32 v[200:201], v[68:69], s[20:21] op_sel_hi:[1,0]
    v_cvt_pk_bf16_f32 v164, v200, v201
    v_pk_mul_f32 v[202:203], v[70:71], s[20:21] op_sel_hi:[1,0]
    v_cvt_pk_bf16_f32 v165, v202, v203
    v_pk_mul_f32 v[204:205], v[84:85], s[20:21] op_sel_hi:[1,0]
    v_cvt_pk_bf16_f32 v166, v204, v205
    v_pk_mul_f32 v[206:207], v[86:87], s[20:21] op_sel_hi:[1,0]
    v_cvt_pk_bf16_f32 v167, v206, v207
    buffer_store_dwordx4 v[164:167], v234, s[12:15], s22 offen offset:1024 sc1
    v_pk_mul_f32 v[192:193], v[72:73], s[20:21] op_sel_hi:[1,0]
    v_cvt_pk_bf16_f32 v168, v192, v193
    v_pk_mul_f32 v[194:195], v[74:75], s[20:21] op_sel_hi:[1,0]
    v_cvt_pk_bf16_f32 v169, v194, v195
    v_pk_mul_f32 v[196:197], v[88:89], s[20:21] op_sel_hi:[1,0]
    v_cvt_pk_bf16_f32 v170, v196, v197
    v_pk_mul_f32 v[198:199], v[90:91], s[20:21] op_sel_hi:[1,0]
    v_cvt_pk_bf16_f32 v171, v198, v199
    buffer_store_dwordx4 v[168:171], v234, s[12:15], s22 offen offset:2048 sc1
    v_pk_mul_f32 v[200:201], v[76:77], s[20:21] op_sel_hi:[1,0]
    v_cvt_pk_bf16_f32 v172, v200, v201
    v_pk_mul_f32 v[202:203], v[78:79], s[20:21] op_sel_hi:[1,0]
    v_cvt_pk_bf16_f32 v173, v202, v203
    v_pk_mul_f32 v[204:205], v[92:93], s[20:21] op_sel_hi:[1,0]
    v_cvt_pk_bf16_f32 v174, v204, v205
    v_pk_mul_f32 v[206:207], v[94:95], s[20:21] op_sel_hi:[1,0]
    v_cvt_pk_bf16_f32 v175, v206, v207
    buffer_store_dwordx4 v[172:175], v234, s[12:15], s22 offen offset:3072 sc1
    s_branch K2_fused_entry
K1_vtype_2:
    s_add_u32 s92, s92, 128
    s_and_b32 s92, s92, 0x3ff
    s_mul_i32 s33, s92, s35
    s_add_u32 m0, s31, 16384
    s_add_u32 s33, s33, s93
    buffer_load_dwordx4 v220, s[8:11], s33 offen offset:0 lds
    buffer_load_dwordx4 v221, s[8:11], s33 offen offset:1024 lds
    buffer_load_dwordx4 v254, s[8:11], s33 offen offset:2048 lds
    buffer_load_dwordx4 v255, s[8:11], s33 offen offset:3072 lds
    s_waitcnt vmcnt(5)
    s_barrier
    ds_read_b128 a[0:3], v216 offset:0
    ds_read_b128 a[4:7], v216 offset:2048
    ds_read_b128 a[8:11], v216 offset:4096
    ds_read_b128 a[12:15], v216 offset:6144
    ds_read_b64_tr_b16 v[128:129], v208 offset:0
    ds_read_b64_tr_b16 v[130:131], v208 offset:1024
    ds_read_b64_tr_b16 v[132:133], v209 offset:0
    ds_read_b64_tr_b16 v[134:135], v209 offset:1024
    ds_read_b64_tr_b16 v[136:137], v210 offset:0
    ds_read_b64_tr_b16 v[138:139], v210 offset:1024
    ds_read_b64_tr_b16 v[140:141], v211 offset:0
    ds_read_b64_tr_b16 v[142:143], v211 offset:1024
    s_waitcnt lgkmcnt(4)
    v_mfma_f32_16x16x32_bf16 v[0:3], a[0:3], v[128:131], 0
    ds_read_b128 a[16:19], v217 offset:0
    ds_read_b128 a[20:23], v217 offset:2048
    ds_read_b64_tr_b16 v[144:145], v212 offset:0
    ds_read_b64_tr_b16 v[146:147], v212 offset:1024
    v_mfma_f32_16x16x32_bf16 v[4:7], a[4:7], v[128:131], 0
    s_add_u32 m0, s30, 8192
    ds_read_b128 a[24:27], v217 offset:4096
    ds_read_b128 a[28:31], v217 offset:6144
    v_mfma_f32_16x16x32_bf16 v[8:11], a[8:11], v[128:131], 0
    s_add_u32 s28, s24, s92
    v_mfma_f32_16x16x32_bf16 v[12:15], a[12:15], v[128:131], 0
    buffer_load_dwordx4 v218, s[4:7], s28 offen offset:0 lds
    v_mfma_f32_16x16x32_bf16 v[28:31], a[12:15], v[132:135], 0
    ds_read_b64_tr_b16 v[148:149], v213 offset:0
    ds_read_b64_tr_b16 v[150:151], v213 offset:1024
    v_mfma_f32_16x16x32_bf16 v[24:27], a[8:11], v[132:135], 0
    buffer_load_dwordx4 v219, s[4:7], s28 offen offset:1024 lds
    v_mfma_f32_16x16x32_bf16 v[20:23], a[4:7], v[132:135], 0
    buffer_load_dwordx4 v252, s[4:7], s28 offen offset:2048 lds
    v_mfma_f32_16x16x32_bf16 v[16:19], a[0:3], v[132:135], 0
    s_waitcnt lgkmcnt(8)
    v_mfma_f32_16x16x32_bf16 v[32:35], a[0:3], v[136:139], 0
    ds_read_b64_tr_b16 v[152:153], v214 offset:0
    ds_read_b64_tr_b16 v[154:155], v214 offset:1024
    v_mfma_f32_16x16x32_bf16 v[36:39], a[4:7], v[136:139], 0
    buffer_load_dwordx4 v253, s[4:7], s28 offen offset:3072 lds
    v_mfma_f32_16x16x32_bf16 v[40:43], a[8:11], v[136:139], 0
    s_add_u32 m0, s30, 12288
    s_add_u32 s28, s25, s92
    v_mfma_f32_16x16x32_bf16 v[44:47], a[12:15], v[136:139], 0
    buffer_load_dwordx4 v218, s[4:7], s28 offen offset:0 lds
    v_mfma_f32_16x16x32_bf16 v[60:63], a[12:15], v[140:143], 0
    ds_read_b64_tr_b16 v[156:157], v215 offset:0
    ds_read_b64_tr_b16 v[158:159], v215 offset:1024
    v_mfma_f32_16x16x32_bf16 v[56:59], a[8:11], v[140:143], 0
    buffer_load_dwordx4 v219, s[4:7], s28 offen offset:1024 lds
    v_mfma_f32_16x16x32_bf16 v[52:55], a[4:7], v[140:143], 0
    buffer_load_dwordx4 v252, s[4:7], s28 offen offset:2048 lds
    v_mfma_f32_16x16x32_bf16 v[48:51], a[0:3], v[140:143], 0
    s_waitcnt lgkmcnt(4)
    buffer_load_dwordx4 v253, s[4:7], s28 offen offset:3072 lds
    v_mfma_f32_16x16x32_bf16 v[64:67], a[0:3], v[144:147], 0
    s_add_u32 s92, s92, 128
    ds_read_b64_tr_b16 v[160:161], v208 offset:8192
    ds_read_b64_tr_b16 v[162:163], v208 offset:9216
    v_mfma_f32_16x16x32_bf16 v[68:71], a[4:7], v[144:147], 0
    s_and_b32 s92, s92, 0x3ff
    s_mul_i32 s33, s92, s35
    v_mfma_f32_16x16x32_bf16 v[72:75], a[8:11], v[144:147], 0
    s_add_u32 m0, s31, 32768
    v_mfma_f32_16x16x32_bf16 v[76:79], a[12:15], v[144:147], 0
    s_add_u32 s33, s33, s93
    v_mfma_f32_16x16x32_bf16 v[92:95], a[12:15], v[148:151], 0
    ds_read_b64_tr_b16 v[164:165], v209 offset:8192
    ds_read_b64_tr_b16 v[166:167], v209 offset:9216
    v_mfma_f32_16x16x32_bf16 v[88:91], a[8:11], v[148:151], 0
    buffer_load_dwordx4 v220, s[8:11], s33 offen offset:0 lds
    v_mfma_f32_16x16x32_bf16 v[84:87], a[4:7], v[148:151], 0
    buffer_load_dwordx4 v221, s[8:11], s33 offen offset:1024 lds
    v_mfma_f32_16x16x32_bf16 v[80:83], a[0:3], v[148:151], 0
    s_waitcnt lgkmcnt(4)
    v_mfma_f32_16x16x32_bf16 v[96:99], a[0:3], v[152:155], 0
    ds_read_b64_tr_b16 v[168:169], v210 offset:8192
    ds_read_b64_tr_b16 v[170:171], v210 offset:9216
    v_mfma_f32_16x16x32_bf16 v[100:103], a[4:7], v[152:155], 0
    buffer_load_dwordx4 v254, s[8:11], s33 offen offset:2048 lds
    buffer_load_dwordx4 v255, s[8:11], s33 offen offset:3072 lds
    v_mfma_f32_16x16x32_bf16 v[104:107], a[8:11], v[152:155], 0
    s_add_u32 m0, s30, 0
    s_add_u32 s28, s24, s92
    v_mfma_f32_16x16x32_bf16 v[108:111], a[12:15], v[152:155], 0
    buffer_load_dwordx4 v218, s[4:7], s28 offen offset:0 lds
    v_mfma_f32_16x16x32_bf16 v[124:127], a[12:15], v[156:159], 0
    ds_read_b64_tr_b16 v[172:173], v211 offset:8192
    ds_read_b64_tr_b16 v[174:175], v211 offset:9216
    v_mfma_f32_16x16x32_bf16 v[120:123], a[8:11], v[156:159], 0
    buffer_load_dwordx4 v219, s[4:7], s28 offen offset:1024 lds
    v_mfma_f32_16x16x32_bf16 v[116:119], a[4:7], v[156:159], 0
    v_mfma_f32_16x16x32_bf16 v[112:115], a[0:3], v[156:159], 0
    s_waitcnt lgkmcnt(4)
    v_mfma_f32_16x16x32_bf16 v[0:3], a[16:19], v[160:163], v[0:3]
    ds_read_b64_tr_b16 v[176:177], v212 offset:8192
    ds_read_b64_tr_b16 v[178:179], v212 offset:9216
    v_mfma_f32_16x16x32_bf16 v[4:7], a[20:23], v[160:163], v[4:7]
    buffer_load_dwordx4 v252, s[4:7], s28 offen offset:2048 lds
    v_mfma_f32_16x16x32_bf16 v[8:11], a[24:27], v[160:163], v[8:11]
    buffer_load_dwordx4 v253, s[4:7], s28 offen offset:3072 lds
    v_mfma_f32_16x16x32_bf16 v[12:15], a[28:31], v[160:163], v[12:15]
    s_add_u32 m0, s30, 4096
    s_add_u32 s28, s25, s92
    v_mfma_f32_16x16x32_bf16 v[28:31], a[28:31], v[164:167], v[28:31]
    ds_read_b64_tr_b16 v[180:181], v213 offset:8192
    ds_read_b64_tr_b16 v[182:183], v213 offset:9216
    v_mfma_f32_16x16x32_bf16 v[24:27], a[24:27], v[164:167], v[24:27]
    buffer_load_dwordx4 v218, s[4:7], s28 offen offset:0 lds
    v_mfma_f32_16x16x32_bf16 v[20:23], a[20:23], v[164:167], v[20:23]
    buffer_load_dwordx4 v219, s[4:7], s28 offen offset:1024 lds
    v_mfma_f32_16x16x32_bf16 v[16:19], a[16:19], v[164:167], v[16:19]
    s_waitcnt lgkmcnt(4)
    v_mfma_f32_16x16x32_bf16 v[32:35], a[16:19], v[168:171], v[32:35]
    ds_read_b64_tr_b16 v[184:185], v214 offset:8192
    ds_read_b64_tr_b16 v[186:187], v214 offset:9216
    v_mfma_f32_16x16x32_bf16 v[36:39], a[20:23], v[168:171], v[36:39]
    buffer_load_dwordx4 v252, s[4:7], s28 offen offset:2048 lds
    v_mfma_f32_16x16x32_bf16 v[40:43], a[24:27], v[168:171], v[40:43]
    buffer_load_dwordx4 v253, s[4:7], s28 offen offset:3072 lds
    v_mfma_f32_16x16x32_bf16 v[44:47], a[28:31], v[168:171], v[44:47]
    v_mfma_f32_16x16x32_bf16 v[60:63], a[28:31], v[172:175], v[60:63]
    s_waitcnt vmcnt(12)
    ds_read_b64_tr_b16 v[188:189], v215 offset:8192
    ds_read_b64_tr_b16 v[190:191], v215 offset:9216
    s_barrier
    v_mfma_f32_16x16x32_bf16 v[56:59], a[24:27], v[172:175], v[56:59]
    ds_read_b128 a[32:35], v216 offset:8192
    ds_read_b128 a[36:39], v216 offset:10240
    v_mfma_f32_16x16x32_bf16 v[52:55], a[20:23], v[172:175], v[52:55]
    ds_read_b128 a[40:43], v216 offset:12288
    ds_read_b128 a[44:47], v216 offset:14336
    v_mfma_f32_16x16x32_bf16 v[48:51], a[16:19], v[172:175], v[48:51]
    s_waitcnt lgkmcnt(8)
    s_add_u32 s92, s92, 128
    v_mfma_f32_16x16x32_bf16 v[64:67], a[16:19], v[176:179], v[64:67]
    ds_read_b64_tr_b16 v[128:129], v208 offset:16384
    ds_read_b64_tr_b16 v[130:131], v208 offset:17408
    v_mfma_f32_16x16x32_bf16 v[68:71], a[20:23], v[176:179], v[68:71]
    s_and_b32 s92, s92, 0x3ff
    v_mfma_f32_16x16x32_bf16 v[72:75], a[24:27], v[176:179], v[72:75]
    ds_read_b128 a[48:51], v217 offset:8192
    ds_read_b128 a[52:55], v217 offset:10240
    v_mfma_f32_16x16x32_bf16 v[76:79], a[28:31], v[176:179], v[76:79]
    s_mul_i32 s33, s92, s35
    v_mfma_f32_16x16x32_bf16 v[92:95], a[28:31], v[180:183], v[92:95]
    ds_read_b64_tr_b16 v[132:133], v209 offset:16384
    ds_read_b64_tr_b16 v[134:135], v209 offset:17408
    v_mfma_f32_16x16x32_bf16 v[88:91], a[24:27], v[180:183], v[88:91]
    s_add_u32 m0, s31, 49152
    v_mfma_f32_16x16x32_bf16 v[84:87], a[20:23], v[180:183], v[84:87]
    ds_read_b128 a[56:59], v217 offset:12288
    ds_read_b128 a[60:63], v217 offset:14336
    v_mfma_f32_16x16x32_bf16 v[80:83], a[16:19], v[180:183], v[80:83]
    s_waitcnt lgkmcnt(12)
    s_add_u32 s33, s33, s93
    v_mfma_f32_16x16x32_bf16 v[96:99], a[16:19], v[184:187], v[96:99]
    ds_read_b64_tr_b16 v[136:137], v210 offset:16384
    ds_read_b64_tr_b16 v[138:139], v210 offset:17408
    v_mfma_f32_16x16x32_bf16 v[100:103], a[20:23], v[184:187], v[100:103]
    buffer_load_dwordx4 v220, s[8:11], s33 offen offset:0 lds
    v_mfma_f32_16x16x32_bf16 v[104:107], a[24:27], v[184:187], v[104:107]
    v_mfma_f32_16x16x32_bf16 v[108:111], a[28:31], v[184:187], v[108:111]
    v_mfma_f32_16x16x32_bf16 v[124:127], a[28:31], v[188:191], v[124:127]
    ds_read_b64_tr_b16 v[140:141], v211 offset:16384
    ds_read_b64_tr_b16 v[142:143], v211 offset:17408
    v_mfma_f32_16x16x32_bf16 v[120:123], a[24:27], v[188:191], v[120:123]
    buffer_load_dwordx4 v221, s[8:11], s33 offen offset:1024 lds
    v_mfma_f32_16x16x32_bf16 v[116:119], a[20:23], v[188:191], v[116:119]
    v_mfma_f32_16x16x32_bf16 v[112:115], a[16:19], v[188:191], v[112:115]
    s_waitcnt lgkmcnt(6)
    v_mfma_f32_16x16x32_bf16 v[0:3], a[32:35], v[128:131], v[0:3]
    ds_read_b64_tr_b16 v[144:145], v212 offset:16384
    ds_read_b64_tr_b16 v[146:147], v212 offset:17408
    v_mfma_f32_16x16x32_bf16 v[4:7], a[36:39], v[128:131], v[4:7]
    buffer_load_dwordx4 v254, s[8:11], s33 offen offset:2048 lds
    v_mfma_f32_16x16x32_bf16 v[8:11], a[40:43], v[128:131], v[8:11]
    v_mfma_f32_16x16x32_bf16 v[12:15], a[44:47], v[128:131], v[12:15]
    v_mfma_f32_16x16x32_bf16 v[28:31], a[44:47], v[132:135], v[28:31]
    ds_read_b64_tr_b16 v[148:149], v213 offset:16384
    ds_read_b64_tr_b16 v[150:151], v213 offset:17408
    v_mfma_f32_16x16x32_bf16 v[24:27], a[40:43], v[132:135], v[24:27]
    buffer_load_dwordx4 v255, s[8:11], s33 offen offset:3072 lds
    v_mfma_f32_16x16x32_bf16 v[20:23], a[36:39], v[132:135], v[20:23]
    v_mfma_f32_16x16x32_bf16 v[16:19], a[32:35], v[132:135], v[16:19]
    s_waitcnt lgkmcnt(4)
    v_mfma_f32_16x16x32_bf16 v[32:35], a[32:35], v[136:139], v[32:35]
    ds_read_b64_tr_b16 v[152:153], v214 offset:16384
    ds_read_b64_tr_b16 v[154:155], v214 offset:17408
    v_mfma_f32_16x16x32_bf16 v[36:39], a[36:39], v[136:139], v[36:39]
    s_add_u32 m0, s30, 8192
    v_mfma_f32_16x16x32_bf16 v[40:43], a[40:43], v[136:139], v[40:43]
    s_add_u32 s28, s24, s92
    v_mfma_f32_16x16x32_bf16 v[44:47], a[44:47], v[136:139], v[44:47]
    v_mfma_f32_16x16x32_bf16 v[60:63], a[44:47], v[140:143], v[60:63]
    ds_read_b64_tr_b16 v[156:157], v215 offset:16384
    ds_read_b64_tr_b16 v[158:159], v215 offset:17408
    v_mfma_f32_16x16x32_bf16 v[56:59], a[40:43], v[140:143], v[56:59]
    buffer_load_dwordx4 v218, s[4:7], s28 offen offset:0 lds
    v_mfma_f32_16x16x32_bf16 v[52:55], a[36:39], v[140:143], v[52:55]
    v_mfma_f32_16x16x32_bf16 v[48:51], a[32:35], v[140:143], v[48:51]
    s_waitcnt lgkmcnt(4)
    v_mfma_f32_16x16x32_bf16 v[64:67], a[32:35], v[144:147], v[64:67]
    ds_read_b64_tr_b16 v[160:161], v208 offset:24576
    ds_read_b64_tr_b16 v[162:163], v208 offset:25600
    v_mfma_f32_16x16x32_bf16 v[68:71], a[36:39], v[144:147], v[68:71]
    buffer_load_dwordx4 v219, s[4:7], s28 offen offset:1024 lds
    v_mfma_f32_16x16x32_bf16 v[72:75], a[40:43], v[144:147], v[72:75]
    v_mfma_f32_16x16x32_bf16 v[76:79], a[44:47], v[144:147], v[76:79]
    buffer_load_dwordx4 v252, s[4:7], s28 offen offset:2048 lds
    v_mfma_f32_16x16x32_bf16 v[92:95], a[44:47], v[148:151], v[92:95]
    ds_read_b64_tr_b16 v[164:165], v209 offset:24576
    ds_read_b64_tr_b16 v[166:167], v209 offset:25600
    v_mfma_f32_16x16x32_bf16 v[88:91], a[40:43], v[148:151], v[88:91]
    v_mfma_f32_16x16x32_bf16 v[84:87], a[36:39], v[148:151], v[84:87]
    buffer_load_dwordx4 v253, s[4:7], s28 offen offset:3072 lds
    v_mfma_f32_16x16x32_bf16 v[80:83], a[32:35], v[148:151], v[80:83]
    s_waitcnt lgkmcnt(4)
    v_mfma_f32_16x16x32_bf16 v[96:99], a[32:35], v[152:155], v[96:99]
    ds_read_b64_tr_b16 v[168:169], v210 offset:24576
    ds_read_b64_tr_b16 v[170:171], v210 offset:25600
    v_mfma_f32_16x16x32_bf16 v[100:103], a[36:39], v[152:155], v[100:103]
    v_mfma_f32_16x16x32_bf16 v[104:107], a[40:43], v[152:155], v[104:107]
    s_add_u32 m0, s30, 12288
    v_mfma_f32_16x16x32_bf16 v[108:111], a[44:47], v[152:155], v[108:111]
    s_add_u32 s28, s25, s92
    v_mfma_f32_16x16x32_bf16 v[124:127], a[44:47], v[156:159], v[124:127]
    ds_read_b64_tr_b16 v[172:173], v211 offset:24576
    ds_read_b64_tr_b16 v[174:175], v211 offset:25600
    v_mfma_f32_16x16x32_bf16 v[120:123], a[40:43], v[156:159], v[120:123]
    buffer_load_dwordx4 v218, s[4:7], s28 offen offset:0 lds
    v_mfma_f32_16x16x32_bf16 v[116:119], a[36:39], v[156:159], v[116:119]
    v_mfma_f32_16x16x32_bf16 v[112:115], a[32:35], v[156:159], v[112:115]
    s_waitcnt lgkmcnt(4)
    v_mfma_f32_16x16x32_bf16 v[0:3], a[48:51], v[160:163], v[0:3]
    ds_read_b64_tr_b16 v[176:177], v212 offset:24576
    ds_read_b64_tr_b16 v[178:179], v212 offset:25600
    v_mfma_f32_16x16x32_bf16 v[4:7], a[52:55], v[160:163], v[4:7]
    buffer_load_dwordx4 v219, s[4:7], s28 offen offset:1024 lds
    v_mfma_f32_16x16x32_bf16 v[8:11], a[56:59], v[160:163], v[8:11]
    v_mfma_f32_16x16x32_bf16 v[12:15], a[60:63], v[160:163], v[12:15]
    v_mfma_f32_16x16x32_bf16 v[28:31], a[60:63], v[164:167], v[28:31]
    ds_read_b64_tr_b16 v[180:181], v213 offset:24576
    ds_read_b64_tr_b16 v[182:183], v213 offset:25600
    v_mfma_f32_16x16x32_bf16 v[24:27], a[56:59], v[164:167], v[24:27]
    buffer_load_dwordx4 v252, s[4:7], s28 offen offset:2048 lds
    v_mfma_f32_16x16x32_bf16 v[20:23], a[52:55], v[164:167], v[20:23]
    v_mfma_f32_16x16x32_bf16 v[16:19], a[48:51], v[164:167], v[16:19]
    s_waitcnt lgkmcnt(4)
    v_mfma_f32_16x16x32_bf16 v[32:35], a[48:51], v[168:171], v[32:35]
    ds_read_b64_tr_b16 v[184:185], v214 offset:24576
    ds_read_b64_tr_b16 v[186:187], v214 offset:25600
    v_mfma_f32_16x16x32_bf16 v[36:39], a[52:55], v[168:171], v[36:39]
    buffer_load_dwordx4 v253, s[4:7], s28 offen offset:3072 lds
    v_mfma_f32_16x16x32_bf16 v[40:43], a[56:59], v[168:171], v[40:43]
    v_mfma_f32_16x16x32_bf16 v[44:47], a[60:63], v[168:171], v[44:47]
    v_mfma_f32_16x16x32_bf16 v[60:63], a[60:63], v[172:175], v[60:63]
    s_waitcnt vmcnt(12)
    ds_read_b64_tr_b16 v[188:189], v215 offset:24576
    ds_read_b64_tr_b16 v[190:191], v215 offset:25600
    s_barrier
    v_mfma_f32_16x16x32_bf16 v[56:59], a[56:59], v[172:175], v[56:59]
    ds_read_b128 a[64:67], v216 offset:0
    ds_read_b128 a[68:71], v216 offset:2048
    v_mfma_f32_16x16x32_bf16 v[52:55], a[52:55], v[172:175], v[52:55]
    ds_read_b128 a[72:75], v216 offset:4096
    ds_read_b128 a[76:79], v216 offset:6144
    v_mfma_f32_16x16x32_bf16 v[48:51], a[48:51], v[172:175], v[48:51]
    s_waitcnt lgkmcnt(8)
    s_add_u32 s92, s92, 128
    v_mfma_f32_16x16x32_bf16 v[64:67], a[48:51], v[176:179], v[64:67]
    ds_read_b64_tr_b16 v[128:129], v208 offset:32768
    ds_read_b64_tr_b16 v[130:131], v208 offset:33792
    v_mfma_f32_16x16x32_bf16 v[68:71], a[52:55], v[176:179], v[68:71]
    s_and_b32 s92, s92, 0x3ff
    v_mfma_f32_16x16x32_bf16 v[72:75], a[56:59], v[176:179], v[72:75]
    ds_read_b128 a[80:83], v217 offset:0
    ds_read_b128 a[84:87], v217 offset:2048
    v_mfma_f32_16x16x32_bf16 v[76:79], a[60:63], v[176:179], v[76:79]
    s_mul_i32 s33, s92, s35
    v_mfma_f32_16x16x32_bf16 v[92:95], a[60:63], v[180:183], v[92:95]
    ds_read_b64_tr_b16 v[132:133], v209 offset:32768
    ds_read_b64_tr_b16 v[134:135], v209 offset:33792
    v_mfma_f32_16x16x32_bf16 v[88:91], a[56:59], v[180:183], v[88:91]
    s_add_u32 m0, s31, 0
    v_mfma_f32_16x16x32_bf16 v[84:87], a[52:55], v[180:183], v[84:87]
    ds_read_b128 a[88:91], v217 offset:4096
    ds_read_b128 a[92:95], v217 offset:6144
    v_mfma_f32_16x16x32_bf16 v[80:83], a[48:51], v[180:183], v[80:83]
    s_waitcnt lgkmcnt(12)
    s_add_u32 s33, s33, s93
    v_mfma_f32_16x16x32_bf16 v[96:99], a[48:51], v[184:187], v[96:99]
    ds_read_b64_tr_b16 v[136:137], v210 offset:32768
    ds_read_b64_tr_b16 v[138:139], v210 offset:33792
    v_mfma_f32_16x16x32_bf16 v[100:103], a[52:55], v[184:187], v[100:103]
    buffer_load_dwordx4 v220, s[8:11], s33 offen offset:0 lds
    v_mfma_f32_16x16x32_bf16 v[104:107], a[56:59], v[184:187], v[104:107]
    v_mfma_f32_16x16x32_bf16 v[108:111], a[60:63], v[184:187], v[108:111]
    v_mfma_f32_16x16x32_bf16 v[124:127], a[60:63], v[188:191], v[124:127]
    ds_read_b64_tr_b16 v[140:141], v211 offset:32768
    ds_read_b64_tr_b16 v[142:143], v211 offset:33792
    v_mfma_f32_16x16x32_bf16 v[120:123], a[56:59], v[188:191], v[120:123]
    buffer_load_dwordx4 v221, s[8:11], s33 offen offset:1024 lds
    v_mfma_f32_16x16x32_bf16 v[116:119], a[52:55], v[188:191], v[116:119]
    v_mfma_f32_16x16x32_bf16 v[112:115], a[48:51], v[188:191], v[112:115]
    s_waitcnt lgkmcnt(6)
    v_mfma_f32_16x16x32_bf16 v[0:3], a[64:67], v[128:131], v[0:3]
    ds_read_b64_tr_b16 v[144:145], v212 offset:32768
    ds_read_b64_tr_b16 v[146:147], v212 offset:33792
    v_mfma_f32_16x16x32_bf16 v[4:7], a[68:71], v[128:131], v[4:7]
    buffer_load_dwordx4 v254, s[8:11], s33 offen offset:2048 lds
    v_mfma_f32_16x16x32_bf16 v[8:11], a[72:75], v[128:131], v[8:11]
    v_mfma_f32_16x16x32_bf16 v[12:15], a[76:79], v[128:131], v[12:15]
    v_mfma_f32_16x16x32_bf16 v[28:31], a[76:79], v[132:135], v[28:31]
    ds_read_b64_tr_b16 v[148:149], v213 offset:32768
    ds_read_b64_tr_b16 v[150:151], v213 offset:33792
    v_mfma_f32_16x16x32_bf16 v[24:27], a[72:75], v[132:135], v[24:27]
    buffer_load_dwordx4 v255, s[8:11], s33 offen offset:3072 lds
    v_mfma_f32_16x16x32_bf16 v[20:23], a[68:71], v[132:135], v[20:23]
    v_mfma_f32_16x16x32_bf16 v[16:19], a[64:67], v[132:135], v[16:19]
    s_waitcnt lgkmcnt(4)
    v_mfma_f32_16x16x32_bf16 v[32:35], a[64:67], v[136:139], v[32:35]
    ds_read_b64_tr_b16 v[152:153], v214 offset:32768
    ds_read_b64_tr_b16 v[154:155], v214 offset:33792
    v_mfma_f32_16x16x32_bf16 v[36:39], a[68:71], v[136:139], v[36:39]
    s_add_u32 m0, s30, 0
    v_mfma_f32_16x16x32_bf16 v[40:43], a[72:75], v[136:139], v[40:43]
    s_add_u32 s28, s24, s92
    v_mfma_f32_16x16x32_bf16 v[44:47], a[76:79], v[136:139], v[44:47]
    v_mfma_f32_16x16x32_bf16 v[60:63], a[76:79], v[140:143], v[60:63]
    ds_read_b64_tr_b16 v[156:157], v215 offset:32768
    ds_read_b64_tr_b16 v[158:159], v215 offset:33792
    v_mfma_f32_16x16x32_bf16 v[56:59], a[72:75], v[140:143], v[56:59]
    buffer_load_dwordx4 v218, s[4:7], s28 offen offset:0 lds
    v_mfma_f32_16x16x32_bf16 v[52:55], a[68:71], v[140:143], v[52:55]
    v_mfma_f32_16x16x32_bf16 v[48:51], a[64:67], v[140:143], v[48:51]
    s_waitcnt lgkmcnt(4)
    v_mfma_f32_16x16x32_bf16 v[64:67], a[64:67], v[144:147], v[64:67]
    ds_read_b64_tr_b16 v[160:161], v208 offset:40960
    ds_read_b64_tr_b16 v[162:163], v208 offset:41984
    v_mfma_f32_16x16x32_bf16 v[68:71], a[68:71], v[144:147], v[68:71]
    buffer_load_dwordx4 v219, s[4:7], s28 offen offset:1024 lds
    v_mfma_f32_16x16x32_bf16 v[72:75], a[72:75], v[144:147], v[72:75]
    v_mfma_f32_16x16x32_bf16 v[76:79], a[76:79], v[144:147], v[76:79]
    buffer_load_dwordx4 v252, s[4:7], s28 offen offset:2048 lds
    v_mfma_f32_16x16x32_bf16 v[92:95], a[76:79], v[148:151], v[92:95]
    ds_read_b64_tr_b16 v[164:165], v209 offset:40960
    ds_read_b64_tr_b16 v[166:167], v209 offset:41984
    v_mfma_f32_16x16x32_bf16 v[88:91], a[72:75], v[148:151], v[88:91]
    v_mfma_f32_16x16x32_bf16 v[84:87], a[68:71], v[148:151], v[84:87]
    buffer_load_dwordx4 v253, s[4:7], s28 offen offset:3072 lds
    v_mfma_f32_16x16x32_bf16 v[80:83], a[64:67], v[148:151], v[80:83]
    s_waitcnt lgkmcnt(4)
    v_mfma_f32_16x16x32_bf16 v[96:99], a[64:67], v[152:155], v[96:99]
    ds_read_b64_tr_b16 v[168:169], v210 offset:40960
    ds_read_b64_tr_b16 v[170:171], v210 offset:41984
    v_mfma_f32_16x16x32_bf16 v[100:103], a[68:71], v[152:155], v[100:103]
    v_mfma_f32_16x16x32_bf16 v[104:107], a[72:75], v[152:155], v[104:107]
    s_add_u32 m0, s30, 4096
    v_mfma_f32_16x16x32_bf16 v[108:111], a[76:79], v[152:155], v[108:111]
    s_add_u32 s28, s25, s92
    v_mfma_f32_16x16x32_bf16 v[124:127], a[76:79], v[156:159], v[124:127]
    ds_read_b64_tr_b16 v[172:173], v211 offset:40960
    ds_read_b64_tr_b16 v[174:175], v211 offset:41984
    v_mfma_f32_16x16x32_bf16 v[120:123], a[72:75], v[156:159], v[120:123]
    buffer_load_dwordx4 v218, s[4:7], s28 offen offset:0 lds
    v_mfma_f32_16x16x32_bf16 v[116:119], a[68:71], v[156:159], v[116:119]
    v_mfma_f32_16x16x32_bf16 v[112:115], a[64:67], v[156:159], v[112:115]
    s_waitcnt lgkmcnt(4)
    v_mfma_f32_16x16x32_bf16 v[0:3], a[80:83], v[160:163], v[0:3]
    ds_read_b64_tr_b16 v[176:177], v212 offset:40960
    ds_read_b64_tr_b16 v[178:179], v212 offset:41984
    v_mfma_f32_16x16x32_bf16 v[4:7], a[84:87], v[160:163], v[4:7]
    buffer_load_dwordx4 v219, s[4:7], s28 offen offset:1024 lds
    v_mfma_f32_16x16x32_bf16 v[8:11], a[88:91], v[160:163], v[8:11]
    v_mfma_f32_16x16x32_bf16 v[12:15], a[92:95], v[160:163], v[12:15]
    v_mfma_f32_16x16x32_bf16 v[28:31], a[92:95], v[164:167], v[28:31]
    ds_read_b64_tr_b16 v[180:181], v213 offset:40960
    ds_read_b64_tr_b16 v[182:183], v213 offset:41984
    v_mfma_f32_16x16x32_bf16 v[24:27], a[88:91], v[164:167], v[24:27]
    buffer_load_dwordx4 v252, s[4:7], s28 offen offset:2048 lds
    v_mfma_f32_16x16x32_bf16 v[20:23], a[84:87], v[164:167], v[20:23]
    v_mfma_f32_16x16x32_bf16 v[16:19], a[80:83], v[164:167], v[16:19]
    s_waitcnt lgkmcnt(4)
    v_mfma_f32_16x16x32_bf16 v[32:35], a[80:83], v[168:171], v[32:35]
    ds_read_b64_tr_b16 v[184:185], v214 offset:40960
    ds_read_b64_tr_b16 v[186:187], v214 offset:41984
    v_mfma_f32_16x16x32_bf16 v[36:39], a[84:87], v[168:171], v[36:39]
    buffer_load_dwordx4 v253, s[4:7], s28 offen offset:3072 lds
    v_mfma_f32_16x16x32_bf16 v[40:43], a[88:91], v[168:171], v[40:43]
    v_mfma_f32_16x16x32_bf16 v[44:47], a[92:95], v[168:171], v[44:47]
    v_mfma_f32_16x16x32_bf16 v[60:63], a[92:95], v[172:175], v[60:63]
    s_waitcnt vmcnt(12)
    ds_read_b64_tr_b16 v[188:189], v215 offset:40960
    ds_read_b64_tr_b16 v[190:191], v215 offset:41984
    s_barrier
    v_mfma_f32_16x16x32_bf16 v[56:59], a[88:91], v[172:175], v[56:59]
    ds_read_b128 a[96:99], v216 offset:8192
    ds_read_b128 a[100:103], v216 offset:10240
    v_mfma_f32_16x16x32_bf16 v[52:55], a[84:87], v[172:175], v[52:55]
    ds_read_b128 a[104:107], v216 offset:12288
    ds_read_b128 a[108:111], v216 offset:14336
    v_mfma_f32_16x16x32_bf16 v[48:51], a[80:83], v[172:175], v[48:51]
    s_waitcnt lgkmcnt(8)
    s_add_u32 s92, s92, 128
    v_mfma_f32_16x16x32_bf16 v[64:67], a[80:83], v[176:179], v[64:67]
    ds_read_b64_tr_b16 v[128:129], v208 offset:49152
    ds_read_b64_tr_b16 v[130:131], v208 offset:50176
    v_mfma_f32_16x16x32_bf16 v[68:71], a[84:87], v[176:179], v[68:71]
    s_and_b32 s92, s92, 0x3ff
    v_mfma_f32_16x16x32_bf16 v[72:75], a[88:91], v[176:179], v[72:75]
    ds_read_b128 a[112:115], v217 offset:8192
    ds_read_b128 a[116:119], v217 offset:10240
    v_mfma_f32_16x16x32_bf16 v[76:79], a[92:95], v[176:179], v[76:79]
    s_mul_i32 s33, s92, s35
    v_mfma_f32_16x16x32_bf16 v[92:95], a[92:95], v[180:183], v[92:95]
    ds_read_b64_tr_b16 v[132:133], v209 offset:49152
    ds_read_b64_tr_b16 v[134:135], v209 offset:50176
    v_mfma_f32_16x16x32_bf16 v[88:91], a[88:91], v[180:183], v[88:91]
    s_add_u32 m0, s31, 16384
    v_mfma_f32_16x16x32_bf16 v[84:87], a[84:87], v[180:183], v[84:87]
    ds_read_b128 a[120:123], v217 offset:12288
    ds_read_b128 a[124:127], v217 offset:14336
    v_mfma_f32_16x16x32_bf16 v[80:83], a[80:83], v[180:183], v[80:83]
    s_waitcnt lgkmcnt(12)
    s_add_u32 s33, s33, s93
    v_mfma_f32_16x16x32_bf16 v[96:99], a[80:83], v[184:187], v[96:99]
    ds_read_b64_tr_b16 v[136:137], v210 offset:49152
    ds_read_b64_tr_b16 v[138:139], v210 offset:50176
    v_mfma_f32_16x16x32_bf16 v[100:103], a[84:87], v[184:187], v[100:103]
    buffer_load_dwordx4 v220, s[8:11], s33 offen offset:0 lds
    v_mfma_f32_16x16x32_bf16 v[104:107], a[88:91], v[184:187], v[104:107]
    v_mfma_f32_16x16x32_bf16 v[108:111], a[92:95], v[184:187], v[108:111]
    v_mfma_f32_16x16x32_bf16 v[124:127], a[92:95], v[188:191], v[124:127]
    ds_read_b64_tr_b16 v[140:141], v211 offset:49152
    ds_read_b64_tr_b16 v[142:143], v211 offset:50176
    v_mfma_f32_16x16x32_bf16 v[120:123], a[88:91], v[188:191], v[120:123]
    buffer_load_dwordx4 v221, s[8:11], s33 offen offset:1024 lds
    v_mfma_f32_16x16x32_bf16 v[116:119], a[84:87], v[188:191], v[116:119]
    v_mfma_f32_16x16x32_bf16 v[112:115], a[80:83], v[188:191], v[112:115]
    s_waitcnt lgkmcnt(6)
    v_mfma_f32_16x16x32_bf16 v[0:3], a[96:99], v[128:131], v[0:3]
    ds_read_b64_tr_b16 v[144:145], v212 offset:49152
    ds_read_b64_tr_b16 v[146:147], v212 offset:50176
    v_mfma_f32_16x16x32_bf16 v[4:7], a[100:103], v[128:131], v[4:7]
    buffer_load_dwordx4 v254, s[8:11], s33 offen offset:2048 lds
    v_mfma_f32_16x16x32_bf16 v[8:11], a[104:107], v[128:131], v[8:11]
    v_mfma_f32_16x16x32_bf16 v[12:15], a[108:111], v[128:131], v[12:15]
    v_mfma_f32_16x16x32_bf16 v[28:31], a[108:111], v[132:135], v[28:31]
    ds_read_b64_tr_b16 v[148:149], v213 offset:49152
    ds_read_b64_tr_b16 v[150:151], v213 offset:50176
    v_mfma_f32_16x16x32_bf16 v[24:27], a[104:107], v[132:135], v[24:27]
    buffer_load_dwordx4 v255, s[8:11], s33 offen offset:3072 lds
    v_mfma_f32_16x16x32_bf16 v[20:23], a[100:103], v[132:135], v[20:23]
    v_mfma_f32_16x16x32_bf16 v[16:19], a[96:99], v[132:135], v[16:19]
    s_waitcnt lgkmcnt(4)
    v_mfma_f32_16x16x32_bf16 v[32:35], a[96:99], v[136:139], v[32:35]
    ds_read_b64_tr_b16 v[152:153], v214 offset:49152
    ds_read_b64_tr_b16 v[154:155], v214 offset:50176
    v_mfma_f32_16x16x32_bf16 v[36:39], a[100:103], v[136:139], v[36:39]
    s_add_u32 m0, s30, 8192
    v_mfma_f32_16x16x32_bf16 v[40:43], a[104:107], v[136:139], v[40:43]
    s_add_u32 s28, s24, s92
    v_mfma_f32_16x16x32_bf16 v[44:47], a[108:111], v[136:139], v[44:47]
    v_mfma_f32_16x16x32_bf16 v[60:63], a[108:111], v[140:143], v[60:63]
    ds_read_b64_tr_b16 v[156:157], v215 offset:49152
    ds_read_b64_tr_b16 v[158:159], v215 offset:50176
    v_mfma_f32_16x16x32_bf16 v[56:59], a[104:107], v[140:143], v[56:59]
    buffer_load_dwordx4 v218, s[4:7], s28 offen offset:0 lds
    v_mfma_f32_16x16x32_bf16 v[52:55], a[100:103], v[140:143], v[52:55]
    v_mfma_f32_16x16x32_bf16 v[48:51], a[96:99], v[140:143], v[48:51]
    s_waitcnt lgkmcnt(4)
    v_mfma_f32_16x16x32_bf16 v[64:67], a[96:99], v[144:147], v[64:67]
    ds_read_b64_tr_b16 v[160:161], v208 offset:57344
    ds_read_b64_tr_b16 v[162:163], v208 offset:58368
    v_mfma_f32_16x16x32_bf16 v[68:71], a[100:103], v[144:147], v[68:71]
    buffer_load_dwordx4 v219, s[4:7], s28 offen offset:1024 lds
    v_mfma_f32_16x16x32_bf16 v[72:75], a[104:107], v[144:147], v[72:75]
    v_mfma_f32_16x16x32_bf16 v[76:79], a[108:111], v[144:147], v[76:79]
    buffer_load_dwordx4 v252, s[4:7], s28 offen offset:2048 lds
    v_mfma_f32_16x16x32_bf16 v[92:95], a[108:111], v[148:151], v[92:95]
    ds_read_b64_tr_b16 v[164:165], v209 offset:57344
    ds_read_b64_tr_b16 v[166:167], v209 offset:58368
    v_mfma_f32_16x16x32_bf16 v[88:91], a[104:107], v[148:151], v[88:91]
    v_mfma_f32_16x16x32_bf16 v[84:87], a[100:103], v[148:151], v[84:87]
    buffer_load_dwordx4 v253, s[4:7], s28 offen offset:3072 lds
    v_mfma_f32_16x16x32_bf16 v[80:83], a[96:99], v[148:151], v[80:83]
    s_waitcnt lgkmcnt(4)
    v_mfma_f32_16x16x32_bf16 v[96:99], a[96:99], v[152:155], v[96:99]
    ds_read_b64_tr_b16 v[168:169], v210 offset:57344
    ds_read_b64_tr_b16 v[170:171], v210 offset:58368
    v_mfma_f32_16x16x32_bf16 v[100:103], a[100:103], v[152:155], v[100:103]
    v_mfma_f32_16x16x32_bf16 v[104:107], a[104:107], v[152:155], v[104:107]
    s_add_u32 m0, s30, 12288
    v_mfma_f32_16x16x32_bf16 v[108:111], a[108:111], v[152:155], v[108:111]
    s_add_u32 s28, s25, s92
    v_mfma_f32_16x16x32_bf16 v[124:127], a[108:111], v[156:159], v[124:127]
    ds_read_b64_tr_b16 v[172:173], v211 offset:57344
    ds_read_b64_tr_b16 v[174:175], v211 offset:58368
    v_mfma_f32_16x16x32_bf16 v[120:123], a[104:107], v[156:159], v[120:123]
    buffer_load_dwordx4 v218, s[4:7], s28 offen offset:0 lds
    v_mfma_f32_16x16x32_bf16 v[116:119], a[100:103], v[156:159], v[116:119]
    v_mfma_f32_16x16x32_bf16 v[112:115], a[96:99], v[156:159], v[112:115]
    s_waitcnt lgkmcnt(4)
    v_mfma_f32_16x16x32_bf16 v[0:3], a[112:115], v[160:163], v[0:3]
    ds_read_b64_tr_b16 v[176:177], v212 offset:57344
    ds_read_b64_tr_b16 v[178:179], v212 offset:58368
    v_mfma_f32_16x16x32_bf16 v[4:7], a[116:119], v[160:163], v[4:7]
    buffer_load_dwordx4 v219, s[4:7], s28 offen offset:1024 lds
    v_mfma_f32_16x16x32_bf16 v[8:11], a[120:123], v[160:163], v[8:11]
    v_mfma_f32_16x16x32_bf16 v[12:15], a[124:127], v[160:163], v[12:15]
    v_mfma_f32_16x16x32_bf16 v[28:31], a[124:127], v[164:167], v[28:31]
    ds_read_b64_tr_b16 v[180:181], v213 offset:57344
    ds_read_b64_tr_b16 v[182:183], v213 offset:58368
    v_mfma_f32_16x16x32_bf16 v[24:27], a[120:123], v[164:167], v[24:27]
    buffer_load_dwordx4 v252, s[4:7], s28 offen offset:2048 lds
    v_mfma_f32_16x16x32_bf16 v[20:23], a[116:119], v[164:167], v[20:23]
    v_mfma_f32_16x16x32_bf16 v[16:19], a[112:115], v[164:167], v[16:19]
    s_waitcnt lgkmcnt(4)
    v_mfma_f32_16x16x32_bf16 v[32:35], a[112:115], v[168:171], v[32:35]
    ds_read_b64_tr_b16 v[184:185], v214 offset:57344
    ds_read_b64_tr_b16 v[186:187], v214 offset:58368
    v_mfma_f32_16x16x32_bf16 v[36:39], a[116:119], v[168:171], v[36:39]
    buffer_load_dwordx4 v253, s[4:7], s28 offen offset:3072 lds
    v_mfma_f32_16x16x32_bf16 v[40:43], a[120:123], v[168:171], v[40:43]
    v_mfma_f32_16x16x32_bf16 v[44:47], a[124:127], v[168:171], v[44:47]
    v_mfma_f32_16x16x32_bf16 v[60:63], a[124:127], v[172:175], v[60:63]
    s_waitcnt vmcnt(12)
    ds_read_b64_tr_b16 v[188:189], v215 offset:57344
    ds_read_b64_tr_b16 v[190:191], v215 offset:58368
    s_barrier
    v_mfma_f32_16x16x32_bf16 v[56:59], a[120:123], v[172:175], v[56:59]
    ds_read_b128 a[128:131], v216 offset:0
    ds_read_b128 a[132:135], v216 offset:2048
    v_mfma_f32_16x16x32_bf16 v[52:55], a[116:119], v[172:175], v[52:55]
    ds_read_b128 a[136:139], v216 offset:4096
    ds_read_b128 a[140:143], v216 offset:6144
    v_mfma_f32_16x16x32_bf16 v[48:51], a[112:115], v[172:175], v[48:51]
    s_waitcnt lgkmcnt(8)
    s_add_u32 s92, s92, 128
    v_mfma_f32_16x16x32_bf16 v[64:67], a[112:115], v[176:179], v[64:67]
    ds_read_b64_tr_b16 v[128:129], v208 offset:0
    ds_read_b64_tr_b16 v[130:131], v208 offset:1024
    v_mfma_f32_16x16x32_bf16 v[68:71], a[116:119], v[176:179], v[68:71]
    s_and_b32 s92, s92, 0x3ff
    v_mfma_f32_16x16x32_bf16 v[72:75], a[120:123], v[176:179], v[72:75]
    ds_read_b128 a[144:147], v217 offset:0
    ds_read_b128 a[148:151], v217 offset:2048
    v_mfma_f32_16x16x32_bf16 v[76:79], a[124:127], v[176:179], v[76:79]
    s_mul_i32 s33, s92, s35
    v_mfma_f32_16x16x32_bf16 v[92:95], a[124:127], v[180:183], v[92:95]
    ds_read_b64_tr_b16 v[132:133], v209 offset:0
    ds_read_b64_tr_b16 v[134:135], v209 offset:1024
    v_mfma_f32_16x16x32_bf16 v[88:91], a[120:123], v[180:183], v[88:91]
    s_add_u32 m0, s31, 32768
    v_mfma_f32_16x16x32_bf16 v[84:87], a[116:119], v[180:183], v[84:87]
    ds_read_b128 a[152:155], v217 offset:4096
    ds_read_b128 a[156:159], v217 offset:6144
    v_mfma_f32_16x16x32_bf16 v[80:83], a[112:115], v[180:183], v[80:83]
    s_waitcnt lgkmcnt(12)
    s_add_u32 s33, s33, s93
    v_mfma_f32_16x16x32_bf16 v[96:99], a[112:115], v[184:187], v[96:99]
    ds_read_b64_tr_b16 v[136:137], v210 offset:0
    ds_read_b64_tr_b16 v[138:139], v210 offset:1024
    v_mfma_f32_16x16x32_bf16 v[100:103], a[116:119], v[184:187], v[100:103]
    buffer_load_dwordx4 v220, s[8:11], s33 offen offset:0 lds
    v_mfma_f32_16x16x32_bf16 v[104:107], a[120:123], v[184:187], v[104:107]
    v_mfma_f32_16x16x32_bf16 v[108:111], a[124:127], v[184:187], v[108:111]
    v_mfma_f32_16x16x32_bf16 v[124:127], a[124:127], v[188:191], v[124:127]
    ds_read_b64_tr_b16 v[140:141], v211 offset:0
    ds_read_b64_tr_b16 v[142:143], v211 offset:1024
    v_mfma_f32_16x16x32_bf16 v[120:123], a[120:123], v[188:191], v[120:123]
    buffer_load_dwordx4 v221, s[8:11], s33 offen offset:1024 lds
    v_mfma_f32_16x16x32_bf16 v[116:119], a[116:119], v[188:191], v[116:119]
    v_mfma_f32_16x16x32_bf16 v[112:115], a[112:115], v[188:191], v[112:115]
    s_waitcnt lgkmcnt(6)
    v_mfma_f32_16x16x32_bf16 v[0:3], a[128:131], v[128:131], v[0:3]
    ds_read_b64_tr_b16 v[144:145], v212 offset:0
    ds_read_b64_tr_b16 v[146:147], v212 offset:1024
    v_mfma_f32_16x16x32_bf16 v[4:7], a[132:135], v[128:131], v[4:7]
    buffer_load_dwordx4 v254, s[8:11], s33 offen offset:2048 lds
    v_mfma_f32_16x16x32_bf16 v[8:11], a[136:139], v[128:131], v[8:11]
    v_mfma_f32_16x16x32_bf16 v[12:15], a[140:143], v[128:131], v[12:15]
    v_mfma_f32_16x16x32_bf16 v[28:31], a[140:143], v[132:135], v[28:31]
    ds_read_b64_tr_b16 v[148:149], v213 offset:0
    ds_read_b64_tr_b16 v[150:151], v213 offset:1024
    v_mfma_f32_16x16x32_bf16 v[24:27], a[136:139], v[132:135], v[24:27]
    buffer_load_dwordx4 v255, s[8:11], s33 offen offset:3072 lds
    v_mfma_f32_16x16x32_bf16 v[20:23], a[132:135], v[132:135], v[20:23]
    v_mfma_f32_16x16x32_bf16 v[16:19], a[128:131], v[132:135], v[16:19]
    s_waitcnt lgkmcnt(4)
    v_mfma_f32_16x16x32_bf16 v[32:35], a[128:131], v[136:139], v[32:35]
    ds_read_b64_tr_b16 v[152:153], v214 offset:0
    ds_read_b64_tr_b16 v[154:155], v214 offset:1024
    v_mfma_f32_16x16x32_bf16 v[36:39], a[132:135], v[136:139], v[36:39]
    s_add_u32 m0, s30, 0
    v_mfma_f32_16x16x32_bf16 v[40:43], a[136:139], v[136:139], v[40:43]
    s_add_u32 s28, s24, s92
    v_mfma_f32_16x16x32_bf16 v[44:47], a[140:143], v[136:139], v[44:47]
    v_mfma_f32_16x16x32_bf16 v[60:63], a[140:143], v[140:143], v[60:63]
    ds_read_b64_tr_b16 v[156:157], v215 offset:0
    ds_read_b64_tr_b16 v[158:159], v215 offset:1024
    v_mfma_f32_16x16x32_bf16 v[56:59], a[136:139], v[140:143], v[56:59]
    buffer_load_dwordx4 v218, s[4:7], s28 offen offset:0 lds
    v_mfma_f32_16x16x32_bf16 v[52:55], a[132:135], v[140:143], v[52:55]
    v_mfma_f32_16x16x32_bf16 v[48:51], a[128:131], v[140:143], v[48:51]
    s_waitcnt lgkmcnt(4)
    v_mfma_f32_16x16x32_bf16 v[64:67], a[128:131], v[144:147], v[64:67]
    ds_read_b64_tr_b16 v[160:161], v208 offset:8192
    ds_read_b64_tr_b16 v[162:163], v208 offset:9216
    v_mfma_f32_16x16x32_bf16 v[68:71], a[132:135], v[144:147], v[68:71]
    buffer_load_dwordx4 v219, s[4:7], s28 offen offset:1024 lds
    v_mfma_f32_16x16x32_bf16 v[72:75], a[136:139], v[144:147], v[72:75]
    v_mfma_f32_16x16x32_bf16 v[76:79], a[140:143], v[144:147], v[76:79]
    buffer_load_dwordx4 v252, s[4:7], s28 offen offset:2048 lds
    v_mfma_f32_16x16x32_bf16 v[92:95], a[140:143], v[148:151], v[92:95]
    ds_read_b64_tr_b16 v[164:165], v209 offset:8192
    ds_read_b64_tr_b16 v[166:167], v209 offset:9216
    v_mfma_f32_16x16x32_bf16 v[88:91], a[136:139], v[148:151], v[88:91]
    v_mfma_f32_16x16x32_bf16 v[84:87], a[132:135], v[148:151], v[84:87]
    buffer_load_dwordx4 v253, s[4:7], s28 offen offset:3072 lds
    v_mfma_f32_16x16x32_bf16 v[80:83], a[128:131], v[148:151], v[80:83]
    s_waitcnt lgkmcnt(4)
    v_mfma_f32_16x16x32_bf16 v[96:99], a[128:131], v[152:155], v[96:99]
    ds_read_b64_tr_b16 v[168:169], v210 offset:8192
    ds_read_b64_tr_b16 v[170:171], v210 offset:9216
    v_mfma_f32_16x16x32_bf16 v[100:103], a[132:135], v[152:155], v[100:103]
    v_mfma_f32_16x16x32_bf16 v[104:107], a[136:139], v[152:155], v[104:107]
    s_add_u32 m0, s30, 4096
    v_mfma_f32_16x16x32_bf16 v[108:111], a[140:143], v[152:155], v[108:111]
    s_add_u32 s28, s25, s92
    v_mfma_f32_16x16x32_bf16 v[124:127], a[140:143], v[156:159], v[124:127]
    ds_read_b64_tr_b16 v[172:173], v211 offset:8192
    ds_read_b64_tr_b16 v[174:175], v211 offset:9216
    v_mfma_f32_16x16x32_bf16 v[120:123], a[136:139], v[156:159], v[120:123]
    buffer_load_dwordx4 v218, s[4:7], s28 offen offset:0 lds
    v_mfma_f32_16x16x32_bf16 v[116:119], a[132:135], v[156:159], v[116:119]
    v_mfma_f32_16x16x32_bf16 v[112:115], a[128:131], v[156:159], v[112:115]
    s_waitcnt lgkmcnt(4)
    v_mfma_f32_16x16x32_bf16 v[0:3], a[144:147], v[160:163], v[0:3]
    ds_read_b64_tr_b16 v[176:177], v212 offset:8192
    ds_read_b64_tr_b16 v[178:179], v212 offset:9216
    v_mfma_f32_16x16x32_bf16 v[4:7], a[148:151], v[160:163], v[4:7]
    buffer_load_dwordx4 v219, s[4:7], s28 offen offset:1024 lds
    v_mfma_f32_16x16x32_bf16 v[8:11], a[152:155], v[160:163], v[8:11]
    v_mfma_f32_16x16x32_bf16 v[12:15], a[156:159], v[160:163], v[12:15]
    v_mfma_f32_16x16x32_bf16 v[28:31], a[156:159], v[164:167], v[28:31]
    ds_read_b64_tr_b16 v[180:181], v213 offset:8192
    ds_read_b64_tr_b16 v[182:183], v213 offset:9216
    v_mfma_f32_16x16x32_bf16 v[24:27], a[152:155], v[164:167], v[24:27]
    buffer_load_dwordx4 v252, s[4:7], s28 offen offset:2048 lds
    v_mfma_f32_16x16x32_bf16 v[20:23], a[148:151], v[164:167], v[20:23]
    v_mfma_f32_16x16x32_bf16 v[16:19], a[144:147], v[164:167], v[16:19]
    s_waitcnt lgkmcnt(4)
    v_mfma_f32_16x16x32_bf16 v[32:35], a[144:147], v[168:171], v[32:35]
    ds_read_b64_tr_b16 v[184:185], v214 offset:8192
    ds_read_b64_tr_b16 v[186:187], v214 offset:9216
    v_mfma_f32_16x16x32_bf16 v[36:39], a[148:151], v[168:171], v[36:39]
    buffer_load_dwordx4 v253, s[4:7], s28 offen offset:3072 lds
    v_mfma_f32_16x16x32_bf16 v[40:43], a[152:155], v[168:171], v[40:43]
    v_mfma_f32_16x16x32_bf16 v[44:47], a[156:159], v[168:171], v[44:47]
    v_mfma_f32_16x16x32_bf16 v[60:63], a[156:159], v[172:175], v[60:63]
    s_waitcnt vmcnt(12)
    ds_read_b64_tr_b16 v[188:189], v215 offset:8192
    ds_read_b64_tr_b16 v[190:191], v215 offset:9216
    s_barrier
    v_mfma_f32_16x16x32_bf16 v[56:59], a[152:155], v[172:175], v[56:59]
    ds_read_b128 a[160:163], v216 offset:8192
    ds_read_b128 a[164:167], v216 offset:10240
    v_mfma_f32_16x16x32_bf16 v[52:55], a[148:151], v[172:175], v[52:55]
    ds_read_b128 a[168:171], v216 offset:12288
    ds_read_b128 a[172:175], v216 offset:14336
    v_mfma_f32_16x16x32_bf16 v[48:51], a[144:147], v[172:175], v[48:51]
    s_waitcnt lgkmcnt(8)
    s_add_u32 s92, s92, 128
    v_mfma_f32_16x16x32_bf16 v[64:67], a[144:147], v[176:179], v[64:67]
    ds_read_b64_tr_b16 v[128:129], v208 offset:16384
    ds_read_b64_tr_b16 v[130:131], v208 offset:17408
    v_mfma_f32_16x16x32_bf16 v[68:71], a[148:151], v[176:179], v[68:71]
    s_and_b32 s92, s92, 0x3ff
    v_mfma_f32_16x16x32_bf16 v[72:75], a[152:155], v[176:179], v[72:75]
    ds_read_b128 a[176:179], v217 offset:8192
    ds_read_b128 a[180:183], v217 offset:10240
    v_mfma_f32_16x16x32_bf16 v[76:79], a[156:159], v[176:179], v[76:79]
    s_mul_i32 s33, s92, s35
    v_mfma_f32_16x16x32_bf16 v[92:95], a[156:159], v[180:183], v[92:95]
    ds_read_b64_tr_b16 v[132:133], v209 offset:16384
    ds_read_b64_tr_b16 v[134:135], v209 offset:17408
    v_mfma_f32_16x16x32_bf16 v[88:91], a[152:155], v[180:183], v[88:91]
    s_add_u32 m0, s31, 49152
    v_mfma_f32_16x16x32_bf16 v[84:87], a[148:151], v[180:183], v[84:87]
    ds_read_b128 a[184:187], v217 offset:12288
    ds_read_b128 a[188:191], v217 offset:14336
    v_mfma_f32_16x16x32_bf16 v[80:83], a[144:147], v[180:183], v[80:83]
    s_waitcnt lgkmcnt(12)
    s_add_u32 s33, s33, s93
    v_mfma_f32_16x16x32_bf16 v[96:99], a[144:147], v[184:187], v[96:99]
    ds_read_b64_tr_b16 v[136:137], v210 offset:16384
    ds_read_b64_tr_b16 v[138:139], v210 offset:17408
    v_mfma_f32_16x16x32_bf16 v[100:103], a[148:151], v[184:187], v[100:103]
    buffer_load_dwordx4 v220, s[8:11], s33 offen offset:0 lds
    v_mfma_f32_16x16x32_bf16 v[104:107], a[152:155], v[184:187], v[104:107]
    v_mfma_f32_16x16x32_bf16 v[108:111], a[156:159], v[184:187], v[108:111]
    v_mfma_f32_16x16x32_bf16 v[124:127], a[156:159], v[188:191], v[124:127]
    ds_read_b64_tr_b16 v[140:141], v211 offset:16384
    ds_read_b64_tr_b16 v[142:143], v211 offset:17408
    v_mfma_f32_16x16x32_bf16 v[120:123], a[152:155], v[188:191], v[120:123]
    buffer_load_dwordx4 v221, s[8:11], s33 offen offset:1024 lds
    v_mfma_f32_16x16x32_bf16 v[116:119], a[148:151], v[188:191], v[116:119]
    v_mfma_f32_16x16x32_bf16 v[112:115], a[144:147], v[188:191], v[112:115]
    s_waitcnt lgkmcnt(6)
    v_mfma_f32_16x16x32_bf16 v[0:3], a[160:163], v[128:131], v[0:3]
    ds_read_b64_tr_b16 v[144:145], v212 offset:16384
    ds_read_b64_tr_b16 v[146:147], v212 offset:17408
    v_mfma_f32_16x16x32_bf16 v[4:7], a[164:167], v[128:131], v[4:7]
    buffer_load_dwordx4 v254, s[8:11], s33 offen offset:2048 lds
    v_mfma_f32_16x16x32_bf16 v[8:11], a[168:171], v[128:131], v[8:11]
    v_mfma_f32_16x16x32_bf16 v[12:15], a[172:175], v[128:131], v[12:15]
    v_mfma_f32_16x16x32_bf16 v[28:31], a[172:175], v[132:135], v[28:31]
    ds_read_b64_tr_b16 v[148:149], v213 offset:16384
    ds_read_b64_tr_b16 v[150:151], v213 offset:17408
    v_mfma_f32_16x16x32_bf16 v[24:27], a[168:171], v[132:135], v[24:27]
    buffer_load_dwordx4 v255, s[8:11], s33 offen offset:3072 lds
    v_mfma_f32_16x16x32_bf16 v[20:23], a[164:167], v[132:135], v[20:23]
    v_mfma_f32_16x16x32_bf16 v[16:19], a[160:163], v[132:135], v[16:19]
    s_waitcnt lgkmcnt(4)
    v_mfma_f32_16x16x32_bf16 v[32:35], a[160:163], v[136:139], v[32:35]
    ds_read_b64_tr_b16 v[152:153], v214 offset:16384
    ds_read_b64_tr_b16 v[154:155], v214 offset:17408
    v_mfma_f32_16x16x32_bf16 v[36:39], a[164:167], v[136:139], v[36:39]
    s_add_u32 m0, s30, 8192
    v_mfma_f32_16x16x32_bf16 v[40:43], a[168:171], v[136:139], v[40:43]
    s_add_u32 s28, s24, s92
    v_mfma_f32_16x16x32_bf16 v[44:47], a[172:175], v[136:139], v[44:47]
    v_mfma_f32_16x16x32_bf16 v[60:63], a[172:175], v[140:143], v[60:63]
    ds_read_b64_tr_b16 v[156:157], v215 offset:16384
    ds_read_b64_tr_b16 v[158:159], v215 offset:17408
    v_mfma_f32_16x16x32_bf16 v[56:59], a[168:171], v[140:143], v[56:59]
    buffer_load_dwordx4 v218, s[4:7], s28 offen offset:0 lds
    v_mfma_f32_16x16x32_bf16 v[52:55], a[164:167], v[140:143], v[52:55]
    v_mfma_f32_16x16x32_bf16 v[48:51], a[160:163], v[140:143], v[48:51]
    s_waitcnt lgkmcnt(4)
    v_mfma_f32_16x16x32_bf16 v[64:67], a[160:163], v[144:147], v[64:67]
    ds_read_b64_tr_b16 v[160:161], v208 offset:24576
    ds_read_b64_tr_b16 v[162:163], v208 offset:25600
    v_mfma_f32_16x16x32_bf16 v[68:71], a[164:167], v[144:147], v[68:71]
    buffer_load_dwordx4 v219, s[4:7], s28 offen offset:1024 lds
    v_mfma_f32_16x16x32_bf16 v[72:75], a[168:171], v[144:147], v[72:75]
    v_mfma_f32_16x16x32_bf16 v[76:79], a[172:175], v[144:147], v[76:79]
    buffer_load_dwordx4 v252, s[4:7], s28 offen offset:2048 lds
    v_mfma_f32_16x16x32_bf16 v[92:95], a[172:175], v[148:151], v[92:95]
    ds_read_b64_tr_b16 v[164:165], v209 offset:24576
    ds_read_b64_tr_b16 v[166:167], v209 offset:25600
    v_mfma_f32_16x16x32_bf16 v[88:91], a[168:171], v[148:151], v[88:91]
    v_mfma_f32_16x16x32_bf16 v[84:87], a[164:167], v[148:151], v[84:87]
    buffer_load_dwordx4 v253, s[4:7], s28 offen offset:3072 lds
    v_mfma_f32_16x16x32_bf16 v[80:83], a[160:163], v[148:151], v[80:83]
    s_waitcnt lgkmcnt(4)
    v_mfma_f32_16x16x32_bf16 v[96:99], a[160:163], v[152:155], v[96:99]
    ds_read_b64_tr_b16 v[168:169], v210 offset:24576
    ds_read_b64_tr_b16 v[170:171], v210 offset:25600
    v_mfma_f32_16x16x32_bf16 v[100:103], a[164:167], v[152:155], v[100:103]
    v_mfma_f32_16x16x32_bf16 v[104:107], a[168:171], v[152:155], v[104:107]
    s_add_u32 m0, s30, 12288
    v_mfma_f32_16x16x32_bf16 v[108:111], a[172:175], v[152:155], v[108:111]
    s_add_u32 s28, s25, s92
    v_mfma_f32_16x16x32_bf16 v[124:127], a[172:175], v[156:159], v[124:127]
    ds_read_b64_tr_b16 v[172:173], v211 offset:24576
    ds_read_b64_tr_b16 v[174:175], v211 offset:25600
    v_mfma_f32_16x16x32_bf16 v[120:123], a[168:171], v[156:159], v[120:123]
    buffer_load_dwordx4 v218, s[4:7], s28 offen offset:0 lds
    v_mfma_f32_16x16x32_bf16 v[116:119], a[164:167], v[156:159], v[116:119]
    v_mfma_f32_16x16x32_bf16 v[112:115], a[160:163], v[156:159], v[112:115]
    s_waitcnt lgkmcnt(4)
    v_mfma_f32_16x16x32_bf16 v[0:3], a[176:179], v[160:163], v[0:3]
    ds_read_b64_tr_b16 v[176:177], v212 offset:24576
    ds_read_b64_tr_b16 v[178:179], v212 offset:25600
    v_mfma_f32_16x16x32_bf16 v[4:7], a[180:183], v[160:163], v[4:7]
    buffer_load_dwordx4 v219, s[4:7], s28 offen offset:1024 lds
    v_mfma_f32_16x16x32_bf16 v[8:11], a[184:187], v[160:163], v[8:11]
    v_mfma_f32_16x16x32_bf16 v[12:15], a[188:191], v[160:163], v[12:15]
    v_mfma_f32_16x16x32_bf16 v[28:31], a[188:191], v[164:167], v[28:31]
    ds_read_b64_tr_b16 v[180:181], v213 offset:24576
    ds_read_b64_tr_b16 v[182:183], v213 offset:25600
    v_mfma_f32_16x16x32_bf16 v[24:27], a[184:187], v[164:167], v[24:27]
    buffer_load_dwordx4 v252, s[4:7], s28 offen offset:2048 lds
    v_mfma_f32_16x16x32_bf16 v[20:23], a[180:183], v[164:167], v[20:23]
    v_mfma_f32_16x16x32_bf16 v[16:19], a[176:179], v[164:167], v[16:19]
    s_waitcnt lgkmcnt(4)
    v_mfma_f32_16x16x32_bf16 v[32:35], a[176:179], v[168:171], v[32:35]
    ds_read_b64_tr_b16 v[184:185], v214 offset:24576
    ds_read_b64_tr_b16 v[186:187], v214 offset:25600
    v_mfma_f32_16x16x32_bf16 v[36:39], a[180:183], v[168:171], v[36:39]
    buffer_load_dwordx4 v253, s[4:7], s28 offen offset:3072 lds
    v_mfma_f32_16x16x32_bf16 v[40:43], a[184:187], v[168:171], v[40:43]
    v_mfma_f32_16x16x32_bf16 v[44:47], a[188:191], v[168:171], v[44:47]
    v_mfma_f32_16x16x32_bf16 v[60:63], a[188:191], v[172:175], v[60:63]
    s_waitcnt vmcnt(12)
    ds_read_b64_tr_b16 v[188:189], v215 offset:24576
    ds_read_b64_tr_b16 v[190:191], v215 offset:25600
    s_barrier
    v_mfma_f32_16x16x32_bf16 v[56:59], a[184:187], v[172:175], v[56:59]
    ds_read_b128 a[192:195], v216 offset:0
    ds_read_b128 a[196:199], v216 offset:2048
    v_mfma_f32_16x16x32_bf16 v[52:55], a[180:183], v[172:175], v[52:55]
    ds_read_b128 a[200:203], v216 offset:4096
    ds_read_b128 a[204:207], v216 offset:6144
    v_mfma_f32_16x16x32_bf16 v[48:51], a[176:179], v[172:175], v[48:51]
    s_waitcnt lgkmcnt(8)
    s_add_u32 m0, s38, 65536
    v_mfma_f32_16x16x32_bf16 v[64:67], a[176:179], v[176:179], v[64:67]
    s_add_u32 s27, s23, s37
    ds_read_b64_tr_b16 v[128:129], v208 offset:32768
    ds_read_b64_tr_b16 v[130:131], v208 offset:33792
    v_mfma_f32_16x16x32_bf16 v[68:71], a[180:183], v[176:179], v[68:71]
    buffer_load_dwordx4 v238, s[8:11], s27 offen lds
    v_mfma_f32_16x16x32_bf16 v[72:75], a[184:187], v[176:179], v[72:75]
    ds_read_b128 a[208:211], v217 offset:0
    ds_read_b128 a[212:215], v217 offset:2048
    v_mfma_f32_16x16x32_bf16 v[76:79], a[188:191], v[176:179], v[76:79]
    v_mfma_f32_16x16x32_bf16 v[92:95], a[188:191], v[180:183], v[92:95]
    s_add_u32 m0, s38, 66560
    ds_read_b64_tr_b16 v[132:133], v209 offset:32768
    ds_read_b64_tr_b16 v[134:135], v209 offset:33792
    v_mfma_f32_16x16x32_bf16 v[88:91], a[184:187], v[180:183], v[88:91]
    v_mfma_f32_16x16x32_bf16 v[84:87], a[180:183], v[180:183], v[84:87]
    s_add_u32 s27, s27, s36
    ds_read_b128 a[216:219], v217 offset:4096
    ds_read_b128 a[220:223], v217 offset:6144
    v_mfma_f32_16x16x32_bf16 v[80:83], a[176:179], v[180:183], v[80:83]
    s_waitcnt lgkmcnt(12)
    v_mfma_f32_16x16x32_bf16 v[96:99], a[176:179], v[184:187], v[96:99]
    ds_read_b64_tr_b16 v[136:137], v210 offset:32768
    ds_read_b64_tr_b16 v[138:139], v210 offset:33792
    v_mfma_f32_16x16x32_bf16 v[100:103], a[180:183], v[184:187], v[100:103]
    buffer_load_dwordx4 v239, s[8:11], s27 offen lds
    v_mfma_f32_16x16x32_bf16 v[104:107], a[184:187], v[184:187], v[104:107]
    s_add_u32 m0, s38, 67584
    v_mfma_f32_16x16x32_bf16 v[108:111], a[188:191], v[184:187], v[108:111]
    v_mfma_f32_16x16x32_bf16 v[124:127], a[188:191], v[188:191], v[124:127]
    s_add_u32 s27, s27, s36
    ds_read_b64_tr_b16 v[140:141], v211 offset:32768
    ds_read_b64_tr_b16 v[142:143], v211 offset:33792
    v_mfma_f32_16x16x32_bf16 v[120:123], a[184:187], v[188:191], v[120:123]
    buffer_load_dwordx4 v238, s[8:11], s27 offen lds
    v_mfma_f32_16x16x32_bf16 v[116:119], a[180:183], v[188:191], v[116:119]
    v_mfma_f32_16x16x32_bf16 v[112:115], a[176:179], v[188:191], v[112:115]
    s_waitcnt lgkmcnt(6)
    v_mfma_f32_16x16x32_bf16 v[0:3], a[192:195], v[128:131], v[0:3]
    s_add_u32 m0, s38, 68608
    ds_read_b64_tr_b16 v[144:145], v212 offset:32768
    ds_read_b64_tr_b16 v[146:147], v212 offset:33792
    v_mfma_f32_16x16x32_bf16 v[4:7], a[196:199], v[128:131], v[4:7]
    v_mfma_f32_16x16x32_bf16 v[8:11], a[200:203], v[128:131], v[8:11]
    s_add_u32 s27, s27, s36
    v_mfma_f32_16x16x32_bf16 v[12:15], a[204:207], v[128:131], v[12:15]
    buffer_load_dwordx4 v239, s[8:11], s27 offen lds
    v_mfma_f32_16x16x32_bf16 v[28:31], a[204:207], v[132:135], v[28:31]
    ds_read_b64_tr_b16 v[148:149], v213 offset:32768
    ds_read_b64_tr_b16 v[150:151], v213 offset:33792
    v_mfma_f32_16x16x32_bf16 v[24:27], a[200:203], v[132:135], v[24:27]
    v_mfma_f32_16x16x32_bf16 v[20:23], a[196:199], v[132:135], v[20:23]
    s_add_u32 m0, s38, 69632
    v_mfma_f32_16x16x32_bf16 v[16:19], a[192:195], v[132:135], v[16:19]
    s_waitcnt lgkmcnt(4)
    s_add_u32 s27, s27, s36
    v_mfma_f32_16x16x32_bf16 v[32:35], a[192:195], v[136:139], v[32:35]
    ds_read_b64_tr_b16 v[152:153], v214 offset:32768
    ds_read_b64_tr_b16 v[154:155], v214 offset:33792
    v_mfma_f32_16x16x32_bf16 v[36:39], a[196:199], v[136:139], v[36:39]
    buffer_load_dwordx4 v238, s[8:11], s27 offen lds
    v_mfma_f32_16x16x32_bf16 v[40:43], a[200:203], v[136:139], v[40:43]
    v_mfma_f32_16x16x32_bf16 v[44:47], a[204:207], v[136:139], v[44:47]
    v_mfma_f32_16x16x32_bf16 v[60:63], a[204:207], v[140:143], v[60:63]
    s_add_u32 m0, s38, 70656
    ds_read_b64_tr_b16 v[156:157], v215 offset:32768
    ds_read_b64_tr_b16 v[158:159], v215 offset:33792
    v_mfma_f32_16x16x32_bf16 v[56:59], a[200:203], v[140:143], v[56:59]
    s_add_u32 s27, s27, s36
    v_mfma_f32_16x16x32_bf16 v[52:55], a[196:199], v[140:143], v[52:55]
    v_mfma_f32_16x16x32_bf16 v[48:51], a[192:195], v[140:143], v[48:51]
    s_waitcnt lgkmcnt(4)
    v_mfma_f32_16x16x32_bf16 v[64:67], a[192:195], v[144:147], v[64:67]
    ds_read_b64_tr_b16 v[160:161], v208 offset:40960
    ds_read_b64_tr_b16 v[162:163], v208 offset:41984
    v_mfma_f32_16x16x32_bf16 v[68:71], a[196:199], v[144:147], v[68:71]
    buffer_load_dwordx4 v239, s[8:11], s27 offen lds
    v_mfma_f32_16x16x32_bf16 v[72:75], a[200:203], v[144:147], v[72:75]
    s_add_u32 m0, s38, 71680
    v_mfma_f32_16x16x32_bf16 v[76:79], a[204:207], v[144:147], v[76:79]
    s_add_u32 s27, s27, s36
    v_mfma_f32_16x16x32_bf16 v[92:95], a[204:207], v[148:151], v[92:95]
    ds_read_b64_tr_b16 v[164:165], v209 offset:40960
    ds_read_b64_tr_b16 v[166:167], v209 offset:41984
    v_mfma_f32_16x16x32_bf16 v[88:91], a[200:203], v[148:151], v[88:91]
    buffer_load_dwordx4 v238, s[8:11], s27 offen lds
    v_mfma_f32_16x16x32_bf16 v[84:87], a[196:199], v[148:151], v[84:87]
    v_mfma_f32_16x16x32_bf16 v[80:83], a[192:195], v[148:151], v[80:83]
    s_waitcnt lgkmcnt(4)
    v_mfma_f32_16x16x32_bf16 v[96:99], a[192:195], v[152:155], v[96:99]
    s_add_u32 m0, s38, 72704
    ds_read_b64_tr_b16 v[168:169], v210 offset:40960
    ds_read_b64_tr_b16 v[170:171], v210 offset:41984
    v_mfma_f32_16x16x32_bf16 v[100:103], a[196:199], v[152:155], v[100:103]
    s_add_u32 s27, s27, s36
    v_mfma_f32_16x16x32_bf16 v[104:107], a[200:203], v[152:155], v[104:107]
    v_mfma_f32_16x16x32_bf16 v[108:111], a[204:207], v[152:155], v[108:111]
    buffer_load_dwordx4 v239, s[8:11], s27 offen lds
    v_mfma_f32_16x16x32_bf16 v[124:127], a[204:207], v[156:159], v[124:127]
    ds_read_b64_tr_b16 v[172:173], v211 offset:40960
    ds_read_b64_tr_b16 v[174:175], v211 offset:41984
    v_mfma_f32_16x16x32_bf16 v[120:123], a[200:203], v[156:159], v[120:123]
    v_mfma_f32_16x16x32_bf16 v[116:119], a[196:199], v[156:159], v[116:119]
    v_mfma_f32_16x16x32_bf16 v[112:115], a[192:195], v[156:159], v[112:115]
    s_waitcnt lgkmcnt(4)
    v_mfma_f32_16x16x32_bf16 v[0:3], a[208:211], v[160:163], v[0:3]
    ds_read_b64_tr_b16 v[176:177], v212 offset:40960
    ds_read_b64_tr_b16 v[178:179], v212 offset:41984
    v_mfma_f32_16x16x32_bf16 v[4:7], a[212:215], v[160:163], v[4:7]
    v_mfma_f32_16x16x32_bf16 v[8:11], a[216:219], v[160:163], v[8:11]
    v_mfma_f32_16x16x32_bf16 v[12:15], a[220:223], v[160:163], v[12:15]
    v_mfma_f32_16x16x32_bf16 v[28:31], a[220:223], v[164:167], v[28:31]
    ds_read_b64_tr_b16 v[180:181], v213 offset:40960
    ds_read_b64_tr_b16 v[182:183], v213 offset:41984
    v_mfma_f32_16x16x32_bf16 v[24:27], a[216:219], v[164:167], v[24:27]
    v_mfma_f32_16x16x32_bf16 v[20:23], a[212:215], v[164:167], v[20:23]
    v_mfma_f32_16x16x32_bf16 v[16:19], a[208:211], v[164:167], v[16:19]
    s_waitcnt lgkmcnt(4)
    v_mfma_f32_16x16x32_bf16 v[32:35], a[208:211], v[168:171], v[32:35]
    ds_read_b64_tr_b16 v[184:185], v214 offset:40960
    ds_read_b64_tr_b16 v[186:187], v214 offset:41984
    v_mfma_f32_16x16x32_bf16 v[36:39], a[212:215], v[168:171], v[36:39]
    v_mfma_f32_16x16x32_bf16 v[40:43], a[216:219], v[168:171], v[40:43]
    v_mfma_f32_16x16x32_bf16 v[44:47], a[220:223], v[168:171], v[44:47]
    v_mfma_f32_16x16x32_bf16 v[60:63], a[220:223], v[172:175], v[60:63]
    s_waitcnt vmcnt(8)
    ds_read_b64_tr_b16 v[188:189], v215 offset:40960
    ds_read_b64_tr_b16 v[190:191], v215 offset:41984
    s_barrier
    v_mfma_f32_16x16x32_bf16 v[56:59], a[216:219], v[172:175], v[56:59]
    ds_read_b128 a[224:227], v216 offset:8192
    ds_read_b128 a[228:231], v216 offset:10240
    v_mfma_f32_16x16x32_bf16 v[52:55], a[212:215], v[172:175], v[52:55]
    ds_read_b128 a[232:235], v216 offset:12288
    ds_read_b128 a[236:239], v216 offset:14336
    v_mfma_f32_16x16x32_bf16 v[48:51], a[208:211], v[172:175], v[48:51]
    s_waitcnt lgkmcnt(8)
    s_add_u32 m0, s38, 0
    v_mfma_f32_16x16x32_bf16 v[64:67], a[208:211], v[176:179], v[64:67]
    s_add_u32 s27, s23, s96
    ds_read_b64_tr_b16 v[128:129], v208 offset:49152
    ds_read_b64_tr_b16 v[130:131], v208 offset:50176
    v_mfma_f32_16x16x32_bf16 v[68:71], a[212:215], v[176:179], v[68:71]
    buffer_load_dwordx4 v238, s[8:11], s27 offen lds
    v_mfma_f32_16x16x32_bf16 v[72:75], a[216:219], v[176:179], v[72:75]
    ds_read_b128 a[240:243], v217 offset:8192
    ds_read_b128 a[244:247], v217 offset:10240
    v_mfma_f32_16x16x32_bf16 v[76:79], a[220:223], v[176:179], v[76:79]
    v_mfma_f32_16x16x32_bf16 v[92:95], a[220:223], v[180:183], v[92:95]
    s_add_u32 m0, s38, 1024
    ds_read_b64_tr_b16 v[132:133], v209 offset:49152
    ds_read_b64_tr_b16 v[134:135], v209 offset:50176
    v_mfma_f32_16x16x32_bf16 v[88:91], a[216:219], v[180:183], v[88:91]
    v_mfma_f32_16x16x32_bf16 v[84:87], a[212:215], v[180:183], v[84:87]
    s_add_u32 s27, s27, s36
    ds_read_b128 a[248:251], v217 offset:12288
    ds_read_b128 a[252:255], v217 offset:14336
    v_mfma_f32_16x16x32_bf16 v[80:83], a[208:211], v[180:183], v[80:83]
    s_waitcnt lgkmcnt(12)
    v_mfma_f32_16x16x32_bf16 v[96:99], a[208:211], v[184:187], v[96:99]
    ds_read_b64_tr_b16 v[136:137], v210 offset:49152
    ds_read_b64_tr_b16 v[138:139], v210 offset:50176
    v_mfma_f32_16x16x32_bf16 v[100:103], a[212:215], v[184:187], v[100:103]
    buffer_load_dwordx4 v239, s[8:11], s27 offen lds
    v_mfma_f32_16x16x32_bf16 v[104:107], a[216:219], v[184:187], v[104:107]
    s_add_u32 m0, s38, 2048
    v_mfma_f32_16x16x32_bf16 v[108:111], a[220:223], v[184:187], v[108:111]
    s_add_u32 s27, s27, s36
    v_mfma_f32_16x16x32_bf16 v[124:127], a[220:223], v[188:191], v[124:127]
    ds_read_b64_tr_b16 v[140:141], v211 offset:49152
    ds_read_b64_tr_b16 v[142:143], v211 offset:50176
    v_mfma_f32_16x16x32_bf16 v[120:123], a[216:219], v[188:191], v[120:123]
    buffer_load_dwordx4 v238, s[8:11], s27 offen lds
    v_mfma_f32_16x16x32_bf16 v[116:119], a[212:215], v[188:191], v[116:119]
    v_mfma_f32_16x16x32_bf16 v[112:115], a[208:211], v[188:191], v[112:115]
    s_waitcnt lgkmcnt(6)
    v_mfma_f32_16x16x32_bf16 v[0:3], a[224:227], v[128:131], v[0:3]
    s_add_u32 m0, s38, 3072
    ds_read_b64_tr_b16 v[144:145], v212 offset:49152
    ds_read_b64_tr_b16 v[146:147], v212 offset:50176
    v_mfma_f32_16x16x32_bf16 v[4:7], a[228:231], v[128:131], v[4:7]
    s_add_u32 s27, s27, s36
    v_mfma_f32_16x16x32_bf16 v[8:11], a[232:235], v[128:131], v[8:11]
    buffer_load_dwordx4 v239, s[8:11], s27 offen lds
    v_mfma_f32_16x16x32_bf16 v[12:15], a[236:239], v[128:131], v[12:15]
    v_mfma_f32_16x16x32_bf16 v[28:31], a[236:239], v[132:135], v[28:31]
    ds_read_b64_tr_b16 v[148:149], v213 offset:49152
    ds_read_b64_tr_b16 v[150:151], v213 offset:50176
    v_mfma_f32_16x16x32_bf16 v[24:27], a[232:235], v[132:135], v[24:27]
    s_add_u32 m0, s38, 4096
    v_mfma_f32_16x16x32_bf16 v[20:23], a[228:231], v[132:135], v[20:23]
    v_mfma_f32_16x16x32_bf16 v[16:19], a[224:227], v[132:135], v[16:19]
    s_waitcnt lgkmcnt(4)
    s_add_u32 s27, s27, s36
    v_mfma_f32_16x16x32_bf16 v[32:35], a[224:227], v[136:139], v[32:35]
    ds_read_b64_tr_b16 v[152:153], v214 offset:49152
    ds_read_b64_tr_b16 v[154:155], v214 offset:50176
    v_mfma_f32_16x16x32_bf16 v[36:39], a[228:231], v[136:139], v[36:39]
    buffer_load_dwordx4 v238, s[8:11], s27 offen lds
    v_mfma_f32_16x16x32_bf16 v[40:43], a[232:235], v[136:139], v[40:43]
    v_mfma_f32_16x16x32_bf16 v[44:47], a[236:239], v[136:139], v[44:47]
    s_add_u32 m0, s38, 5120
    v_mfma_f32_16x16x32_bf16 v[60:63], a[236:239], v[140:143], v[60:63]
    s_add_u32 s27, s27, s36
    ds_read_b64_tr_b16 v[156:157], v215 offset:49152
    ds_read_b64_tr_b16 v[158:159], v215 offset:50176
    v_mfma_f32_16x16x32_bf16 v[56:59], a[232:235], v[140:143], v[56:59]
    v_mfma_f32_16x16x32_bf16 v[52:55], a[228:231], v[140:143], v[52:55]
    buffer_load_dwordx4 v239, s[8:11], s27 offen lds
    v_mfma_f32_16x16x32_bf16 v[48:51], a[224:227], v[140:143], v[48:51]
    s_waitcnt lgkmcnt(4)
    v_mfma_f32_16x16x32_bf16 v[64:67], a[224:227], v[144:147], v[64:67]
    ds_read_b64_tr_b16 v[160:161], v208 offset:57344
    ds_read_b64_tr_b16 v[162:163], v208 offset:58368
    v_mfma_f32_16x16x32_bf16 v[68:71], a[228:231], v[144:147], v[68:71]
    s_add_u32 m0, s38, 6144
    v_mfma_f32_16x16x32_bf16 v[72:75], a[232:235], v[144:147], v[72:75]
    s_add_u32 s27, s27, s36
    v_mfma_f32_16x16x32_bf16 v[76:79], a[236:239], v[144:147], v[76:79]
    v_mfma_f32_16x16x32_bf16 v[92:95], a[236:239], v[148:151], v[92:95]
    ds_read_b64_tr_b16 v[164:165], v209 offset:57344
    ds_read_b64_tr_b16 v[166:167], v209 offset:58368
    v_mfma_f32_16x16x32_bf16 v[88:91], a[232:235], v[148:151], v[88:91]
    buffer_load_dwordx4 v238, s[8:11], s27 offen lds
    v_mfma_f32_16x16x32_bf16 v[84:87], a[228:231], v[148:151], v[84:87]
    s_add_u32 m0, s38, 7168
    v_mfma_f32_16x16x32_bf16 v[80:83], a[224:227], v[148:151], v[80:83]
    s_waitcnt lgkmcnt(4)
    v_mfma_f32_16x16x32_bf16 v[96:99], a[224:227], v[152:155], v[96:99]
    s_add_u32 s27, s27, s36
    ds_read_b64_tr_b16 v[168:169], v210 offset:57344
    ds_read_b64_tr_b16 v[170:171], v210 offset:58368
    v_mfma_f32_16x16x32_bf16 v[100:103], a[228:231], v[152:155], v[100:103]
    buffer_load_dwordx4 v239, s[8:11], s27 offen lds
    v_mfma_f32_16x16x32_bf16 v[104:107], a[232:235], v[152:155], v[104:107]
    v_mfma_f32_16x16x32_bf16 v[108:111], a[236:239], v[152:155], v[108:111]
    v_mfma_f32_16x16x32_bf16 v[124:127], a[236:239], v[156:159], v[124:127]
    s_add_u32 s23, s23, 128
    ds_read_b64_tr_b16 v[172:173], v211 offset:57344
    ds_read_b64_tr_b16 v[174:175], v211 offset:58368
    v_mfma_f32_16x16x32_bf16 v[120:123], a[232:235], v[156:159], v[120:123]
    v_mfma_f32_16x16x32_bf16 v[116:119], a[228:231], v[156:159], v[116:119]
    v_mfma_f32_16x16x32_bf16 v[112:115], a[224:227], v[156:159], v[112:115]
    s_waitcnt lgkmcnt(4)
    v_mfma_f32_16x16x32_bf16 v[0:3], a[240:243], v[160:163], v[0:3]
    ds_read_b64_tr_b16 v[176:177], v212 offset:57344
    ds_read_b64_tr_b16 v[178:179], v212 offset:58368
    v_mfma_f32_16x16x32_bf16 v[4:7], a[244:247], v[160:163], v[4:7]
    v_mfma_f32_16x16x32_bf16 v[8:11], a[248:251], v[160:163], v[8:11]
    v_mfma_f32_16x16x32_bf16 v[12:15], a[252:255], v[160:163], v[12:15]
    v_mfma_f32_16x16x32_bf16 v[28:31], a[252:255], v[164:167], v[28:31]
    ds_read_b64_tr_b16 v[180:181], v213 offset:57344
    ds_read_b64_tr_b16 v[182:183], v213 offset:58368
    v_mfma_f32_16x16x32_bf16 v[24:27], a[248:251], v[164:167], v[24:27]
    v_mfma_f32_16x16x32_bf16 v[20:23], a[244:247], v[164:167], v[20:23]
    v_mfma_f32_16x16x32_bf16 v[16:19], a[240:243], v[164:167], v[16:19]
    s_waitcnt lgkmcnt(4)
    v_mfma_f32_16x16x32_bf16 v[32:35], a[240:243], v[168:171], v[32:35]
    ds_read_b64_tr_b16 v[184:185], v214 offset:57344
    ds_read_b64_tr_b16 v[186:187], v214 offset:58368
    v_mfma_f32_16x16x32_bf16 v[36:39], a[244:247], v[168:171], v[36:39]
    v_mfma_f32_16x16x32_bf16 v[40:43], a[248:251], v[168:171], v[40:43]
    v_mfma_f32_16x16x32_bf16 v[44:47], a[252:255], v[168:171], v[44:47]
    v_mfma_f32_16x16x32_bf16 v[60:63], a[252:255], v[172:175], v[60:63]
    ds_read_b64_tr_b16 v[188:189], v215 offset:57344
    ds_read_b64_tr_b16 v[190:191], v215 offset:58368
    v_mfma_f32_16x16x32_bf16 v[56:59], a[248:251], v[172:175], v[56:59]
    v_mfma_f32_16x16x32_bf16 v[52:55], a[244:247], v[172:175], v[52:55]
    v_mfma_f32_16x16x32_bf16 v[48:51], a[240:243], v[172:175], v[48:51]
    s_waitcnt lgkmcnt(4)
    v_mfma_f32_16x16x32_bf16 v[64:67], a[240:243], v[176:179], v[64:67]
    v_mfma_f32_16x16x32_bf16 v[68:71], a[244:247], v[176:179], v[68:71]
    v_mfma_f32_16x16x32_bf16 v[72:75], a[248:251], v[176:179], v[72:75]
    v_mfma_f32_16x16x32_bf16 v[76:79], a[252:255], v[176:179], v[76:79]
    v_mfma_f32_16x16x32_bf16 v[92:95], a[252:255], v[180:183], v[92:95]
    v_mfma_f32_16x16x32_bf16 v[88:91], a[248:251], v[180:183], v[88:91]
    v_mfma_f32_16x16x32_bf16 v[84:87], a[244:247], v[180:183], v[84:87]
    v_mfma_f32_16x16x32_bf16 v[80:83], a[240:243], v[180:183], v[80:83]
    s_waitcnt lgkmcnt(0)
    v_mfma_f32_16x16x32_bf16 v[96:99], a[240:243], v[184:187], v[96:99]
    v_mfma_f32_16x16x32_bf16 v[100:103], a[244:247], v[184:187], v[100:103]
    v_mfma_f32_16x16x32_bf16 v[104:107], a[248:251], v[184:187], v[104:107]
    v_mfma_f32_16x16x32_bf16 v[108:111], a[252:255], v[184:187], v[108:111]
    v_mfma_f32_16x16x32_bf16 v[124:127], a[252:255], v[188:191], v[124:127]
    v_mfma_f32_16x16x32_bf16 v[120:123], a[248:251], v[188:191], v[120:123]
    v_mfma_f32_16x16x32_bf16 v[116:119], a[244:247], v[188:191], v[116:119]
    v_mfma_f32_16x16x32_bf16 v[112:115], a[240:243], v[188:191], v[112:115]
    s_cmp_lg_u32 s16, 0
    s_cbranch_scc1 K1_cnt_13
    s_load_dwordx2 s[88:89], s[0:1], 88
    s_mov_b32 s90, 256
    s_mov_b32 s91, 0x20000
    v_mov_b32 v241, 1
    v_mov_b32 v242, 0
    s_waitcnt lgkmcnt(0)
    s_mov_b64 exec, 1
    buffer_atomic_add v241, v242, s[88:91], 0 offen sc1
    s_mov_b64 exec, -1
K1_cnt_13:
    s_nop 3
    s_lshr_b32 s22, s19, 2
    s_lshl_b32 s22, s22, 19
    s_and_b32 s26, s19, 3
    s_lshl_b32 s26, s26, 12
    s_add_u32 s22, s22, s26
    s_add_u32 s22, s22, s32
    s_add_u32 s19, s19, 1
    v_pk_mul_f32 v[192:193], v[0:1], s[20:21] op_sel_hi:[1,0]
    v_cvt_pk_bf16_f32 v160, v192, v193
    v_pk_mul_f32 v[194:195], v[2:3], s[20:21] op_sel_hi:[1,0]
    v_cvt_pk_bf16_f32 v161, v194, v195
    v_pk_mul_f32 v[196:197], v[4:5], s[20:21] op_sel_hi:[1,0]
    v_cvt_pk_bf16_f32 v162, v196, v197
    v_pk_mul_f32 v[198:199], v[6:7], s[20:21] op_sel_hi:[1,0]
    v_cvt_pk_bf16_f32 v163, v198, v199
    buffer_store_dwordx4 v[160:163], v234, s[12:15], s22 offen offset:0 sc1
    v_pk_mul_f32 v[200:201], v[16:17], s[20:21] op_sel_hi:[1,0]
    v_cvt_pk_bf16_f32 v164, v200, v201
    v_pk_mul_f32 v[202:203], v[18:19], s[20:21] op_sel_hi:[1,0]
    v_cvt_pk_bf16_f32 v165, v202, v203
    v_pk_mul_f32 v[204:205], v[20:21], s[20:21] op_sel_hi:[1,0]
    v_cvt_pk_bf16_f32 v166, v204, v205
    v_pk_mul_f32 v[206:207], v[22:23], s[20:21] op_sel_hi:[1,0]
    v_cvt_pk_bf16_f32 v167, v206, v207
    buffer_store_dwordx4 v[164:167], v234, s[12:15], s22 offen offset:1024 sc1
    v_pk_mul_f32 v[192:193], v[8:9], s[20:21] op_sel_hi:[1,0]
    v_cvt_pk_bf16_f32 v168, v192, v193
    v_pk_mul_f32 v[194:195], v[10:11], s[20:21] op_sel_hi:[1,0]
    v_cvt_pk_bf16_f32 v169, v194, v195
    v_pk_mul_f32 v[196:197], v[12:13], s[20:21] op_sel_hi:[1,0]
    v_cvt_pk_bf16_f32 v170, v196, v197
    v_pk_mul_f32 v[198:199], v[14:15], s[20:21] op_sel_hi:[1,0]
    v_cvt_pk_bf16_f32 v171, v198, v199
    buffer_store_dwordx4 v[168:171], v234, s[12:15], s22 offen offset:2048 sc1
    v_pk_mul_f32 v[200:201], v[24:25], s[20:21] op_sel_hi:[1,0]
    v_cvt_pk_bf16_f32 v172, v200, v201
    v_pk_mul_f32 v[202:203], v[26:27], s[20:21] op_sel_hi:[1,0]
    v_cvt_pk_bf16_f32 v173, v202, v203
    v_pk_mul_f32 v[204:205], v[28:29], s[20:21] op_sel_hi:[1,0]
    v_cvt_pk_bf16_f32 v174, v204, v205
    v_pk_mul_f32 v[206:207], v[30:31], s[20:21] op_sel_hi:[1,0]
    v_cvt_pk_bf16_f32 v175, v206, v207
    buffer_store_dwordx4 v[172:175], v234, s[12:15], s22 offen offset:3072 sc1
    s_lshr_b32 s22, s19, 2
    s_lshl_b32 s22, s22, 19
    s_and_b32 s26, s19, 3
    s_lshl_b32 s26, s26, 12
    s_add_u32 s22, s22, s26
    s_add_u32 s22, s22, s32
    s_add_u32 s19, s19, 1
    v_pk_mul_f32 v[192:193], v[32:33], s[20:21] op_sel_hi:[1,0]
    v_cvt_pk_bf16_f32 v176, v192, v193
    v_pk_mul_f32 v[194:195], v[34:35], s[20:21] op_sel_hi:[1,0]
    v_cvt_pk_bf16_f32 v177, v194, v195
    v_pk_mul_f32 v[196:197], v[36:37], s[20:21] op_sel_hi:[1,0]
    v_cvt_pk_bf16_f32 v178, v196, v197
    v_pk_mul_f32 v[198:199], v[38:39], s[20:21] op_sel_hi:[1,0]
    v_cvt_pk_bf16_f32 v179, v198, v199
    buffer_store_dwordx4 v[176:179], v234, s[12:15], s22 offen offset:0 sc1
    v_pk_mul_f32 v[200:201], v[48:49], s[20:21] op_sel_hi:[1,0]
    v_cvt_pk_bf16_f32 v180, v200, v201
    v_pk_mul_f32 v[202:203], v[50:51], s[20:21] op_sel_hi:[1,0]
    v_cvt_pk_bf16_f32 v181, v202, v203
    v_pk_mul_f32 v[204:205], v[52:53], s[20:21] op_sel_hi:[1,0]
    v_cvt_pk_bf16_f32 v182, v204, v205
    v_pk_mul_f32 v[206:207], v[54:55], s[20:21] op_sel_hi:[1,0]
    v_cvt_pk_bf16_f32 v183, v206, v207
    buffer_store_dwordx4 v[180:183], v234, s[12:15], s22 offen offset:1024 sc1
    v_pk_mul_f32 v[192:193], v[40:41], s[20:21] op_sel_hi:[1,0]
    v_cvt_pk_bf16_f32 v184, v192, v193
    v_pk_mul_f32 v[194:195], v[42:43], s[20:21] op_sel_hi:[1,0]
    v_cvt_pk_bf16_f32 v185, v194, v195
    v_pk_mul_f32 v[196:197], v[44:45], s[20:21] op_sel_hi:[1,0]
    v_cvt_pk_bf16_f32 v186, v196, v197
    v_pk_mul_f32 v[198:199], v[46:47], s[20:21] op_sel_hi:[1,0]
    v_cvt_pk_bf16_f32 v187, v198, v199
    buffer_store_dwordx4 v[184:187], v234, s[12:15], s22 offen offset:2048 sc1
    v_pk_mul_f32 v[200:201], v[56:57], s[20:21] op_sel_hi:[1,0]
    v_cvt_pk_bf16_f32 v188, v200, v201
    v_pk_mul_f32 v[202:203], v[58:59], s[20:21] op_sel_hi:[1,0]
    v_cvt_pk_bf16_f32 v189, v202, v203
    v_pk_mul_f32 v[204:205], v[60:61], s[20:21] op_sel_hi:[1,0]
    v_cvt_pk_bf16_f32 v190, v204, v205
    v_pk_mul_f32 v[206:207], v[62:63], s[20:21] op_sel_hi:[1,0]
    v_cvt_pk_bf16_f32 v191, v206, v207
    buffer_store_dwordx4 v[188:191], v234, s[12:15], s22 offen offset:3072 sc1
    s_waitcnt vmcnt(16)
    s_barrier
    ds_read_b64_tr_b16 v[128:129], v226 offset:0
    ds_read_b64_tr_b16 v[130:131], v226 offset:512
    ds_read_b64_tr_b16 v[132:133], v227 offset:0
    ds_read_b64_tr_b16 v[134:135], v227 offset:512
    ds_read_b64_tr_b16 v[136:137], v228 offset:0
    ds_read_b64_tr_b16 v[138:139], v228 offset:512
    s_mov_b32 s29, 0
K1_loop_14:
    s_waitcnt lgkmcnt(2)
    v_mfma_f32_16x16x32_bf16 v[0:3], a[0:3], v[128:131], 0
    s_add_u32 m0, s38, 32768
    ds_read_b64_tr_b16 v[140:141], v229 offset:0
    ds_read_b64_tr_b16 v[142:143], v229 offset:512
    v_mfma_f32_16x16x32_bf16 v[4:7], a[4:7], v[128:131], 0
    s_add_u32 s27, s23, s37
    v_mfma_f32_16x16x32_bf16 v[8:11], a[8:11], v[128:131], 0
    buffer_load_dwordx4 v238, s[8:11], s27 offen lds
    v_mfma_f32_16x16x32_bf16 v[12:15], a[12:15], v[128:131], 0
    s_add_u32 m0, s38, 33792
    v_mfma_f32_16x16x32_bf16 v[28:31], a[12:15], v[132:135], 0
    s_add_u32 s27, s27, s36
    ds_read_b64_tr_b16 v[144:145], v226 offset:4096
    ds_read_b64_tr_b16 v[146:147], v226 offset:4608
    v_mfma_f32_16x16x32_bf16 v[24:27], a[8:11], v[132:135], 0
    buffer_load_dwordx4 v239, s[8:11], s27 offen lds
    v_mfma_f32_16x16x32_bf16 v[20:23], a[4:7], v[132:135], 0
    s_add_u32 m0, s38, 34816
    v_mfma_f32_16x16x32_bf16 v[16:19], a[0:3], v[132:135], 0
    s_waitcnt lgkmcnt(2)
    s_add_u32 s27, s27, s36
    v_mfma_f32_16x16x32_bf16 v[32:35], a[0:3], v[136:139], 0
    ds_read_b64_tr_b16 v[148:149], v227 offset:4096
    ds_read_b64_tr_b16 v[150:151], v227 offset:4608
    v_mfma_f32_16x16x32_bf16 v[36:39], a[4:7], v[136:139], 0
    buffer_load_dwordx4 v238, s[8:11], s27 offen lds
    v_mfma_f32_16x16x32_bf16 v[40:43], a[8:11], v[136:139], 0
    s_add_u32 m0, s38, 35840
    s_add_u32 s27, s27, s36
    v_mfma_f32_16x16x32_bf16 v[44:47], a[12:15], v[136:139], 0
    buffer_load_dwordx4 v239, s[8:11], s27 offen lds
    v_mfma_f32_16x16x32_bf16 v[60:63], a[12:15], v[140:143], 0
    ds_read_b64_tr_b16 v[152:153], v228 offset:4096
    ds_read_b64_tr_b16 v[154:155], v228 offset:4608
    v_mfma_f32_16x16x32_bf16 v[56:59], a[8:11], v[140:143], 0
    s_add_u32 m0, s38, 36864
    s_add_u32 s27, s27, s36
    v_mfma_f32_16x16x32_bf16 v[52:55], a[4:7], v[140:143], 0
    buffer_load_dwordx4 v238, s[8:11], s27 offen lds
    v_mfma_f32_16x16x32_bf16 v[48:51], a[0:3], v[140:143], 0
    s_waitcnt lgkmcnt(2)
    s_lshr_b32 s22, s19, 2
    s_lshl_b32 s22, s22, 19
    v_mfma_f32_16x16x32_bf16 v[0:3], a[16:19], v[144:147], v[0:3]
    s_add_u32 m0, s38, 37888
    ds_read_b64_tr_b16 v[156:157], v229 offset:4096
    ds_read_b64_tr_b16 v[158:159], v229 offset:4608
    v_mfma_f32_16x16x32_bf16 v[4:7], a[20:23], v[144:147], v[4:7]
    s_add_u32 s27, s27, s36
    s_and_b32 s26, s19, 3
    v_mfma_f32_16x16x32_bf16 v[8:11], a[24:27], v[144:147], v[8:11]
    buffer_load_dwordx4 v239, s[8:11], s27 offen lds
    v_mfma_f32_16x16x32_bf16 v[12:15], a[28:31], v[144:147], v[12:15]
    s_add_u32 m0, s38, 38912
    s_lshl_b32 s26, s26, 12
    v_mfma_f32_16x16x32_bf16 v[28:31], a[28:31], v[148:151], v[28:31]
    s_add_u32 s27, s27, s36
    ds_read_b64_tr_b16 v[128:129], v226 offset:8192
    ds_read_b64_tr_b16 v[130:131], v226 offset:8704
    v_mfma_f32_16x16x32_bf16 v[24:27], a[24:27], v[148:151], v[24:27]
    buffer_load_dwordx4 v238, s[8:11], s27 offen lds
    v_mfma_f32_16x16x32_bf16 v[20:23], a[20:23], v[148:151], v[20:23]
    s_add_u32 m0, s38, 39936
    s_add_u32 s22, s22, s26
    s_add_u32 s22, s22, s32
    v_mfma_f32_16x16x32_bf16 v[16:19], a[16:19], v[148:151], v[16:19]
    s_waitcnt lgkmcnt(2)
    s_add_u32 s27, s27, s36
    s_add_u32 s19, s19, 1
    v_mfma_f32_16x16x32_bf16 v[32:35], a[16:19], v[152:155], v[32:35]
    ds_read_b64_tr_b16 v[132:133], v227 offset:8192
    ds_read_b64_tr_b16 v[134:135], v227 offset:8704
    v_mfma_f32_16x16x32_bf16 v[36:39], a[20:23], v[152:155], v[36:39]
    buffer_load_dwordx4 v239, s[8:11], s27 offen lds
    v_mfma_f32_16x16x32_bf16 v[40:43], a[24:27], v[152:155], v[40:43]
    v_mul_f32 v192, s20, v64
    v_mul_f32 v193, s20, v65
    v_mfma_f32_16x16x32_bf16 v[44:47], a[28:31], v[152:155], v[44:47]
    v_cvt_pk_bf16_f32 v160, v192, v193
    v_mfma_f32_16x16x32_bf16 v[60:63], a[28:31], v[156:159], v[60:63]
    ds_read_b64_tr_b16 v[136:137], v228 offset:8192
    ds_read_b64_tr_b16 v[138:139], v228 offset:8704
    v_mfma_f32_16x16x32_bf16 v[56:59], a[24:27], v[156:159], v[56:59]
    v_mul_f32 v194, s20, v66
    v_mfma_f32_16x16x32_bf16 v[52:55], a[20:23], v[156:159], v[52:55]
    v_mul_f32 v195, s20, v67
    v_mfma_f32_16x16x32_bf16 v[48:51], a[16:19], v[156:159], v[48:51]
    s_waitcnt lgkmcnt(2)
    v_mfma_f32_16x16x32_bf16 v[0:3], a[32:35], v[128:131], v[0:3]
    ds_read_b64_tr_b16 v[140:141], v229 offset:8192
    ds_read_b64_tr_b16 v[142:143], v229 offset:8704
    v_mfma_f32_16x16x32_bf16 v[4:7], a[36:39], v[128:131], v[4:7]
    v_cvt_pk_bf16_f32 v161, v194, v195
    v_mul_f32 v196, s20, v68
    v_mfma_f32_16x16x32_bf16 v[8:11], a[40:43], v[128:131], v[8:11]
    v_mfma_f32_16x16x32_bf16 v[12:15], a[44:47], v[128:131], v[12:15]
    v_mul_f32 v197, s20, v69
    v_mfma_f32_16x16x32_bf16 v[28:31], a[44:47], v[132:135], v[28:31]
    ds_read_b64_tr_b16 v[144:145], v226 offset:12288
    ds_read_b64_tr_b16 v[146:147], v226 offset:12800
    v_mfma_f32_16x16x32_bf16 v[24:27], a[40:43], v[132:135], v[24:27]
    v_cvt_pk_bf16_f32 v162, v196, v197
    v_mfma_f32_16x16x32_bf16 v[20:23], a[36:39], v[132:135], v[20:23]
    v_mul_f32 v198, s20, v70
    v_mfma_f32_16x16x32_bf16 v[16:19], a[32:35], v[132:135], v[16:19]
    s_waitcnt lgkmcnt(2)
    v_mul_f32 v199, s20, v71
    v_mfma_f32_16x16x32_bf16 v[32:35], a[32:35], v[136:139], v[32:35]
    ds_read_b64_tr_b16 v[148:149], v227 offset:12288
    ds_read_b64_tr_b16 v[150:151], v227 offset:12800
    v_mfma_f32_16x16x32_bf16 v[36:39], a[36:39], v[136:139], v[36:39]
    v_cvt_pk_bf16_f32 v163, v198, v199
    v_mfma_f32_16x16x32_bf16 v[40:43], a[40:43], v[136:139], v[40:43]
    buffer_store_dwordx4 v[160:163], v234, s[12:15], s22 offen offset:0 sc1
    v_mfma_f32_16x16x32_bf16 v[44:47], a[44:47], v[136:139], v[44:47]
    v_mfma_f32_16x16x32_bf16 v[60:63], a[44:47], v[140:143], v[60:63]
    ds_read_b64_tr_b16 v[152:153], v228 offset:12288
    ds_read_b64_tr_b16 v[154:155], v228 offset:12800
    v_mfma_f32_16x16x32_bf16 v[56:59], a[40:43], v[140:143], v[56:59]
    v_mfma_f32_16x16x32_bf16 v[52:55], a[36:39], v[140:143], v[52:55]
    v_mul_f32 v200, s20, v80
    v_mfma_f32_16x16x32_bf16 v[48:51], a[32:35], v[140:143], v[48:51]
    s_waitcnt lgkmcnt(2)
    v_mul_f32 v201, s20, v81
    v_mfma_f32_16x16x32_bf16 v[0:3], a[48:51], v[144:147], v[0:3]
    ds_read_b64_tr_b16 v[156:157], v229 offset:12288
    ds_read_b64_tr_b16 v[158:159], v229 offset:12800
    v_mfma_f32_16x16x32_bf16 v[4:7], a[52:55], v[144:147], v[4:7]
    v_cvt_pk_bf16_f32 v164, v200, v201
    v_mfma_f32_16x16x32_bf16 v[8:11], a[56:59], v[144:147], v[8:11]
    v_mul_f32 v202, s20, v82
    v_mfma_f32_16x16x32_bf16 v[12:15], a[60:63], v[144:147], v[12:15]
    v_mfma_f32_16x16x32_bf16 v[28:31], a[60:63], v[148:151], v[28:31]
    ds_read_b64_tr_b16 v[128:129], v226 offset:16384
    ds_read_b64_tr_b16 v[130:131], v226 offset:16896
    v_mfma_f32_16x16x32_bf16 v[24:27], a[56:59], v[148:151], v[24:27]
    v_mul_f32 v203, s20, v83
    v_cvt_pk_bf16_f32 v165, v202, v203
    v_mfma_f32_16x16x32_bf16 v[20:23], a[52:55], v[148:151], v[20:23]
    v_mfma_f32_16x16x32_bf16 v[16:19], a[48:51], v[148:151], v[16:19]
    s_waitcnt lgkmcnt(2)
    v_mul_f32 v204, s20, v84
    v_mfma_f32_16x16x32_bf16 v[32:35], a[48:51], v[152:155], v[32:35]
    ds_read_b64_tr_b16 v[132:133], v227 offset:16384
    ds_read_b64_tr_b16 v[134:135], v227 offset:16896
    v_mfma_f32_16x16x32_bf16 v[36:39], a[52:55], v[152:155], v[36:39]
    v_mul_f32 v205, s20, v85
    v_mfma_f32_16x16x32_bf16 v[40:43], a[56:59], v[152:155], v[40:43]
    v_cvt_pk_bf16_f32 v166, v204, v205
    v_mfma_f32_16x16x32_bf16 v[44:47], a[60:63], v[152:155], v[44:47]
    v_mul_f32 v206, s20, v86
    v_mfma_f32_16x16x32_bf16 v[60:63], a[60:63], v[156:159], v[60:63]
    ds_read_b64_tr_b16 v[136:137], v228 offset:16384
    ds_read_b64_tr_b16 v[138:139], v228 offset:16896
    v_mfma_f32_16x16x32_bf16 v[56:59], a[56:59], v[156:159], v[56:59]
    v_mul_f32 v207, s20, v87
    v_mfma_f32_16x16x32_bf16 v[52:55], a[52:55], v[156:159], v[52:55]
    v_cvt_pk_bf16_f32 v167, v206, v207
    v_mfma_f32_16x16x32_bf16 v[48:51], a[48:51], v[156:159], v[48:51]
    s_waitcnt lgkmcnt(2)
    v_mfma_f32_16x16x32_bf16 v[0:3], a[64:67], v[128:131], v[0:3]
    ds_read_b64_tr_b16 v[140:141], v229 offset:16384
    ds_read_b64_tr_b16 v[142:143], v229 offset:16896
    v_mfma_f32_16x16x32_bf16 v[4:7], a[68:71], v[128:131], v[4:7]
    buffer_store_dwordx4 v[164:167], v234, s[12:15], s22 offen offset:1024 sc1
    v_mfma_f32_16x16x32_bf16 v[8:11], a[72:75], v[128:131], v[8:11]
    v_mfma_f32_16x16x32_bf16 v[12:15], a[76:79], v[128:131], v[12:15]
    v_mul_f32 v192, s20, v72
    v_mfma_f32_16x16x32_bf16 v[28:31], a[76:79], v[132:135], v[28:31]
    ds_read_b64_tr_b16 v[144:145], v226 offset:20480
    ds_read_b64_tr_b16 v[146:147], v226 offset:20992
    v_mfma_f32_16x16x32_bf16 v[24:27], a[72:75], v[132:135], v[24:27]
    v_mul_f32 v193, s20, v73
    v_mfma_f32_16x16x32_bf16 v[20:23], a[68:71], v[132:135], v[20:23]
    v_cvt_pk_bf16_f32 v168, v192, v193
    v_mfma_f32_16x16x32_bf16 v[16:19], a[64:67], v[132:135], v[16:19]
    s_waitcnt lgkmcnt(2)
    v_mul_f32 v194, s20, v74
    v_mfma_f32_16x16x32_bf16 v[32:35], a[64:67], v[136:139], v[32:35]
    ds_read_b64_tr_b16 v[148:149], v227 offset:20480
    ds_read_b64_tr_b16 v[150:151], v227 offset:20992
    v_mfma_f32_16x16x32_bf16 v[36:39], a[68:71], v[136:139], v[36:39]
    v_mul_f32 v195, s20, v75
    v_mfma_f32_16x16x32_bf16 v[40:43], a[72:75], v[136:139], v[40:43]
    v_cvt_pk_bf16_f32 v169, v194, v195
    v_mfma_f32_16x16x32_bf16 v[44:47], a[76:79], v[136:139], v[44:47]
    v_mfma_f32_16x16x32_bf16 v[60:63], a[76:79], v[140:143], v[60:63]
    ds_read_b64_tr_b16 v[152:153], v228 offset:20480
    ds_read_b64_tr_b16 v[154:155], v228 offset:20992
    v_mfma_f32_16x16x32_bf16 v[56:59], a[72:75], v[140:143], v[56:59]
    v_mul_f32 v196, s20, v76
    v_mfma_f32_16x16x32_bf16 v[52:55], a[68:71], v[140:143], v[52:55]
    v_mul_f32 v197, s20, v77
    v_mfma_f32_16x16x32_bf16 v[48:51], a[64:67], v[140:143], v[48:51]
    s_waitcnt lgkmcnt(2)
    v_cvt_pk_bf16_f32 v170, v196, v197
    v_mfma_f32_16x16x32_bf16 v[0:3], a[80:83], v[144:147], v[0:3]
    ds_read_b64_tr_b16 v[156:157], v229 offset:20480
    ds_read_b64_tr_b16 v[158:159], v229 offset:20992
    v_mfma_f32_16x16x32_bf16 v[4:7], a[84:87], v[144:147], v[4:7]
    v_mul_f32 v198, s20, v78
    v_mfma_f32_16x16x32_bf16 v[8:11], a[88:91], v[144:147], v[8:11]
    v_mul_f32 v199, s20, v79
    v_mfma_f32_16x16x32_bf16 v[12:15], a[92:95], v[144:147], v[12:15]
    v_mfma_f32_16x16x32_bf16 v[28:31], a[92:95], v[148:151], v[28:31]
    ds_read_b64_tr_b16 v[128:129], v226 offset:24576
    ds_read_b64_tr_b16 v[130:131], v226 offset:25088
    v_mfma_f32_16x16x32_bf16 v[24:27], a[88:91], v[148:151], v[24:27]
    v_cvt_pk_bf16_f32 v171, v198, v199
    v_mfma_f32_16x16x32_bf16 v[20:23], a[84:87], v[148:151], v[20:23]
    buffer_store_dwordx4 v[168:171], v234, s[12:15], s22 offen offset:2048 sc1
    v_mfma_f32_16x16x32_bf16 v[16:19], a[80:83], v[148:151], v[16:19]
    s_waitcnt lgkmcnt(2)
    v_mfma_f32_16x16x32_bf16 v[32:35], a[80:83], v[152:155], v[32:35]
    ds_read_b64_tr_b16 v[132:133], v227 offset:24576
    ds_read_b64_tr_b16 v[134:135], v227 offset:25088
    v_mfma_f32_16x16x32_bf16 v[36:39], a[84:87], v[152:155], v[36:39]
    v_mul_f32 v200, s20, v88
    v_mfma_f32_16x16x32_bf16 v[40:43], a[88:91], v[152:155], v[40:43]
    v_mul_f32 v201, s20, v89
    v_mfma_f32_16x16x32_bf16 v[44:47], a[92:95], v[152:155], v[44:47]
    v_cvt_pk_bf16_f32 v172, v200, v201
    v_mfma_f32_16x16x32_bf16 v[60:63], a[92:95], v[156:159], v[60:63]
    ds_read_b64_tr_b16 v[136:137], v228 offset:24576
    ds_read_b64_tr_b16 v[138:139], v228 offset:25088
    v_mfma_f32_16x16x32_bf16 v[56:59], a[88:91], v[156:159], v[56:59]
    v_mul_f32 v202, s20, v90
    v_mfma_f32_16x16x32_bf16 v[52:55], a[84:87], v[156:159], v[52:55]
    v_mul_f32 v203, s20, v91
    v_mfma_f32_16x16x32_bf16 v[48:51], a[80:83], v[156:159], v[48:51]
    s_waitcnt lgkmcnt(2)
    v_mfma_f32_16x16x32_bf16 v[0:3], a[96:99], v[128:131], v[0:3]
    ds_read_b64_tr_b16 v[140:141], v229 offset:24576
    ds_read_b64_tr_b16 v[142:143], v229 offset:25088
    v_mfma_f32_16x16x32_bf16 v[4:7], a[100:103], v[128:131], v[4:7]
    v_cvt_pk_bf16_f32 v173, v202, v203
    v_mul_f32 v204, s20, v92
    v_mfma_f32_16x16x32_bf16 v[8:11], a[104:107], v[128:131], v[8:11]
    v_mfma_f32_16x16x32_bf16 v[12:15], a[108:111], v[128:131], v[12:15]
    v_mul_f32 v205, s20, v93
    v_mfma_f32_16x16x32_bf16 v[28:31], a[108:111], v[132:135], v[28:31]
    ds_read_b64_tr_b16 v[144:145], v226 offset:28672
    ds_read_b64_tr_b16 v[146:147], v226 offset:29184
    v_mfma_f32_16x16x32_bf16 v[24:27], a[104:107], v[132:135], v[24:27]
    v_cvt_pk_bf16_f32 v174, v204, v205
    v_mfma_f32_16x16x32_bf16 v[20:23], a[100:103], v[132:135], v[20:23]
    v_mul_f32 v206, s20, v94
    v_mfma_f32_16x16x32_bf16 v[16:19], a[96:99], v[132:135], v[16:19]
    s_waitcnt lgkmcnt(2)
    v_mul_f32 v207, s20, v95
    v_mfma_f32_16x16x32_bf16 v[32:35], a[96:99], v[136:139], v[32:35]
    ds_read_b64_tr_b16 v[148:149], v227 offset:28672
    ds_read_b64_tr_b16 v[150:151], v227 offset:29184
    v_mfma_f32_16x16x32_bf16 v[36:39], a[100:103], v[136:139], v[36:39]
    v_cvt_pk_bf16_f32 v175, v206, v207
    v_mfma_f32_16x16x32_bf16 v[40:43], a[104:107], v[136:139], v[40:43]
    buffer_store_dwordx4 v[172:175], v234, s[12:15], s22 offen offset:3072 sc1
    v_mfma_f32_16x16x32_bf16 v[44:47], a[108:111], v[136:139], v[44:47]
    v_mfma_f32_16x16x32_bf16 v[60:63], a[108:111], v[140:143], v[60:63]
    ds_read_b64_tr_b16 v[152:153], v228 offset:28672
    ds_read_b64_tr_b16 v[154:155], v228 offset:29184
    v_mfma_f32_16x16x32_bf16 v[56:59], a[104:107], v[140:143], v[56:59]
    v_mfma_f32_16x16x32_bf16 v[52:55], a[100:103], v[140:143], v[52:55]
    v_mfma_f32_16x16x32_bf16 v[48:51], a[96:99], v[140:143], v[48:51]
    s_waitcnt lgkmcnt(2)
    v_mfma_f32_16x16x32_bf16 v[0:3], a[112:115], v[144:147], v[0:3]
    ds_read_b64_tr_b16 v[156:157], v229 offset:28672
    ds_read_b64_tr_b16 v[158:159], v229 offset:29184
    v_mfma_f32_16x16x32_bf16 v[4:7], a[116:119], v[144:147], v[4:7]
    v_mfma_f32_16x16x32_bf16 v[8:11], a[120:123], v[144:147], v[8:11]
    s_waitcnt vmcnt(16)
    s_barrier
    v_mfma_f32_16x16x32_bf16 v[12:15], a[124:127], v[144:147], v[12:15]
    v_mfma_f32_16x16x32_bf16 v[28:31], a[124:127], v[148:151], v[28:31]
    s_add_u32 m0, s94, 98304
    ds_read_b64_tr_b16 v[128:129], v222 offset:0
    ds_read_b64_tr_b16 v[130:131], v222 offset:512
    v_mfma_f32_16x16x32_bf16 v[24:27], a[120:123], v[148:151], v[24:27]
    s_add_u32 s27, s23, s96
    v_mfma_f32_16x16x32_bf16 v[20:23], a[116:119], v[148:151], v[20:23]
    buffer_load_dwordx4 v238, s[8:11], s27 offen lds
    v_mfma_f32_16x16x32_bf16 v[16:19], a[112:115], v[148:151], v[16:19]
    s_waitcnt lgkmcnt(2)
    s_add_u32 m0, s94, 99328
    s_add_u32 s27, s27, s36
    v_mfma_f32_16x16x32_bf16 v[32:35], a[112:115], v[152:155], v[32:35]
    ds_read_b64_tr_b16 v[132:133], v223 offset:0
    ds_read_b64_tr_b16 v[134:135], v223 offset:512
    v_mfma_f32_16x16x32_bf16 v[36:39], a[116:119], v[152:155], v[36:39]
    buffer_load_dwordx4 v239, s[8:11], s27 offen lds
    v_mfma_f32_16x16x32_bf16 v[40:43], a[120:123], v[152:155], v[40:43]
    s_add_u32 m0, s94, 100352
    v_mfma_f32_16x16x32_bf16 v[44:47], a[124:127], v[152:155], v[44:47]
    s_add_u32 s27, s27, s36
    v_mfma_f32_16x16x32_bf16 v[60:63], a[124:127], v[156:159], v[60:63]
    ds_read_b64_tr_b16 v[136:137], v224 offset:0
    ds_read_b64_tr_b16 v[138:139], v224 offset:512
    v_mfma_f32_16x16x32_bf16 v[56:59], a[120:123], v[156:159], v[56:59]
    buffer_load_dwordx4 v238, s[8:11], s27 offen lds
    v_mfma_f32_16x16x32_bf16 v[52:55], a[116:119], v[156:159], v[52:55]
    s_add_u32 m0, s94, 101376
    s_add_u32 s27, s27, s36
    v_mfma_f32_16x16x32_bf16 v[48:51], a[112:115], v[156:159], v[48:51]
    s_waitcnt lgkmcnt(2)
    v_mfma_f32_16x16x32_bf16 v[0:3], a[128:131], v[128:131], v[0:3]
    ds_read_b64_tr_b16 v[140:141], v225 offset:0
    ds_read_b64_tr_b16 v[142:143], v225 offset:512
    v_mfma_f32_16x16x32_bf16 v[4:7], a[132:135], v[128:131], v[4:7]
    buffer_load_dwordx4 v239, s[8:11], s27 offen lds
    v_mfma_f32_16x16x32_bf16 v[8:11], a[136:139], v[128:131], v[8:11]
    s_add_u32 m0, s94, 102400
    s_add_u32 s27, s27, s36
    v_mfma_f32_16x16x32_bf16 v[12:15], a[140:143], v[128:131], v[12:15]
    buffer_load_dwordx4 v238, s[8:11], s27 offen lds
    v_mfma_f32_16x16x32_bf16 v[28:31], a[140:143], v[132:135], v[28:31]
    s_add_u32 m0, s94, 103424
    ds_read_b64_tr_b16 v[144:145], v222 offset:4096
    ds_read_b64_tr_b16 v[146:147], v222 offset:4608
    v_mfma_f32_16x16x32_bf16 v[24:27], a[136:139], v[132:135], v[24:27]
    s_add_u32 s27, s27, s36
    s_lshr_b32 s22, s19, 2
    s_lshl_b32 s22, s22, 19
    v_mfma_f32_16x16x32_bf16 v[20:23], a[132:135], v[132:135], v[20:23]
    buffer_load_dwordx4 v239, s[8:11], s27 offen lds
    v_mfma_f32_16x16x32_bf16 v[16:19], a[128:131], v[132:135], v[16:19]
    s_waitcnt lgkmcnt(2)
    s_add_u32 m0, s94, 104448
    s_add_u32 s27, s27, s36
    v_mfma_f32_16x16x32_bf16 v[32:35], a[128:131], v[136:139], v[32:35]
    s_and_b32 s26, s19, 3
    ds_read_b64_tr_b16 v[148:149], v223 offset:4096
    ds_read_b64_tr_b16 v[150:151], v223 offset:4608
    v_mfma_f32_16x16x32_bf16 v[36:39], a[132:135], v[136:139], v[36:39]
    buffer_load_dwordx4 v238, s[8:11], s27 offen lds
    v_mfma_f32_16x16x32_bf16 v[40:43], a[136:139], v[136:139], v[40:43]
    s_add_u32 m0, s94, 105472
    s_add_u32 s27, s27, s36
    s_lshl_b32 s26, s26, 12
    v_mfma_f32_16x16x32_bf16 v[44:47], a[140:143], v[136:139], v[44:47]
    buffer_load_dwordx4 v239, s[8:11], s27 offen lds
    v_mfma_f32_16x16x32_bf16 v[60:63], a[140:143], v[140:143], v[60:63]
    s_add_u32 s22, s22, s26
    ds_read_b64_tr_b16 v[152:153], v224 offset:4096
    ds_read_b64_tr_b16 v[154:155], v224 offset:4608
    v_mfma_f32_16x16x32_bf16 v[56:59], a[136:139], v[140:143], v[56:59]
    s_add_u32 s23, s23, 128
    s_add_u32 s22, s22, s32
    s_add_u32 s19, s19, 1
    v_mfma_f32_16x16x32_bf16 v[52:55], a[132:135], v[140:143], v[52:55]
    v_mfma_f32_16x16x32_bf16 v[48:51], a[128:131], v[140:143], v[48:51]
    s_waitcnt lgkmcnt(2)
    v_mul_f32 v192, s20, v96
    v_mfma_f32_16x16x32_bf16 v[0:3], a[144:147], v[144:147], v[0:3]
    ds_read_b64_tr_b16 v[156:157], v225 offset:4096
    ds_read_b64_tr_b16 v[158:159], v225 offset:4608
    v_mfma_f32_16x16x32_bf16 v[4:7], a[148:151], v[144:147], v[4:7]
    v_mul_f32 v193, s20, v97
    v_mfma_f32_16x16x32_bf16 v[8:11], a[152:155], v[144:147], v[8:11]
    v_cvt_pk_bf16_f32 v176, v192, v193
    v_mfma_f32_16x16x32_bf16 v[12:15], a[156:159], v[144:147], v[12:15]
    v_mfma_f32_16x16x32_bf16 v[28:31], a[156:159], v[148:151], v[28:31]
    ds_read_b64_tr_b16 v[128:129], v222 offset:8192
    ds_read_b64_tr_b16 v[130:131], v222 offset:8704
    v_mfma_f32_16x16x32_bf16 v[24:27], a[152:155], v[148:151], v[24:27]
    v_mul_f32 v194, s20, v98
    v_mfma_f32_16x16x32_bf16 v[20:23], a[148:151], v[148:151], v[20:23]
    v_mul_f32 v195, s20, v99
    v_mfma_f32_16x16x32_bf16 v[16:19], a[144:147], v[148:151], v[16:19]
    s_waitcnt lgkmcnt(2)
    v_cvt_pk_bf16_f32 v177, v194, v195
    v_mfma_f32_16x16x32_bf16 v[32:35], a[144:147], v[152:155], v[32:35]
    ds_read_b64_tr_b16 v[132:133], v223 offset:8192
    ds_read_b64_tr_b16 v[134:135], v223 offset:8704
    v_mfma_f32_16x16x32_bf16 v[36:39], a[148:151], v[152:155], v[36:39]
    v_mul_f32 v196, s20, v100
    v_mfma_f32_16x16x32_bf16 v[40:43], a[152:155], v[152:155], v[40:43]
    v_mfma_f32_16x16x32_bf16 v[44:47], a[156:159], v[152:155], v[44:47]
    v_mul_f32 v197, s20, v101
    v_mfma_f32_16x16x32_bf16 v[60:63], a[156:159], v[156:159], v[60:63]
    ds_read_b64_tr_b16 v[136:137], v224 offset:8192
    ds_read_b64_tr_b16 v[138:139], v224 offset:8704
    v_mfma_f32_16x16x32_bf16 v[56:59], a[152:155], v[156:159], v[56:59]
    v_cvt_pk_bf16_f32 v178, v196, v197
    v_mfma_f32_16x16x32_bf16 v[52:55], a[148:151], v[156:159], v[52:55]
    v_mul_f32 v198, s20, v102
    v_mfma_f32_16x16x32_bf16 v[48:51], a[144:147], v[156:159], v[48:51]
    s_waitcnt lgkmcnt(2)
    v_mfma_f32_16x16x32_bf16 v[0:3], a[160:163], v[128:131], v[0:3]
    ds_read_b64_tr_b16 v[140:141], v225 offset:8192
    ds_read_b64_tr_b16 v[142:143], v225 offset:8704
    v_mfma_f32_16x16x32_bf16 v[4:7], a[164:167], v[128:131], v[4:7]
    v_mul_f32 v199, s20, v103
    v_cvt_pk_bf16_f32 v179, v198, v199
    v_mfma_f32_16x16x32_bf16 v[8:11], a[168:171], v[128:131], v[8:11]
    v_mfma_f32_16x16x32_bf16 v[12:15], a[172:175], v[128:131], v[12:15]
    buffer_store_dwordx4 v[176:179], v234, s[12:15], s22 offen offset:0 sc1
    v_mfma_f32_16x16x32_bf16 v[28:31], a[172:175], v[132:135], v[28:31]
    ds_read_b64_tr_b16 v[144:145], v222 offset:12288
    ds_read_b64_tr_b16 v[146:147], v222 offset:12800
    v_mfma_f32_16x16x32_bf16 v[24:27], a[168:171], v[132:135], v[24:27]
    v_mfma_f32_16x16x32_bf16 v[20:23], a[164:167], v[132:135], v[20:23]
    v_mul_f32 v200, s20, v112
    v_mfma_f32_16x16x32_bf16 v[16:19], a[160:163], v[132:135], v[16:19]
    s_waitcnt lgkmcnt(2)
    v_mfma_f32_16x16x32_bf16 v[32:35], a[160:163], v[136:139], v[32:35]
    ds_read_b64_tr_b16 v[148:149], v223 offset:12288
    ds_read_b64_tr_b16 v[150:151], v223 offset:12800
    v_mfma_f32_16x16x32_bf16 v[36:39], a[164:167], v[136:139], v[36:39]
    v_mul_f32 v201, s20, v113
    v_cvt_pk_bf16_f32 v180, v200, v201
    v_mfma_f32_16x16x32_bf16 v[40:43], a[168:171], v[136:139], v[40:43]
    v_mfma_f32_16x16x32_bf16 v[44:47], a[172:175], v[136:139], v[44:47]
    v_mul_f32 v202, s20, v114
    v_mfma_f32_16x16x32_bf16 v[60:63], a[172:175], v[140:143], v[60:63]
    ds_read_b64_tr_b16 v[152:153], v224 offset:12288
    ds_read_b64_tr_b16 v[154:155], v224 offset:12800
    v_mfma_f32_16x16x32_bf16 v[56:59], a[168:171], v[140:143], v[56:59]
    v_mul_f32 v203, s20, v115
    v_mfma_f32_16x16x32_bf16 v[52:55], a[164:167], v[140:143], v[52:55]
    v_cvt_pk_bf16_f32 v181, v202, v203
    v_mfma_f32_16x16x32_bf16 v[48:51], a[160:163], v[140:143], v[48:51]
    s_waitcnt lgkmcnt(2)
    v_mfma_f32_16x16x32_bf16 v[0:3], a[176:179], v[144:147], v[0:3]
    ds_read_b64_tr_b16 v[156:157], v225 offset:12288
    ds_read_b64_tr_b16 v[158:159], v225 offset:12800
    v_mfma_f32_16x16x32_bf16 v[4:7], a[180:183], v[144:147], v[4:7]
    v_mul_f32 v204, s20, v116
    v_mfma_f32_16x16x32_bf16 v[8:11], a[184:187], v[144:147], v[8:11]
    v_mul_f32 v205, s20, v117
    v_mfma_f32_16x16x32_bf16 v[12:15], a[188:191], v[144:147], v[12:15]
    v_cvt_pk_bf16_f32 v182, v204, v205
    v_mfma_f32_16x16x32_bf16 v[28:31], a[188:191], v[148:151], v[28:31]
    ds_read_b64_tr_b16 v[128:129], v222 offset:16384
    ds_read_b64_tr_b16 v[130:131], v222 offset:16896
    v_mfma_f32_16x16x32_bf16 v[24:27], a[184:187], v[148:151], v[24:27]
    v_mul_f32 v206, s20, v118
    v_mfma_f32_16x16x32_bf16 v[20:23], a[180:183], v[148:151], v[20:23]
    v_mfma_f32_16x16x32_bf16 v[16:19], a[176:179], v[148:151], v[16:19]
    s_waitcnt lgkmcnt(2)
    v_mul_f32 v207, s20, v119
    v_mfma_f32_16x16x32_bf16 v[32:35], a[176:179], v[152:155], v[32:35]
    ds_read_b64_tr_b16 v[132:133], v223 offset:16384
    ds_read_b64_tr_b16 v[134:135], v223 offset:16896
    v_mfma_f32_16x16x32_bf16 v[36:39], a[180:183], v[152:155], v[36:39]
    v_cvt_pk_bf16_f32 v183, v206, v207
    v_mfma_f32_16x16x32_bf16 v[40:43], a[184:187], v[152:155], v[40:43]
    buffer_store_dwordx4 v[180:183], v234, s[12:15], s22 offen offset:1024 sc1
    v_mfma_f32_16x16x32_bf16 v[44:47], a[188:191], v[152:155], v[44:47]
    v_mfma_f32_16x16x32_bf16 v[60:63], a[188:191], v[156:159], v[60:63]
    ds_read_b64_tr_b16 v[136:137], v224 offset:16384
    ds_read_b64_tr_b16 v[138:139], v224 offset:16896
    v_mfma_f32_16x16x32_bf16 v[56:59], a[184:187], v[156:159], v[56:59]
    v_mul_f32 v192, s20, v104
    v_mfma_f32_16x16x32_bf16 v[52:55], a[180:183], v[156:159], v[52:55]
    v_mfma_f32_16x16x32_bf16 v[48:51], a[176:179], v[156:159], v[48:51]
    s_waitcnt lgkmcnt(2)
    v_mul_f32 v193, s20, v105
    v_mfma_f32_16x16x32_bf16 v[0:3], a[192:195], v[128:131], v[0:3]
    ds_read_b64_tr_b16 v[140:141], v225 offset:16384
    ds_read_b64_tr_b16 v[142:143], v225 offset:16896
    v_mfma_f32_16x16x32_bf16 v[4:7], a[196:199], v[128:131], v[4:7]
    v_cvt_pk_bf16_f32 v184, v192, v193
    v_mfma_f32_16x16x32_bf16 v[8:11], a[200:203], v[128:131], v[8:11]
    v_mul_f32 v194, s20, v106
    v_mfma_f32_16x16x32_bf16 v[12:15], a[204:207], v[128:131], v[12:15]
    v_mfma_f32_16x16x32_bf16 v[28:31], a[204:207], v[132:135], v[28:31]
    ds_read_b64_tr_b16 v[144:145], v222 offset:20480
    ds_read_b64_tr_b16 v[146:147], v222 offset:20992
    v_mfma_f32_16x16x32_bf16 v[24:27], a[200:203], v[132:135], v[24:27]
    v_mul_f32 v195, s20, v107
    v_mfma_f32_16x16x32_bf16 v[20:23], a[196:199], v[132:135], v[20:23]
    v_cvt_pk_bf16_f32 v185, v194, v195
    v_mfma_f32_16x16x32_bf16 v[16:19], a[192:195], v[132:135], v[16:19]
    s_waitcnt lgkmcnt(2)
    v_mul_f32 v196, s20, v108
    v_mfma_f32_16x16x32_bf16 v[32:35], a[192:195], v[136:139], v[32:35]
    ds_read_b64_tr_b16 v[148:149], v223 offset:20480
    ds_read_b64_tr_b16 v[150:151], v223 offset:20992
    v_mfma_f32_16x16x32_bf16 v[36:39], a[196:199], v[136:139], v[36:39]
    v_mul_f32 v197, s20, v109
    v_mfma_f32_16x16x32_bf16 v[40:43], a[200:203], v[136:139], v[40:43]
    v_cvt_pk_bf16_f32 v186, v196, v197
    v_mfma_f32_16x16x32_bf16 v[44:47], a[204:207], v[136:139], v[44:47]
    v_mfma_f32_16x16x32_bf16 v[60:63], a[204:207], v[140:143], v[60:63]
    ds_read_b64_tr_b16 v[152:153], v224 offset:20480
    ds_read_b64_tr_b16 v[154:155], v224 offset:20992
    v_mfma_f32_16x16x32_bf16 v[56:59], a[200:203], v[140:143], v[56:59]
    v_mul_f32 v198, s20, v110
    v_mfma_f32_16x16x32_bf16 v[52:55], a[196:199], v[140:143], v[52:55]
    v_mul_f32 v199, s20, v111
    v_mfma_f32_16x16x32_bf16 v[48:51], a[192:195], v[140:143], v[48:51]
    s_waitcnt lgkmcnt(2)
    v_cvt_pk_bf16_f32 v187, v198, v199
    v_mfma_f32_16x16x32_bf16 v[0:3], a[208:211], v[144:147], v[0:3]
    ds_read_b64_tr_b16 v[156:157], v225 offset:20480
    ds_read_b64_tr_b16 v[158:159], v225 offset:20992
    v_mfma_f32_16x16x32_bf16 v[4:7], a[212:215], v[144:147], v[4:7]
    buffer_store_dwordx4 v[184:187], v234, s[12:15], s22 offen offset:2048 sc1
    v_mfma_f32_16x16x32_bf16 v[8:11], a[216:219], v[144:147], v[8:11]
    v_mfma_f32_16x16x32_bf16 v[12:15], a[220:223], v[144:147], v[12:15]
    v_mfma_f32_16x16x32_bf16 v[28:31], a[220:223], v[148:151], v[28:31]
    ds_read_b64_tr_b16 v[128:129], v222 offset:24576
    ds_read_b64_tr_b16 v[130:131], v222 offset:25088
    v_mfma_f32_16x16x32_bf16 v[24:27], a[216:219], v[148:151], v[24:27]
    v_mul_f32 v200, s20, v120
    v_mfma_f32_16x16x32_bf16 v[20:23], a[212:215], v[148:151], v[20:23]
    v_mul_f32 v201, s20, v121
    v_mfma_f32_16x16x32_bf16 v[16:19], a[208:211], v[148:151], v[16:19]
    s_waitcnt lgkmcnt(2)
    v_mfma_f32_16x16x32_bf16 v[32:35], a[208:211], v[152:155], v[32:35]
    ds_read_b64_tr_b16 v[132:133], v223 offset:24576
    ds_read_b64_tr_b16 v[134:135], v223 offset:25088
    v_mfma_f32_16x16x32_bf16 v[36:39], a[212:215], v[152:155], v[36:39]
    v_cvt_pk_bf16_f32 v188, v200, v201
    v_mul_f32 v202, s20, v122
    v_mfma_f32_16x16x32_bf16 v[40:43], a[216:219], v[152:155], v[40:43]
    v_mfma_f32_16x16x32_bf16 v[44:47], a[220:223], v[152:155], v[44:47]
    v_mul_f32 v203, s20, v123
    v_mfma_f32_16x16x32_bf16 v[60:63], a[220:223], v[156:159], v[60:63]
    ds_read_b64_tr_b16 v[136:137], v224 offset:24576
    ds_read_b64_tr_b16 v[138:139], v224 offset:25088
    v_mfma_f32_16x16x32_bf16 v[56:59], a[216:219], v[156:159], v[56:59]
    v_cvt_pk_bf16_f32 v189, v202, v203
    v_mfma_f32_16x16x32_bf16 v[52:55], a[212:215], v[156:159], v[52:55]
    v_mul_f32 v204, s20, v124
    v_mfma_f32_16x16x32_bf16 v[48:51], a[208:211], v[156:159], v[48:51]
    s_waitcnt lgkmcnt(2)
    v_mfma_f32_16x16x32_bf16 v[0:3], a[224:227], v[128:131], v[0:3]
    ds_read_b64_tr_b16 v[140:141], v225 offset:24576
    ds_read_b64_tr_b16 v[142:143], v225 offset:25088
    v_mfma_f32_16x16x32_bf16 v[4:7], a[228:231], v[128:131], v[4:7]
    v_mul_f32 v205, s20, v125
    v_mfma_f32_16x16x32_bf16 v[8:11], a[232:235], v[128:131], v[8:11]
    v_cvt_pk_bf16_f32 v190, v204, v205
    v_mfma_f32_16x16x32_bf16 v[12:15], a[236:239], v[128:131], v[12:15]
    v_mul_f32 v206, s20, v126
    v_mfma_f32_16x16x32_bf16 v[28:31], a[236:239], v[132:135], v[28:31]
    ds_read_b64_tr_b16 v[144:145], v222 offset:28672
    ds_read_b64_tr_b16 v[146:147], v222 offset:29184
    v_mfma_f32_16x16x32_bf16 v[24:27], a[232:235], v[132:135], v[24:27]
    v_mul_f32 v207, s20, v127
    v_mfma_f32_16x16x32_bf16 v[20:23], a[228:231], v[132:135], v[20:23]
    v_mfma_f32_16x16x32_bf16 v[16:19], a[224:227], v[132:135], v[16:19]
    s_waitcnt lgkmcnt(2)
    v_cvt_pk_bf16_f32 v191, v206, v207
    v_mfma_f32_16x16x32_bf16 v[32:35], a[224:227], v[136:139], v[32:35]
    ds_read_b64_tr_b16 v[148:149], v223 offset:28672
    ds_read_b64_tr_b16 v[150:151], v223 offset:29184
    v_mfma_f32_16x16x32_bf16 v[36:39], a[228:231], v[136:139], v[36:39]
    buffer_store_dwordx4 v[188:191], v234, s[12:15], s22 offen offset:3072 sc1
    v_mfma_f32_16x16x32_bf16 v[40:43], a[232:235], v[136:139], v[40:43]
    v_mfma_f32_16x16x32_bf16 v[44:47], a[236:239], v[136:139], v[44:47]
    v_mfma_f32_16x16x32_bf16 v[60:63], a[236:239], v[140:143], v[60:63]
    ds_read_b64_tr_b16 v[152:153], v224 offset:28672
    ds_read_b64_tr_b16 v[154:155], v224 offset:29184
    v_mfma_f32_16x16x32_bf16 v[56:59], a[232:235], v[140:143], v[56:59]
    v_mfma_f32_16x16x32_bf16 v[52:55], a[228:231], v[140:143], v[52:55]
    v_mfma_f32_16x16x32_bf16 v[48:51], a[224:227], v[140:143], v[48:51]
    s_waitcnt lgkmcnt(2)
    v_mfma_f32_16x16x32_bf16 v[0:3], a[240:243], v[144:147], v[0:3]
    ds_read_b64_tr_b16 v[156:157], v225 offset:28672
    ds_read_b64_tr_b16 v[158:159], v225 offset:29184
    v_mfma_f32_16x16x32_bf16 v[4:7], a[244:247], v[144:147], v[4:7]
    v_mfma_f32_16x16x32_bf16 v[8:11], a[248:251], v[144:147], v[8:11]
    s_waitcnt vmcnt(16)
    s_barrier
    v_mfma_f32_16x16x32_bf16 v[12:15], a[252:255], v[144:147], v[12:15]
    v_mfma_f32_16x16x32_bf16 v[28:31], a[252:255], v[148:151], v[28:31]
    ds_read_b64_tr_b16 v[128:129], v222 offset:32768
    ds_read_b64_tr_b16 v[130:131], v222 offset:33280
    v_mfma_f32_16x16x32_bf16 v[24:27], a[248:251], v[148:151], v[24:27]
    v_mfma_f32_16x16x32_bf16 v[20:23], a[244:247], v[148:151], v[20:23]
    v_mfma_f32_16x16x32_bf16 v[16:19], a[240:243], v[148:151], v[16:19]
    s_waitcnt lgkmcnt(2)
    v_mfma_f32_16x16x32_bf16 v[32:35], a[240:243], v[152:155], v[32:35]
    ds_read_b64_tr_b16 v[132:133], v223 offset:32768
    ds_read_b64_tr_b16 v[134:135], v223 offset:33280
    v_mfma_f32_16x16x32_bf16 v[36:39], a[244:247], v[152:155], v[36:39]
    v_mfma_f32_16x16x32_bf16 v[40:43], a[248:251], v[152:155], v[40:43]
    v_mfma_f32_16x16x32_bf16 v[44:47], a[252:255], v[152:155], v[44:47]
    v_mfma_f32_16x16x32_bf16 v[60:63], a[252:255], v[156:159], v[60:63]
    ds_read_b64_tr_b16 v[136:137], v224 offset:32768
    ds_read_b64_tr_b16 v[138:139], v224 offset:33280
    v_mfma_f32_16x16x32_bf16 v[56:59], a[248:251], v[156:159], v[56:59]
    v_mfma_f32_16x16x32_bf16 v[52:55], a[244:247], v[156:159], v[52:55]
    v_mfma_f32_16x16x32_bf16 v[48:51], a[240:243], v[156:159], v[48:51]
    s_cmp_eq_u32 s29, 1
    s_cbranch_scc1 K1_done_15
    s_waitcnt lgkmcnt(2)
    v_mfma_f32_16x16x32_bf16 v[64:67], a[0:3], v[128:131], 0
    s_add_u32 m0, s38, 65536
    ds_read_b64_tr_b16 v[140:141], v225 offset:32768
    ds_read_b64_tr_b16 v[142:143], v225 offset:33280
    v_mfma_f32_16x16x32_bf16 v[68:71], a[4:7], v[128:131], 0
    s_add_u32 s27, s23, s37
    v_mfma_f32_16x16x32_bf16 v[72:75], a[8:11], v[128:131], 0
    buffer_load_dwordx4 v238, s[8:11], s27 offen lds
    v_mfma_f32_16x16x32_bf16 v[76:79], a[12:15], v[128:131], 0
    s_add_u32 m0, s38, 66560
    v_mfma_f32_16x16x32_bf16 v[92:95], a[12:15], v[132:135], 0
    s_add_u32 s27, s27, s36
    ds_read_b64_tr_b16 v[144:145], v222 offset:36864
    ds_read_b64_tr_b16 v[146:147], v222 offset:37376
    v_mfma_f32_16x16x32_bf16 v[88:91], a[8:11], v[132:135], 0
    buffer_load_dwordx4 v239, s[8:11], s27 offen lds
    v_mfma_f32_16x16x32_bf16 v[84:87], a[4:7], v[132:135], 0
    s_add_u32 m0, s38, 67584
    v_mfma_f32_16x16x32_bf16 v[80:83], a[0:3], v[132:135], 0
    s_waitcnt lgkmcnt(2)
    s_add_u32 s27, s27, s36
    v_mfma_f32_16x16x32_bf16 v[96:99], a[0:3], v[136:139], 0
    ds_read_b64_tr_b16 v[148:149], v223 offset:36864
    ds_read_b64_tr_b16 v[150:151], v223 offset:37376
    v_mfma_f32_16x16x32_bf16 v[100:103], a[4:7], v[136:139], 0
    buffer_load_dwordx4 v238, s[8:11], s27 offen lds
    v_mfma_f32_16x16x32_bf16 v[104:107], a[8:11], v[136:139], 0
    s_add_u32 m0, s38, 68608
    s_add_u32 s27, s27, s36
    v_mfma_f32_16x16x32_bf16 v[108:111], a[12:15], v[136:139], 0
    buffer_load_dwordx4 v239, s[8:11], s27 offen lds
    v_mfma_f32_16x16x32_bf16 v[124:127], a[12:15], v[140:143], 0
    ds_read_b64_tr_b16 v[152:153], v224 offset:36864
    ds_read_b64_tr_b16 v[154:155], v224 offset:37376
    v_mfma_f32_16x16x32_bf16 v[120:123], a[8:11], v[140:143], 0
    s_add_u32 m0, s38, 69632
    s_add_u32 s27, s27, s36
    v_mfma_f32_16x16x32_bf16 v[116:119], a[4:7], v[140:143], 0
    buffer_load_dwordx4 v238, s[8:11], s27 offen lds
    v_mfma_f32_16x16x32_bf16 v[112:115], a[0:3], v[140:143], 0
    s_waitcnt lgkmcnt(2)
    s_lshr_b32 s22, s19, 2
    s_lshl_b32 s22, s22, 19
    v_mfma_f32_16x16x32_bf16 v[64:67], a[16:19], v[144:147], v[64:67]
    s_add_u32 m0, s38, 70656
    ds_read_b64_tr_b16 v[156:157], v225 offset:36864
    ds_read_b64_tr_b16 v[158:159], v225 offset:37376
    v_mfma_f32_16x16x32_bf16 v[68:71], a[20:23], v[144:147], v[68:71]
    s_add_u32 s27, s27, s36
    s_and_b32 s26, s19, 3
    v_mfma_f32_16x16x32_bf16 v[72:75], a[24:27], v[144:147], v[72:75]
    buffer_load_dwordx4 v239, s[8:11], s27 offen lds
    v_mfma_f32_16x16x32_bf16 v[76:79], a[28:31], v[144:147], v[76:79]
    s_add_u32 m0, s38, 71680
    s_lshl_b32 s26, s26, 12
    v_mfma_f32_16x16x32_bf16 v[92:95], a[28:31], v[148:151], v[92:95]
    s_add_u32 s27, s27, s36
    ds_read_b64_tr_b16 v[128:129], v222 offset:40960
    ds_read_b64_tr_b16 v[130:131], v222 offset:41472
    v_mfma_f32_16x16x32_bf16 v[88:91], a[24:27], v[148:151], v[88:91]
    buffer_load_dwordx4 v238, s[8:11], s27 offen lds
    v_mfma_f32_16x16x32_bf16 v[84:87], a[20:23], v[148:151], v[84:87]
    s_add_u32 m0, s38, 72704
    s_add_u32 s22, s22, s26
    s_add_u32 s22, s22, s32
    v_mfma_f32_16x16x32_bf16 v[80:83], a[16:19], v[148:151], v[80:83]
    s_waitcnt lgkmcnt(2)
    s_add_u32 s27, s27, s36
    s_add_u32 s19, s19, 1
    v_mfma_f32_16x16x32_bf16 v[96:99], a[16:19], v[152:155], v[96:99]
    ds_read_b64_tr_b16 v[132:133], v223 offset:40960
    ds_read_b64_tr_b16 v[134:135], v223 offset:41472
    v_mfma_f32_16x16x32_bf16 v[100:103], a[20:23], v[152:155], v[100:103]
    buffer_load_dwordx4 v239, s[8:11], s27 offen lds
    v_mfma_f32_16x16x32_bf16 v[104:107], a[24:27], v[152:155], v[104:107]
    v_mul_f32 v192, s20, v0
    v_mul_f32 v193, s20, v1
    v_mfma_f32_16x16x32_bf16 v[108:111], a[28:31], v[152:155], v[108:111]
    v_cvt_pk_bf16_f32 v160, v192, v193
    v_mfma_f32_16x16x32_bf16 v[124:127], a[28:31], v[156:159], v[124:127]
    ds_read_b64_tr_b16 v[136:137], v224 offset:40960
    ds_read_b64_tr_b16 v[138:139], v224 offset:41472
    v_mfma_f32_16x16x32_bf16 v[120:123], a[24:27], v[156:159], v[120:123]
    v_mul_f32 v194, s20, v2
    v_mfma_f32_16x16x32_bf16 v[116:119], a[20:23], v[156:159], v[116:119]
    v_mul_f32 v195, s20, v3
    v_mfma_f32_16x16x32_bf16 v[112:115], a[16:19], v[156:159], v[112:115]
    s_waitcnt lgkmcnt(2)
    v_mfma_f32_16x16x32_bf16 v[64:67], a[32:35], v[128:131], v[64:67]
    ds_read_b64_tr_b16 v[140:141], v225 offset:40960
    ds_read_b64_tr_b16 v[142:143], v225 offset:41472
    v_mfma_f32_16x16x32_bf16 v[68:71], a[36:39], v[128:131], v[68:71]
    v_cvt_pk_bf16_f32 v161, v194, v195
    v_mul_f32 v196, s20, v4
    v_mfma_f32_16x16x32_bf16 v[72:75], a[40:43], v[128:131], v[72:75]
    v_mfma_f32_16x16x32_bf16 v[76:79], a[44:47], v[128:131], v[76:79]
    v_mul_f32 v197, s20, v5
    v_mfma_f32_16x16x32_bf16 v[92:95], a[44:47], v[132:135], v[92:95]
    ds_read_b64_tr_b16 v[144:145], v222 offset:45056
    ds_read_b64_tr_b16 v[146:147], v222 offset:45568
    v_mfma_f32_16x16x32_bf16 v[88:91], a[40:43], v[132:135], v[88:91]
    v_cvt_pk_bf16_f32 v162, v196, v197
    v_mfma_f32_16x16x32_bf16 v[84:87], a[36:39], v[132:135], v[84:87]
    v_mul_f32 v198, s20, v6
    v_mfma_f32_16x16x32_bf16 v[80:83], a[32:35], v[132:135], v[80:83]
    s_waitcnt lgkmcnt(2)
    v_mul_f32 v199, s20, v7
    v_mfma_f32_16x16x32_bf16 v[96:99], a[32:35], v[136:139], v[96:99]
    ds_read_b64_tr_b16 v[148:149], v223 offset:45056
    ds_read_b64_tr_b16 v[150:151], v223 offset:45568
    v_mfma_f32_16x16x32_bf16 v[100:103], a[36:39], v[136:139], v[100:103]
    v_cvt_pk_bf16_f32 v163, v198, v199
    v_mfma_f32_16x16x32_bf16 v[104:107], a[40:43], v[136:139], v[104:107]
    buffer_store_dwordx4 v[160:163], v234, s[12:15], s22 offen offset:0 sc1
    v_mfma_f32_16x16x32_bf16 v[108:111], a[44:47], v[136:139], v[108:111]
    v_mfma_f32_16x16x32_bf16 v[124:127], a[44:47], v[140:143], v[124:127]
    ds_read_b64_tr_b16 v[152:153], v224 offset:45056
    ds_read_b64_tr_b16 v[154:155], v224 offset:45568
    v_mfma_f32_16x16x32_bf16 v[120:123], a[40:43], v[140:143], v[120:123]
    v_mfma_f32_16x16x32_bf16 v[116:119], a[36:39], v[140:143], v[116:119]
    v_mul_f32 v200, s20, v16
    v_mfma_f32_16x16x32_bf16 v[112:115], a[32:35], v[140:143], v[112:115]
    s_waitcnt lgkmcnt(2)
    v_mul_f32 v201, s20, v17
    v_mfma_f32_16x16x32_bf16 v[64:67], a[48:51], v[144:147], v[64:67]
    ds_read_b64_tr_b16 v[156:157], v225 offset:45056
    ds_read_b64_tr_b16 v[158:159], v225 offset:45568
    v_mfma_f32_16x16x32_bf16 v[68:71], a[52:55], v[144:147], v[68:71]
    v_cvt_pk_bf16_f32 v164, v200, v201
    v_mfma_f32_16x16x32_bf16 v[72:75], a[56:59], v[144:147], v[72:75]
    v_mul_f32 v202, s20, v18
    v_mfma_f32_16x16x32_bf16 v[76:79], a[60:63], v[144:147], v[76:79]
    v_mfma_f32_16x16x32_bf16 v[92:95], a[60:63], v[148:151], v[92:95]
    ds_read_b64_tr_b16 v[128:129], v222 offset:49152
    ds_read_b64_tr_b16 v[130:131], v222 offset:49664
    v_mfma_f32_16x16x32_bf16 v[88:91], a[56:59], v[148:151], v[88:91]
    v_mul_f32 v203, s20, v19
    v_cvt_pk_bf16_f32 v165, v202, v203
    v_mfma_f32_16x16x32_bf16 v[84:87], a[52:55], v[148:151], v[84:87]
    v_mfma_f32_16x16x32_bf16 v[80:83], a[48:51], v[148:151], v[80:83]
    s_waitcnt lgkmcnt(2)
    v_mul_f32 v204, s20, v20
    v_mfma_f32_16x16x32_bf16 v[96:99], a[48:51], v[152:155], v[96:99]
    ds_read_b64_tr_b16 v[132:133], v223 offset:49152
    ds_read_b64_tr_b16 v[134:135], v223 offset:49664
    v_mfma_f32_16x16x32_bf16 v[100:103], a[52:55], v[152:155], v[100:103]
    v_mul_f32 v205, s20, v21
    v_mfma_f32_16x16x32_bf16 v[104:107], a[56:59], v[152:155], v[104:107]
    v_cvt_pk_bf16_f32 v166, v204, v205
    v_mfma_f32_16x16x32_bf16 v[108:111], a[60:63], v[152:155], v[108:111]
    v_mul_f32 v206, s20, v22
    v_mfma_f32_16x16x32_bf16 v[124:127], a[60:63], v[156:159], v[124:127]
    ds_read_b64_tr_b16 v[136:137], v224 offset:49152
    ds_read_b64_tr_b16 v[138:139], v224 offset:49664
    v_mfma_f32_16x16x32_bf16 v[120:123], a[56:59], v[156:159], v[120:123]
    v_mul_f32 v207, s20, v23
    v_mfma_f32_16x16x32_bf16 v[116:119], a[52:55], v[156:159], v[116:119]
    v_cvt_pk_bf16_f32 v167, v206, v207
    v_mfma_f32_16x16x32_bf16 v[112:115], a[48:51], v[156:159], v[112:115]
    s_waitcnt lgkmcnt(2)
    v_mfma_f32_16x16x32_bf16 v[64:67], a[64:67], v[128:131], v[64:67]
    ds_read_b64_tr_b16 v[140:141], v225 offset:49152
    ds_read_b64_tr_b16 v[142:143], v225 offset:49664
    v_mfma_f32_16x16x32_bf16 v[68:71], a[68:71], v[128:131], v[68:71]
    buffer_store_dwordx4 v[164:167], v234, s[12:15], s22 offen offset:1024 sc1
    v_mfma_f32_16x16x32_bf16 v[72:75], a[72:75], v[128:131], v[72:75]
    v_mfma_f32_16x16x32_bf16 v[76:79], a[76:79], v[128:131], v[76:79]
    v_mul_f32 v192, s20, v8
    v_mfma_f32_16x16x32_bf16 v[92:95], a[76:79], v[132:135], v[92:95]
    ds_read_b64_tr_b16 v[144:145], v222 offset:53248
    ds_read_b64_tr_b16 v[146:147], v222 offset:53760
    v_mfma_f32_16x16x32_bf16 v[88:91], a[72:75], v[132:135], v[88:91]
    v_mul_f32 v193, s20, v9
    v_mfma_f32_16x16x32_bf16 v[84:87], a[68:71], v[132:135], v[84:87]
    v_cvt_pk_bf16_f32 v168, v192, v193
    v_mfma_f32_16x16x32_bf16 v[80:83], a[64:67], v[132:135], v[80:83]
    s_waitcnt lgkmcnt(2)
    v_mul_f32 v194, s20, v10
    v_mfma_f32_16x16x32_bf16 v[96:99], a[64:67], v[136:139], v[96:99]
    ds_read_b64_tr_b16 v[148:149], v223 offset:53248
    ds_read_b64_tr_b16 v[150:151], v223 offset:53760
    v_mfma_f32_16x16x32_bf16 v[100:103], a[68:71], v[136:139], v[100:103]
    v_mul_f32 v195, s20, v11
    v_mfma_f32_16x16x32_bf16 v[104:107], a[72:75], v[136:139], v[104:107]
    v_cvt_pk_bf16_f32 v169, v194, v195
    v_mfma_f32_16x16x32_bf16 v[108:111], a[76:79], v[136:139], v[108:111]
    v_mfma_f32_16x16x32_bf16 v[124:127], a[76:79], v[140:143], v[124:127]
    ds_read_b64_tr_b16 v[152:153], v224 offset:53248
    ds_read_b64_tr_b16 v[154:155], v224 offset:53760
    v_mfma_f32_16x16x32_bf16 v[120:123], a[72:75], v[140:143], v[120:123]
    v_mul_f32 v196, s20, v12
    v_mfma_f32_16x16x32_bf16 v[116:119], a[68:71], v[140:143], v[116:119]
    v_mul_f32 v197, s20, v13
    v_mfma_f32_16x16x32_bf16 v[112:115], a[64:67], v[140:143], v[112:115]
    s_waitcnt lgkmcnt(2)
    v_cvt_pk_bf16_f32 v170, v196, v197
    v_mfma_f32_16x16x32_bf16 v[64:67], a[80:83], v[144:147], v[64:67]
    ds_read_b64_tr_b16 v[156:157], v225 offset:53248
    ds_read_b64_tr_b16 v[158:159], v225 offset:53760
    v_mfma_f32_16x16x32_bf16 v[68:71], a[84:87], v[144:147], v[68:71]
    v_mul_f32 v198, s20, v14
    v_mfma_f32_16x16x32_bf16 v[72:75], a[88:91], v[144:147], v[72:75]
    v_mul_f32 v199, s20, v15
    v_mfma_f32_16x16x32_bf16 v[76:79], a[92:95], v[144:147], v[76:79]
    v_mfma_f32_16x16x32_bf16 v[92:95], a[92:95], v[148:151], v[92:95]
    ds_read_b64_tr_b16 v[128:129], v222 offset:57344
    ds_read_b64_tr_b16 v[130:131], v222 offset:57856
    v_mfma_f32_16x16x32_bf16 v[88:91], a[88:91], v[148:151], v[88:91]
    v_cvt_pk_bf16_f32 v171, v198, v199
    v_mfma_f32_16x16x32_bf16 v[84:87], a[84:87], v[148:151], v[84:87]
    buffer_store_dwordx4 v[168:171], v234, s[12:15], s22 offen offset:2048 sc1
    v_mfma_f32_16x16x32_bf16 v[80:83], a[80:83], v[148:151], v[80:83]
    s_waitcnt lgkmcnt(2)
    v_mfma_f32_16x16x32_bf16 v[96:99], a[80:83], v[152:155], v[96:99]
    ds_read_b64_tr_b16 v[132:133], v223 offset:57344
    ds_read_b64_tr_b16 v[134:135], v223 offset:57856
    v_mfma_f32_16x16x32_bf16 v[100:103], a[84:87], v[152:155], v[100:103]
    v_mul_f32 v200, s20, v24
    v_mfma_f32_16x16x32_bf16 v[104:107], a[88:91], v[152:155], v[104:107]
    v_mul_f32 v201, s20, v25
    v_mfma_f32_16x16x32_bf16 v[108:111], a[92:95], v[152:155], v[108:111]
    v_cvt_pk_bf16_f32 v172, v200, v201
    v_mfma_f32_16x16x32_bf16 v[124:127], a[92:95], v[156:159], v[124:127]
    ds_read_b64_tr_b16 v[136:137], v224 offset:57344
    ds_read_b64_tr_b16 v[138:139], v224 offset:57856
    v_mfma_f32_16x16x32_bf16 v[120:123], a[88:91], v[156:159], v[120:123]
    v_mul_f32 v202, s20, v26
    v_mfma_f32_16x16x32_bf16 v[116:119], a[84:87], v[156:159], v[116:119]
    v_mul_f32 v203, s20, v27
    v_mfma_f32_16x16x32_bf16 v[112:115], a[80:83], v[156:159], v[112:115]
    s_waitcnt lgkmcnt(2)
    v_mfma_f32_16x16x32_bf16 v[64:67], a[96:99], v[128:131], v[64:67]
    ds_read_b64_tr_b16 v[140:141], v225 offset:57344
    ds_read_b64_tr_b16 v[142:143], v225 offset:57856
    v_mfma_f32_16x16x32_bf16 v[68:71], a[100:103], v[128:131], v[68:71]
    v_cvt_pk_bf16_f32 v173, v202, v203
    v_mul_f32 v204, s20, v28
    v_mfma_f32_16x16x32_bf16 v[72:75], a[104:107], v[128:131], v[72:75]
    v_mfma_f32_16x16x32_bf16 v[76:79], a[108:111], v[128:131], v[76:79]
    v_mul_f32 v205, s20, v29
    v_mfma_f32_16x16x32_bf16 v[92:95], a[108:111], v[132:135], v[92:95]
    ds_read_b64_tr_b16 v[144:145], v222 offset:61440
    ds_read_b64_tr_b16 v[146:147], v222 offset:61952
    v_mfma_f32_16x16x32_bf16 v[88:91], a[104:107], v[132:135], v[88:91]
    v_cvt_pk_bf16_f32 v174, v204, v205
    v_mfma_f32_16x16x32_bf16 v[84:87], a[100:103], v[132:135], v[84:87]
    v_mul_f32 v206, s20, v30
    v_mfma_f32_16x16x32_bf16 v[80:83], a[96:99], v[132:135], v[80:83]
    s_waitcnt lgkmcnt(2)
    v_mul_f32 v207, s20, v31
    v_mfma_f32_16x16x32_bf16 v[96:99], a[96:99], v[136:139], v[96:99]
    ds_read_b64_tr_b16 v[148:149], v223 offset:61440
    ds_read_b64_tr_b16 v[150:151], v223 offset:61952
    v_mfma_f32_16x16x32_bf16 v[100:103], a[100:103], v[136:139], v[100:103]
    v_cvt_pk_bf16_f32 v175, v206, v207
    v_mfma_f32_16x16x32_bf16 v[104:107], a[104:107], v[136:139], v[104:107]
    buffer_store_dwordx4 v[172:175], v234, s[12:15], s22 offen offset:3072 sc1
    v_mfma_f32_16x16x32_bf16 v[108:111], a[108:111], v[136:139], v[108:111]
    v_mfma_f32_16x16x32_bf16 v[124:127], a[108:111], v[140:143], v[124:127]
    ds_read_b64_tr_b16 v[152:153], v224 offset:61440
    ds_read_b64_tr_b16 v[154:155], v224 offset:61952
    v_mfma_f32_16x16x32_bf16 v[120:123], a[104:107], v[140:143], v[120:123]
    v_mfma_f32_16x16x32_bf16 v[116:119], a[100:103], v[140:143], v[116:119]
    v_mfma_f32_16x16x32_bf16 v[112:115], a[96:99], v[140:143], v[112:115]
    s_waitcnt lgkmcnt(2)
    v_mfma_f32_16x16x32_bf16 v[64:67], a[112:115], v[144:147], v[64:67]
    ds_read_b64_tr_b16 v[156:157], v225 offset:61440
    ds_read_b64_tr_b16 v[158:159], v225 offset:61952
    v_mfma_f32_16x16x32_bf16 v[68:71], a[116:119], v[144:147], v[68:71]
    v_mfma_f32_16x16x32_bf16 v[72:75], a[120:123], v[144:147], v[72:75]
    s_waitcnt vmcnt(16)
    s_barrier
    v_mfma_f32_16x16x32_bf16 v[76:79], a[124:127], v[144:147], v[76:79]
    v_mfma_f32_16x16x32_bf16 v[92:95], a[124:127], v[148:151], v[92:95]
    s_add_u32 m0, s38, 0
    ds_read_b64_tr_b16 v[128:129], v226 offset:32768
    ds_read_b64_tr_b16 v[130:131], v226 offset:33280
    v_mfma_f32_16x16x32_bf16 v[88:91], a[120:123], v[148:151], v[88:91]
    s_add_u32 s27, s23, s96
    v_mfma_f32_16x16x32_bf16 v[84:87], a[116:119], v[148:151], v[84:87]
    buffer_load_dwordx4 v238, s[8:11], s27 offen lds
    v_mfma_f32_16x16x32_bf16 v[80:83], a[112:115], v[148:151], v[80:83]
    s_waitcnt lgkmcnt(2)
    s_add_u32 m0, s38, 1024
    s_add_u32 s27, s27, s36
    v_mfma_f32_16x16x32_bf16 v[96:99], a[112:115], v[152:155], v[96:99]
    ds_read_b64_tr_b16 v[132:133], v227 offset:32768
    ds_read_b64_tr_b16 v[134:135], v227 offset:33280
    v_mfma_f32_16x16x32_bf16 v[100:103], a[116:119], v[152:155], v[100:103]
    buffer_load_dwordx4 v239, s[8:11], s27 offen lds
    v_mfma_f32_16x16x32_bf16 v[104:107], a[120:123], v[152:155], v[104:107]
    s_add_u32 m0, s38, 2048
    v_mfma_f32_16x16x32_bf16 v[108:111], a[124:127], v[152:155], v[108:111]
    s_add_u32 s27, s27, s36
    v_mfma_f32_16x16x32_bf16 v[124:127], a[124:127], v[156:159], v[124:127]
    ds_read_b64_tr_b16 v[136:137], v228 offset:32768
    ds_read_b64_tr_b16 v[138:139], v228 offset:33280
    v_mfma_f32_16x16x32_bf16 v[120:123], a[120:123], v[156:159], v[120:123]
    buffer_load_dwordx4 v238, s[8:11], s27 offen lds
    v_mfma_f32_16x16x32_bf16 v[116:119], a[116:119], v[156:159], v[116:119]
    s_add_u32 m0, s38, 3072
    s_add_u32 s27, s27, s36
    v_mfma_f32_16x16x32_bf16 v[112:115], a[112:115], v[156:159], v[112:115]
    s_waitcnt lgkmcnt(2)
    v_mfma_f32_16x16x32_bf16 v[64:67], a[128:131], v[128:131], v[64:67]
    ds_read_b64_tr_b16 v[140:141], v229 offset:32768
    ds_read_b64_tr_b16 v[142:143], v229 offset:33280
    v_mfma_f32_16x16x32_bf16 v[68:71], a[132:135], v[128:131], v[68:71]
    buffer_load_dwordx4 v239, s[8:11], s27 offen lds
    v_mfma_f32_16x16x32_bf16 v[72:75], a[136:139], v[128:131], v[72:75]
    s_add_u32 m0, s38, 4096
    s_add_u32 s27, s27, s36
    v_mfma_f32_16x16x32_bf16 v[76:79], a[140:143], v[128:131], v[76:79]
    buffer_load_dwordx4 v238, s[8:11], s27 offen lds
    v_mfma_f32_16x16x32_bf16 v[92:95], a[140:143], v[132:135], v[92:95]
    s_add_u32 m0, s38, 5120
    ds_read_b64_tr_b16 v[144:145], v226 offset:36864
    ds_read_b64_tr_b16 v[146:147], v226 offset:37376
    v_mfma_f32_16x16x32_bf16 v[88:91], a[136:139], v[132:135], v[88:91]
    s_add_u32 s27, s27, s36
    s_lshr_b32 s22, s19, 2
    s_lshl_b32 s22, s22, 19
    v_mfma_f32_16x16x32_bf16 v[84:87], a[132:135], v[132:135], v[84:87]
    buffer_load_dwordx4 v239, s[8:11], s27 offen lds
    v_mfma_f32_16x16x32_bf16 v[80:83], a[128:131], v[132:135], v[80:83]
    s_waitcnt lgkmcnt(2)
    s_add_u32 m0, s38, 6144
    s_add_u32 s27, s27, s36
    v_mfma_f32_16x16x32_bf16 v[96:99], a[128:131], v[136:139], v[96:99]
    s_and_b32 s26, s19, 3
    ds_read_b64_tr_b16 v[148:149], v227 offset:36864
    ds_read_b64_tr_b16 v[150:151], v227 offset:37376
    v_mfma_f32_16x16x32_bf16 v[100:103], a[132:135], v[136:139], v[100:103]
    buffer_load_dwordx4 v238, s[8:11], s27 offen lds
    v_mfma_f32_16x16x32_bf16 v[104:107], a[136:139], v[136:139], v[104:107]
    s_add_u32 m0, s38, 7168
    s_add_u32 s27, s27, s36
    s_lshl_b32 s26, s26, 12
    v_mfma_f32_16x16x32_bf16 v[108:111], a[140:143], v[136:139], v[108:111]
    buffer_load_dwordx4 v239, s[8:11], s27 offen lds
    v_mfma_f32_16x16x32_bf16 v[124:127], a[140:143], v[140:143], v[124:127]
    s_add_u32 s22, s22, s26
    ds_read_b64_tr_b16 v[152:153], v228 offset:36864
    ds_read_b64_tr_b16 v[154:155], v228 offset:37376
    v_mfma_f32_16x16x32_bf16 v[120:123], a[136:139], v[140:143], v[120:123]
    s_add_u32 s23, s23, 128
    s_add_u32 s22, s22, s32
    s_add_u32 s19, s19, 1
    v_mfma_f32_16x16x32_bf16 v[116:119], a[132:135], v[140:143], v[116:119]
    v_mfma_f32_16x16x32_bf16 v[112:115], a[128:131], v[140:143], v[112:115]
    s_waitcnt lgkmcnt(2)
    v_mul_f32 v192, s20, v32
    v_mfma_f32_16x16x32_bf16 v[64:67], a[144:147], v[144:147], v[64:67]
    ds_read_b64_tr_b16 v[156:157], v229 offset:36864
    ds_read_b64_tr_b16 v[158:159], v229 offset:37376
    v_mfma_f32_16x16x32_bf16 v[68:71], a[148:151], v[144:147], v[68:71]
    v_mul_f32 v193, s20, v33
    v_mfma_f32_16x16x32_bf16 v[72:75], a[152:155], v[144:147], v[72:75]
    v_cvt_pk_bf16_f32 v176, v192, v193
    v_mfma_f32_16x16x32_bf16 v[76:79], a[156:159], v[144:147], v[76:79]
    v_mfma_f32_16x16x32_bf16 v[92:95], a[156:159], v[148:151], v[92:95]
    ds_read_b64_tr_b16 v[128:129], v226 offset:40960
    ds_read_b64_tr_b16 v[130:131], v226 offset:41472
    v_mfma_f32_16x16x32_bf16 v[88:91], a[152:155], v[148:151], v[88:91]
    v_mul_f32 v194, s20, v34
    v_mfma_f32_16x16x32_bf16 v[84:87], a[148:151], v[148:151], v[84:87]
    v_mul_f32 v195, s20, v35
    v_mfma_f32_16x16x32_bf16 v[80:83], a[144:147], v[148:151], v[80:83]
    s_waitcnt lgkmcnt(2)
    v_cvt_pk_bf16_f32 v177, v194, v195
    v_mfma_f32_16x16x32_bf16 v[96:99], a[144:147], v[152:155], v[96:99]
    ds_read_b64_tr_b16 v[132:133], v227 offset:40960
    ds_read_b64_tr_b16 v[134:135], v227 offset:41472
    v_mfma_f32_16x16x32_bf16 v[100:103], a[148:151], v[152:155], v[100:103]
    v_mul_f32 v196, s20, v36
    v_mfma_f32_16x16x32_bf16 v[104:107], a[152:155], v[152:155], v[104:107]
    v_mfma_f32_16x16x32_bf16 v[108:111], a[156:159], v[152:155], v[108:111]
    v_mul_f32 v197, s20, v37
    v_mfma_f32_16x16x32_bf16 v[124:127], a[156:159], v[156:159], v[124:127]
    ds_read_b64_tr_b16 v[136:137], v228 offset:40960
    ds_read_b64_tr_b16 v[138:139], v228 offset:41472
    v_mfma_f32_16x16x32_bf16 v[120:123], a[152:155], v[156:159], v[120:123]
    v_cvt_pk_bf16_f32 v178, v196, v197
    v_mfma_f32_16x16x32_bf16 v[116:119], a[148:151], v[156:159], v[116:119]
    v_mul_f32 v198, s20, v38
    v_mfma_f32_16x16x32_bf16 v[112:115], a[144:147], v[156:159], v[112:115]
    s_waitcnt lgkmcnt(2)
    v_mfma_f32_16x16x32_bf16 v[64:67], a[160:163], v[128:131], v[64:67]
    ds_read_b64_tr_b16 v[140:141], v229 offset:40960
    ds_read_b64_tr_b16 v[142:143], v229 offset:41472
    v_mfma_f32_16x16x32_bf16 v[68:71], a[164:167], v[128:131], v[68:71]
    v_mul_f32 v199, s20, v39
    v_cvt_pk_bf16_f32 v179, v198, v199
    v_mfma_f32_16x16x32_bf16 v[72:75], a[168:171], v[128:131], v[72:75]
    v_mfma_f32_16x16x32_bf16 v[76:79], a[172:175], v[128:131], v[76:79]
    buffer_store_dwordx4 v[176:179], v234, s[12:15], s22 offen offset:0 sc1
    v_mfma_f32_16x16x32_bf16 v[92:95], a[172:175], v[132:135], v[92:95]
    ds_read_b64_tr_b16 v[144:145], v226 offset:45056
    ds_read_b64_tr_b16 v[146:147], v226 offset:45568
    v_mfma_f32_16x16x32_bf16 v[88:91], a[168:171], v[132:135], v[88:91]
    v_mfma_f32_16x16x32_bf16 v[84:87], a[164:167], v[132:135], v[84:87]
    v_mul_f32 v200, s20, v48
    v_mfma_f32_16x16x32_bf16 v[80:83], a[160:163], v[132:135], v[80:83]
    s_waitcnt lgkmcnt(2)
    v_mfma_f32_16x16x32_bf16 v[96:99], a[160:163], v[136:139], v[96:99]
    ds_read_b64_tr_b16 v[148:149], v227 offset:45056
    ds_read_b64_tr_b16 v[150:151], v227 offset:45568
    v_mfma_f32_16x16x32_bf16 v[100:103], a[164:167], v[136:139], v[100:103]
    v_mul_f32 v201, s20, v49
    v_cvt_pk_bf16_f32 v180, v200, v201
    v_mfma_f32_16x16x32_bf16 v[104:107], a[168:171], v[136:139], v[104:107]
    v_mfma_f32_16x16x32_bf16 v[108:111], a[172:175], v[136:139], v[108:111]
    v_mul_f32 v202, s20, v50
    v_mfma_f32_16x16x32_bf16 v[124:127], a[172:175], v[140:143], v[124:127]
    ds_read_b64_tr_b16 v[152:153], v228 offset:45056
    ds_read_b64_tr_b16 v[154:155], v228 offset:45568
    v_mfma_f32_16x16x32_bf16 v[120:123], a[168:171], v[140:143], v[120:123]
    v_mul_f32 v203, s20, v51
    v_mfma_f32_16x16x32_bf16 v[116:119], a[164:167], v[140:143], v[116:119]
    v_cvt_pk_bf16_f32 v181, v202, v203
    v_mfma_f32_16x16x32_bf16 v[112:115], a[160:163], v[140:143], v[112:115]
    s_waitcnt lgkmcnt(2)
    v_mfma_f32_16x16x32_bf16 v[64:67], a[176:179], v[144:147], v[64:67]
    ds_read_b64_tr_b16 v[156:157], v229 offset:45056
    ds_read_b64_tr_b16 v[158:159], v229 offset:45568
    v_mfma_f32_16x16x32_bf16 v[68:71], a[180:183], v[144:147], v[68:71]
    v_mul_f32 v204, s20, v52
    v_mfma_f32_16x16x32_bf16 v[72:75], a[184:187], v[144:147], v[72:75]
    v_mul_f32 v205, s20, v53
    v_mfma_f32_16x16x32_bf16 v[76:79], a[188:191], v[144:147], v[76:79]
    v_cvt_pk_bf16_f32 v182, v204, v205
    v_mfma_f32_16x16x32_bf16 v[92:95], a[188:191], v[148:151], v[92:95]
    ds_read_b64_tr_b16 v[128:129], v226 offset:49152
    ds_read_b64_tr_b16 v[130:131], v226 offset:49664
    v_mfma_f32_16x16x32_bf16 v[88:91], a[184:187], v[148:151], v[88:91]
    v_mul_f32 v206, s20, v54
    v_mfma_f32_16x16x32_bf16 v[84:87], a[180:183], v[148:151], v[84:87]
    v_mfma_f32_16x16x32_bf16 v[80:83], a[176:179], v[148:151], v[80:83]
    s_waitcnt lgkmcnt(2)
    v_mul_f32 v207, s20, v55
    v_mfma_f32_16x16x32_bf16 v[96:99], a[176:179], v[152:155], v[96:99]
    ds_read_b64_tr_b16 v[132:133], v227 offset:49152
    ds_read_b64_tr_b16 v[134:135], v227 offset:49664
    v_mfma_f32_16x16x32_bf16 v[100:103], a[180:183], v[152:155], v[100:103]
    v_cvt_pk_bf16_f32 v183, v206, v207
    v_mfma_f32_16x16x32_bf16 v[104:107], a[184:187], v[152:155], v[104:107]
    buffer_store_dwordx4 v[180:183], v234, s[12:15], s22 offen offset:1024 sc1
    v_mfma_f32_16x16x32_bf16 v[108:111], a[188:191], v[152:155], v[108:111]
    v_mfma_f32_16x16x32_bf16 v[124:127], a[188:191], v[156:159], v[124:127]
    ds_read_b64_tr_b16 v[136:137], v228 offset:49152
    ds_read_b64_tr_b16 v[138:139], v228 offset:49664
    v_mfma_f32_16x16x32_bf16 v[120:123], a[184:187], v[156:159], v[120:123]
    v_mul_f32 v192, s20, v40
    v_mfma_f32_16x16x32_bf16 v[116:119], a[180:183], v[156:159], v[116:119]
    v_mfma_f32_16x16x32_bf16 v[112:115], a[176:179], v[156:159], v[112:115]
    s_waitcnt lgkmcnt(2)
    v_mul_f32 v193, s20, v41
    v_mfma_f32_16x16x32_bf16 v[64:67], a[192:195], v[128:131], v[64:67]
    ds_read_b64_tr_b16 v[140:141], v229 offset:49152
    ds_read_b64_tr_b16 v[142:143], v229 offset:49664
    v_mfma_f32_16x16x32_bf16 v[68:71], a[196:199], v[128:131], v[68:71]
    v_cvt_pk_bf16_f32 v184, v192, v193
    v_mfma_f32_16x16x32_bf16 v[72:75], a[200:203], v[128:131], v[72:75]
    v_mul_f32 v194, s20, v42
    v_mfma_f32_16x16x32_bf16 v[76:79], a[204:207], v[128:131], v[76:79]
    v_mfma_f32_16x16x32_bf16 v[92:95], a[204:207], v[132:135], v[92:95]
    ds_read_b64_tr_b16 v[144:145], v226 offset:53248
    ds_read_b64_tr_b16 v[146:147], v226 offset:53760
    v_mfma_f32_16x16x32_bf16 v[88:91], a[200:203], v[132:135], v[88:91]
    v_mul_f32 v195, s20, v43
    v_mfma_f32_16x16x32_bf16 v[84:87], a[196:199], v[132:135], v[84:87]
    v_cvt_pk_bf16_f32 v185, v194, v195
    v_mfma_f32_16x16x32_bf16 v[80:83], a[192:195], v[132:135], v[80:83]
    s_waitcnt lgkmcnt(2)
    v_mul_f32 v196, s20, v44
    v_mfma_f32_16x16x32_bf16 v[96:99], a[192:195], v[136:139], v[96:99]
    ds_read_b64_tr_b16 v[148:149], v227 offset:53248
    ds_read_b64_tr_b16 v[150:151], v227 offset:53760
    v_mfma_f32_16x16x32_bf16 v[100:103], a[196:199], v[136:139], v[100:103]
    v_mul_f32 v197, s20, v45
    v_mfma_f32_16x16x32_bf16 v[104:107], a[200:203], v[136:139], v[104:107]
    v_cvt_pk_bf16_f32 v186, v196, v197
    v_mfma_f32_16x16x32_bf16 v[108:111], a[204:207], v[136:139], v[108:111]
    v_mfma_f32_16x16x32_bf16 v[124:127], a[204:207], v[140:143], v[124:127]
    ds_read_b64_tr_b16 v[152:153], v228 offset:53248
    ds_read_b64_tr_b16 v[154:155], v228 offset:53760
    v_mfma_f32_16x16x32_bf16 v[120:123], a[200:203], v[140:143], v[120:123]
    v_mul_f32 v198, s20, v46
    v_mfma_f32_16x16x32_bf16 v[116:119], a[196:199], v[140:143], v[116:119]
    v_mul_f32 v199, s20, v47
    v_mfma_f32_16x16x32_bf16 v[112:115], a[192:195], v[140:143], v[112:115]
    s_waitcnt lgkmcnt(2)
    v_cvt_pk_bf16_f32 v187, v198, v199
    v_mfma_f32_16x16x32_bf16 v[64:67], a[208:211], v[144:147], v[64:67]
    ds_read_b64_tr_b16 v[156:157], v229 offset:53248
    ds_read_b64_tr_b16 v[158:159], v229 offset:53760
    v_mfma_f32_16x16x32_bf16 v[68:71], a[212:215], v[144:147], v[68:71]
    buffer_store_dwordx4 v[184:187], v234, s[12:15], s22 offen offset:2048 sc1
    v_mfma_f32_16x16x32_bf16 v[72:75], a[216:219], v[144:147], v[72:75]
    v_mfma_f32_16x16x32_bf16 v[76:79], a[220:223], v[144:147], v[76:79]
    v_mfma_f32_16x16x32_bf16 v[92:95], a[220:223], v[148:151], v[92:95]
    ds_read_b64_tr_b16 v[128:129], v226 offset:57344
    ds_read_b64_tr_b16 v[130:131], v226 offset:57856
    v_mfma_f32_16x16x32_bf16 v[88:91], a[216:219], v[148:151], v[88:91]
    v_mul_f32 v200, s20, v56
    v_mfma_f32_16x16x32_bf16 v[84:87], a[212:215], v[148:151], v[84:87]
    v_mul_f32 v201, s20, v57
    v_mfma_f32_16x16x32_bf16 v[80:83], a[208:211], v[148:151], v[80:83]
    s_waitcnt lgkmcnt(2)
    v_mfma_f32_16x16x32_bf16 v[96:99], a[208:211], v[152:155], v[96:99]
    ds_read_b64_tr_b16 v[132:133], v227 offset:57344
    ds_read_b64_tr_b16 v[134:135], v227 offset:57856
    v_mfma_f32_16x16x32_bf16 v[100:103], a[212:215], v[152:155], v[100:103]
    v_cvt_pk_bf16_f32 v188, v200, v201
    v_mul_f32 v202, s20, v58
    v_mfma_f32_16x16x32_bf16 v[104:107], a[216:219], v[152:155], v[104:107]
    v_mfma_f32_16x16x32_bf16 v[108:111], a[220:223], v[152:155], v[108:111]
    v_mul_f32 v203, s20, v59
    v_mfma_f32_16x16x32_bf16 v[124:127], a[220:223], v[156:159], v[124:127]
    ds_read_b64_tr_b16 v[136:137], v228 offset:57344
    ds_read_b64_tr_b16 v[138:139], v228 offset:57856
    v_mfma_f32_16x16x32_bf16 v[120:123], a[216:219], v[156:159], v[120:123]
    v_cvt_pk_bf16_f32 v189, v202, v203
    v_mfma_f32_16x16x32_bf16 v[116:119], a[212:215], v[156:159], v[116:119]
    v_mul_f32 v204, s20, v60
    v_mfma_f32_16x16x32_bf16 v[112:115], a[208:211], v[156:159], v[112:115]
    s_waitcnt lgkmcnt(2)
    v_mfma_f32_16x16x32_bf16 v[64:67], a[224:227], v[128:131], v[64:67]
    ds_read_b64_tr_b16 v[140:141], v229 offset:57344
    ds_read_b64_tr_b16 v[142:143], v229 offset:57856
    v_mfma_f32_16x16x32_bf16 v[68:71], a[228:231], v[128:131], v[68:71]
    v_mul_f32 v205, s20, v61
    v_mfma_f32_16x16x32_bf16 v[72:75], a[232:235], v[128:131], v[72:75]
    v_cvt_pk_bf16_f32 v190, v204, v205
    v_mfma_f32_16x16x32_bf16 v[76:79], a[236:239], v[128:131], v[76:79]
    v_mul_f32 v206, s20, v62
    v_mfma_f32_16x16x32_bf16 v[92:95], a[236:239], v[132:135], v[92:95]
    ds_read_b64_tr_b16 v[144:145], v226 offset:61440
    ds_read_b64_tr_b16 v[146:147], v226 offset:61952
    v_mfma_f32_16x16x32_bf16 v[88:91], a[232:235], v[132:135], v[88:91]
    v_mul_f32 v207, s20, v63
    v_mfma_f32_16x16x32_bf16 v[84:87], a[228:231], v[132:135], v[84:87]
    v_mfma_f32_16x16x32_bf16 v[80:83], a[224:227], v[132:135], v[80:83]
    s_waitcnt lgkmcnt(2)
    v_cvt_pk_bf16_f32 v191, v206, v207
    v_mfma_f32_16x16x32_bf16 v[96:99], a[224:227], v[136:139], v[96:99]
    ds_read_b64_tr_b16 v[148:149], v227 offset:61440
    ds_read_b64_tr_b16 v[150:151], v227 offset:61952
    v_mfma_f32_16x16x32_bf16 v[100:103], a[228:231], v[136:139], v[100:103]
    buffer_store_dwordx4 v[188:191], v234, s[12:15], s22 offen offset:3072 sc1
    v_mfma_f32_16x16x32_bf16 v[104:107], a[232:235], v[136:139], v[104:107]
    v_mfma_f32_16x16x32_bf16 v[108:111], a[236:239], v[136:139], v[108:111]
    v_mfma_f32_16x16x32_bf16 v[124:127], a[236:239], v[140:143], v[124:127]
    ds_read_b64_tr_b16 v[152:153], v228 offset:61440
    ds_read_b64_tr_b16 v[154:155], v228 offset:61952
    v_mfma_f32_16x16x32_bf16 v[120:123], a[232:235], v[140:143], v[120:123]
    v_mfma_f32_16x16x32_bf16 v[116:119], a[228:231], v[140:143], v[116:119]
    v_mfma_f32_16x16x32_bf16 v[112:115], a[224:227], v[140:143], v[112:115]
    s_waitcnt lgkmcnt(2)
    v_mfma_f32_16x16x32_bf16 v[64:67], a[240:243], v[144:147], v[64:67]
    ds_read_b64_tr_b16 v[156:157], v229 offset:61440
    ds_read_b64_tr_b16 v[158:159], v229 offset:61952
    v_mfma_f32_16x16x32_bf16 v[68:71], a[244:247], v[144:147], v[68:71]
    v_mfma_f32_16x16x32_bf16 v[72:75], a[248:251], v[144:147], v[72:75]
    s_waitcnt vmcnt(16)
    s_barrier
    v_mfma_f32_16x16x32_bf16 v[76:79], a[252:255], v[144:147], v[76:79]
    v_mfma_f32_16x16x32_bf16 v[92:95], a[252:255], v[148:151], v[92:95]
    ds_read_b64_tr_b16 v[128:129], v226 offset:0
    ds_read_b64_tr_b16 v[130:131], v226 offset:512
    v_mfma_f32_16x16x32_bf16 v[88:91], a[248:251], v[148:151], v[88:91]
    v_mfma_f32_16x16x32_bf16 v[84:87], a[244:247], v[148:151], v[84:87]
    v_mfma_f32_16x16x32_bf16 v[80:83], a[240:243], v[148:151], v[80:83]
    s_waitcnt lgkmcnt(2)
    v_mfma_f32_16x16x32_bf16 v[96:99], a[240:243], v[152:155], v[96:99]
    ds_read_b64_tr_b16 v[132:133], v227 offset:0
    ds_read_b64_tr_b16 v[134:135], v227 offset:512
    v_mfma_f32_16x16x32_bf16 v[100:103], a[244:247], v[152:155], v[100:103]
    v_mfma_f32_16x16x32_bf16 v[104:107], a[248:251], v[152:155], v[104:107]
    v_mfma_f32_16x16x32_bf16 v[108:111], a[252:255], v[152:155], v[108:111]
    v_mfma_f32_16x16x32_bf16 v[124:127], a[252:255], v[156:159], v[124:127]
    ds_read_b64_tr_b16 v[136:137], v228 offset:0
    ds_read_b64_tr_b16 v[138:139], v228 offset:512
    v_mfma_f32_16x16x32_bf16 v[120:123], a[248:251], v[156:159], v[120:123]
    v_mfma_f32_16x16x32_bf16 v[116:119], a[244:247], v[156:159], v[116:119]
    v_mfma_f32_16x16x32_bf16 v[112:115], a[240:243], v[156:159], v[112:115]
    s_mov_b32 s29, 1
    s_lshl_b32 s23, s97, 6
    v_and_b32 v238, 0xffffffbf, v238
    v_and_b32 v239, 0xffffffbf, v239
    s_branch K1_loop_14
K1_done_15:
    ds_read_b64_tr_b16 v[144:145], v222 offset:36864
    ds_read_b64_tr_b16 v[146:147], v222 offset:37376
    s_waitcnt lgkmcnt(6)
    v_mfma_f32_16x16x32_bf16 v[64:67], a[0:3], v[128:131], 0
    ds_read_b64_tr_b16 v[148:149], v223 offset:36864
    ds_read_b64_tr_b16 v[150:151], v223 offset:37376
    v_mfma_f32_16x16x32_bf16 v[68:71], a[4:7], v[128:131], 0
    v_mfma_f32_16x16x32_bf16 v[72:75], a[8:11], v[128:131], 0
    v_mfma_f32_16x16x32_bf16 v[76:79], a[12:15], v[128:131], 0
    s_waitcnt lgkmcnt(6)
    v_mfma_f32_16x16x32_bf16 v[92:95], a[12:15], v[132:135], 0
    ds_read_b64_tr_b16 v[128:129], v222 offset:40960
    ds_read_b64_tr_b16 v[130:131], v222 offset:41472
    v_mfma_f32_16x16x32_bf16 v[88:91], a[8:11], v[132:135], 0
    v_mfma_f32_16x16x32_bf16 v[84:87], a[4:7], v[132:135], 0
    v_mfma_f32_16x16x32_bf16 v[80:83], a[0:3], v[132:135], 0
    s_waitcnt lgkmcnt(4)
    v_mfma_f32_16x16x32_bf16 v[64:67], a[16:19], v[144:147], v[64:67]
    s_lshr_b32 s22, s19, 2
    ds_read_b64_tr_b16 v[132:133], v223 offset:40960
    ds_read_b64_tr_b16 v[134:135], v223 offset:41472
    v_mfma_f32_16x16x32_bf16 v[68:71], a[20:23], v[144:147], v[68:71]
    s_lshl_b32 s22, s22, 19
    s_and_b32 s26, s19, 3
    v_mfma_f32_16x16x32_bf16 v[72:75], a[24:27], v[144:147], v[72:75]
    s_lshl_b32 s26, s26, 12
    v_mfma_f32_16x16x32_bf16 v[76:79], a[28:31], v[144:147], v[76:79]
    s_waitcnt lgkmcnt(4)
    s_add_u32 s22, s22, s26
    v_mfma_f32_16x16x32_bf16 v[92:95], a[28:31], v[148:151], v[92:95]
    s_add_u32 s22, s22, s32
    ds_read_b64_tr_b16 v[144:145], v222 offset:45056
    ds_read_b64_tr_b16 v[146:147], v222 offset:45568
    v_mfma_f32_16x16x32_bf16 v[88:91], a[24:27], v[148:151], v[88:91]
    s_add_u32 s19, s19, 1
    v_mfma_f32_16x16x32_bf16 v[84:87], a[20:23], v[148:151], v[84:87]
    v_mul_f32 v192, s20, v0
    v_mfma_f32_16x16x32_bf16 v[80:83], a[16:19], v[148:151], v[80:83]
    s_waitcnt lgkmcnt(4)
    v_mul_f32 v193, s20, v1
    v_mfma_f32_16x16x32_bf16 v[64:67], a[32:35], v[128:131], v[64:67]
    ds_read_b64_tr_b16 v[148:149], v223 offset:45056
    ds_read_b64_tr_b16 v[150:151], v223 offset:45568
    v_mfma_f32_16x16x32_bf16 v[68:71], a[36:39], v[128:131], v[68:71]
    v_cvt_pk_bf16_f32 v160, v192, v193
    v_mul_f32 v194, s20, v2
    v_mfma_f32_16x16x32_bf16 v[72:75], a[40:43], v[128:131], v[72:75]
    v_mul_f32 v195, s20, v3
    v_mfma_f32_16x16x32_bf16 v[76:79], a[44:47], v[128:131], v[76:79]
    s_waitcnt lgkmcnt(4)
    v_cvt_pk_bf16_f32 v161, v194, v195
    v_mul_f32 v196, s20, v4
    v_mfma_f32_16x16x32_bf16 v[92:95], a[44:47], v[132:135], v[92:95]
    ds_read_b64_tr_b16 v[128:129], v222 offset:49152
    ds_read_b64_tr_b16 v[130:131], v222 offset:49664
    v_mfma_f32_16x16x32_bf16 v[88:91], a[40:43], v[132:135], v[88:91]
    v_mul_f32 v197, s20, v5
    v_cvt_pk_bf16_f32 v162, v196, v197
    v_mfma_f32_16x16x32_bf16 v[84:87], a[36:39], v[132:135], v[84:87]
    v_mul_f32 v198, s20, v6
    v_mfma_f32_16x16x32_bf16 v[80:83], a[32:35], v[132:135], v[80:83]
    s_waitcnt lgkmcnt(4)
    v_mul_f32 v199, s20, v7
    v_mfma_f32_16x16x32_bf16 v[64:67], a[48:51], v[144:147], v[64:67]
    ds_read_b64_tr_b16 v[132:133], v223 offset:49152
    ds_read_b64_tr_b16 v[134:135], v223 offset:49664
    v_mfma_f32_16x16x32_bf16 v[68:71], a[52:55], v[144:147], v[68:71]
    v_cvt_pk_bf16_f32 v163, v198, v199
    v_mfma_f32_16x16x32_bf16 v[72:75], a[56:59], v[144:147], v[72:75]
    buffer_store_dwordx4 v[160:163], v234, s[12:15], s22 offen offset:0 sc1
    v_mfma_f32_16x16x32_bf16 v[76:79], a[60:63], v[144:147], v[76:79]
    s_waitcnt lgkmcnt(4)
    v_mul_f32 v200, s20, v16
    v_mfma_f32_16x16x32_bf16 v[92:95], a[60:63], v[148:151], v[92:95]
    ds_read_b64_tr_b16 v[144:145], v222 offset:53248
    ds_read_b64_tr_b16 v[146:147], v222 offset:53760
    v_mfma_f32_16x16x32_bf16 v[88:91], a[56:59], v[148:151], v[88:91]
    v_mul_f32 v201, s20, v17
    v_cvt_pk_bf16_f32 v164, v200, v201
    v_mfma_f32_16x16x32_bf16 v[84:87], a[52:55], v[148:151], v[84:87]
    v_mul_f32 v202, s20, v18
    v_mfma_f32_16x16x32_bf16 v[80:83], a[48:51], v[148:151], v[80:83]
    s_waitcnt lgkmcnt(4)
    v_mul_f32 v203, s20, v19
    v_cvt_pk_bf16_f32 v165, v202, v203
    v_mfma_f32_16x16x32_bf16 v[64:67], a[64:67], v[128:131], v[64:67]
    ds_read_b64_tr_b16 v[148:149], v223 offset:53248
    ds_read_b64_tr_b16 v[150:151], v223 offset:53760
    v_mfma_f32_16x16x32_bf16 v[68:71], a[68:71], v[128:131], v[68:71]
    v_mul_f32 v204, s20, v20
    v_mul_f32 v205, s20, v21
    v_mfma_f32_16x16x32_bf16 v[72:75], a[72:75], v[128:131], v[72:75]
    v_cvt_pk_bf16_f32 v166, v204, v205
    v_mfma_f32_16x16x32_bf16 v[76:79], a[76:79], v[128:131], v[76:79]
    s_waitcnt lgkmcnt(4)
    v_mul_f32 v206, s20, v22
    v_mfma_f32_16x16x32_bf16 v[92:95], a[76:79], v[132:135], v[92:95]
    ds_read_b64_tr_b16 v[128:129], v222 offset:57344
    ds_read_b64_tr_b16 v[130:131], v222 offset:57856
    v_mfma_f32_16x16x32_bf16 v[88:91], a[72:75], v[132:135], v[88:91]
    v_mul_f32 v207, s20, v23
    v_cvt_pk_bf16_f32 v167, v206, v207
    v_mfma_f32_16x16x32_bf16 v[84:87], a[68:71], v[132:135], v[84:87]
    buffer_store_dwordx4 v[164:167], v234, s[12:15], s22 offen offset:1024 sc1
    v_mfma_f32_16x16x32_bf16 v[80:83], a[64:67], v[132:135], v[80:83]
    s_waitcnt lgkmcnt(4)
    v_mfma_f32_16x16x32_bf16 v[64:67], a[80:83], v[144:147], v[64:67]
    ds_read_b64_tr_b16 v[132:133], v223 offset:57344
    ds_read_b64_tr_b16 v[134:135], v223 offset:57856
    v_mfma_f32_16x16x32_bf16 v[68:71], a[84:87], v[144:147], v[68:71]
    v_mul_f32 v192, s20, v8
    v_mul_f32 v193, s20, v9
    v_mfma_f32_16x16x32_bf16 v[72:75], a[88:91], v[144:147], v[72:75]
    v_cvt_pk_bf16_f32 v168, v192, v193
    v_mul_f32 v194, s20, v10
    v_mfma_f32_16x16x32_bf16 v[76:79], a[92:95], v[144:147], v[76:79]
    s_waitcnt lgkmcnt(4)
    v_mul_f32 v195, s20, v11
    v_mfma_f32_16x16x32_bf16 v[92:95], a[92:95], v[148:151], v[92:95]
    ds_read_b64_tr_b16 v[144:145], v222 offset:61440
    ds_read_b64_tr_b16 v[146:147], v222 offset:61952
    v_mfma_f32_16x16x32_bf16 v[88:91], a[88:91], v[148:151], v[88:91]
    v_cvt_pk_bf16_f32 v169, v194, v195
    v_mul_f32 v196, s20, v12
    v_mfma_f32_16x16x32_bf16 v[84:87], a[84:87], v[148:151], v[84:87]
    v_mul_f32 v197, s20, v13
    v_mfma_f32_16x16x32_bf16 v[80:83], a[80:83], v[148:151], v[80:83]
    s_waitcnt lgkmcnt(4)
    v_cvt_pk_bf16_f32 v170, v196, v197
    v_mfma_f32_16x16x32_bf16 v[64:67], a[96:99], v[128:131], v[64:67]
    ds_read_b64_tr_b16 v[148:149], v223 offset:61440
    ds_read_b64_tr_b16 v[150:151], v223 offset:61952
    v_mfma_f32_16x16x32_bf16 v[68:71], a[100:103], v[128:131], v[68:71]
    v_mul_f32 v198, s20, v14
    v_mul_f32 v199, s20, v15
    v_mfma_f32_16x16x32_bf16 v[72:75], a[104:107], v[128:131], v[72:75]
    s_waitcnt vmcnt(6)
    v_cvt_pk_bf16_f32 v171, v198, v199
    s_barrier
    v_mfma_f32_16x16x32_bf16 v[76:79], a[108:111], v[128:131], v[76:79]
    s_waitcnt lgkmcnt(4)
    v_mfma_f32_16x16x32_bf16 v[92:95], a[108:111], v[132:135], v[92:95]
    ds_read_b64_tr_b16 v[128:129], v226 offset:32768
    ds_read_b64_tr_b16 v[130:131], v226 offset:33280
    v_mfma_f32_16x16x32_bf16 v[88:91], a[104:107], v[132:135], v[88:91]
    buffer_store_dwordx4 v[168:171], v234, s[12:15], s22 offen offset:2048 sc1
    v_mfma_f32_16x16x32_bf16 v[84:87], a[100:103], v[132:135], v[84:87]
    v_mul_f32 v200, s20, v24
    v_mul_f32 v201, s20, v25
    v_mfma_f32_16x16x32_bf16 v[80:83], a[96:99], v[132:135], v[80:83]
    s_waitcnt lgkmcnt(4)
    v_cvt_pk_bf16_f32 v172, v200, v201
    v_mul_f32 v202, s20, v26
    v_mfma_f32_16x16x32_bf16 v[64:67], a[112:115], v[144:147], v[64:67]
    ds_read_b64_tr_b16 v[132:133], v227 offset:32768
    ds_read_b64_tr_b16 v[134:135], v227 offset:33280
    v_mfma_f32_16x16x32_bf16 v[68:71], a[116:119], v[144:147], v[68:71]
    v_mul_f32 v203, s20, v27
    v_cvt_pk_bf16_f32 v173, v202, v203
    v_mfma_f32_16x16x32_bf16 v[72:75], a[120:123], v[144:147], v[72:75]
    v_mul_f32 v204, s20, v28
    v_mfma_f32_16x16x32_bf16 v[76:79], a[124:127], v[144:147], v[76:79]
    s_waitcnt lgkmcnt(4)
    v_mul_f32 v205, s20, v29
    v_mfma_f32_16x16x32_bf16 v[92:95], a[124:127], v[148:151], v[92:95]
    ds_read_b64_tr_b16 v[144:145], v226 offset:36864
    ds_read_b64_tr_b16 v[146:147], v226 offset:37376
    v_mfma_f32_16x16x32_bf16 v[88:91], a[120:123], v[148:151], v[88:91]
    v_cvt_pk_bf16_f32 v174, v204, v205
    v_mul_f32 v206, s20, v30
    v_mfma_f32_16x16x32_bf16 v[84:87], a[116:119], v[148:151], v[84:87]
    v_mul_f32 v207, s20, v31
    v_mfma_f32_16x16x32_bf16 v[80:83], a[112:115], v[148:151], v[80:83]
    s_waitcnt lgkmcnt(4)
    v_cvt_pk_bf16_f32 v175, v206, v207
    v_mfma_f32_16x16x32_bf16 v[64:67], a[128:131], v[128:131], v[64:67]
    ds_read_b64_tr_b16 v[148:149], v227 offset:36864
    ds_read_b64_tr_b16 v[150:151], v227 offset:37376
    v_mfma_f32_16x16x32_bf16 v[68:71], a[132:135], v[128:131], v[68:71]
    buffer_store_dwordx4 v[172:175], v234, s[12:15], s22 offen offset:3072 sc1
    v_mfma_f32_16x16x32_bf16 v[72:75], a[136:139], v[128:131], v[72:75]
    s_lshr_b32 s22, s19, 2
    s_lshl_b32 s22, s22, 19
    v_mfma_f32_16x16x32_bf16 v[76:79], a[140:143], v[128:131], v[76:79]
    s_waitcnt lgkmcnt(4)
    s_and_b32 s26, s19, 3
    v_mfma_f32_16x16x32_bf16 v[92:95], a[140:143], v[132:135], v[92:95]
    s_lshl_b32 s26, s26, 12
    ds_read_b64_tr_b16 v[128:129], v226 offset:40960
    ds_read_b64_tr_b16 v[130:131], v226 offset:41472
    v_mfma_f32_16x16x32_bf16 v[88:91], a[136:139], v[132:135], v[88:91]
    s_add_u32 s22, s22, s26
    v_mfma_f32_16x16x32_bf16 v[84:87], a[132:135], v[132:135], v[84:87]
    s_add_u32 s22, s22, s32
    v_mfma_f32_16x16x32_bf16 v[80:83], a[128:131], v[132:135], v[80:83]
    s_waitcnt lgkmcnt(4)
    s_add_u32 s19, s19, 1
    v_mfma_f32_16x16x32_bf16 v[64:67], a[144:147], v[144:147], v[64:67]
    ds_read_b64_tr_b16 v[132:133], v227 offset:40960
    ds_read_b64_tr_b16 v[134:135], v227 offset:41472
    v_mfma_f32_16x16x32_bf16 v[68:71], a[148:151], v[144:147], v[68:71]
    v_mul_f32 v192, s20, v32
    v_mul_f32 v193, s20, v33
    v_mfma_f32_16x16x32_bf16 v[72:75], a[152:155], v[144:147], v[72:75]
    v_cvt_pk_bf16_f32 v176, v192, v193
    v_mfma_f32_16x16x32_bf16 v[76:79], a[156:159], v[144:147], v[76:79]
    s_waitcnt lgkmcnt(4)
    v_mul_f32 v194, s20, v34
    v_mfma_f32_16x16x32_bf16 v[92:95], a[156:159], v[148:151], v[92:95]
    ds_read_b64_tr_b16 v[144:145], v226 offset:45056
    ds_read_b64_tr_b16 v[146:147], v226 offset:45568
    v_mfma_f32_16x16x32_bf16 v[88:91], a[152:155], v[148:151], v[88:91]
    v_mul_f32 v195, s20, v35
    v_cvt_pk_bf16_f32 v177, v194, v195
    v_mfma_f32_16x16x32_bf16 v[84:87], a[148:151], v[148:151], v[84:87]
    v_mul_f32 v196, s20, v36
    v_mul_f32 v197, s20, v37
    v_mfma_f32_16x16x32_bf16 v[80:83], a[144:147], v[148:151], v[80:83]
    s_waitcnt lgkmcnt(4)
    v_cvt_pk_bf16_f32 v178, v196, v197
    v_mfma_f32_16x16x32_bf16 v[64:67], a[160:163], v[128:131], v[64:67]
    ds_read_b64_tr_b16 v[148:149], v227 offset:45056
    ds_read_b64_tr_b16 v[150:151], v227 offset:45568
    v_mfma_f32_16x16x32_bf16 v[68:71], a[164:167], v[128:131], v[68:71]
    v_mul_f32 v198, s20, v38
    v_mul_f32 v199, s20, v39
    v_mfma_f32_16x16x32_bf16 v[72:75], a[168:171], v[128:131], v[72:75]
    v_cvt_pk_bf16_f32 v179, v198, v199
    v_mfma_f32_16x16x32_bf16 v[76:79], a[172:175], v[128:131], v[76:79]
    s_waitcnt lgkmcnt(4)
    v_mfma_f32_16x16x32_bf16 v[92:95], a[172:175], v[132:135], v[92:95]
    ds_read_b64_tr_b16 v[128:129], v226 offset:49152
    ds_read_b64_tr_b16 v[130:131], v226 offset:49664
    v_mfma_f32_16x16x32_bf16 v[88:91], a[168:171], v[132:135], v[88:91]
    buffer_store_dwordx4 v[176:179], v234, s[12:15], s22 offen offset:0 sc1
    v_mfma_f32_16x16x32_bf16 v[84:87], a[164:167], v[132:135], v[84:87]
    v_mul_f32 v200, s20, v48
    v_mul_f32 v201, s20, v49
    v_mfma_f32_16x16x32_bf16 v[80:83], a[160:163], v[132:135], v[80:83]
    s_waitcnt lgkmcnt(4)
    v_cvt_pk_bf16_f32 v180, v200, v201
    v_mfma_f32_16x16x32_bf16 v[64:67], a[176:179], v[144:147], v[64:67]
    ds_read_b64_tr_b16 v[132:133], v227 offset:49152
    ds_read_b64_tr_b16 v[134:135], v227 offset:49664
    v_mfma_f32_16x16x32_bf16 v[68:71], a[180:183], v[144:147], v[68:71]
    v_mul_f32 v202, s20, v50
    v_mul_f32 v203, s20, v51
    v_mfma_f32_16x16x32_bf16 v[72:75], a[184:187], v[144:147], v[72:75]
    v_cvt_pk_bf16_f32 v181, v202, v203
    v_mul_f32 v204, s20, v52
    v_mfma_f32_16x16x32_bf16 v[76:79], a[188:191], v[144:147], v[76:79]
    s_waitcnt lgkmcnt(4)
    v_mul_f32 v205, s20, v53
    v_mfma_f32_16x16x32_bf16 v[92:95], a[188:191], v[148:151], v[92:95]
    ds_read_b64_tr_b16 v[144:145], v226 offset:53248
    ds_read_b64_tr_b16 v[146:147], v226 offset:53760
    v_mfma_f32_16x16x32_bf16 v[88:91], a[184:187], v[148:151], v[88:91]
    v_cvt_pk_bf16_f32 v182, v204, v205
    v_mul_f32 v206, s20, v54
    v_mfma_f32_16x16x32_bf16 v[84:87], a[180:183], v[148:151], v[84:87]
    v_mul_f32 v207, s20, v55
    v_mfma_f32_16x16x32_bf16 v[80:83], a[176:179], v[148:151], v[80:83]
    s_waitcnt lgkmcnt(4)
    v_cvt_pk_bf16_f32 v183, v206, v207
    v_mfma_f32_16x16x32_bf16 v[64:67], a[192:195], v[128:131], v[64:67]
    ds_read_b64_tr_b16 v[148:149], v227 offset:53248
    ds_read_b64_tr_b16 v[150:151], v227 offset:53760
    v_mfma_f32_16x16x32_bf16 v[68:71], a[196:199], v[128:131], v[68:71]
    buffer_store_dwordx4 v[180:183], v234, s[12:15], s22 offen offset:1024 sc1
    v_mfma_f32_16x16x32_bf16 v[72:75], a[200:203], v[128:131], v[72:75]
    v_mul_f32 v192, s20, v40
    v_mfma_f32_16x16x32_bf16 v[76:79], a[204:207], v[128:131], v[76:79]
    s_waitcnt lgkmcnt(4)
    v_mul_f32 v193, s20, v41
    v_mfma_f32_16x16x32_bf16 v[92:95], a[204:207], v[132:135], v[92:95]
    ds_read_b64_tr_b16 v[128:129], v226 offset:57344
    ds_read_b64_tr_b16 v[130:131], v226 offset:57856
    v_mfma_f32_16x16x32_bf16 v[88:91], a[200:203], v[132:135], v[88:91]
    v_cvt_pk_bf16_f32 v184, v192, v193
    v_mul_f32 v194, s20, v42
    v_mfma_f32_16x16x32_bf16 v[84:87], a[196:199], v[132:135], v[84:87]
    v_mul_f32 v195, s20, v43
    v_cvt_pk_bf16_f32 v185, v194, v195
    v_mfma_f32_16x16x32_bf16 v[80:83], a[192:195], v[132:135], v[80:83]
    s_waitcnt lgkmcnt(4)
    v_mul_f32 v196, s20, v44
    v_mfma_f32_16x16x32_bf16 v[64:67], a[208:211], v[144:147], v[64:67]
    ds_read_b64_tr_b16 v[132:133], v227 offset:57344
    ds_read_b64_tr_b16 v[134:135], v227 offset:57856
    v_mfma_f32_16x16x32_bf16 v[68:71], a[212:215], v[144:147], v[68:71]
    v_mul_f32 v197, s20, v45
    v_cvt_pk_bf16_f32 v186, v196, v197
    v_mfma_f32_16x16x32_bf16 v[72:75], a[216:219], v[144:147], v[72:75]
    v_mul_f32 v198, s20, v46
    v_mfma_f32_16x16x32_bf16 v[76:79], a[220:223], v[144:147], v[76:79]
    s_waitcnt lgkmcnt(4)
    v_mul_f32 v199, s20, v47
    v_mfma_f32_16x16x32_bf16 v[92:95], a[220:223], v[148:151], v[92:95]
    ds_read_b64_tr_b16 v[144:145], v226 offset:61440
    ds_read_b64_tr_b16 v[146:147], v226 offset:61952
    v_mfma_f32_16x16x32_bf16 v[88:91], a[216:219], v[148:151], v[88:91]
    v_cvt_pk_bf16_f32 v187, v198, v199
    v_mfma_f32_16x16x32_bf16 v[84:87], a[212:215], v[148:151], v[84:87]
    buffer_store_dwordx4 v[184:187], v234, s[12:15], s22 offen offset:2048 sc1
    v_mfma_f32_16x16x32_bf16 v[80:83], a[208:211], v[148:151], v[80:83]
    s_waitcnt lgkmcnt(4)
    v_mul_f32 v200, s20, v56
    v_mfma_f32_16x16x32_bf16 v[64:67], a[224:227], v[128:131], v[64:67]
    ds_read_b64_tr_b16 v[148:149], v227 offset:61440
    ds_read_b64_tr_b16 v[150:151], v227 offset:61952
    v_mfma_f32_16x16x32_bf16 v[68:71], a[228:231], v[128:131], v[68:71]
    v_mul_f32 v201, s20, v57
    v_cvt_pk_bf16_f32 v188, v200, v201
    v_mfma_f32_16x16x32_bf16 v[72:75], a[232:235], v[128:131], v[72:75]
    v_mul_f32 v202, s20, v58
    v_mul_f32 v203, s20, v59
    v_mfma_f32_16x16x32_bf16 v[76:79], a[236:239], v[128:131], v[76:79]
    s_waitcnt lgkmcnt(4)
    v_cvt_pk_bf16_f32 v189, v202, v203
    v_mfma_f32_16x16x32_bf16 v[92:95], a[236:239], v[132:135], v[92:95]
    v_mul_f32 v204, s20, v60
    v_mfma_f32_16x16x32_bf16 v[88:91], a[232:235], v[132:135], v[88:91]
    v_mul_f32 v205, s20, v61
    v_mfma_f32_16x16x32_bf16 v[84:87], a[228:231], v[132:135], v[84:87]
    v_cvt_pk_bf16_f32 v190, v204, v205
    v_mfma_f32_16x16x32_bf16 v[80:83], a[224:227], v[132:135], v[80:83]
    s_waitcnt lgkmcnt(2)
    v_mul_f32 v206, s20, v62
    v_mfma_f32_16x16x32_bf16 v[64:67], a[240:243], v[144:147], v[64:67]
    v_mul_f32 v207, s20, v63
    v_mfma_f32_16x16x32_bf16 v[68:71], a[244:247], v[144:147], v[68:71]
    v_cvt_pk_bf16_f32 v191, v206, v207
    v_mfma_f32_16x16x32_bf16 v[72:75], a[248:251], v[144:147], v[72:75]
    buffer_store_dwordx4 v[188:191], v234, s[12:15], s22 offen offset:3072 sc1
    v_mfma_f32_16x16x32_bf16 v[76:79], a[252:255], v[144:147], v[76:79]
    s_waitcnt lgkmcnt(0)
    v_mfma_f32_16x16x32_bf16 v[92:95], a[252:255], v[148:151], v[92:95]
    v_mfma_f32_16x16x32_bf16 v[88:91], a[248:251], v[148:151], v[88:91]
    v_mfma_f32_16x16x32_bf16 v[84:87], a[244:247], v[148:151], v[84:87]
    v_mfma_f32_16x16x32_bf16 v[80:83], a[240:243], v[148:151], v[80:83]
    s_mov_b32 s19, s97
    s_nop 3
    s_lshr_b32 s22, s19, 2
    s_lshl_b32 s22, s22, 19
    s_and_b32 s26, s19, 3
    s_lshl_b32 s26, s26, 12
    s_add_u32 s22, s22, s26
    s_add_u32 s22, s22, s32
    s_add_u32 s19, s19, 1
    v_pk_mul_f32 v[192:193], v[64:65], s[20:21] op_sel_hi:[1,0]
    v_cvt_pk_bf16_f32 v160, v192, v193
    v_pk_mul_f32 v[194:195], v[66:67], s[20:21] op_sel_hi:[1,0]
    v_cvt_pk_bf16_f32 v161, v194, v195
    v_pk_mul_f32 v[196:197], v[68:69], s[20:21] op_sel_hi:[1,0]
    v_cvt_pk_bf16_f32 v162, v196, v197
    v_pk_mul_f32 v[198:199], v[70:71], s[20:21] op_sel_hi:[1,0]
    v_cvt_pk_bf16_f32 v163, v198, v199
    buffer_store_dwordx4 v[160:163], v234, s[12:15], s22 offen offset:0 sc1
    v_pk_mul_f32 v[200:201], v[80:81], s[20:21] op_sel_hi:[1,0]
    v_cvt_pk_bf16_f32 v164, v200, v201
    v_pk_mul_f32 v[202:203], v[82:83], s[20:21] op_sel_hi:[1,0]
    v_cvt_pk_bf16_f32 v165, v202, v203
    v_pk_mul_f32 v[204:205], v[84:85], s[20:21] op_sel_hi:[1,0]
    v_cvt_pk_bf16_f32 v166, v204, v205
    v_pk_mul_f32 v[206:207], v[86:87], s[20:21] op_sel_hi:[1,0]
    v_cvt_pk_bf16_f32 v167, v206, v207
    buffer_store_dwordx4 v[164:167], v234, s[12:15], s22 offen offset:1024 sc1
    v_pk_mul_f32 v[192:193], v[72:73], s[20:21] op_sel_hi:[1,0]
    v_cvt_pk_bf16_f32 v168, v192, v193
    v_pk_mul_f32 v[194:195], v[74:75], s[20:21] op_sel_hi:[1,0]
    v_cvt_pk_bf16_f32 v169, v194, v195
    v_pk_mul_f32 v[196:197], v[76:77], s[20:21] op_sel_hi:[1,0]
    v_cvt_pk_bf16_f32 v170, v196, v197
    v_pk_mul_f32 v[198:199], v[78:79], s[20:21] op_sel_hi:[1,0]
    v_cvt_pk_bf16_f32 v171, v198, v199
    buffer_store_dwordx4 v[168:171], v234, s[12:15], s22 offen offset:2048 sc1
    v_pk_mul_f32 v[200:201], v[88:89], s[20:21] op_sel_hi:[1,0]
    v_cvt_pk_bf16_f32 v172, v200, v201
    v_pk_mul_f32 v[202:203], v[90:91], s[20:21] op_sel_hi:[1,0]
    v_cvt_pk_bf16_f32 v173, v202, v203
    v_pk_mul_f32 v[204:205], v[92:93], s[20:21] op_sel_hi:[1,0]
    v_cvt_pk_bf16_f32 v174, v204, v205
    v_pk_mul_f32 v[206:207], v[94:95], s[20:21] op_sel_hi:[1,0]
    v_cvt_pk_bf16_f32 v175, v206, v207
    buffer_store_dwordx4 v[172:175], v234, s[12:15], s22 offen offset:3072 sc1
    s_branch K2_fused_entry
K1_bkv_3:
    s_mov_b32 s40, s58
    s_mov_b32 s41, s59
    s_mov_b32 s42, 16384
    s_mov_b32 s43, 0x20000
    s_mov_b32 s60, 0x3fb8aa3b
    s_sub_u32 s23, s23, 1280
    v_and_b32 v241, 15, v240
    v_lshrrev_b32 v242, 4, v240
    v_bfe_u32 v243, v240, 2, 2
    v_cmp_eq_u32 s[48:49], 0, v243
    v_cmp_eq_u32 s[50:51], 1, v243
    v_cmp_eq_u32 s[52:53], 2, v243
    v_cmp_eq_u32 s[54:55], 3, v243
    v_and_b32 v246, 3, v240
    v_lshlrev_b32 v246, 1, v246
    v_lshl_add_u32 v246, v242, 7, v246
    v_lshl_add_u32 v246, v243, 9, v246
    v_lshlrev_b32 v247, 6, v241
    v_lshl_add_u32 v247, v242, 14, v247
    s_lshl_b32 s26, s16, 12
    s_add_u32 s26, s26, 98304
    v_add_u32 v247, s26, v247
    v_lshlrev_b32 v230, 4, v241
    v_lshl_add_u32 v230, v242, 17, v230
    v_lshl_add_u32 v243, v242, 2, v243
    v_lshlrev_b32 v248, 6, v243
    v_and_b32 v243, 3, v240
    v_lshl_add_u32 v248, v243, 4, v248
    v_add_u32 v248, s30, v248
    v_lshlrev_b32 v250, 4, v242
    s_add_u32 s26, s38, 65536
    v_add_u32 v249, s26, v234
    s_lshl_b32 s26, s16, 10
    s_add_u32 s26, s26, 65536
    v_add_u32 v232, s26, v234
    s_lshl_b32 s26, s19, 11
    buffer_load_ushort v192, v246, s[40:43], s26 offen offset:0
    buffer_load_ushort v193, v246, s[40:43], s26 offen offset:32
    buffer_load_ushort v194, v246, s[40:43], s26 offen offset:64
    buffer_load_ushort v195, v246, s[40:43], s26 offen offset:96
    buffer_load_ushort v196, v246, s[40:43], s26 offen offset:8
    buffer_load_ushort v197, v246, s[40:43], s26 offen offset:40
    buffer_load_ushort v198, v246, s[40:43], s26 offen offset:72
    buffer_load_ushort v199, v246, s[40:43], s26 offen offset:104
    buffer_load_ushort v200, v246, s[40:43], s26 offen offset:16
    buffer_load_ushort v201, v246, s[40:43], s26 offen offset:48
    buffer_load_ushort v202, v246, s[40:43], s26 offen offset:80
    buffer_load_ushort v203, v246, s[40:43], s26 offen offset:112
    buffer_load_ushort v204, v246, s[40:43], s26 offen offset:24
    buffer_load_ushort v205, v246, s[40:43], s26 offen offset:56
    buffer_load_ushort v206, v246, s[40:43], s26 offen offset:88
    buffer_load_ushort v207, v246, s[40:43], s26 offen offset:120
    s_add_u32 s92, s92, 128
    s_and_b32 s92, s92, 0x3ff
    s_mul_i32 s33, s92, s35
    s_add_u32 m0, s31, 16384
    s_add_u32 s33, s33, s93
    buffer_load_dwordx4 v220, s[8:11], s33 offen offset:0 lds
    buffer_load_dwordx4 v221, s[8:11], s33 offen offset:1024 lds
    buffer_load_dwordx4 v254, s[8:11], s33 offen offset:2048 lds
    buffer_load_dwordx4 v255, s[8:11], s33 offen offset:3072 lds
    s_waitcnt vmcnt(21)
    s_barrier
    ds_read_b128 a[0:3], v216 offset:0
    ds_read_b128 a[4:7], v216 offset:2048
    ds_read_b128 a[8:11], v216 offset:4096
    ds_read_b128 a[12:15], v216 offset:6144
    ds_read_b64_tr_b16 v[128:129], v208 offset:0
    ds_read_b64_tr_b16 v[130:131], v208 offset:1024
    ds_read_b64_tr_b16 v[132:133], v209 offset:0
    ds_read_b64_tr_b16 v[134:135], v209 offset:1024
    ds_read_b64_tr_b16 v[136:137], v210 offset:0
    ds_read_b64_tr_b16 v[138:139], v210 offset:1024
    ds_read_b64_tr_b16 v[140:141], v211 offset:0
    ds_read_b64_tr_b16 v[142:143], v211 offset:1024
    s_waitcnt lgkmcnt(4)
    v_mfma_f32_16x16x32_bf16 v[0:3], v[128:131], a[0:3], 0
    ds_read_b128 a[16:19], v217 offset:0
    ds_read_b128 a[20:23], v217 offset:2048
    ds_read_b64_tr_b16 v[144:145], v212 offset:0
    ds_read_b64_tr_b16 v[146:147], v212 offset:1024
    v_mfma_f32_16x16x32_bf16 v[4:7], v[128:131], a[4:7], 0
    s_add_u32 m0, s30, 8192
    ds_read_b128 a[24:27], v217 offset:4096
    ds_read_b128 a[28:31], v217 offset:6144
    v_mfma_f32_16x16x32_bf16 v[8:11], v[128:131], a[8:11], 0
    s_add_u32 s28, s24, s92
    v_mfma_f32_16x16x32_bf16 v[12:15], v[128:131], a[12:15], 0
    buffer_load_dwordx4 v218, s[4:7], s28 offen offset:0 lds
    v_mfma_f32_16x16x32_bf16 v[28:31], v[132:135], a[12:15], 0
    ds_read_b64_tr_b16 v[148:149], v213 offset:0
    ds_read_b64_tr_b16 v[150:151], v213 offset:1024
    v_mfma_f32_16x16x32_bf16 v[24:27], v[132:135], a[8:11], 0
    buffer_load_dwordx4 v219, s[4:7], s28 offen offset:1024 lds
    v_mfma_f32_16x16x32_bf16 v[20:23], v[132:135], a[4:7], 0
    buffer_load_dwordx4 v252, s[4:7], s28 offen offset:2048 lds
    v_mfma_f32_16x16x32_bf16 v[16:19], v[132:135], a[0:3], 0
    s_waitcnt lgkmcnt(8)
    v_mfma_f32_16x16x32_bf16 v[32:35], v[136:139], a[0:3], 0
    ds_read_b64_tr_b16 v[152:153], v214 offset:0
    ds_read_b64_tr_b16 v[154:155], v214 offset:1024
    v_mfma_f32_16x16x32_bf16 v[36:39], v[136:139], a[4:7], 0
    buffer_load_dwordx4 v253, s[4:7], s28 offen offset:3072 lds
    v_mfma_f32_16x16x32_bf16 v[40:43], v[136:139], a[8:11], 0
    s_add_u32 m0, s30, 12288
    s_add_u32 s28, s25, s92
    v_mfma_f32_16x16x32_bf16 v[44:47], v[136:139], a[12:15], 0
    buffer_load_dwordx4 v218, s[4:7], s28 offen offset:0 lds
    v_mfma_f32_16x16x32_bf16 v[60:63], v[140:143], a[12:15], 0
    ds_read_b64_tr_b16 v[156:157], v215 offset:0
    ds_read_b64_tr_b16 v[158:159], v215 offset:1024
    v_mfma_f32_16x16x32_bf16 v[56:59], v[140:143], a[8:11], 0
    buffer_load_dwordx4 v219, s[4:7], s28 offen offset:1024 lds
    v_mfma_f32_16x16x32_bf16 v[52:55], v[140:143], a[4:7], 0
    buffer_load_dwordx4 v252, s[4:7], s28 offen offset:2048 lds
    v_mfma_f32_16x16x32_bf16 v[48:51], v[140:143], a[0:3], 0
    s_waitcnt lgkmcnt(4)
    buffer_load_dwordx4 v253, s[4:7], s28 offen offset:3072 lds
    v_mfma_f32_16x16x32_bf16 v[64:67], a[0:3], v[144:147], 0
    s_add_u32 s92, s92, 128
    ds_read_b64_tr_b16 v[160:161], v208 offset:8192
    ds_read_b64_tr_b16 v[162:163], v208 offset:9216
    v_mfma_f32_16x16x32_bf16 v[68:71], a[4:7], v[144:147], 0
    s_and_b32 s92, s92, 0x3ff
    s_mul_i32 s33, s92, s35
    v_mfma_f32_16x16x32_bf16 v[72:75], a[8:11], v[144:147], 0
    s_add_u32 m0, s31, 32768
    v_mfma_f32_16x16x32_bf16 v[76:79], a[12:15], v[144:147], 0
    s_add_u32 s33, s33, s93
    v_mfma_f32_16x16x32_bf16 v[92:95], a[12:15], v[148:151], 0
    ds_read_b64_tr_b16 v[164:165], v209 offset:8192
    ds_read_b64_tr_b16 v[166:167], v209 offset:9216
    v_mfma_f32_16x16x32_bf16 v[88:91], a[8:11], v[148:151], 0
    buffer_load_dwordx4 v220, s[8:11], s33 offen offset:0 lds
    v_mfma_f32_16x16x32_bf16 v[84:87], a[4:7], v[148:151], 0
    buffer_load_dwordx4 v221, s[8:11], s33 offen offset:1024 lds
    v_mfma_f32_16x16x32_bf16 v[80:83], a[0:3], v[148:151], 0
    s_waitcnt lgkmcnt(4)
    v_mfma_f32_16x16x32_bf16 v[96:99], a[0:3], v[152:155], 0
    ds_read_b64_tr_b16 v[168:169], v210 offset:8192
    ds_read_b64_tr_b16 v[170:171], v210 offset:9216
    v_mfma_f32_16x16x32_bf16 v[100:103], a[4:7], v[152:155], 0
    buffer_load_dwordx4 v254, s[8:11], s33 offen offset:2048 lds
    buffer_load_dwordx4 v255, s[8:11], s33 offen offset:3072 lds
    v_mfma_f32_16x16x32_bf16 v[104:107], a[8:11], v[152:155], 0
    s_add_u32 m0, s30, 0
    s_add_u32 s28, s24, s92
    v_mfma_f32_16x16x32_bf16 v[108:111], a[12:15], v[152:155], 0
    buffer_load_dwordx4 v218, s[4:7], s28 offen offset:0 lds
    v_mfma_f32_16x16x32_bf16 v[124:127], a[12:15], v[156:159], 0
    ds_read_b64_tr_b16 v[172:173], v211 offset:8192
    ds_read_b64_tr_b16 v[174:175], v211 offset:9216
    v_mfma_f32_16x16x32_bf16 v[120:123], a[8:11], v[156:159], 0
    buffer_load_dwordx4 v219, s[4:7], s28 offen offset:1024 lds
    v_mfma_f32_16x16x32_bf16 v[116:119], a[4:7], v[156:159], 0
    v_mfma_f32_16x16x32_bf16 v[112:115], a[0:3], v[156:159], 0
    s_waitcnt lgkmcnt(4)
    v_mfma_f32_16x16x32_bf16 v[0:3], v[160:163], a[16:19], v[0:3]
    ds_read_b64_tr_b16 v[176:177], v212 offset:8192
    ds_read_b64_tr_b16 v[178:179], v212 offset:9216
    v_mfma_f32_16x16x32_bf16 v[4:7], v[160:163], a[20:23], v[4:7]
    buffer_load_dwordx4 v252, s[4:7], s28 offen offset:2048 lds
    v_mfma_f32_16x16x32_bf16 v[8:11], v[160:163], a[24:27], v[8:11]
    buffer_load_dwordx4 v253, s[4:7], s28 offen offset:3072 lds
    v_mfma_f32_16x16x32_bf16 v[12:15], v[160:163], a[28:31], v[12:15]
    s_add_u32 m0, s30, 4096
    s_add_u32 s28, s25, s92
    v_mfma_f32_16x16x32_bf16 v[28:31], v[164:167], a[28:31], v[28:31]
    ds_read_b64_tr_b16 v[180:181], v213 offset:8192
    ds_read_b64_tr_b16 v[182:183], v213 offset:9216
    v_mfma_f32_16x16x32_bf16 v[24:27], v[164:167], a[24:27], v[24:27]
    buffer_load_dwordx4 v218, s[4:7], s28 offen offset:0 lds
    v_mfma_f32_16x16x32_bf16 v[20:23], v[164:167], a[20:23], v[20:23]
    buffer_load_dwordx4 v219, s[4:7], s28 offen offset:1024 lds
    v_mfma_f32_16x16x32_bf16 v[16:19], v[164:167], a[16:19], v[16:19]
    s_waitcnt lgkmcnt(4)
    v_mfma_f32_16x16x32_bf16 v[32:35], v[168:171], a[16:19], v[32:35]
    ds_read_b64_tr_b16 v[184:185], v214 offset:8192
    ds_read_b64_tr_b16 v[186:187], v214 offset:9216
    v_mfma_f32_16x16x32_bf16 v[36:39], v[168:171], a[20:23], v[36:39]
    buffer_load_dwordx4 v252, s[4:7], s28 offen offset:2048 lds
    v_mfma_f32_16x16x32_bf16 v[40:43], v[168:171], a[24:27], v[40:43]
    buffer_load_dwordx4 v253, s[4:7], s28 offen offset:3072 lds
    v_mfma_f32_16x16x32_bf16 v[44:47], v[168:171], a[28:31], v[44:47]
    v_mfma_f32_16x16x32_bf16 v[60:63], v[172:175], a[28:31], v[60:63]
    s_waitcnt vmcnt(12)
    ds_read_b64_tr_b16 v[188:189], v215 offset:8192
    ds_read_b64_tr_b16 v[190:191], v215 offset:9216
    s_barrier
    v_mfma_f32_16x16x32_bf16 v[56:59], v[172:175], a[24:27], v[56:59]
    ds_read_b128 a[32:35], v216 offset:8192
    ds_read_b128 a[36:39], v216 offset:10240
    v_mfma_f32_16x16x32_bf16 v[52:55], v[172:175], a[20:23], v[52:55]
    ds_read_b128 a[40:43], v216 offset:12288
    ds_read_b128 a[44:47], v216 offset:14336
    v_mfma_f32_16x16x32_bf16 v[48:51], v[172:175], a[16:19], v[48:51]
    s_waitcnt lgkmcnt(8)
    s_add_u32 s92, s92, 128
    v_mfma_f32_16x16x32_bf16 v[64:67], a[16:19], v[176:179], v[64:67]
    ds_read_b64_tr_b16 v[128:129], v208 offset:16384
    ds_read_b64_tr_b16 v[130:131], v208 offset:17408
    v_mfma_f32_16x16x32_bf16 v[68:71], a[20:23], v[176:179], v[68:71]
    s_and_b32 s92, s92, 0x3ff
    v_mfma_f32_16x16x32_bf16 v[72:75], a[24:27], v[176:179], v[72:75]
    ds_read_b128 a[48:51], v217 offset:8192
    ds_read_b128 a[52:55], v217 offset:10240
    v_mfma_f32_16x16x32_bf16 v[76:79], a[28:31], v[176:179], v[76:79]
    s_mul_i32 s33, s92, s35
    v_mfma_f32_16x16x32_bf16 v[92:95], a[28:31], v[180:183], v[92:95]
    ds_read_b64_tr_b16 v[132:133], v209 offset:16384
    ds_read_b64_tr_b16 v[134:135], v209 offset:17408
    v_mfma_f32_16x16x32_bf16 v[88:91], a[24:27], v[180:183], v[88:91]
    s_add_u32 m0, s31, 49152
    v_mfma_f32_16x16x32_bf16 v[84:87], a[20:23], v[180:183], v[84:87]
    ds_read_b128 a[56:59], v217 offset:12288
    ds_read_b128 a[60:63], v217 offset:14336
    v_mfma_f32_16x16x32_bf16 v[80:83], a[16:19], v[180:183], v[80:83]
    s_waitcnt lgkmcnt(12)
    s_add_u32 s33, s33, s93
    v_mfma_f32_16x16x32_bf16 v[96:99], a[16:19], v[184:187], v[96:99]
    ds_read_b64_tr_b16 v[136:137], v210 offset:16384
    ds_read_b64_tr_b16 v[138:139], v210 offset:17408
    v_mfma_f32_16x16x32_bf16 v[100:103], a[20:23], v[184:187], v[100:103]
    buffer_load_dwordx4 v220, s[8:11], s33 offen offset:0 lds
    v_mfma_f32_16x16x32_bf16 v[104:107], a[24:27], v[184:187], v[104:107]
    v_mfma_f32_16x16x32_bf16 v[108:111], a[28:31], v[184:187], v[108:111]
    v_mfma_f32_16x16x32_bf16 v[124:127], a[28:31], v[188:191], v[124:127]
    ds_read_b64_tr_b16 v[140:141], v211 offset:16384
    ds_read_b64_tr_b16 v[142:143], v211 offset:17408
    v_mfma_f32_16x16x32_bf16 v[120:123], a[24:27], v[188:191], v[120:123]
    buffer_load_dwordx4 v221, s[8:11], s33 offen offset:1024 lds
    v_mfma_f32_16x16x32_bf16 v[116:119], a[20:23], v[188:191], v[116:119]
    v_mfma_f32_16x16x32_bf16 v[112:115], a[16:19], v[188:191], v[112:115]
    s_waitcnt lgkmcnt(6)
    v_mfma_f32_16x16x32_bf16 v[0:3], v[128:131], a[32:35], v[0:3]
    ds_read_b64_tr_b16 v[144:145], v212 offset:16384
    ds_read_b64_tr_b16 v[146:147], v212 offset:17408
    v_mfma_f32_16x16x32_bf16 v[4:7], v[128:131], a[36:39], v[4:7]
    buffer_load_dwordx4 v254, s[8:11], s33 offen offset:2048 lds
    v_mfma_f32_16x16x32_bf16 v[8:11], v[128:131], a[40:43], v[8:11]
    v_mfma_f32_16x16x32_bf16 v[12:15], v[128:131], a[44:47], v[12:15]
    v_mfma_f32_16x16x32_bf16 v[28:31], v[132:135], a[44:47], v[28:31]
    ds_read_b64_tr_b16 v[148:149], v213 offset:16384
    ds_read_b64_tr_b16 v[150:151], v213 offset:17408
    v_mfma_f32_16x16x32_bf16 v[24:27], v[132:135], a[40:43], v[24:27]
    buffer_load_dwordx4 v255, s[8:11], s33 offen offset:3072 lds
    v_mfma_f32_16x16x32_bf16 v[20:23], v[132:135], a[36:39], v[20:23]
    v_mfma_f32_16x16x32_bf16 v[16:19], v[132:135], a[32:35], v[16:19]
    s_waitcnt lgkmcnt(4)
    v_mfma_f32_16x16x32_bf16 v[32:35], v[136:139], a[32:35], v[32:35]
    ds_read_b64_tr_b16 v[152:153], v214 offset:16384
    ds_read_b64_tr_b16 v[154:155], v214 offset:17408
    v_mfma_f32_16x16x32_bf16 v[36:39], v[136:139], a[36:39], v[36:39]
    s_add_u32 m0, s30, 8192
    v_mfma_f32_16x16x32_bf16 v[40:43], v[136:139], a[40:43], v[40:43]
    s_add_u32 s28, s24, s92
    v_mfma_f32_16x16x32_bf16 v[44:47], v[136:139], a[44:47], v[44:47]
    v_mfma_f32_16x16x32_bf16 v[60:63], v[140:143], a[44:47], v[60:63]
    ds_read_b64_tr_b16 v[156:157], v215 offset:16384
    ds_read_b64_tr_b16 v[158:159], v215 offset:17408
    v_mfma_f32_16x16x32_bf16 v[56:59], v[140:143], a[40:43], v[56:59]
    buffer_load_dwordx4 v218, s[4:7], s28 offen offset:0 lds
    v_mfma_f32_16x16x32_bf16 v[52:55], v[140:143], a[36:39], v[52:55]
    v_mfma_f32_16x16x32_bf16 v[48:51], v[140:143], a[32:35], v[48:51]
    s_waitcnt lgkmcnt(4)
    v_mfma_f32_16x16x32_bf16 v[64:67], a[32:35], v[144:147], v[64:67]
    ds_read_b64_tr_b16 v[160:161], v208 offset:24576
    ds_read_b64_tr_b16 v[162:163], v208 offset:25600
    v_mfma_f32_16x16x32_bf16 v[68:71], a[36:39], v[144:147], v[68:71]
    buffer_load_dwordx4 v219, s[4:7], s28 offen offset:1024 lds
    v_mfma_f32_16x16x32_bf16 v[72:75], a[40:43], v[144:147], v[72:75]
    v_mfma_f32_16x16x32_bf16 v[76:79], a[44:47], v[144:147], v[76:79]
    buffer_load_dwordx4 v252, s[4:7], s28 offen offset:2048 lds
    v_mfma_f32_16x16x32_bf16 v[92:95], a[44:47], v[148:151], v[92:95]
    ds_read_b64_tr_b16 v[164:165], v209 offset:24576
    ds_read_b64_tr_b16 v[166:167], v209 offset:25600
    v_mfma_f32_16x16x32_bf16 v[88:91], a[40:43], v[148:151], v[88:91]
    v_mfma_f32_16x16x32_bf16 v[84:87], a[36:39], v[148:151], v[84:87]
    buffer_load_dwordx4 v253, s[4:7], s28 offen offset:3072 lds
    v_mfma_f32_16x16x32_bf16 v[80:83], a[32:35], v[148:151], v[80:83]
    s_waitcnt lgkmcnt(4)
    v_mfma_f32_16x16x32_bf16 v[96:99], a[32:35], v[152:155], v[96:99]
    ds_read_b64_tr_b16 v[168:169], v210 offset:24576
    ds_read_b64_tr_b16 v[170:171], v210 offset:25600
    v_mfma_f32_16x16x32_bf16 v[100:103], a[36:39], v[152:155], v[100:103]
    v_mfma_f32_16x16x32_bf16 v[104:107], a[40:43], v[152:155], v[104:107]
    s_add_u32 m0, s30, 12288
    v_mfma_f32_16x16x32_bf16 v[108:111], a[44:47], v[152:155], v[108:111]
    s_add_u32 s28, s25, s92
    v_mfma_f32_16x16x32_bf16 v[124:127], a[44:47], v[156:159], v[124:127]
    ds_read_b64_tr_b16 v[172:173], v211 offset:24576
    ds_read_b64_tr_b16 v[174:175], v211 offset:25600
    v_mfma_f32_16x16x32_bf16 v[120:123], a[40:43], v[156:159], v[120:123]
    buffer_load_dwordx4 v218, s[4:7], s28 offen offset:0 lds
    v_mfma_f32_16x16x32_bf16 v[116:119], a[36:39], v[156:159], v[116:119]
    v_mfma_f32_16x16x32_bf16 v[112:115], a[32:35], v[156:159], v[112:115]
    s_waitcnt lgkmcnt(4)
    v_mfma_f32_16x16x32_bf16 v[0:3], v[160:163], a[48:51], v[0:3]
    ds_read_b64_tr_b16 v[176:177], v212 offset:24576
    ds_read_b64_tr_b16 v[178:179], v212 offset:25600
    v_mfma_f32_16x16x32_bf16 v[4:7], v[160:163], a[52:55], v[4:7]
    buffer_load_dwordx4 v219, s[4:7], s28 offen offset:1024 lds
    v_mfma_f32_16x16x32_bf16 v[8:11], v[160:163], a[56:59], v[8:11]
    v_mfma_f32_16x16x32_bf16 v[12:15], v[160:163], a[60:63], v[12:15]
    v_mfma_f32_16x16x32_bf16 v[28:31], v[164:167], a[60:63], v[28:31]
    ds_read_b64_tr_b16 v[180:181], v213 offset:24576
    ds_read_b64_tr_b16 v[182:183], v213 offset:25600
    v_mfma_f32_16x16x32_bf16 v[24:27], v[164:167], a[56:59], v[24:27]
    buffer_load_dwordx4 v252, s[4:7], s28 offen offset:2048 lds
    v_mfma_f32_16x16x32_bf16 v[20:23], v[164:167], a[52:55], v[20:23]
    v_mfma_f32_16x16x32_bf16 v[16:19], v[164:167], a[48:51], v[16:19]
    s_waitcnt lgkmcnt(4)
    v_mfma_f32_16x16x32_bf16 v[32:35], v[168:171], a[48:51], v[32:35]
    ds_read_b64_tr_b16 v[184:185], v214 offset:24576
    ds_read_b64_tr_b16 v[186:187], v214 offset:25600
    v_mfma_f32_16x16x32_bf16 v[36:39], v[168:171], a[52:55], v[36:39]
    buffer_load_dwordx4 v253, s[4:7], s28 offen offset:3072 lds
    v_mfma_f32_16x16x32_bf16 v[40:43], v[168:171], a[56:59], v[40:43]
    v_mfma_f32_16x16x32_bf16 v[44:47], v[168:171], a[60:63], v[44:47]
    v_mfma_f32_16x16x32_bf16 v[60:63], v[172:175], a[60:63], v[60:63]
    s_waitcnt vmcnt(12)
    ds_read_b64_tr_b16 v[188:189], v215 offset:24576
    ds_read_b64_tr_b16 v[190:191], v215 offset:25600
    s_barrier
    v_mfma_f32_16x16x32_bf16 v[56:59], v[172:175], a[56:59], v[56:59]
    ds_read_b128 a[64:67], v216 offset:0
    ds_read_b128 a[68:71], v216 offset:2048
    v_mfma_f32_16x16x32_bf16 v[52:55], v[172:175], a[52:55], v[52:55]
    ds_read_b128 a[72:75], v216 offset:4096
    ds_read_b128 a[76:79], v216 offset:6144
    v_mfma_f32_16x16x32_bf16 v[48:51], v[172:175], a[48:51], v[48:51]
    s_waitcnt lgkmcnt(8)
    s_add_u32 s92, s92, 128
    v_mfma_f32_16x16x32_bf16 v[64:67], a[48:51], v[176:179], v[64:67]
    ds_read_b64_tr_b16 v[128:129], v208 offset:32768
    ds_read_b64_tr_b16 v[130:131], v208 offset:33792
    v_mfma_f32_16x16x32_bf16 v[68:71], a[52:55], v[176:179], v[68:71]
    s_and_b32 s92, s92, 0x3ff
    v_mfma_f32_16x16x32_bf16 v[72:75], a[56:59], v[176:179], v[72:75]
    ds_read_b128 a[80:83], v217 offset:0
    ds_read_b128 a[84:87], v217 offset:2048
    v_mfma_f32_16x16x32_bf16 v[76:79], a[60:63], v[176:179], v[76:79]
    s_mul_i32 s33, s92, s35
    v_mfma_f32_16x16x32_bf16 v[92:95], a[60:63], v[180:183], v[92:95]
    ds_read_b64_tr_b16 v[132:133], v209 offset:32768
    ds_read_b64_tr_b16 v[134:135], v209 offset:33792
    v_mfma_f32_16x16x32_bf16 v[88:91], a[56:59], v[180:183], v[88:91]
    s_add_u32 m0, s31, 0
    v_mfma_f32_16x16x32_bf16 v[84:87], a[52:55], v[180:183], v[84:87]
    ds_read_b128 a[88:91], v217 offset:4096
    ds_read_b128 a[92:95], v217 offset:6144
    v_mfma_f32_16x16x32_bf16 v[80:83], a[48:51], v[180:183], v[80:83]
    s_waitcnt lgkmcnt(12)
    s_add_u32 s33, s33, s93
    v_mfma_f32_16x16x32_bf16 v[96:99], a[48:51], v[184:187], v[96:99]
    ds_read_b64_tr_b16 v[136:137], v210 offset:32768
    ds_read_b64_tr_b16 v[138:139], v210 offset:33792
    v_mfma_f32_16x16x32_bf16 v[100:103], a[52:55], v[184:187], v[100:103]
    buffer_load_dwordx4 v220, s[8:11], s33 offen offset:0 lds
    v_mfma_f32_16x16x32_bf16 v[104:107], a[56:59], v[184:187], v[104:107]
    v_mfma_f32_16x16x32_bf16 v[108:111], a[60:63], v[184:187], v[108:111]
    v_mfma_f32_16x16x32_bf16 v[124:127], a[60:63], v[188:191], v[124:127]
    ds_read_b64_tr_b16 v[140:141], v211 offset:32768
    ds_read_b64_tr_b16 v[142:143], v211 offset:33792
    v_mfma_f32_16x16x32_bf16 v[120:123], a[56:59], v[188:191], v[120:123]
    buffer_load_dwordx4 v221, s[8:11], s33 offen offset:1024 lds
    v_mfma_f32_16x16x32_bf16 v[116:119], a[52:55], v[188:191], v[116:119]
    v_mfma_f32_16x16x32_bf16 v[112:115], a[48:51], v[188:191], v[112:115]
    s_waitcnt lgkmcnt(6)
    v_mfma_f32_16x16x32_bf16 v[0:3], v[128:131], a[64:67], v[0:3]
    ds_read_b64_tr_b16 v[144:145], v212 offset:32768
    ds_read_b64_tr_b16 v[146:147], v212 offset:33792
    v_mfma_f32_16x16x32_bf16 v[4:7], v[128:131], a[68:71], v[4:7]
    buffer_load_dwordx4 v254, s[8:11], s33 offen offset:2048 lds
    v_mfma_f32_16x16x32_bf16 v[8:11], v[128:131], a[72:75], v[8:11]
    v_mfma_f32_16x16x32_bf16 v[12:15], v[128:131], a[76:79], v[12:15]
    v_mfma_f32_16x16x32_bf16 v[28:31], v[132:135], a[76:79], v[28:31]
    ds_read_b64_tr_b16 v[148:149], v213 offset:32768
    ds_read_b64_tr_b16 v[150:151], v213 offset:33792
    v_mfma_f32_16x16x32_bf16 v[24:27], v[132:135], a[72:75], v[24:27]
    buffer_load_dwordx4 v255, s[8:11], s33 offen offset:3072 lds
    v_mfma_f32_16x16x32_bf16 v[20:23], v[132:135], a[68:71], v[20:23]
    v_mfma_f32_16x16x32_bf16 v[16:19], v[132:135], a[64:67], v[16:19]
    s_waitcnt lgkmcnt(4)
    v_mfma_f32_16x16x32_bf16 v[32:35], v[136:139], a[64:67], v[32:35]
    ds_read_b64_tr_b16 v[152:153], v214 offset:32768
    ds_read_b64_tr_b16 v[154:155], v214 offset:33792
    v_mfma_f32_16x16x32_bf16 v[36:39], v[136:139], a[68:71], v[36:39]
    s_add_u32 m0, s30, 0
    v_mfma_f32_16x16x32_bf16 v[40:43], v[136:139], a[72:75], v[40:43]
    s_add_u32 s28, s24, s92
    v_mfma_f32_16x16x32_bf16 v[44:47], v[136:139], a[76:79], v[44:47]
    v_mfma_f32_16x16x32_bf16 v[60:63], v[140:143], a[76:79], v[60:63]
    ds_read_b64_tr_b16 v[156:157], v215 offset:32768
    ds_read_b64_tr_b16 v[158:159], v215 offset:33792
    v_mfma_f32_16x16x32_bf16 v[56:59], v[140:143], a[72:75], v[56:59]
    buffer_load_dwordx4 v218, s[4:7], s28 offen offset:0 lds
    v_mfma_f32_16x16x32_bf16 v[52:55], v[140:143], a[68:71], v[52:55]
    v_mfma_f32_16x16x32_bf16 v[48:51], v[140:143], a[64:67], v[48:51]
    s_waitcnt lgkmcnt(4)
    v_mfma_f32_16x16x32_bf16 v[64:67], a[64:67], v[144:147], v[64:67]
    ds_read_b64_tr_b16 v[160:161], v208 offset:40960
    ds_read_b64_tr_b16 v[162:163], v208 offset:41984
    v_mfma_f32_16x16x32_bf16 v[68:71], a[68:71], v[144:147], v[68:71]
    buffer_load_dwordx4 v219, s[4:7], s28 offen offset:1024 lds
    v_mfma_f32_16x16x32_bf16 v[72:75], a[72:75], v[144:147], v[72:75]
    v_mfma_f32_16x16x32_bf16 v[76:79], a[76:79], v[144:147], v[76:79]
    buffer_load_dwordx4 v252, s[4:7], s28 offen offset:2048 lds
    v_mfma_f32_16x16x32_bf16 v[92:95], a[76:79], v[148:151], v[92:95]
    ds_read_b64_tr_b16 v[164:165], v209 offset:40960
    ds_read_b64_tr_b16 v[166:167], v209 offset:41984
    v_mfma_f32_16x16x32_bf16 v[88:91], a[72:75], v[148:151], v[88:91]
    v_mfma_f32_16x16x32_bf16 v[84:87], a[68:71], v[148:151], v[84:87]
    buffer_load_dwordx4 v253, s[4:7], s28 offen offset:3072 lds
    v_mfma_f32_16x16x32_bf16 v[80:83], a[64:67], v[148:151], v[80:83]
    s_waitcnt lgkmcnt(4)
    v_mfma_f32_16x16x32_bf16 v[96:99], a[64:67], v[152:155], v[96:99]
    ds_read_b64_tr_b16 v[168:169], v210 offset:40960
    ds_read_b64_tr_b16 v[170:171], v210 offset:41984
    v_mfma_f32_16x16x32_bf16 v[100:103], a[68:71], v[152:155], v[100:103]
    v_mfma_f32_16x16x32_bf16 v[104:107], a[72:75], v[152:155], v[104:107]
    s_add_u32 m0, s30, 4096
    v_mfma_f32_16x16x32_bf16 v[108:111], a[76:79], v[152:155], v[108:111]
    s_add_u32 s28, s25, s92
    v_mfma_f32_16x16x32_bf16 v[124:127], a[76:79], v[156:159], v[124:127]
    ds_read_b64_tr_b16 v[172:173], v211 offset:40960
    ds_read_b64_tr_b16 v[174:175], v211 offset:41984
    v_mfma_f32_16x16x32_bf16 v[120:123], a[72:75], v[156:159], v[120:123]
    buffer_load_dwordx4 v218, s[4:7], s28 offen offset:0 lds
    v_mfma_f32_16x16x32_bf16 v[116:119], a[68:71], v[156:159], v[116:119]
    v_mfma_f32_16x16x32_bf16 v[112:115], a[64:67], v[156:159], v[112:115]
    s_waitcnt lgkmcnt(4)
    v_mfma_f32_16x16x32_bf16 v[0:3], v[160:163], a[80:83], v[0:3]
    ds_read_b64_tr_b16 v[176:177], v212 offset:40960
    ds_read_b64_tr_b16 v[178:179], v212 offset:41984
    v_mfma_f32_16x16x32_bf16 v[4:7], v[160:163], a[84:87], v[4:7]
    buffer_load_dwordx4 v219, s[4:7], s28 offen offset:1024 lds
    v_mfma_f32_16x16x32_bf16 v[8:11], v[160:163], a[88:91], v[8:11]
    v_mfma_f32_16x16x32_bf16 v[12:15], v[160:163], a[92:95], v[12:15]
    v_mfma_f32_16x16x32_bf16 v[28:31], v[164:167], a[92:95], v[28:31]
    ds_read_b64_tr_b16 v[180:181], v213 offset:40960
    ds_read_b64_tr_b16 v[182:183], v213 offset:41984
    v_mfma_f32_16x16x32_bf16 v[24:27], v[164:167], a[88:91], v[24:27]
    buffer_load_dwordx4 v252, s[4:7], s28 offen offset:2048 lds
    v_mfma_f32_16x16x32_bf16 v[20:23], v[164:167], a[84:87], v[20:23]
    v_mfma_f32_16x16x32_bf16 v[16:19], v[164:167], a[80:83], v[16:19]
    s_waitcnt lgkmcnt(4)
    v_mfma_f32_16x16x32_bf16 v[32:35], v[168:171], a[80:83], v[32:35]
    ds_read_b64_tr_b16 v[184:185], v214 offset:40960
    ds_read_b64_tr_b16 v[186:187], v214 offset:41984
    v_mfma_f32_16x16x32_bf16 v[36:39], v[168:171], a[84:87], v[36:39]
    buffer_load_dwordx4 v253, s[4:7], s28 offen offset:3072 lds
    v_mfma_f32_16x16x32_bf16 v[40:43], v[168:171], a[88:91], v[40:43]
    v_mfma_f32_16x16x32_bf16 v[44:47], v[168:171], a[92:95], v[44:47]
    v_mfma_f32_16x16x32_bf16 v[60:63], v[172:175], a[92:95], v[60:63]
    s_waitcnt vmcnt(12)
    ds_read_b64_tr_b16 v[188:189], v215 offset:40960
    ds_read_b64_tr_b16 v[190:191], v215 offset:41984
    s_barrier
    v_mfma_f32_16x16x32_bf16 v[56:59], v[172:175], a[88:91], v[56:59]
    ds_read_b128 a[96:99], v216 offset:8192
    ds_read_b128 a[100:103], v216 offset:10240
    v_mfma_f32_16x16x32_bf16 v[52:55], v[172:175], a[84:87], v[52:55]
    ds_read_b128 a[104:107], v216 offset:12288
    ds_read_b128 a[108:111], v216 offset:14336
    v_mfma_f32_16x16x32_bf16 v[48:51], v[172:175], a[80:83], v[48:51]
    s_waitcnt lgkmcnt(8)
    s_add_u32 s92, s92, 128
    v_mfma_f32_16x16x32_bf16 v[64:67], a[80:83], v[176:179], v[64:67]
    ds_read_b64_tr_b16 v[128:129], v208 offset:49152
    ds_read_b64_tr_b16 v[130:131], v208 offset:50176
    v_mfma_f32_16x16x32_bf16 v[68:71], a[84:87], v[176:179], v[68:71]
    s_and_b32 s92, s92, 0x3ff
    v_mfma_f32_16x16x32_bf16 v[72:75], a[88:91], v[176:179], v[72:75]
    ds_read_b128 a[112:115], v217 offset:8192
    ds_read_b128 a[116:119], v217 offset:10240
    v_mfma_f32_16x16x32_bf16 v[76:79], a[92:95], v[176:179], v[76:79]
    s_mul_i32 s33, s92, s35
    v_mfma_f32_16x16x32_bf16 v[92:95], a[92:95], v[180:183], v[92:95]
    ds_read_b64_tr_b16 v[132:133], v209 offset:49152
    ds_read_b64_tr_b16 v[134:135], v209 offset:50176
    v_mfma_f32_16x16x32_bf16 v[88:91], a[88:91], v[180:183], v[88:91]
    s_add_u32 m0, s31, 16384
    v_mfma_f32_16x16x32_bf16 v[84:87], a[84:87], v[180:183], v[84:87]
    ds_read_b128 a[120:123], v217 offset:12288
    ds_read_b128 a[124:127], v217 offset:14336
    v_mfma_f32_16x16x32_bf16 v[80:83], a[80:83], v[180:183], v[80:83]
    s_waitcnt lgkmcnt(12)
    s_add_u32 s33, s33, s93
    v_mfma_f32_16x16x32_bf16 v[96:99], a[80:83], v[184:187], v[96:99]
    ds_read_b64_tr_b16 v[136:137], v210 offset:49152
    ds_read_b64_tr_b16 v[138:139], v210 offset:50176
    v_mfma_f32_16x16x32_bf16 v[100:103], a[84:87], v[184:187], v[100:103]
    buffer_load_dwordx4 v220, s[8:11], s33 offen offset:0 lds
    v_mfma_f32_16x16x32_bf16 v[104:107], a[88:91], v[184:187], v[104:107]
    v_mfma_f32_16x16x32_bf16 v[108:111], a[92:95], v[184:187], v[108:111]
    v_mfma_f32_16x16x32_bf16 v[124:127], a[92:95], v[188:191], v[124:127]
    ds_read_b64_tr_b16 v[140:141], v211 offset:49152
    ds_read_b64_tr_b16 v[142:143], v211 offset:50176
    v_mfma_f32_16x16x32_bf16 v[120:123], a[88:91], v[188:191], v[120:123]
    buffer_load_dwordx4 v221, s[8:11], s33 offen offset:1024 lds
    v_mfma_f32_16x16x32_bf16 v[116:119], a[84:87], v[188:191], v[116:119]
    v_mfma_f32_16x16x32_bf16 v[112:115], a[80:83], v[188:191], v[112:115]
    s_waitcnt lgkmcnt(6)
    v_mfma_f32_16x16x32_bf16 v[0:3], v[128:131], a[96:99], v[0:3]
    ds_read_b64_tr_b16 v[144:145], v212 offset:49152
    ds_read_b64_tr_b16 v[146:147], v212 offset:50176
    v_mfma_f32_16x16x32_bf16 v[4:7], v[128:131], a[100:103], v[4:7]
    buffer_load_dwordx4 v254, s[8:11], s33 offen offset:2048 lds
    v_mfma_f32_16x16x32_bf16 v[8:11], v[128:131], a[104:107], v[8:11]
    v_mfma_f32_16x16x32_bf16 v[12:15], v[128:131], a[108:111], v[12:15]
    v_mfma_f32_16x16x32_bf16 v[28:31], v[132:135], a[108:111], v[28:31]
    ds_read_b64_tr_b16 v[148:149], v213 offset:49152
    ds_read_b64_tr_b16 v[150:151], v213 offset:50176
    v_mfma_f32_16x16x32_bf16 v[24:27], v[132:135], a[104:107], v[24:27]
    buffer_load_dwordx4 v255, s[8:11], s33 offen offset:3072 lds
    v_mfma_f32_16x16x32_bf16 v[20:23], v[132:135], a[100:103], v[20:23]
    v_mfma_f32_16x16x32_bf16 v[16:19], v[132:135], a[96:99], v[16:19]
    s_waitcnt lgkmcnt(4)
    v_mfma_f32_16x16x32_bf16 v[32:35], v[136:139], a[96:99], v[32:35]
    ds_read_b64_tr_b16 v[152:153], v214 offset:49152
    ds_read_b64_tr_b16 v[154:155], v214 offset:50176
    v_mfma_f32_16x16x32_bf16 v[36:39], v[136:139], a[100:103], v[36:39]
    s_add_u32 m0, s30, 8192
    v_mfma_f32_16x16x32_bf16 v[40:43], v[136:139], a[104:107], v[40:43]
    s_add_u32 s28, s24, s92
    v_mfma_f32_16x16x32_bf16 v[44:47], v[136:139], a[108:111], v[44:47]
    v_mfma_f32_16x16x32_bf16 v[60:63], v[140:143], a[108:111], v[60:63]
    ds_read_b64_tr_b16 v[156:157], v215 offset:49152
    ds_read_b64_tr_b16 v[158:159], v215 offset:50176
    v_mfma_f32_16x16x32_bf16 v[56:59], v[140:143], a[104:107], v[56:59]
    buffer_load_dwordx4 v218, s[4:7], s28 offen offset:0 lds
    v_mfma_f32_16x16x32_bf16 v[52:55], v[140:143], a[100:103], v[52:55]
    v_mfma_f32_16x16x32_bf16 v[48:51], v[140:143], a[96:99], v[48:51]
    s_waitcnt lgkmcnt(4)
    v_mfma_f32_16x16x32_bf16 v[64:67], a[96:99], v[144:147], v[64:67]
    ds_read_b64_tr_b16 v[160:161], v208 offset:57344
    ds_read_b64_tr_b16 v[162:163], v208 offset:58368
    v_mfma_f32_16x16x32_bf16 v[68:71], a[100:103], v[144:147], v[68:71]
    buffer_load_dwordx4 v219, s[4:7], s28 offen offset:1024 lds
    v_mfma_f32_16x16x32_bf16 v[72:75], a[104:107], v[144:147], v[72:75]
    v_mfma_f32_16x16x32_bf16 v[76:79], a[108:111], v[144:147], v[76:79]
    buffer_load_dwordx4 v252, s[4:7], s28 offen offset:2048 lds
    v_mfma_f32_16x16x32_bf16 v[92:95], a[108:111], v[148:151], v[92:95]
    ds_read_b64_tr_b16 v[164:165], v209 offset:57344
    ds_read_b64_tr_b16 v[166:167], v209 offset:58368
    v_mfma_f32_16x16x32_bf16 v[88:91], a[104:107], v[148:151], v[88:91]
    v_mfma_f32_16x16x32_bf16 v[84:87], a[100:103], v[148:151], v[84:87]
    buffer_load_dwordx4 v253, s[4:7], s28 offen offset:3072 lds
    v_mfma_f32_16x16x32_bf16 v[80:83], a[96:99], v[148:151], v[80:83]
    s_waitcnt lgkmcnt(4)
    v_mfma_f32_16x16x32_bf16 v[96:99], a[96:99], v[152:155], v[96:99]
    ds_read_b64_tr_b16 v[168:169], v210 offset:57344
    ds_read_b64_tr_b16 v[170:171], v210 offset:58368
    v_mfma_f32_16x16x32_bf16 v[100:103], a[100:103], v[152:155], v[100:103]
    v_mfma_f32_16x16x32_bf16 v[104:107], a[104:107], v[152:155], v[104:107]
    s_add_u32 m0, s30, 12288
    v_mfma_f32_16x16x32_bf16 v[108:111], a[108:111], v[152:155], v[108:111]
    s_add_u32 s28, s25, s92
    v_mfma_f32_16x16x32_bf16 v[124:127], a[108:111], v[156:159], v[124:127]
    ds_read_b64_tr_b16 v[172:173], v211 offset:57344
    ds_read_b64_tr_b16 v[174:175], v211 offset:58368
    v_mfma_f32_16x16x32_bf16 v[120:123], a[104:107], v[156:159], v[120:123]
    buffer_load_dwordx4 v218, s[4:7], s28 offen offset:0 lds
    v_mfma_f32_16x16x32_bf16 v[116:119], a[100:103], v[156:159], v[116:119]
    v_mfma_f32_16x16x32_bf16 v[112:115], a[96:99], v[156:159], v[112:115]
    s_waitcnt lgkmcnt(4)
    v_mfma_f32_16x16x32_bf16 v[0:3], v[160:163], a[112:115], v[0:3]
    ds_read_b64_tr_b16 v[176:177], v212 offset:57344
    ds_read_b64_tr_b16 v[178:179], v212 offset:58368
    v_mfma_f32_16x16x32_bf16 v[4:7], v[160:163], a[116:119], v[4:7]
    buffer_load_dwordx4 v219, s[4:7], s28 offen offset:1024 lds
    v_mfma_f32_16x16x32_bf16 v[8:11], v[160:163], a[120:123], v[8:11]
    v_mfma_f32_16x16x32_bf16 v[12:15], v[160:163], a[124:127], v[12:15]
    v_mfma_f32_16x16x32_bf16 v[28:31], v[164:167], a[124:127], v[28:31]
    ds_read_b64_tr_b16 v[180:181], v213 offset:57344
    ds_read_b64_tr_b16 v[182:183], v213 offset:58368
    v_mfma_f32_16x16x32_bf16 v[24:27], v[164:167], a[120:123], v[24:27]
    buffer_load_dwordx4 v252, s[4:7], s28 offen offset:2048 lds
    v_mfma_f32_16x16x32_bf16 v[20:23], v[164:167], a[116:119], v[20:23]
    v_mfma_f32_16x16x32_bf16 v[16:19], v[164:167], a[112:115], v[16:19]
    s_waitcnt lgkmcnt(4)
    v_mfma_f32_16x16x32_bf16 v[32:35], v[168:171], a[112:115], v[32:35]
    ds_read_b64_tr_b16 v[184:185], v214 offset:57344
    ds_read_b64_tr_b16 v[186:187], v214 offset:58368
    v_mfma_f32_16x16x32_bf16 v[36:39], v[168:171], a[116:119], v[36:39]
    buffer_load_dwordx4 v253, s[4:7], s28 offen offset:3072 lds
    v_mfma_f32_16x16x32_bf16 v[40:43], v[168:171], a[120:123], v[40:43]
    v_mfma_f32_16x16x32_bf16 v[44:47], v[168:171], a[124:127], v[44:47]
    v_mfma_f32_16x16x32_bf16 v[60:63], v[172:175], a[124:127], v[60:63]
    s_waitcnt vmcnt(12)
    ds_read_b64_tr_b16 v[188:189], v215 offset:57344
    ds_read_b64_tr_b16 v[190:191], v215 offset:58368
    s_barrier
    v_mfma_f32_16x16x32_bf16 v[56:59], v[172:175], a[120:123], v[56:59]
    ds_read_b128 a[128:131], v216 offset:0
    ds_read_b128 a[132:135], v216 offset:2048
    v_mfma_f32_16x16x32_bf16 v[52:55], v[172:175], a[116:119], v[52:55]
    ds_read_b128 a[136:139], v216 offset:4096
    ds_read_b128 a[140:143], v216 offset:6144
    v_mfma_f32_16x16x32_bf16 v[48:51], v[172:175], a[112:115], v[48:51]
    s_waitcnt lgkmcnt(8)
    s_add_u32 s92, s92, 128
    v_mfma_f32_16x16x32_bf16 v[64:67], a[112:115], v[176:179], v[64:67]
    ds_read_b64_tr_b16 v[128:129], v208 offset:0
    ds_read_b64_tr_b16 v[130:131], v208 offset:1024
    v_mfma_f32_16x16x32_bf16 v[68:71], a[116:119], v[176:179], v[68:71]
    s_and_b32 s92, s92, 0x3ff
    v_mfma_f32_16x16x32_bf16 v[72:75], a[120:123], v[176:179], v[72:75]
    ds_read_b128 a[144:147], v217 offset:0
    ds_read_b128 a[148:151], v217 offset:2048
    v_mfma_f32_16x16x32_bf16 v[76:79], a[124:127], v[176:179], v[76:79]
    s_mul_i32 s33, s92, s35
    v_mfma_f32_16x16x32_bf16 v[92:95], a[124:127], v[180:183], v[92:95]
    ds_read_b64_tr_b16 v[132:133], v209 offset:0
    ds_read_b64_tr_b16 v[134:135], v209 offset:1024
    v_mfma_f32_16x16x32_bf16 v[88:91], a[120:123], v[180:183], v[88:91]
    s_add_u32 m0, s31, 32768
    v_mfma_f32_16x16x32_bf16 v[84:87], a[116:119], v[180:183], v[84:87]
    ds_read_b128 a[152:155], v217 offset:4096
    ds_read_b128 a[156:159], v217 offset:6144
    v_mfma_f32_16x16x32_bf16 v[80:83], a[112:115], v[180:183], v[80:83]
    s_waitcnt lgkmcnt(12)
    s_add_u32 s33, s33, s93
    v_mfma_f32_16x16x32_bf16 v[96:99], a[112:115], v[184:187], v[96:99]
    ds_read_b64_tr_b16 v[136:137], v210 offset:0
    ds_read_b64_tr_b16 v[138:139], v210 offset:1024
    v_mfma_f32_16x16x32_bf16 v[100:103], a[116:119], v[184:187], v[100:103]
    buffer_load_dwordx4 v220, s[8:11], s33 offen offset:0 lds
    v_mfma_f32_16x16x32_bf16 v[104:107], a[120:123], v[184:187], v[104:107]
    v_mfma_f32_16x16x32_bf16 v[108:111], a[124:127], v[184:187], v[108:111]
    v_mfma_f32_16x16x32_bf16 v[124:127], a[124:127], v[188:191], v[124:127]
    ds_read_b64_tr_b16 v[140:141], v211 offset:0
    ds_read_b64_tr_b16 v[142:143], v211 offset:1024
    v_mfma_f32_16x16x32_bf16 v[120:123], a[120:123], v[188:191], v[120:123]
    buffer_load_dwordx4 v221, s[8:11], s33 offen offset:1024 lds
    v_mfma_f32_16x16x32_bf16 v[116:119], a[116:119], v[188:191], v[116:119]
    v_mfma_f32_16x16x32_bf16 v[112:115], a[112:115], v[188:191], v[112:115]
    s_waitcnt lgkmcnt(6)
    v_mfma_f32_16x16x32_bf16 v[0:3], v[128:131], a[128:131], v[0:3]
    ds_read_b64_tr_b16 v[144:145], v212 offset:0
    ds_read_b64_tr_b16 v[146:147], v212 offset:1024
    v_mfma_f32_16x16x32_bf16 v[4:7], v[128:131], a[132:135], v[4:7]
    buffer_load_dwordx4 v254, s[8:11], s33 offen offset:2048 lds
    v_mfma_f32_16x16x32_bf16 v[8:11], v[128:131], a[136:139], v[8:11]
    v_mfma_f32_16x16x32_bf16 v[12:15], v[128:131], a[140:143], v[12:15]
    v_mfma_f32_16x16x32_bf16 v[28:31], v[132:135], a[140:143], v[28:31]
    ds_read_b64_tr_b16 v[148:149], v213 offset:0
    ds_read_b64_tr_b16 v[150:151], v213 offset:1024
    v_mfma_f32_16x16x32_bf16 v[24:27], v[132:135], a[136:139], v[24:27]
    buffer_load_dwordx4 v255, s[8:11], s33 offen offset:3072 lds
    v_mfma_f32_16x16x32_bf16 v[20:23], v[132:135], a[132:135], v[20:23]
    v_mfma_f32_16x16x32_bf16 v[16:19], v[132:135], a[128:131], v[16:19]
    s_waitcnt lgkmcnt(4)
    v_mfma_f32_16x16x32_bf16 v[32:35], v[136:139], a[128:131], v[32:35]
    ds_read_b64_tr_b16 v[152:153], v214 offset:0
    ds_read_b64_tr_b16 v[154:155], v214 offset:1024
    v_mfma_f32_16x16x32_bf16 v[36:39], v[136:139], a[132:135], v[36:39]
    s_add_u32 m0, s30, 0
    v_mfma_f32_16x16x32_bf16 v[40:43], v[136:139], a[136:139], v[40:43]
    s_add_u32 s28, s24, s92
    v_mfma_f32_16x16x32_bf16 v[44:47], v[136:139], a[140:143], v[44:47]
    v_mfma_f32_16x16x32_bf16 v[60:63], v[140:143], a[140:143], v[60:63]
    ds_read_b64_tr_b16 v[156:157], v215 offset:0
    ds_read_b64_tr_b16 v[158:159], v215 offset:1024
    v_mfma_f32_16x16x32_bf16 v[56:59], v[140:143], a[136:139], v[56:59]
    buffer_load_dwordx4 v218, s[4:7], s28 offen offset:0 lds
    v_mfma_f32_16x16x32_bf16 v[52:55], v[140:143], a[132:135], v[52:55]
    v_mfma_f32_16x16x32_bf16 v[48:51], v[140:143], a[128:131], v[48:51]
    s_waitcnt lgkmcnt(4)
    v_mfma_f32_16x16x32_bf16 v[64:67], a[128:131], v[144:147], v[64:67]
    ds_read_b64_tr_b16 v[160:161], v208 offset:8192
    ds_read_b64_tr_b16 v[162:163], v208 offset:9216
    v_mfma_f32_16x16x32_bf16 v[68:71], a[132:135], v[144:147], v[68:71]
    buffer_load_dwordx4 v219, s[4:7], s28 offen offset:1024 lds
    v_mfma_f32_16x16x32_bf16 v[72:75], a[136:139], v[144:147], v[72:75]
    v_mfma_f32_16x16x32_bf16 v[76:79], a[140:143], v[144:147], v[76:79]
    buffer_load_dwordx4 v252, s[4:7], s28 offen offset:2048 lds
    v_mfma_f32_16x16x32_bf16 v[92:95], a[140:143], v[148:151], v[92:95]
    ds_read_b64_tr_b16 v[164:165], v209 offset:8192
    ds_read_b64_tr_b16 v[166:167], v209 offset:9216
    v_mfma_f32_16x16x32_bf16 v[88:91], a[136:139], v[148:151], v[88:91]
    v_mfma_f32_16x16x32_bf16 v[84:87], a[132:135], v[148:151], v[84:87]
    buffer_load_dwordx4 v253, s[4:7], s28 offen offset:3072 lds
    v_mfma_f32_16x16x32_bf16 v[80:83], a[128:131], v[148:151], v[80:83]
    s_waitcnt lgkmcnt(4)
    v_mfma_f32_16x16x32_bf16 v[96:99], a[128:131], v[152:155], v[96:99]
    ds_read_b64_tr_b16 v[168:169], v210 offset:8192
    ds_read_b64_tr_b16 v[170:171], v210 offset:9216
    v_mfma_f32_16x16x32_bf16 v[100:103], a[132:135], v[152:155], v[100:103]
    v_mfma_f32_16x16x32_bf16 v[104:107], a[136:139], v[152:155], v[104:107]
    s_add_u32 m0, s30, 4096
    v_mfma_f32_16x16x32_bf16 v[108:111], a[140:143], v[152:155], v[108:111]
    s_add_u32 s28, s25, s92
    v_mfma_f32_16x16x32_bf16 v[124:127], a[140:143], v[156:159], v[124:127]
    ds_read_b64_tr_b16 v[172:173], v211 offset:8192
    ds_read_b64_tr_b16 v[174:175], v211 offset:9216
    v_mfma_f32_16x16x32_bf16 v[120:123], a[136:139], v[156:159], v[120:123]
    buffer_load_dwordx4 v218, s[4:7], s28 offen offset:0 lds
    v_mfma_f32_16x16x32_bf16 v[116:119], a[132:135], v[156:159], v[116:119]
    v_mfma_f32_16x16x32_bf16 v[112:115], a[128:131], v[156:159], v[112:115]
    s_waitcnt lgkmcnt(4)
    v_mfma_f32_16x16x32_bf16 v[0:3], v[160:163], a[144:147], v[0:3]
    ds_read_b64_tr_b16 v[176:177], v212 offset:8192
    ds_read_b64_tr_b16 v[178:179], v212 offset:9216
    v_mfma_f32_16x16x32_bf16 v[4:7], v[160:163], a[148:151], v[4:7]
    buffer_load_dwordx4 v219, s[4:7], s28 offen offset:1024 lds
    v_mfma_f32_16x16x32_bf16 v[8:11], v[160:163], a[152:155], v[8:11]
    v_mfma_f32_16x16x32_bf16 v[12:15], v[160:163], a[156:159], v[12:15]
    v_mfma_f32_16x16x32_bf16 v[28:31], v[164:167], a[156:159], v[28:31]
    ds_read_b64_tr_b16 v[180:181], v213 offset:8192
    ds_read_b64_tr_b16 v[182:183], v213 offset:9216
    v_mfma_f32_16x16x32_bf16 v[24:27], v[164:167], a[152:155], v[24:27]
    buffer_load_dwordx4 v252, s[4:7], s28 offen offset:2048 lds
    v_mfma_f32_16x16x32_bf16 v[20:23], v[164:167], a[148:151], v[20:23]
    v_mfma_f32_16x16x32_bf16 v[16:19], v[164:167], a[144:147], v[16:19]
    s_waitcnt lgkmcnt(4)
    v_mfma_f32_16x16x32_bf16 v[32:35], v[168:171], a[144:147], v[32:35]
    ds_read_b64_tr_b16 v[184:185], v214 offset:8192
    ds_read_b64_tr_b16 v[186:187], v214 offset:9216
    v_mfma_f32_16x16x32_bf16 v[36:39], v[168:171], a[148:151], v[36:39]
    buffer_load_dwordx4 v253, s[4:7], s28 offen offset:3072 lds
    v_mfma_f32_16x16x32_bf16 v[40:43], v[168:171], a[152:155], v[40:43]
    v_mfma_f32_16x16x32_bf16 v[44:47], v[168:171], a[156:159], v[44:47]
    v_mfma_f32_16x16x32_bf16 v[60:63], v[172:175], a[156:159], v[60:63]
    s_waitcnt vmcnt(12)
    ds_read_b64_tr_b16 v[188:189], v215 offset:8192
    ds_read_b64_tr_b16 v[190:191], v215 offset:9216
    s_barrier
    v_mfma_f32_16x16x32_bf16 v[56:59], v[172:175], a[152:155], v[56:59]
    ds_read_b128 a[160:163], v216 offset:8192
    ds_read_b128 a[164:167], v216 offset:10240
    v_mfma_f32_16x16x32_bf16 v[52:55], v[172:175], a[148:151], v[52:55]
    ds_read_b128 a[168:171], v216 offset:12288
    ds_read_b128 a[172:175], v216 offset:14336
    v_mfma_f32_16x16x32_bf16 v[48:51], v[172:175], a[144:147], v[48:51]
    s_waitcnt lgkmcnt(8)
    s_add_u32 s92, s92, 128
    v_mfma_f32_16x16x32_bf16 v[64:67], a[144:147], v[176:179], v[64:67]
    ds_read_b64_tr_b16 v[128:129], v208 offset:16384
    ds_read_b64_tr_b16 v[130:131], v208 offset:17408
    v_mfma_f32_16x16x32_bf16 v[68:71], a[148:151], v[176:179], v[68:71]
    s_and_b32 s92, s92, 0x3ff
    v_mfma_f32_16x16x32_bf16 v[72:75], a[152:155], v[176:179], v[72:75]
    ds_read_b128 a[176:179], v217 offset:8192
    ds_read_b128 a[180:183], v217 offset:10240
    v_mfma_f32_16x16x32_bf16 v[76:79], a[156:159], v[176:179], v[76:79]
    s_mul_i32 s33, s92, s35
    v_mfma_f32_16x16x32_bf16 v[92:95], a[156:159], v[180:183], v[92:95]
    ds_read_b64_tr_b16 v[132:133], v209 offset:16384
    ds_read_b64_tr_b16 v[134:135], v209 offset:17408
    v_mfma_f32_16x16x32_bf16 v[88:91], a[152:155], v[180:183], v[88:91]
    s_add_u32 m0, s31, 49152
    v_mfma_f32_16x16x32_bf16 v[84:87], a[148:151], v[180:183], v[84:87]
    ds_read_b128 a[184:187], v217 offset:12288
    ds_read_b128 a[188:191], v217 offset:14336
    v_mfma_f32_16x16x32_bf16 v[80:83], a[144:147], v[180:183], v[80:83]
    s_waitcnt lgkmcnt(12)
    s_add_u32 s33, s33, s93
    v_mfma_f32_16x16x32_bf16 v[96:99], a[144:147], v[184:187], v[96:99]
    ds_read_b64_tr_b16 v[136:137], v210 offset:16384
    ds_read_b64_tr_b16 v[138:139], v210 offset:17408
    v_mfma_f32_16x16x32_bf16 v[100:103], a[148:151], v[184:187], v[100:103]
    buffer_load_dwordx4 v220, s[8:11], s33 offen offset:0 lds
    v_mfma_f32_16x16x32_bf16 v[104:107], a[152:155], v[184:187], v[104:107]
    v_mfma_f32_16x16x32_bf16 v[108:111], a[156:159], v[184:187], v[108:111]
    v_mfma_f32_16x16x32_bf16 v[124:127], a[156:159], v[188:191], v[124:127]
    ds_read_b64_tr_b16 v[140:141], v211 offset:16384
    ds_read_b64_tr_b16 v[142:143], v211 offset:17408
    v_mfma_f32_16x16x32_bf16 v[120:123], a[152:155], v[188:191], v[120:123]
    buffer_load_dwordx4 v221, s[8:11], s33 offen offset:1024 lds
    v_mfma_f32_16x16x32_bf16 v[116:119], a[148:151], v[188:191], v[116:119]
    v_mfma_f32_16x16x32_bf16 v[112:115], a[144:147], v[188:191], v[112:115]
    s_waitcnt lgkmcnt(6)
    v_mfma_f32_16x16x32_bf16 v[0:3], v[128:131], a[160:163], v[0:3]
    ds_read_b64_tr_b16 v[144:145], v212 offset:16384
    ds_read_b64_tr_b16 v[146:147], v212 offset:17408
    v_mfma_f32_16x16x32_bf16 v[4:7], v[128:131], a[164:167], v[4:7]
    buffer_load_dwordx4 v254, s[8:11], s33 offen offset:2048 lds
    v_mfma_f32_16x16x32_bf16 v[8:11], v[128:131], a[168:171], v[8:11]
    v_mfma_f32_16x16x32_bf16 v[12:15], v[128:131], a[172:175], v[12:15]
    v_mfma_f32_16x16x32_bf16 v[28:31], v[132:135], a[172:175], v[28:31]
    ds_read_b64_tr_b16 v[148:149], v213 offset:16384
    ds_read_b64_tr_b16 v[150:151], v213 offset:17408
    v_mfma_f32_16x16x32_bf16 v[24:27], v[132:135], a[168:171], v[24:27]
    buffer_load_dwordx4 v255, s[8:11], s33 offen offset:3072 lds
    v_mfma_f32_16x16x32_bf16 v[20:23], v[132:135], a[164:167], v[20:23]
    v_mfma_f32_16x16x32_bf16 v[16:19], v[132:135], a[160:163], v[16:19]
    s_waitcnt lgkmcnt(4)
    v_mfma_f32_16x16x32_bf16 v[32:35], v[136:139], a[160:163], v[32:35]
    ds_read_b64_tr_b16 v[152:153], v214 offset:16384
    ds_read_b64_tr_b16 v[154:155], v214 offset:17408
    v_mfma_f32_16x16x32_bf16 v[36:39], v[136:139], a[164:167], v[36:39]
    s_add_u32 m0, s30, 8192
    v_mfma_f32_16x16x32_bf16 v[40:43], v[136:139], a[168:171], v[40:43]
    s_add_u32 s28, s24, s92
    v_mfma_f32_16x16x32_bf16 v[44:47], v[136:139], a[172:175], v[44:47]
    v_mfma_f32_16x16x32_bf16 v[60:63], v[140:143], a[172:175], v[60:63]
    ds_read_b64_tr_b16 v[156:157], v215 offset:16384
    ds_read_b64_tr_b16 v[158:159], v215 offset:17408
    v_mfma_f32_16x16x32_bf16 v[56:59], v[140:143], a[168:171], v[56:59]
    buffer_load_dwordx4 v218, s[4:7], s28 offen offset:0 lds
    v_mfma_f32_16x16x32_bf16 v[52:55], v[140:143], a[164:167], v[52:55]
    v_mfma_f32_16x16x32_bf16 v[48:51], v[140:143], a[160:163], v[48:51]
    s_waitcnt lgkmcnt(4)
    v_mfma_f32_16x16x32_bf16 v[64:67], a[160:163], v[144:147], v[64:67]
    ds_read_b64_tr_b16 v[160:161], v208 offset:24576
    ds_read_b64_tr_b16 v[162:163], v208 offset:25600
    v_mfma_f32_16x16x32_bf16 v[68:71], a[164:167], v[144:147], v[68:71]
    buffer_load_dwordx4 v219, s[4:7], s28 offen offset:1024 lds
    v_mfma_f32_16x16x32_bf16 v[72:75], a[168:171], v[144:147], v[72:75]
    v_mfma_f32_16x16x32_bf16 v[76:79], a[172:175], v[144:147], v[76:79]
    buffer_load_dwordx4 v252, s[4:7], s28 offen offset:2048 lds
    v_mfma_f32_16x16x32_bf16 v[92:95], a[172:175], v[148:151], v[92:95]
    ds_read_b64_tr_b16 v[164:165], v209 offset:24576
    ds_read_b64_tr_b16 v[166:167], v209 offset:25600
    v_mfma_f32_16x16x32_bf16 v[88:91], a[168:171], v[148:151], v[88:91]
    v_mfma_f32_16x16x32_bf16 v[84:87], a[164:167], v[148:151], v[84:87]
    buffer_load_dwordx4 v253, s[4:7], s28 offen offset:3072 lds
    v_mfma_f32_16x16x32_bf16 v[80:83], a[160:163], v[148:151], v[80:83]
    s_waitcnt lgkmcnt(4)
    v_mfma_f32_16x16x32_bf16 v[96:99], a[160:163], v[152:155], v[96:99]
    ds_read_b64_tr_b16 v[168:169], v210 offset:24576
    ds_read_b64_tr_b16 v[170:171], v210 offset:25600
    v_mfma_f32_16x16x32_bf16 v[100:103], a[164:167], v[152:155], v[100:103]
    v_mfma_f32_16x16x32_bf16 v[104:107], a[168:171], v[152:155], v[104:107]
    s_add_u32 m0, s30, 12288
    v_mfma_f32_16x16x32_bf16 v[108:111], a[172:175], v[152:155], v[108:111]
    s_add_u32 s28, s25, s92
    v_mfma_f32_16x16x32_bf16 v[124:127], a[172:175], v[156:159], v[124:127]
    ds_read_b64_tr_b16 v[172:173], v211 offset:24576
    ds_read_b64_tr_b16 v[174:175], v211 offset:25600
    v_mfma_f32_16x16x32_bf16 v[120:123], a[168:171], v[156:159], v[120:123]
    buffer_load_dwordx4 v218, s[4:7], s28 offen offset:0 lds
    v_mfma_f32_16x16x32_bf16 v[116:119], a[164:167], v[156:159], v[116:119]
    v_mfma_f32_16x16x32_bf16 v[112:115], a[160:163], v[156:159], v[112:115]
    s_waitcnt lgkmcnt(4)
    v_mfma_f32_16x16x32_bf16 v[0:3], v[160:163], a[176:179], v[0:3]
    ds_read_b64_tr_b16 v[176:177], v212 offset:24576
    ds_read_b64_tr_b16 v[178:179], v212 offset:25600
    v_mfma_f32_16x16x32_bf16 v[4:7], v[160:163], a[180:183], v[4:7]
    buffer_load_dwordx4 v219, s[4:7], s28 offen offset:1024 lds
    v_mfma_f32_16x16x32_bf16 v[8:11], v[160:163], a[184:187], v[8:11]
    v_mfma_f32_16x16x32_bf16 v[12:15], v[160:163], a[188:191], v[12:15]
    v_mfma_f32_16x16x32_bf16 v[28:31], v[164:167], a[188:191], v[28:31]
    ds_read_b64_tr_b16 v[180:181], v213 offset:24576
    ds_read_b64_tr_b16 v[182:183], v213 offset:25600
    v_mfma_f32_16x16x32_bf16 v[24:27], v[164:167], a[184:187], v[24:27]
    buffer_load_dwordx4 v252, s[4:7], s28 offen offset:2048 lds
    v_mfma_f32_16x16x32_bf16 v[20:23], v[164:167], a[180:183], v[20:23]
    v_mfma_f32_16x16x32_bf16 v[16:19], v[164:167], a[176:179], v[16:19]
    s_waitcnt lgkmcnt(4)
    v_mfma_f32_16x16x32_bf16 v[32:35], v[168:171], a[176:179], v[32:35]
    ds_read_b64_tr_b16 v[184:185], v214 offset:24576
    ds_read_b64_tr_b16 v[186:187], v214 offset:25600
    v_mfma_f32_16x16x32_bf16 v[36:39], v[168:171], a[180:183], v[36:39]
    buffer_load_dwordx4 v253, s[4:7], s28 offen offset:3072 lds
    v_mfma_f32_16x16x32_bf16 v[40:43], v[168:171], a[184:187], v[40:43]
    v_mfma_f32_16x16x32_bf16 v[44:47], v[168:171], a[188:191], v[44:47]
    v_mfma_f32_16x16x32_bf16 v[60:63], v[172:175], a[188:191], v[60:63]
    s_waitcnt vmcnt(12)
    ds_read_b64_tr_b16 v[188:189], v215 offset:24576
    ds_read_b64_tr_b16 v[190:191], v215 offset:25600
    s_barrier
    v_mfma_f32_16x16x32_bf16 v[56:59], v[172:175], a[184:187], v[56:59]
    ds_read_b128 a[192:195], v216 offset:0
    ds_read_b128 a[196:199], v216 offset:2048
    v_mfma_f32_16x16x32_bf16 v[52:55], v[172:175], a[180:183], v[52:55]
    ds_read_b128 a[200:203], v216 offset:4096
    ds_read_b128 a[204:207], v216 offset:6144
    v_mfma_f32_16x16x32_bf16 v[48:51], v[172:175], a[176:179], v[48:51]
    s_waitcnt lgkmcnt(8)
    v_mfma_f32_16x16x32_bf16 v[64:67], a[176:179], v[176:179], v[64:67]
    ds_read_b64_tr_b16 v[128:129], v208 offset:32768
    ds_read_b64_tr_b16 v[130:131], v208 offset:33792
    v_mfma_f32_16x16x32_bf16 v[68:71], a[180:183], v[176:179], v[68:71]
    v_mfma_f32_16x16x32_bf16 v[72:75], a[184:187], v[176:179], v[72:75]
    ds_read_b128 a[208:211], v217 offset:0
    ds_read_b128 a[212:215], v217 offset:2048
    v_mfma_f32_16x16x32_bf16 v[76:79], a[188:191], v[176:179], v[76:79]
    v_mfma_f32_16x16x32_bf16 v[92:95], a[188:191], v[180:183], v[92:95]
    ds_read_b64_tr_b16 v[132:133], v209 offset:32768
    ds_read_b64_tr_b16 v[134:135], v209 offset:33792
    v_mfma_f32_16x16x32_bf16 v[88:91], a[184:187], v[180:183], v[88:91]
    v_mfma_f32_16x16x32_bf16 v[84:87], a[180:183], v[180:183], v[84:87]
    ds_read_b128 a[216:219], v217 offset:4096
    ds_read_b128 a[220:223], v217 offset:6144
    v_mfma_f32_16x16x32_bf16 v[80:83], a[176:179], v[180:183], v[80:83]
    s_waitcnt lgkmcnt(12)
    v_mfma_f32_16x16x32_bf16 v[96:99], a[176:179], v[184:187], v[96:99]
    ds_read_b64_tr_b16 v[136:137], v210 offset:32768
    ds_read_b64_tr_b16 v[138:139], v210 offset:33792
    v_mfma_f32_16x16x32_bf16 v[100:103], a[180:183], v[184:187], v[100:103]
    v_mfma_f32_16x16x32_bf16 v[104:107], a[184:187], v[184:187], v[104:107]
    v_mfma_f32_16x16x32_bf16 v[108:111], a[188:191], v[184:187], v[108:111]
    v_mfma_f32_16x16x32_bf16 v[124:127], a[188:191], v[188:191], v[124:127]
    ds_read_b64_tr_b16 v[140:141], v211 offset:32768
    ds_read_b64_tr_b16 v[142:143], v211 offset:33792
    v_mfma_f32_16x16x32_bf16 v[120:123], a[184:187], v[188:191], v[120:123]
    v_mfma_f32_16x16x32_bf16 v[116:119], a[180:183], v[188:191], v[116:119]
    v_mfma_f32_16x16x32_bf16 v[112:115], a[176:179], v[188:191], v[112:115]
    s_waitcnt lgkmcnt(6)
    v_mfma_f32_16x16x32_bf16 v[0:3], v[128:131], a[192:195], v[0:3]
    ds_read_b64_tr_b16 v[144:145], v212 offset:32768
    ds_read_b64_tr_b16 v[146:147], v212 offset:33792
    v_mfma_f32_16x16x32_bf16 v[4:7], v[128:131], a[196:199], v[4:7]
    v_mfma_f32_16x16x32_bf16 v[8:11], v[128:131], a[200:203], v[8:11]
    v_mfma_f32_16x16x32_bf16 v[12:15], v[128:131], a[204:207], v[12:15]
    v_mfma_f32_16x16x32_bf16 v[28:31], v[132:135], a[204:207], v[28:31]
    ds_read_b64_tr_b16 v[148:149], v213 offset:32768
    ds_read_b64_tr_b16 v[150:151], v213 offset:33792
    v_mfma_f32_16x16x32_bf16 v[24:27], v[132:135], a[200:203], v[24:27]
    v_mfma_f32_16x16x32_bf16 v[20:23], v[132:135], a[196:199], v[20:23]
    v_mfma_f32_16x16x32_bf16 v[16:19], v[132:135], a[192:195], v[16:19]
    s_waitcnt lgkmcnt(4)
    v_mfma_f32_16x16x32_bf16 v[32:35], v[136:139], a[192:195], v[32:35]
    ds_read_b64_tr_b16 v[152:153], v214 offset:32768
    ds_read_b64_tr_b16 v[154:155], v214 offset:33792
    v_mfma_f32_16x16x32_bf16 v[36:39], v[136:139], a[196:199], v[36:39]
    v_mfma_f32_16x16x32_bf16 v[40:43], v[136:139], a[200:203], v[40:43]
    v_mfma_f32_16x16x32_bf16 v[44:47], v[136:139], a[204:207], v[44:47]
    v_mfma_f32_16x16x32_bf16 v[60:63], v[140:143], a[204:207], v[60:63]
    ds_read_b64_tr_b16 v[156:157], v215 offset:32768
    ds_read_b64_tr_b16 v[158:159], v215 offset:33792
    v_mfma_f32_16x16x32_bf16 v[56:59], v[140:143], a[200:203], v[56:59]
    v_mfma_f32_16x16x32_bf16 v[52:55], v[140:143], a[196:199], v[52:55]
    v_mfma_f32_16x16x32_bf16 v[48:51], v[140:143], a[192:195], v[48:51]
    s_waitcnt lgkmcnt(4)
    v_mfma_f32_16x16x32_bf16 v[64:67], a[192:195], v[144:147], v[64:67]
    ds_read_b64_tr_b16 v[160:161], v208 offset:40960
    ds_read_b64_tr_b16 v[162:163], v208 offset:41984
    v_mfma_f32_16x16x32_bf16 v[68:71], a[196:199], v[144:147], v[68:71]
    v_mfma_f32_16x16x32_bf16 v[72:75], a[200:203], v[144:147], v[72:75]
    v_mfma_f32_16x16x32_bf16 v[76:79], a[204:207], v[144:147], v[76:79]
    v_mfma_f32_16x16x32_bf16 v[92:95], a[204:207], v[148:151], v[92:95]
    ds_read_b64_tr_b16 v[164:165], v209 offset:40960
    ds_read_b64_tr_b16 v[166:167], v209 offset:41984
    v_mfma_f32_16x16x32_bf16 v[88:91], a[200:203], v[148:151], v[88:91]
    v_mfma_f32_16x16x32_bf16 v[84:87], a[196:199], v[148:151], v[84:87]
    v_mfma_f32_16x16x32_bf16 v[80:83], a[192:195], v[148:151], v[80:83]
    s_waitcnt lgkmcnt(4)
    v_mfma_f32_16x16x32_bf16 v[96:99], a[192:195], v[152:155], v[96:99]
    ds_read_b64_tr_b16 v[168:169], v210 offset:40960
    ds_read_b64_tr_b16 v[170:171], v210 offset:41984
    v_mfma_f32_16x16x32_bf16 v[100:103], a[196:199], v[152:155], v[100:103]
    v_mfma_f32_16x16x32_bf16 v[104:107], a[200:203], v[152:155], v[104:107]
    v_mfma_f32_16x16x32_bf16 v[108:111], a[204:207], v[152:155], v[108:111]
    v_mfma_f32_16x16x32_bf16 v[124:127], a[204:207], v[156:159], v[124:127]
    ds_read_b64_tr_b16 v[172:173], v211 offset:40960
    ds_read_b64_tr_b16 v[174:175], v211 offset:41984
    v_mfma_f32_16x16x32_bf16 v[120:123], a[200:203], v[156:159], v[120:123]
    v_mfma_f32_16x16x32_bf16 v[116:119], a[196:199], v[156:159], v[116:119]
    v_mfma_f32_16x16x32_bf16 v[112:115], a[192:195], v[156:159], v[112:115]
    s_waitcnt lgkmcnt(4)
    v_mfma_f32_16x16x32_bf16 v[0:3], v[160:163], a[208:211], v[0:3]
    ds_read_b64_tr_b16 v[176:177], v212 offset:40960
    ds_read_b64_tr_b16 v[178:179], v212 offset:41984
    v_mfma_f32_16x16x32_bf16 v[4:7], v[160:163], a[212:215], v[4:7]
    v_mfma_f32_16x16x32_bf16 v[8:11], v[160:163], a[216:219], v[8:11]
    v_mfma_f32_16x16x32_bf16 v[12:15], v[160:163], a[220:223], v[12:15]
    v_mfma_f32_16x16x32_bf16 v[28:31], v[164:167], a[220:223], v[28:31]
    ds_read_b64_tr_b16 v[180:181], v213 offset:40960
    ds_read_b64_tr_b16 v[182:183], v213 offset:41984
    v_mfma_f32_16x16x32_bf16 v[24:27], v[164:167], a[216:219], v[24:27]
    v_mfma_f32_16x16x32_bf16 v[20:23], v[164:167], a[212:215], v[20:23]
    v_mfma_f32_16x16x32_bf16 v[16:19], v[164:167], a[208:211], v[16:19]
    s_waitcnt lgkmcnt(4)
    v_mfma_f32_16x16x32_bf16 v[32:35], v[168:171], a[208:211], v[32:35]
    ds_read_b64_tr_b16 v[184:185], v214 offset:40960
    ds_read_b64_tr_b16 v[186:187], v214 offset:41984
    v_mfma_f32_16x16x32_bf16 v[36:39], v[168:171], a[212:215], v[36:39]
    v_mfma_f32_16x16x32_bf16 v[40:43], v[168:171], a[216:219], v[40:43]
    v_mfma_f32_16x16x32_bf16 v[44:47], v[168:171], a[220:223], v[44:47]
    v_mfma_f32_16x16x32_bf16 v[60:63], v[172:175], a[220:223], v[60:63]
    s_waitcnt vmcnt(0)
    ds_read_b64_tr_b16 v[188:189], v215 offset:40960
    ds_read_b64_tr_b16 v[190:191], v215 offset:41984
    s_barrier
    v_mfma_f32_16x16x32_bf16 v[56:59], v[172:175], a[216:219], v[56:59]
    ds_read_b128 a[224:227], v216 offset:8192
    ds_read_b128 a[228:231], v216 offset:10240
    v_mfma_f32_16x16x32_bf16 v[52:55], v[172:175], a[212:215], v[52:55]
    ds_read_b128 a[232:235], v216 offset:12288
    ds_read_b128 a[236:239], v216 offset:14336
    v_mfma_f32_16x16x32_bf16 v[48:51], v[172:175], a[208:211], v[48:51]
    s_waitcnt lgkmcnt(8)
    s_add_u32 m0, s38, 0
    v_mfma_f32_16x16x32_bf16 v[64:67], a[208:211], v[176:179], v[64:67]
    s_add_u32 s27, s23, s37
    ds_read_b64_tr_b16 v[128:129], v208 offset:49152
    ds_read_b64_tr_b16 v[130:131], v208 offset:50176
    v_mfma_f32_16x16x32_bf16 v[68:71], a[212:215], v[176:179], v[68:71]
    buffer_load_dwordx4 v238, s[8:11], s27 offen lds
    v_mfma_f32_16x16x32_bf16 v[72:75], a[216:219], v[176:179], v[72:75]
    ds_read_b128 a[240:243], v217 offset:8192
    ds_read_b128 a[244:247], v217 offset:10240
    v_mfma_f32_16x16x32_bf16 v[76:79], a[220:223], v[176:179], v[76:79]
    v_mfma_f32_16x16x32_bf16 v[92:95], a[220:223], v[180:183], v[92:95]
    s_add_u32 m0, s38, 1024
    ds_read_b64_tr_b16 v[132:133], v209 offset:49152
    ds_read_b64_tr_b16 v[134:135], v209 offset:50176
    v_mfma_f32_16x16x32_bf16 v[88:91], a[216:219], v[180:183], v[88:91]
    v_mfma_f32_16x16x32_bf16 v[84:87], a[212:215], v[180:183], v[84:87]
    s_add_u32 s27, s27, s36
    ds_read_b128 a[248:251], v217 offset:12288
    ds_read_b128 a[252:255], v217 offset:14336
    v_mfma_f32_16x16x32_bf16 v[80:83], a[208:211], v[180:183], v[80:83]
    s_waitcnt lgkmcnt(12)
    v_mfma_f32_16x16x32_bf16 v[96:99], a[208:211], v[184:187], v[96:99]
    ds_read_b64_tr_b16 v[136:137], v210 offset:49152
    ds_read_b64_tr_b16 v[138:139], v210 offset:50176
    v_mfma_f32_16x16x32_bf16 v[100:103], a[212:215], v[184:187], v[100:103]
    buffer_load_dwordx4 v239, s[8:11], s27 offen lds
    v_mfma_f32_16x16x32_bf16 v[104:107], a[216:219], v[184:187], v[104:107]
    s_add_u32 m0, s38, 2048
    v_mfma_f32_16x16x32_bf16 v[108:111], a[220:223], v[184:187], v[108:111]
    v_mfma_f32_16x16x32_bf16 v[124:127], a[220:223], v[188:191], v[124:127]
    s_add_u32 s27, s27, s36
    ds_read_b64_tr_b16 v[140:141], v211 offset:49152
    ds_read_b64_tr_b16 v[142:143], v211 offset:50176
    v_mfma_f32_16x16x32_bf16 v[120:123], a[216:219], v[188:191], v[120:123]
    buffer_load_dwordx4 v238, s[8:11], s27 offen lds
    v_mfma_f32_16x16x32_bf16 v[116:119], a[212:215], v[188:191], v[116:119]
    v_mfma_f32_16x16x32_bf16 v[112:115], a[208:211], v[188:191], v[112:115]
    s_waitcnt lgkmcnt(6)
    v_mfma_f32_16x16x32_bf16 v[0:3], v[128:131], a[224:227], v[0:3]
    s_add_u32 m0, s38, 3072
    ds_read_b64_tr_b16 v[144:145], v212 offset:49152
    ds_read_b64_tr_b16 v[146:147], v212 offset:50176
    v_mfma_f32_16x16x32_bf16 v[4:7], v[128:131], a[228:231], v[4:7]
    v_mfma_f32_16x16x32_bf16 v[8:11], v[128:131], a[232:235], v[8:11]
    s_add_u32 s27, s27, s36
    v_mfma_f32_16x16x32_bf16 v[12:15], v[128:131], a[236:239], v[12:15]
    buffer_load_dwordx4 v239, s[8:11], s27 offen lds
    v_mfma_f32_16x16x32_bf16 v[28:31], v[132:135], a[236:239], v[28:31]
    ds_read_b64_tr_b16 v[148:149], v213 offset:49152
    ds_read_b64_tr_b16 v[150:151], v213 offset:50176
    v_mfma_f32_16x16x32_bf16 v[24:27], v[132:135], a[232:235], v[24:27]
    v_mfma_f32_16x16x32_bf16 v[20:23], v[132:135], a[228:231], v[20:23]
    s_add_u32 m0, s38, 4096
    v_mfma_f32_16x16x32_bf16 v[16:19], v[132:135], a[224:227], v[16:19]
    s_waitcnt lgkmcnt(4)
    s_add_u32 s27, s27, s36
    v_mfma_f32_16x16x32_bf16 v[32:35], v[136:139], a[224:227], v[32:35]
    ds_read_b64_tr_b16 v[152:153], v214 offset:49152
    ds_read_b64_tr_b16 v[154:155], v214 offset:50176
    v_mfma_f32_16x16x32_bf16 v[36:39], v[136:139], a[228:231], v[36:39]
    buffer_load_dwordx4 v238, s[8:11], s27 offen lds
    v_mfma_f32_16x16x32_bf16 v[40:43], v[136:139], a[232:235], v[40:43]
    v_mfma_f32_16x16x32_bf16 v[44:47], v[136:139], a[236:239], v[44:47]
    v_mfma_f32_16x16x32_bf16 v[60:63], v[140:143], a[236:239], v[60:63]
    s_add_u32 m0, s38, 5120
    ds_read_b64_tr_b16 v[156:157], v215 offset:49152
    ds_read_b64_tr_b16 v[158:159], v215 offset:50176
    v_mfma_f32_16x16x32_bf16 v[56:59], v[140:143], a[232:235], v[56:59]
    s_add_u32 s27, s27, s36
    v_mfma_f32_16x16x32_bf16 v[52:55], v[140:143], a[228:231], v[52:55]
    v_mfma_f32_16x16x32_bf16 v[48:51], v[140:143], a[224:227], v[48:51]
    s_waitcnt lgkmcnt(4)
    v_mfma_f32_16x16x32_bf16 v[64:67], a[224:227], v[144:147], v[64:67]
    ds_read_b64_tr_b16 v[160:161], v208 offset:57344
    ds_read_b64_tr_b16 v[162:163], v208 offset:58368
    v_mfma_f32_16x16x32_bf16 v[68:71], a[228:231], v[144:147], v[68:71]
    buffer_load_dwordx4 v239, s[8:11], s27 offen lds
    v_mfma_f32_16x16x32_bf16 v[72:75], a[232:235], v[144:147], v[72:75]
    s_add_u32 m0, s38, 6144
    v_mfma_f32_16x16x32_bf16 v[76:79], a[236:239], v[144:147], v[76:79]
    s_add_u32 s27, s27, s36
    v_mfma_f32_16x16x32_bf16 v[92:95], a[236:239], v[148:151], v[92:95]
    ds_read_b64_tr_b16 v[164:165], v209 offset:57344
    ds_read_b64_tr_b16 v[166:167], v209 offset:58368
    v_mfma_f32_16x16x32_bf16 v[88:91], a[232:235], v[148:151], v[88:91]
    buffer_load_dwordx4 v238, s[8:11], s27 offen lds
    v_mfma_f32_16x16x32_bf16 v[84:87], a[228:231], v[148:151], v[84:87]
    v_mfma_f32_16x16x32_bf16 v[80:83], a[224:227], v[148:151], v[80:83]
    s_waitcnt lgkmcnt(4)
    v_mfma_f32_16x16x32_bf16 v[96:99], a[224:227], v[152:155], v[96:99]
    s_add_u32 m0, s38, 7168
    ds_read_b64_tr_b16 v[168:169], v210 offset:57344
    ds_read_b64_tr_b16 v[170:171], v210 offset:58368
    v_mfma_f32_16x16x32_bf16 v[100:103], a[228:231], v[152:155], v[100:103]
    s_add_u32 s27, s27, s36
    v_mfma_f32_16x16x32_bf16 v[104:107], a[232:235], v[152:155], v[104:107]
    v_mfma_f32_16x16x32_bf16 v[108:111], a[236:239], v[152:155], v[108:111]
    buffer_load_dwordx4 v239, s[8:11], s27 offen lds
    v_mfma_f32_16x16x32_bf16 v[124:127], a[236:239], v[156:159], v[124:127]
    ds_read_b64_tr_b16 v[172:173], v211 offset:57344
    ds_read_b64_tr_b16 v[174:175], v211 offset:58368
    v_mfma_f32_16x16x32_bf16 v[120:123], a[232:235], v[156:159], v[120:123]
    v_mfma_f32_16x16x32_bf16 v[116:119], a[228:231], v[156:159], v[116:119]
    v_mfma_f32_16x16x32_bf16 v[112:115], a[224:227], v[156:159], v[112:115]
    s_waitcnt lgkmcnt(4)
    v_mfma_f32_16x16x32_bf16 v[0:3], v[160:163], a[240:243], v[0:3]
    ds_read_b64_tr_b16 v[176:177], v212 offset:57344
    ds_read_b64_tr_b16 v[178:179], v212 offset:58368
    v_mfma_f32_16x16x32_bf16 v[4:7], v[160:163], a[244:247], v[4:7]
    v_mfma_f32_16x16x32_bf16 v[8:11], v[160:163], a[248:251], v[8:11]
    v_mfma_f32_16x16x32_bf16 v[12:15], v[160:163], a[252:255], v[12:15]
    v_mfma_f32_16x16x32_bf16 v[28:31], v[164:167], a[252:255], v[28:31]
    ds_read_b64_tr_b16 v[180:181], v213 offset:57344
    ds_read_b64_tr_b16 v[182:183], v213 offset:58368
    v_mfma_f32_16x16x32_bf16 v[24:27], v[164:167], a[248:251], v[24:27]
    v_mfma_f32_16x16x32_bf16 v[20:23], v[164:167], a[244:247], v[20:23]
    v_mfma_f32_16x16x32_bf16 v[16:19], v[164:167], a[240:243], v[16:19]
    s_waitcnt lgkmcnt(4)
    v_mfma_f32_16x16x32_bf16 v[32:35], v[168:171], a[240:243], v[32:35]
    ds_read_b64_tr_b16 v[184:185], v214 offset:57344
    ds_read_b64_tr_b16 v[186:187], v214 offset:58368
    v_mfma_f32_16x16x32_bf16 v[36:39], v[168:171], a[244:247], v[36:39]
    v_mfma_f32_16x16x32_bf16 v[40:43], v[168:171], a[248:251], v[40:43]
    v_mfma_f32_16x16x32_bf16 v[44:47], v[168:171], a[252:255], v[44:47]
    v_mfma_f32_16x16x32_bf16 v[60:63], v[172:175], a[252:255], v[60:63]
    ds_read_b64_tr_b16 v[188:189], v215 offset:57344
    ds_read_b64_tr_b16 v[190:191], v215 offset:58368
    v_mfma_f32_16x16x32_bf16 v[56:59], v[172:175], a[248:251], v[56:59]
    v_mfma_f32_16x16x32_bf16 v[52:55], v[172:175], a[244:247], v[52:55]
    v_mfma_f32_16x16x32_bf16 v[48:51], v[172:175], a[240:243], v[48:51]
    s_waitcnt lgkmcnt(4)
    v_mfma_f32_16x16x32_bf16 v[64:67], a[240:243], v[176:179], v[64:67]
    v_mfma_f32_16x16x32_bf16 v[68:71], a[244:247], v[176:179], v[68:71]
    v_mfma_f32_16x16x32_bf16 v[72:75], a[248:251], v[176:179], v[72:75]
    v_mfma_f32_16x16x32_bf16 v[76:79], a[252:255], v[176:179], v[76:79]
    v_mfma_f32_16x16x32_bf16 v[92:95], a[252:255], v[180:183], v[92:95]
    v_mfma_f32_16x16x32_bf16 v[88:91], a[248:251], v[180:183], v[88:91]
    v_mfma_f32_16x16x32_bf16 v[84:87], a[244:247], v[180:183], v[84:87]
    v_mfma_f32_16x16x32_bf16 v[80:83], a[240:243], v[180:183], v[80:83]
    s_waitcnt lgkmcnt(0)
    v_mfma_f32_16x16x32_bf16 v[96:99], a[240:243], v[184:187], v[96:99]
    v_mfma_f32_16x16x32_bf16 v[100:103], a[244:247], v[184:187], v[100:103]
    v_mfma_f32_16x16x32_bf16 v[104:107], a[248:251], v[184:187], v[104:107]
    v_mfma_f32_16x16x32_bf16 v[108:111], a[252:255], v[184:187], v[108:111]
    v_mfma_f32_16x16x32_bf16 v[124:127], a[252:255], v[188:191], v[124:127]
    v_mfma_f32_16x16x32_bf16 v[120:123], a[248:251], v[188:191], v[120:123]
    v_mfma_f32_16x16x32_bf16 v[116:119], a[244:247], v[188:191], v[116:119]
    v_mfma_f32_16x16x32_bf16 v[112:115], a[240:243], v[188:191], v[112:115]
    s_barrier
    s_add_u32 m0, s38, 32768
    s_add_u32 s27, s23, s96
    buffer_load_dwordx4 v238, s[8:11], s27 offen lds
    s_add_u32 m0, s38, 33792
    s_add_u32 s27, s27, s36
    buffer_load_dwordx4 v239, s[8:11], s27 offen lds
    s_add_u32 m0, s38, 34816
    s_add_u32 s27, s27, s36
    buffer_load_dwordx4 v238, s[8:11], s27 offen lds
    s_add_u32 m0, s38, 35840
    s_add_u32 s27, s27, s36
    buffer_load_dwordx4 v239, s[8:11], s27 offen lds
    s_add_u32 m0, s38, 36864
    s_add_u32 s27, s27, s36
    buffer_load_dwordx4 v238, s[8:11], s27 offen lds
    s_add_u32 m0, s38, 37888
    s_add_u32 s27, s27, s36
    buffer_load_dwordx4 v239, s[8:11], s27 offen lds
    s_add_u32 m0, s38, 38912
    s_add_u32 s27, s27, s36
    buffer_load_dwordx4 v238, s[8:11], s27 offen lds
    s_add_u32 m0, s38, 39936
    s_add_u32 s27, s27, s36
    buffer_load_dwordx4 v239, s[8:11], s27 offen lds
    s_add_u32 s23, s23, 128
    s_cmp_lg_u32 s16, 0
    s_cbranch_scc1 K1_cnt_17
    s_load_dwordx2 s[88:89], s[0:1], 88
    s_mov_b32 s90, 256
    s_mov_b32 s91, 0x20000
    v_mov_b32 v241, 1
    v_mov_b32 v242, 0
    s_waitcnt lgkmcnt(0)
    s_mov_b64 exec, 1
    buffer_atomic_add v241, v242, s[88:91], 0 offen sc1
    s_mov_b64 exec, -1
K1_cnt_17:
    v_mov_b32 v252, 0x3f803f80
    v_mov_b32 v253, 0x3f803f80
    v_mov_b32 v254, 0x3f803f80
    v_mov_b32 v255, 0x3f803f80
    s_sub_u32 s26, s18, 24
    s_lshl_b32 s26, s26, 3
    s_add_u32 s26, s26, s17
    s_lshl_b32 s26, s26, 2
    s_add_u32 s26, s26, s16
    v_lshlrev_b32 v244, 7, v240
    s_mov_b32 s88, s46
    s_mov_b32 s89, s47
    s_mov_b32 s90, 0x400000
    s_mov_b32 s91, 0x20000
    s_lshl_b32 s25, s26, 14
    s_lshl_b32 s24, s26, 13
    s_waitcnt lgkmcnt(0)
    s_mov_b32 s4, s44
    s_mov_b32 s5, s45
    v_cvt_pk_bf16_f32 v128, v64, v65
    v_cvt_pk_bf16_f32 v129, v66, v67
    v_cvt_pk_bf16_f32 v130, v68, v69
    v_cvt_pk_bf16_f32 v131, v70, v71
    ds_write_b128 v249, v[128:131] offset:0
    v_cvt_pk_bf16_f32 v132, v80, v81
    v_cvt_pk_bf16_f32 v133, v82, v83
    v_cvt_pk_bf16_f32 v134, v84, v85
    v_cvt_pk_bf16_f32 v135, v86, v87
    ds_write_b128 v249, v[132:135] offset:1024
    v_cvt_pk_bf16_f32 v136, v96, v97
    v_cvt_pk_bf16_f32 v137, v98, v99
    v_cvt_pk_bf16_f32 v138, v100, v101
    v_cvt_pk_bf16_f32 v139, v102, v103
    ds_write_b128 v249, v[136:139] offset:2048
    v_cvt_pk_bf16_f32 v140, v112, v113
    v_cvt_pk_bf16_f32 v141, v114, v115
    v_cvt_pk_bf16_f32 v142, v116, v117
    v_cvt_pk_bf16_f32 v143, v118, v119
    ds_write_b128 v249, v[140:143] offset:3072
    v_cvt_pk_bf16_f32 v144, v72, v73
    v_cvt_pk_bf16_f32 v145, v74, v75
    v_cvt_pk_bf16_f32 v146, v76, v77
    v_cvt_pk_bf16_f32 v147, v78, v79
    ds_write_b128 v249, v[144:147] offset:4096
    v_cvt_pk_bf16_f32 v148, v88, v89
    v_cvt_pk_bf16_f32 v149, v90, v91
    v_cvt_pk_bf16_f32 v150, v92, v93
    v_cvt_pk_bf16_f32 v151, v94, v95
    ds_write_b128 v249, v[148:151] offset:5120
    v_cvt_pk_bf16_f32 v152, v104, v105
    v_cvt_pk_bf16_f32 v153, v106, v107
    v_cvt_pk_bf16_f32 v154, v108, v109
    v_cvt_pk_bf16_f32 v155, v110, v111
    ds_write_b128 v249, v[152:155] offset:6144
    v_cvt_pk_bf16_f32 v156, v120, v121
    v_cvt_pk_bf16_f32 v157, v122, v123
    v_cvt_pk_bf16_f32 v158, v124, v125
    v_cvt_pk_bf16_f32 v159, v126, v127
    ds_write_b128 v249, v[156:159] offset:7168
    v_lshl_or_b32 v192, v193, 16, v192
    v_lshl_or_b32 v193, v195, 16, v194
    v_lshl_or_b32 v196, v197, 16, v196
    v_lshl_or_b32 v197, v199, 16, v198
    v_lshl_or_b32 v200, v201, 16, v200
    v_lshl_or_b32 v201, v203, 16, v202
    v_lshl_or_b32 v204, v205, 16, v204
    v_lshl_or_b32 v205, v207, 16, v206
    v_cndmask_b32 v160, 0, v192, s[48:49]
    v_cndmask_b32 v161, 0, v193, s[48:49]
    v_cndmask_b32 v162, 0, v192, s[50:51]
    v_cndmask_b32 v163, 0, v193, s[50:51]
    v_cndmask_b32 v164, 0, v192, s[52:53]
    v_cndmask_b32 v165, 0, v193, s[52:53]
    v_cndmask_b32 v166, 0, v192, s[54:55]
    v_cndmask_b32 v167, 0, v193, s[54:55]
    v_cndmask_b32 v168, 0, v196, s[48:49]
    v_cndmask_b32 v169, 0, v197, s[48:49]
    v_cndmask_b32 v170, 0, v196, s[50:51]
    v_cndmask_b32 v171, 0, v197, s[50:51]
    v_cndmask_b32 v172, 0, v196, s[52:53]
    v_cndmask_b32 v173, 0, v197, s[52:53]
    v_cndmask_b32 v174, 0, v196, s[54:55]
    v_cndmask_b32 v175, 0, v197, s[54:55]
    v_cndmask_b32 v176, 0, v200, s[48:49]
    v_cndmask_b32 v177, 0, v201, s[48:49]
    v_cndmask_b32 v178, 0, v200, s[50:51]
    v_cndmask_b32 v179, 0, v201, s[50:51]
    v_cndmask_b32 v180, 0, v200, s[52:53]
    v_cndmask_b32 v181, 0, v201, s[52:53]
    v_cndmask_b32 v182, 0, v200, s[54:55]
    v_cndmask_b32 v183, 0, v201, s[54:55]
    v_cndmask_b32 v184, 0, v204, s[48:49]
    v_cndmask_b32 v185, 0, v205, s[48:49]
    v_cndmask_b32 v186, 0, v204, s[50:51]
    v_cndmask_b32 v187, 0, v205, s[50:51]
    v_cndmask_b32 v188, 0, v204, s[52:53]
    v_cndmask_b32 v189, 0, v205, s[52:53]
    v_cndmask_b32 v190, 0, v204, s[54:55]
    v_cndmask_b32 v191, 0, v205, s[54:55]
    s_waitcnt lgkmcnt(0)
    v_cvt_pk_bf16_f32 v136, v0, v1
    v_cvt_pk_bf16_f32 v137, v2, v3
    v_cvt_pk_bf16_f32 v138, v16, v17
    v_cvt_pk_bf16_f32 v139, v18, v19
    v_cvt_pk_bf16_f32 v140, v32, v33
    v_cvt_pk_bf16_f32 v141, v34, v35
    v_cvt_pk_bf16_f32 v142, v48, v49
    v_cvt_pk_bf16_f32 v143, v50, v51
    s_nop 1
    v_mfma_f32_16x16x32_bf16 v[64:67], v[160:163], v[136:139], 0
    v_mfma_f32_16x16x32_bf16 v[68:71], v[168:171], v[136:139], 0
    v_mfma_f32_16x16x32_bf16 v[72:75], v[176:179], v[136:139], 0
    v_mfma_f32_16x16x32_bf16 v[76:79], v[184:187], v[136:139], 0
    v_mfma_f32_16x16x32_bf16 v[64:67], v[164:167], v[140:143], v[64:67]
    v_mfma_f32_16x16x32_bf16 v[68:71], v[172:175], v[140:143], v[68:71]
    v_mfma_f32_16x16x32_bf16 v[72:75], v[180:183], v[140:143], v[72:75]
    v_mfma_f32_16x16x32_bf16 v[76:79], v[188:191], v[140:143], v[76:79]
    buffer_load_dword v245, v244, s[4:7], s24 offen
    v_cvt_pk_bf16_f32 v136, v4, v5
    v_cvt_pk_bf16_f32 v137, v6, v7
    v_cvt_pk_bf16_f32 v138, v20, v21
    v_cvt_pk_bf16_f32 v139, v22, v23
    v_cvt_pk_bf16_f32 v140, v36, v37
    v_cvt_pk_bf16_f32 v141, v38, v39
    v_cvt_pk_bf16_f32 v142, v52, v53
    v_cvt_pk_bf16_f32 v143, v54, v55
    s_call_b64 s[62:63], K1_sm16_16
    ds_write_b128 v247, v[112:115] offset:0
    ds_write_b128 v247, v[116:119] offset:16
    ds_write_b128 v247, v[120:123] offset:32
    ds_write_b128 v247, v[124:127] offset:48
    buffer_load_dword v245, v244, s[88:91], s25 offen
    s_add_u32 s25, s25, 8192
    v_cvt_pk_bf16_f32 v136, v8, v9
    v_cvt_pk_bf16_f32 v137, v10, v11
    v_cvt_pk_bf16_f32 v138, v24, v25
    v_cvt_pk_bf16_f32 v139, v26, v27
    v_cvt_pk_bf16_f32 v140, v40, v41
    v_cvt_pk_bf16_f32 v141, v42, v43
    v_cvt_pk_bf16_f32 v142, v56, v57
    v_cvt_pk_bf16_f32 v143, v58, v59
    s_call_b64 s[62:63], K1_sm16_16
    ds_write_b128 v247, v[112:115] offset:1024
    ds_write_b128 v247, v[116:119] offset:1040
    ds_write_b128 v247, v[120:123] offset:1056
    ds_write_b128 v247, v[124:127] offset:1072
    buffer_load_dword v245, v244, s[88:91], s25 offen
    s_add_u32 s25, s25, 8192
    v_cvt_pk_bf16_f32 v136, v12, v13
    v_cvt_pk_bf16_f32 v137, v14, v15
    v_cvt_pk_bf16_f32 v138, v28, v29
    v_cvt_pk_bf16_f32 v139, v30, v31
    v_cvt_pk_bf16_f32 v140, v44, v45
    v_cvt_pk_bf16_f32 v141, v46, v47
    v_cvt_pk_bf16_f32 v142, v60, v61
    v_cvt_pk_bf16_f32 v143, v62, v63
    s_call_b64 s[62:63], K1_sm16_16
    ds_write_b128 v247, v[112:115] offset:2048
    ds_write_b128 v247, v[116:119] offset:2064
    ds_write_b128 v247, v[120:123] offset:2080
    ds_write_b128 v247, v[124:127] offset:2096
    v_cvt_pk_bf16_f32 v136, v12, v13
    v_cvt_pk_bf16_f32 v137, v14, v15
    v_cvt_pk_bf16_f32 v138, v28, v29
    v_cvt_pk_bf16_f32 v139, v30, v31
    v_cvt_pk_bf16_f32 v140, v44, v45
    v_cvt_pk_bf16_f32 v141, v46, v47
    v_cvt_pk_bf16_f32 v142, v60, v61
    v_cvt_pk_bf16_f32 v143, v62, v63
    s_call_b64 s[62:63], K1_sm16_16
    ds_write_b128 v247, v[112:115] offset:3072
    ds_write_b128 v247, v[116:119] offset:3088
    ds_write_b128 v247, v[120:123] offset:3104
    ds_write_b128 v247, v[124:127] offset:3120
    s_waitcnt lgkmcnt(0)
    s_barrier
    ds_read_b128 v[16:19], v232 offset:0
    ds_read_b64_tr_b16 v[20:21], v248 offset:0
    ds_read_b64_tr_b16 v[22:23], v248 offset:1024
    ds_read_b64_tr_b16 v[24:25], v248 offset:8
    ds_read_b64_tr_b16 v[26:27], v248 offset:1032
    ds_read_b128 v[28:31], v232 offset:4096
    ds_read_b64_tr_b16 v[32:33], v248 offset:2048
    ds_read_b64_tr_b16 v[34:35], v248 offset:3072
    ds_read_b64_tr_b16 v[36:37], v248 offset:2056
    ds_read_b64_tr_b16 v[38:39], v248 offset:3080
    ds_read_b128 v[40:43], v232 offset:8192
    ds_read_b64_tr_b16 v[44:45], v248 offset:4096
    ds_read_b64_tr_b16 v[46:47], v248 offset:5120
    ds_read_b64_tr_b16 v[48:49], v248 offset:4104
    ds_read_b64_tr_b16 v[50:51], v248 offset:5128
    s_waitcnt lgkmcnt(10)
    v_mfma_f32_16x16x32_bf16 v[0:3], v[20:23], v[16:19], 0
    v_mfma_f32_16x16x32_bf16 v[4:7], v[24:27], v[16:19], 0
    v_mfma_f32_16x16x32_bf16 v[8:11], v[20:23], v[252:255], 0
    v_mfma_f32_16x16x32_bf16 v[12:15], v[24:27], v[252:255], 0
    ds_read_b128 v[52:55], v232 offset:12288
    ds_read_b64_tr_b16 v[56:57], v248 offset:6144
    ds_read_b64_tr_b16 v[58:59], v248 offset:7168
    ds_read_b64_tr_b16 v[60:61], v248 offset:6152
    ds_read_b64_tr_b16 v[62:63], v248 offset:7176
    s_waitcnt lgkmcnt(10)
    v_mfma_f32_16x16x32_bf16 v[0:3], v[32:35], v[28:31], v[0:3]
    v_mfma_f32_16x16x32_bf16 v[4:7], v[36:39], v[28:31], v[4:7]
    v_mfma_f32_16x16x32_bf16 v[8:11], v[32:35], v[252:255], v[8:11]
    v_mfma_f32_16x16x32_bf16 v[12:15], v[36:39], v[252:255], v[12:15]
    ds_read_b128 v[64:67], v232 offset:16384
    ds_read_b64_tr_b16 v[68:69], v248 offset:8192
    ds_read_b64_tr_b16 v[70:71], v248 offset:9216
    ds_read_b64_tr_b16 v[72:73], v248 offset:8200
    ds_read_b64_tr_b16 v[74:75], v248 offset:9224
    s_waitcnt lgkmcnt(10)
    v_mfma_f32_16x16x32_bf16 v[0:3], v[44:47], v[40:43], v[0:3]
    v_mfma_f32_16x16x32_bf16 v[4:7], v[48:51], v[40:43], v[4:7]
    v_mfma_f32_16x16x32_bf16 v[8:11], v[44:47], v[252:255], v[8:11]
    v_mfma_f32_16x16x32_bf16 v[12:15], v[48:51], v[252:255], v[12:15]
    ds_read_b128 v[76:79], v232 offset:20480
    ds_read_b64_tr_b16 v[80:81], v248 offset:10240
    ds_read_b64_tr_b16 v[82:83], v248 offset:11264
    ds_read_b64_tr_b16 v[84:85], v248 offset:10248
    ds_read_b64_tr_b16 v[86:87], v248 offset:11272
    s_waitcnt lgkmcnt(10)
    v_mfma_f32_16x16x32_bf16 v[0:3], v[56:59], v[52:55], v[0:3]
    v_mfma_f32_16x16x32_bf16 v[4:7], v[60:63], v[52:55], v[4:7]
    v_mfma_f32_16x16x32_bf16 v[8:11], v[56:59], v[252:255], v[8:11]
    v_mfma_f32_16x16x32_bf16 v[12:15], v[60:63], v[252:255], v[12:15]
    ds_read_b128 v[88:91], v232 offset:24576
    ds_read_b64_tr_b16 v[92:93], v248 offset:12288
    ds_read_b64_tr_b16 v[94:95], v248 offset:13312
    ds_read_b64_tr_b16 v[96:97], v248 offset:12296
    ds_read_b64_tr_b16 v[98:99], v248 offset:13320
    s_waitcnt lgkmcnt(10)
    v_mfma_f32_16x16x32_bf16 v[0:3], v[68:71], v[64:67], v[0:3]
    v_mfma_f32_16x16x32_bf16 v[4:7], v[72:75], v[64:67], v[4:7]
    v_mfma_f32_16x16x32_bf16 v[8:11], v[68:71], v[252:255], v[8:11]
    v_mfma_f32_16x16x32_bf16 v[12:15], v[72:75], v[252:255], v[12:15]
    ds_read_b128 v[100:103], v232 offset:28672
    ds_read_b64_tr_b16 v[104:105], v248 offset:14336
    ds_read_b64_tr_b16 v[106:107], v248 offset:15360
    ds_read_b64_tr_b16 v[108:109], v248 offset:14344
    ds_read_b64_tr_b16 v[110:111], v248 offset:15368
    s_waitcnt lgkmcnt(10)
    v_mfma_f32_16x16x32_bf16 v[0:3], v[80:83], v[76:79], v[0:3]
    v_mfma_f32_16x16x32_bf16 v[4:7], v[84:87], v[76:79], v[4:7]
    v_mfma_f32_16x16x32_bf16 v[8:11], v[80:83], v[252:255], v[8:11]
    v_mfma_f32_16x16x32_bf16 v[12:15], v[84:87], v[252:255], v[12:15]
    s_waitcnt lgkmcnt(5)
    v_mfma_f32_16x16x32_bf16 v[0:3], v[92:95], v[88:91], v[0:3]
    v_mfma_f32_16x16x32_bf16 v[4:7], v[96:99], v[88:91], v[4:7]
    v_mfma_f32_16x16x32_bf16 v[8:11], v[92:95], v[252:255], v[8:11]
    v_mfma_f32_16x16x32_bf16 v[12:15], v[96:99], v[252:255], v[12:15]
    s_waitcnt lgkmcnt(0)
    v_mfma_f32_16x16x32_bf16 v[0:3], v[104:107], v[100:103], v[0:3]
    v_mfma_f32_16x16x32_bf16 v[4:7], v[108:111], v[100:103], v[4:7]
    v_mfma_f32_16x16x32_bf16 v[8:11], v[104:107], v[252:255], v[8:11]
    v_mfma_f32_16x16x32_bf16 v[12:15], v[108:111], v[252:255], v[12:15]
    s_lshl_b32 s26, s19, 2
    s_add_u32 s26, s26, s16
    s_lshl_b32 s26, s26, 3
    s_add_u32 s26, s26, s17
    s_mul_i32 s26, s26, 2304
    s_add_u32 s26, s26, 54525952
    v_and_b32 v241, 15, v240
    v_cmp_eq_u32 vcc, 0, v241
    buffer_store_dwordx4 v[0:3], v234, s[12:15], s26 offen sc1
    buffer_store_dwordx4 v[4:7], v234, s[12:15], s26 offen offset:1024 sc1
    s_mov_b64 exec, vcc
    buffer_store_dwordx4 v[8:11], v250, s[12:15], s26 offen offset:2048 sc1
    buffer_store_dwordx4 v[12:15], v250, s[12:15], s26 offen offset:2112 sc1
    s_mov_b64 exec, -1
    s_waitcnt vmcnt(15)
    s_barrier
    ds_read_b64_tr_b16 v[128:129], v222 offset:0
    ds_read_b64_tr_b16 v[130:131], v222 offset:512
    ds_read_b64_tr_b16 v[132:133], v223 offset:0
    ds_read_b64_tr_b16 v[134:135], v223 offset:512
    ds_read_b64_tr_b16 v[136:137], v224 offset:0
    ds_read_b64_tr_b16 v[138:139], v224 offset:512
    s_waitcnt lgkmcnt(2)
    v_mfma_f32_16x16x32_bf16 v[0:3], v[128:131], a[0:3], 0
    ds_read_b64_tr_b16 v[140:141], v225 offset:0
    ds_read_b64_tr_b16 v[142:143], v225 offset:512
    v_mfma_f32_16x16x32_bf16 v[4:7], v[128:131], a[4:7], 0
    v_mfma_f32_16x16x32_bf16 v[8:11], v[128:131], a[8:11], 0
    v_mfma_f32_16x16x32_bf16 v[12:15], v[128:131], a[12:15], 0
    v_mfma_f32_16x16x32_bf16 v[28:31], v[132:135], a[12:15], 0
    ds_read_b64_tr_b16 v[144:145], v222 offset:4096
    ds_read_b64_tr_b16 v[146:147], v222 offset:4608
    v_mfma_f32_16x16x32_bf16 v[24:27], v[132:135], a[8:11], 0
    v_mfma_f32_16x16x32_bf16 v[20:23], v[132:135], a[4:7], 0
    v_mfma_f32_16x16x32_bf16 v[16:19], v[132:135], a[0:3], 0
    s_waitcnt lgkmcnt(2)
    v_mfma_f32_16x16x32_bf16 v[32:35], v[136:139], a[0:3], 0
    ds_read_b64_tr_b16 v[148:149], v223 offset:4096
    ds_read_b64_tr_b16 v[150:151], v223 offset:4608
    v_mfma_f32_16x16x32_bf16 v[36:39], v[136:139], a[4:7], 0
    v_mfma_f32_16x16x32_bf16 v[40:43], v[136:139], a[8:11], 0
    v_mfma_f32_16x16x32_bf16 v[44:47], v[136:139], a[12:15], 0
    v_mfma_f32_16x16x32_bf16 v[60:63], v[140:143], a[12:15], 0
    ds_read_b64_tr_b16 v[152:153], v224 offset:4096
    ds_read_b64_tr_b16 v[154:155], v224 offset:4608
    v_mfma_f32_16x16x32_bf16 v[56:59], v[140:143], a[8:11], 0
    v_mfma_f32_16x16x32_bf16 v[52:55], v[140:143], a[4:7], 0
    v_mfma_f32_16x16x32_bf16 v[48:51], v[140:143], a[0:3], 0
    s_waitcnt lgkmcnt(2)
    v_mfma_f32_16x16x32_bf16 v[0:3], v[144:147], a[16:19], v[0:3]
    ds_read_b64_tr_b16 v[156:157], v225 offset:4096
    ds_read_b64_tr_b16 v[158:159], v225 offset:4608
    v_mfma_f32_16x16x32_bf16 v[4:7], v[144:147], a[20:23], v[4:7]
    v_mfma_f32_16x16x32_bf16 v[8:11], v[144:147], a[24:27], v[8:11]
    v_mfma_f32_16x16x32_bf16 v[12:15], v[144:147], a[28:31], v[12:15]
    v_mfma_f32_16x16x32_bf16 v[28:31], v[148:151], a[28:31], v[28:31]
    ds_read_b64_tr_b16 v[128:129], v222 offset:8192
    ds_read_b64_tr_b16 v[130:131], v222 offset:8704
    v_mfma_f32_16x16x32_bf16 v[24:27], v[148:151], a[24:27], v[24:27]
    v_mfma_f32_16x16x32_bf16 v[20:23], v[148:151], a[20:23], v[20:23]
    v_mfma_f32_16x16x32_bf16 v[16:19], v[148:151], a[16:19], v[16:19]
    s_waitcnt lgkmcnt(2)
    v_mfma_f32_16x16x32_bf16 v[32:35], v[152:155], a[16:19], v[32:35]
    ds_read_b64_tr_b16 v[132:133], v223 offset:8192
    ds_read_b64_tr_b16 v[134:135], v223 offset:8704
    v_mfma_f32_16x16x32_bf16 v[36:39], v[152:155], a[20:23], v[36:39]
    v_mfma_f32_16x16x32_bf16 v[40:43], v[152:155], a[24:27], v[40:43]
    v_mfma_f32_16x16x32_bf16 v[44:47], v[152:155], a[28:31], v[44:47]
    v_mfma_f32_16x16x32_bf16 v[60:63], v[156:159], a[28:31], v[60:63]
    ds_read_b64_tr_b16 v[136:137], v224 offset:8192
    ds_read_b64_tr_b16 v[138:139], v224 offset:8704
    v_mfma_f32_16x16x32_bf16 v[56:59], v[156:159], a[24:27], v[56:59]
    v_mfma_f32_16x16x32_bf16 v[52:55], v[156:159], a[20:23], v[52:55]
    v_mfma_f32_16x16x32_bf16 v[48:51], v[156:159], a[16:19], v[48:51]
    s_waitcnt lgkmcnt(2)
    v_mfma_f32_16x16x32_bf16 v[0:3], v[128:131], a[32:35], v[0:3]
    ds_read_b64_tr_b16 v[140:141], v225 offset:8192
    ds_read_b64_tr_b16 v[142:143], v225 offset:8704
    v_mfma_f32_16x16x32_bf16 v[4:7], v[128:131], a[36:39], v[4:7]
    v_mfma_f32_16x16x32_bf16 v[8:11], v[128:131], a[40:43], v[8:11]
    v_mfma_f32_16x16x32_bf16 v[12:15], v[128:131], a[44:47], v[12:15]
    v_mfma_f32_16x16x32_bf16 v[28:31], v[132:135], a[44:47], v[28:31]
    ds_read_b64_tr_b16 v[144:145], v222 offset:12288
    ds_read_b64_tr_b16 v[146:147], v222 offset:12800
    v_mfma_f32_16x16x32_bf16 v[24:27], v[132:135], a[40:43], v[24:27]
    v_mfma_f32_16x16x32_bf16 v[20:23], v[132:135], a[36:39], v[20:23]
    v_mfma_f32_16x16x32_bf16 v[16:19], v[132:135], a[32:35], v[16:19]
    s_waitcnt lgkmcnt(2)
    v_mfma_f32_16x16x32_bf16 v[32:35], v[136:139], a[32:35], v[32:35]
    ds_read_b64_tr_b16 v[148:149], v223 offset:12288
    ds_read_b64_tr_b16 v[150:151], v223 offset:12800
    v_mfma_f32_16x16x32_bf16 v[36:39], v[136:139], a[36:39], v[36:39]
    v_mfma_f32_16x16x32_bf16 v[40:43], v[136:139], a[40:43], v[40:43]
    v_mfma_f32_16x16x32_bf16 v[44:47], v[136:139], a[44:47], v[44:47]
    v_mfma_f32_16x16x32_bf16 v[60:63], v[140:143], a[44:47], v[60:63]
    ds_read_b64_tr_b16 v[152:153], v224 offset:12288
    ds_read_b64_tr_b16 v[154:155], v224 offset:12800
    v_mfma_f32_16x16x32_bf16 v[56:59], v[140:143], a[40:43], v[56:59]
    v_mfma_f32_16x16x32_bf16 v[52:55], v[140:143], a[36:39], v[52:55]
    v_mfma_f32_16x16x32_bf16 v[48:51], v[140:143], a[32:35], v[48:51]
    s_waitcnt lgkmcnt(2)
    v_mfma_f32_16x16x32_bf16 v[0:3], v[144:147], a[48:51], v[0:3]
    ds_read_b64_tr_b16 v[156:157], v225 offset:12288
    ds_read_b64_tr_b16 v[158:159], v225 offset:12800
    v_mfma_f32_16x16x32_bf16 v[4:7], v[144:147], a[52:55], v[4:7]
    v_mfma_f32_16x16x32_bf16 v[8:11], v[144:147], a[56:59], v[8:11]
    v_mfma_f32_16x16x32_bf16 v[12:15], v[144:147], a[60:63], v[12:15]
    v_mfma_f32_16x16x32_bf16 v[28:31], v[148:151], a[60:63], v[28:31]
    ds_read_b64_tr_b16 v[128:129], v222 offset:16384
    ds_read_b64_tr_b16 v[130:131], v222 offset:16896
    v_mfma_f32_16x16x32_bf16 v[24:27], v[148:151], a[56:59], v[24:27]
    v_mfma_f32_16x16x32_bf16 v[20:23], v[148:151], a[52:55], v[20:23]
    v_mfma_f32_16x16x32_bf16 v[16:19], v[148:151], a[48:51], v[16:19]
    s_waitcnt lgkmcnt(2)
    v_mfma_f32_16x16x32_bf16 v[32:35], v[152:155], a[48:51], v[32:35]
    ds_read_b64_tr_b16 v[132:133], v223 offset:16384
    ds_read_b64_tr_b16 v[134:135], v223 offset:16896
    v_mfma_f32_16x16x32_bf16 v[36:39], v[152:155], a[52:55], v[36:39]
    v_mfma_f32_16x16x32_bf16 v[40:43], v[152:155], a[56:59], v[40:43]
    v_mfma_f32_16x16x32_bf16 v[44:47], v[152:155], a[60:63], v[44:47]
    v_mfma_f32_16x16x32_bf16 v[60:63], v[156:159], a[60:63], v[60:63]
    ds_read_b64_tr_b16 v[136:137], v224 offset:16384
    ds_read_b64_tr_b16 v[138:139], v224 offset:16896
    v_mfma_f32_16x16x32_bf16 v[56:59], v[156:159], a[56:59], v[56:59]
    v_mfma_f32_16x16x32_bf16 v[52:55], v[156:159], a[52:55], v[52:55]
    v_mfma_f32_16x16x32_bf16 v[48:51], v[156:159], a[48:51], v[48:51]
    s_waitcnt lgkmcnt(2)
    v_mfma_f32_16x16x32_bf16 v[0:3], v[128:131], a[64:67], v[0:3]
    ds_read_b64_tr_b16 v[140:141], v225 offset:16384
    ds_read_b64_tr_b16 v[142:143], v225 offset:16896
    v_mfma_f32_16x16x32_bf16 v[4:7], v[128:131], a[68:71], v[4:7]
    v_mfma_f32_16x16x32_bf16 v[8:11], v[128:131], a[72:75], v[8:11]
    v_mfma_f32_16x16x32_bf16 v[12:15], v[128:131], a[76:79], v[12:15]
    v_mfma_f32_16x16x32_bf16 v[28:31], v[132:135], a[76:79], v[28:31]
    ds_read_b64_tr_b16 v[144:145], v222 offset:20480
    ds_read_b64_tr_b16 v[146:147], v222 offset:20992
    v_mfma_f32_16x16x32_bf16 v[24:27], v[132:135], a[72:75], v[24:27]
    v_mfma_f32_16x16x32_bf16 v[20:23], v[132:135], a[68:71], v[20:23]
    v_mfma_f32_16x16x32_bf16 v[16:19], v[132:135], a[64:67], v[16:19]
    s_waitcnt lgkmcnt(2)
    v_mfma_f32_16x16x32_bf16 v[32:35], v[136:139], a[64:67], v[32:35]
    ds_read_b64_tr_b16 v[148:149], v223 offset:20480
    ds_read_b64_tr_b16 v[150:151], v223 offset:20992
    v_mfma_f32_16x16x32_bf16 v[36:39], v[136:139], a[68:71], v[36:39]
    v_mfma_f32_16x16x32_bf16 v[40:43], v[136:139], a[72:75], v[40:43]
    v_mfma_f32_16x16x32_bf16 v[44:47], v[136:139], a[76:79], v[44:47]
    v_mfma_f32_16x16x32_bf16 v[60:63], v[140:143], a[76:79], v[60:63]
    ds_read_b64_tr_b16 v[152:153], v224 offset:20480
    ds_read_b64_tr_b16 v[154:155], v224 offset:20992
    v_mfma_f32_16x16x32_bf16 v[56:59], v[140:143], a[72:75], v[56:59]
    v_mfma_f32_16x16x32_bf16 v[52:55], v[140:143], a[68:71], v[52:55]
    v_mfma_f32_16x16x32_bf16 v[48:51], v[140:143], a[64:67], v[48:51]
    s_waitcnt lgkmcnt(2)
    v_mfma_f32_16x16x32_bf16 v[0:3], v[144:147], a[80:83], v[0:3]
    ds_read_b64_tr_b16 v[156:157], v225 offset:20480
    ds_read_b64_tr_b16 v[158:159], v225 offset:20992
    v_mfma_f32_16x16x32_bf16 v[4:7], v[144:147], a[84:87], v[4:7]
    v_mfma_f32_16x16x32_bf16 v[8:11], v[144:147], a[88:91], v[8:11]
    v_mfma_f32_16x16x32_bf16 v[12:15], v[144:147], a[92:95], v[12:15]
    v_mfma_f32_16x16x32_bf16 v[28:31], v[148:151], a[92:95], v[28:31]
    ds_read_b64_tr_b16 v[128:129], v222 offset:24576
    ds_read_b64_tr_b16 v[130:131], v222 offset:25088
    v_mfma_f32_16x16x32_bf16 v[24:27], v[148:151], a[88:91], v[24:27]
    v_mfma_f32_16x16x32_bf16 v[20:23], v[148:151], a[84:87], v[20:23]
    v_mfma_f32_16x16x32_bf16 v[16:19], v[148:151], a[80:83], v[16:19]
    s_waitcnt lgkmcnt(2)
    v_mfma_f32_16x16x32_bf16 v[32:35], v[152:155], a[80:83], v[32:35]
    ds_read_b64_tr_b16 v[132:133], v223 offset:24576
    ds_read_b64_tr_b16 v[134:135], v223 offset:25088
    v_mfma_f32_16x16x32_bf16 v[36:39], v[152:155], a[84:87], v[36:39]
    v_mfma_f32_16x16x32_bf16 v[40:43], v[152:155], a[88:91], v[40:43]
    v_mfma_f32_16x16x32_bf16 v[44:47], v[152:155], a[92:95], v[44:47]
    v_mfma_f32_16x16x32_bf16 v[60:63], v[156:159], a[92:95], v[60:63]
    ds_read_b64_tr_b16 v[136:137], v224 offset:24576
    ds_read_b64_tr_b16 v[138:139], v224 offset:25088
    v_mfma_f32_16x16x32_bf16 v[56:59], v[156:159], a[88:91], v[56:59]
    v_mfma_f32_16x16x32_bf16 v[52:55], v[156:159], a[84:87], v[52:55]
    v_mfma_f32_16x16x32_bf16 v[48:51], v[156:159], a[80:83], v[48:51]
    s_waitcnt lgkmcnt(2)
    v_mfma_f32_16x16x32_bf16 v[0:3], v[128:131], a[96:99], v[0:3]
    ds_read_b64_tr_b16 v[140:141], v225 offset:24576
    ds_read_b64_tr_b16 v[142:143], v225 offset:25088
    v_mfma_f32_16x16x32_bf16 v[4:7], v[128:131], a[100:103], v[4:7]
    v_mfma_f32_16x16x32_bf16 v[8:11], v[128:131], a[104:107], v[8:11]
    v_mfma_f32_16x16x32_bf16 v[12:15], v[128:131], a[108:111], v[12:15]
    v_mfma_f32_16x16x32_bf16 v[28:31], v[132:135], a[108:111], v[28:31]
    ds_read_b64_tr_b16 v[144:145], v222 offset:28672
    ds_read_b64_tr_b16 v[146:147], v222 offset:29184
    v_mfma_f32_16x16x32_bf16 v[24:27], v[132:135], a[104:107], v[24:27]
    v_mfma_f32_16x16x32_bf16 v[20:23], v[132:135], a[100:103], v[20:23]
    v_mfma_f32_16x16x32_bf16 v[16:19], v[132:135], a[96:99], v[16:19]
    s_waitcnt lgkmcnt(2)
    v_mfma_f32_16x16x32_bf16 v[32:35], v[136:139], a[96:99], v[32:35]
    ds_read_b64_tr_b16 v[148:149], v223 offset:28672
    ds_read_b64_tr_b16 v[150:151], v223 offset:29184
    v_mfma_f32_16x16x32_bf16 v[36:39], v[136:139], a[100:103], v[36:39]
    v_mfma_f32_16x16x32_bf16 v[40:43], v[136:139], a[104:107], v[40:43]
    v_mfma_f32_16x16x32_bf16 v[44:47], v[136:139], a[108:111], v[44:47]
    v_mfma_f32_16x16x32_bf16 v[60:63], v[140:143], a[108:111], v[60:63]
    ds_read_b64_tr_b16 v[152:153], v224 offset:28672
    ds_read_b64_tr_b16 v[154:155], v224 offset:29184
    v_mfma_f32_16x16x32_bf16 v[56:59], v[140:143], a[104:107], v[56:59]
    v_mfma_f32_16x16x32_bf16 v[52:55], v[140:143], a[100:103], v[52:55]
    v_mfma_f32_16x16x32_bf16 v[48:51], v[140:143], a[96:99], v[48:51]
    s_waitcnt lgkmcnt(2)
    v_mfma_f32_16x16x32_bf16 v[0:3], v[144:147], a[112:115], v[0:3]
    ds_read_b64_tr_b16 v[156:157], v225 offset:28672
    ds_read_b64_tr_b16 v[158:159], v225 offset:29184
    v_mfma_f32_16x16x32_bf16 v[4:7], v[144:147], a[116:119], v[4:7]
    v_mfma_f32_16x16x32_bf16 v[8:11], v[144:147], a[120:123], v[8:11]
    s_waitcnt vmcnt(7)
    s_barrier
    v_mfma_f32_16x16x32_bf16 v[12:15], v[144:147], a[124:127], v[12:15]
    v_mfma_f32_16x16x32_bf16 v[28:31], v[148:151], a[124:127], v[28:31]
    ds_read_b64_tr_b16 v[128:129], v222 offset:32768
    ds_read_b64_tr_b16 v[130:131], v222 offset:33280
    v_mfma_f32_16x16x32_bf16 v[24:27], v[148:151], a[120:123], v[24:27]
    v_mfma_f32_16x16x32_bf16 v[20:23], v[148:151], a[116:119], v[20:23]
    v_mfma_f32_16x16x32_bf16 v[16:19], v[148:151], a[112:115], v[16:19]
    s_waitcnt lgkmcnt(2)
    v_mfma_f32_16x16x32_bf16 v[32:35], v[152:155], a[112:115], v[32:35]
    ds_read_b64_tr_b16 v[132:133], v223 offset:32768
    ds_read_b64_tr_b16 v[134:135], v223 offset:33280
    v_mfma_f32_16x16x32_bf16 v[36:39], v[152:155], a[116:119], v[36:39]
    v_mfma_f32_16x16x32_bf16 v[40:43], v[152:155], a[120:123], v[40:43]
    v_mfma_f32_16x16x32_bf16 v[44:47], v[152:155], a[124:127], v[44:47]
    v_mfma_f32_16x16x32_bf16 v[60:63], v[156:159], a[124:127], v[60:63]
    ds_read_b64_tr_b16 v[136:137], v224 offset:32768
    ds_read_b64_tr_b16 v[138:139], v224 offset:33280
    v_mfma_f32_16x16x32_bf16 v[56:59], v[156:159], a[120:123], v[56:59]
    v_mfma_f32_16x16x32_bf16 v[52:55], v[156:159], a[116:119], v[52:55]
    v_mfma_f32_16x16x32_bf16 v[48:51], v[156:159], a[112:115], v[48:51]
    s_waitcnt lgkmcnt(2)
    v_mfma_f32_16x16x32_bf16 v[0:3], v[128:131], a[128:131], v[0:3]
    ds_read_b64_tr_b16 v[140:141], v225 offset:32768
    ds_read_b64_tr_b16 v[142:143], v225 offset:33280
    v_mfma_f32_16x16x32_bf16 v[4:7], v[128:131], a[132:135], v[4:7]
    v_mfma_f32_16x16x32_bf16 v[8:11], v[128:131], a[136:139], v[8:11]
    v_mfma_f32_16x16x32_bf16 v[12:15], v[128:131], a[140:143], v[12:15]
    v_mfma_f32_16x16x32_bf16 v[28:31], v[132:135], a[140:143], v[28:31]
    ds_read_b64_tr_b16 v[144:145], v222 offset:36864
    ds_read_b64_tr_b16 v[146:147], v222 offset:37376
    v_mfma_f32_16x16x32_bf16 v[24:27], v[132:135], a[136:139], v[24:27]
    v_mfma_f32_16x16x32_bf16 v[20:23], v[132:135], a[132:135], v[20:23]
    v_mfma_f32_16x16x32_bf16 v[16:19], v[132:135], a[128:131], v[16:19]
    s_waitcnt lgkmcnt(2)
    v_mfma_f32_16x16x32_bf16 v[32:35], v[136:139], a[128:131], v[32:35]
    ds_read_b64_tr_b16 v[148:149], v223 offset:36864
    ds_read_b64_tr_b16 v[150:151], v223 offset:37376
    v_mfma_f32_16x16x32_bf16 v[36:39], v[136:139], a[132:135], v[36:39]
    v_mfma_f32_16x16x32_bf16 v[40:43], v[136:139], a[136:139], v[40:43]
    v_mfma_f32_16x16x32_bf16 v[44:47], v[136:139], a[140:143], v[44:47]
    v_mfma_f32_16x16x32_bf16 v[60:63], v[140:143], a[140:143], v[60:63]
    ds_read_b64_tr_b16 v[152:153], v224 offset:36864
    ds_read_b64_tr_b16 v[154:155], v224 offset:37376
    v_mfma_f32_16x16x32_bf16 v[56:59], v[140:143], a[136:139], v[56:59]
    v_mfma_f32_16x16x32_bf16 v[52:55], v[140:143], a[132:135], v[52:55]
    v_mfma_f32_16x16x32_bf16 v[48:51], v[140:143], a[128:131], v[48:51]
    s_waitcnt lgkmcnt(2)
    v_mfma_f32_16x16x32_bf16 v[0:3], v[144:147], a[144:147], v[0:3]
    ds_read_b64_tr_b16 v[156:157], v225 offset:36864
    ds_read_b64_tr_b16 v[158:159], v225 offset:37376
    v_mfma_f32_16x16x32_bf16 v[4:7], v[144:147], a[148:151], v[4:7]
    v_mfma_f32_16x16x32_bf16 v[8:11], v[144:147], a[152:155], v[8:11]
    v_mfma_f32_16x16x32_bf16 v[12:15], v[144:147], a[156:159], v[12:15]
    v_mfma_f32_16x16x32_bf16 v[28:31], v[148:151], a[156:159], v[28:31]
    ds_read_b64_tr_b16 v[128:129], v222 offset:40960
    ds_read_b64_tr_b16 v[130:131], v222 offset:41472
    v_mfma_f32_16x16x32_bf16 v[24:27], v[148:151], a[152:155], v[24:27]
    v_mfma_f32_16x16x32_bf16 v[20:23], v[148:151], a[148:151], v[20:23]
    v_mfma_f32_16x16x32_bf16 v[16:19], v[148:151], a[144:147], v[16:19]
    s_waitcnt lgkmcnt(2)
    v_mfma_f32_16x16x32_bf16 v[32:35], v[152:155], a[144:147], v[32:35]
    ds_read_b64_tr_b16 v[132:133], v223 offset:40960
    ds_read_b64_tr_b16 v[134:135], v223 offset:41472
    v_mfma_f32_16x16x32_bf16 v[36:39], v[152:155], a[148:151], v[36:39]
    v_mfma_f32_16x16x32_bf16 v[40:43], v[152:155], a[152:155], v[40:43]
    v_mfma_f32_16x16x32_bf16 v[44:47], v[152:155], a[156:159], v[44:47]
    v_mfma_f32_16x16x32_bf16 v[60:63], v[156:159], a[156:159], v[60:63]
    ds_read_b64_tr_b16 v[136:137], v224 offset:40960
    ds_read_b64_tr_b16 v[138:139], v224 offset:41472
    v_mfma_f32_16x16x32_bf16 v[56:59], v[156:159], a[152:155], v[56:59]
    v_mfma_f32_16x16x32_bf16 v[52:55], v[156:159], a[148:151], v[52:55]
    v_mfma_f32_16x16x32_bf16 v[48:51], v[156:159], a[144:147], v[48:51]
    s_waitcnt lgkmcnt(2)
    v_mfma_f32_16x16x32_bf16 v[0:3], v[128:131], a[160:163], v[0:3]
    ds_read_b64_tr_b16 v[140:141], v225 offset:40960
    ds_read_b64_tr_b16 v[142:143], v225 offset:41472
    v_mfma_f32_16x16x32_bf16 v[4:7], v[128:131], a[164:167], v[4:7]
    v_mfma_f32_16x16x32_bf16 v[8:11], v[128:131], a[168:171], v[8:11]
    v_mfma_f32_16x16x32_bf16 v[12:15], v[128:131], a[172:175], v[12:15]
    v_mfma_f32_16x16x32_bf16 v[28:31], v[132:135], a[172:175], v[28:31]
    ds_read_b64_tr_b16 v[144:145], v222 offset:45056
    ds_read_b64_tr_b16 v[146:147], v222 offset:45568
    v_mfma_f32_16x16x32_bf16 v[24:27], v[132:135], a[168:171], v[24:27]
    v_mfma_f32_16x16x32_bf16 v[20:23], v[132:135], a[164:167], v[20:23]
    v_mfma_f32_16x16x32_bf16 v[16:19], v[132:135], a[160:163], v[16:19]
    s_waitcnt lgkmcnt(2)
    v_mfma_f32_16x16x32_bf16 v[32:35], v[136:139], a[160:163], v[32:35]
    ds_read_b64_tr_b16 v[148:149], v223 offset:45056
    ds_read_b64_tr_b16 v[150:151], v223 offset:45568
    v_mfma_f32_16x16x32_bf16 v[36:39], v[136:139], a[164:167], v[36:39]
    v_mfma_f32_16x16x32_bf16 v[40:43], v[136:139], a[168:171], v[40:43]
    v_mfma_f32_16x16x32_bf16 v[44:47], v[136:139], a[172:175], v[44:47]
    v_mfma_f32_16x16x32_bf16 v[60:63], v[140:143], a[172:175], v[60:63]
    ds_read_b64_tr_b16 v[152:153], v224 offset:45056
    ds_read_b64_tr_b16 v[154:155], v224 offset:45568
    v_mfma_f32_16x16x32_bf16 v[56:59], v[140:143], a[168:171], v[56:59]
    v_mfma_f32_16x16x32_bf16 v[52:55], v[140:143], a[164:167], v[52:55]
    v_mfma_f32_16x16x32_bf16 v[48:51], v[140:143], a[160:163], v[48:51]
    s_waitcnt lgkmcnt(2)
    v_mfma_f32_16x16x32_bf16 v[0:3], v[144:147], a[176:179], v[0:3]
    ds_read_b64_tr_b16 v[156:157], v225 offset:45056
    ds_read_b64_tr_b16 v[158:159], v225 offset:45568
    v_mfma_f32_16x16x32_bf16 v[4:7], v[144:147], a[180:183], v[4:7]
    v_mfma_f32_16x16x32_bf16 v[8:11], v[144:147], a[184:187], v[8:11]
    v_mfma_f32_16x16x32_bf16 v[12:15], v[144:147], a[188:191], v[12:15]
    v_mfma_f32_16x16x32_bf16 v[28:31], v[148:151], a[188:191], v[28:31]
    ds_read_b64_tr_b16 v[128:129], v222 offset:49152
    ds_read_b64_tr_b16 v[130:131], v222 offset:49664
    v_mfma_f32_16x16x32_bf16 v[24:27], v[148:151], a[184:187], v[24:27]
    v_mfma_f32_16x16x32_bf16 v[20:23], v[148:151], a[180:183], v[20:23]
    v_mfma_f32_16x16x32_bf16 v[16:19], v[148:151], a[176:179], v[16:19]
    s_waitcnt lgkmcnt(2)
    v_mfma_f32_16x16x32_bf16 v[32:35], v[152:155], a[176:179], v[32:35]
    ds_read_b64_tr_b16 v[132:133], v223 offset:49152
    ds_read_b64_tr_b16 v[134:135], v223 offset:49664
    v_mfma_f32_16x16x32_bf16 v[36:39], v[152:155], a[180:183], v[36:39]
    v_mfma_f32_16x16x32_bf16 v[40:43], v[152:155], a[184:187], v[40:43]
    v_mfma_f32_16x16x32_bf16 v[44:47], v[152:155], a[188:191], v[44:47]
    v_mfma_f32_16x16x32_bf16 v[60:63], v[156:159], a[188:191], v[60:63]
    ds_read_b64_tr_b16 v[136:137], v224 offset:49152
    ds_read_b64_tr_b16 v[138:139], v224 offset:49664
    v_mfma_f32_16x16x32_bf16 v[56:59], v[156:159], a[184:187], v[56:59]
    v_mfma_f32_16x16x32_bf16 v[52:55], v[156:159], a[180:183], v[52:55]
    v_mfma_f32_16x16x32_bf16 v[48:51], v[156:159], a[176:179], v[48:51]
    s_waitcnt lgkmcnt(2)
    v_mfma_f32_16x16x32_bf16 v[0:3], v[128:131], a[192:195], v[0:3]
    ds_read_b64_tr_b16 v[140:141], v225 offset:49152
    ds_read_b64_tr_b16 v[142:143], v225 offset:49664
    v_mfma_f32_16x16x32_bf16 v[4:7], v[128:131], a[196:199], v[4:7]
    v_mfma_f32_16x16x32_bf16 v[8:11], v[128:131], a[200:203], v[8:11]
    v_mfma_f32_16x16x32_bf16 v[12:15], v[128:131], a[204:207], v[12:15]
    v_mfma_f32_16x16x32_bf16 v[28:31], v[132:135], a[204:207], v[28:31]
    ds_read_b64_tr_b16 v[144:145], v222 offset:53248
    ds_read_b64_tr_b16 v[146:147], v222 offset:53760
    v_mfma_f32_16x16x32_bf16 v[24:27], v[132:135], a[200:203], v[24:27]
    v_mfma_f32_16x16x32_bf16 v[20:23], v[132:135], a[196:199], v[20:23]
    v_mfma_f32_16x16x32_bf16 v[16:19], v[132:135], a[192:195], v[16:19]
    s_waitcnt lgkmcnt(2)
    v_mfma_f32_16x16x32_bf16 v[32:35], v[136:139], a[192:195], v[32:35]
    ds_read_b64_tr_b16 v[148:149], v223 offset:53248
    ds_read_b64_tr_b16 v[150:151], v223 offset:53760
    v_mfma_f32_16x16x32_bf16 v[36:39], v[136:139], a[196:199], v[36:39]
    v_mfma_f32_16x16x32_bf16 v[40:43], v[136:139], a[200:203], v[40:43]
    v_mfma_f32_16x16x32_bf16 v[44:47], v[136:139], a[204:207], v[44:47]
    v_mfma_f32_16x16x32_bf16 v[60:63], v[140:143], a[204:207], v[60:63]
    ds_read_b64_tr_b16 v[152:153], v224 offset:53248
    ds_read_b64_tr_b16 v[154:155], v224 offset:53760
    v_mfma_f32_16x16x32_bf16 v[56:59], v[140:143], a[200:203], v[56:59]
    v_mfma_f32_16x16x32_bf16 v[52:55], v[140:143], a[196:199], v[52:55]
    v_mfma_f32_16x16x32_bf16 v[48:51], v[140:143], a[192:195], v[48:51]
    s_waitcnt lgkmcnt(2)
    v_mfma_f32_16x16x32_bf16 v[0:3], v[144:147], a[208:211], v[0:3]
    ds_read_b64_tr_b16 v[156:157], v225 offset:53248
    ds_read_b64_tr_b16 v[158:159], v225 offset:53760
    v_mfma_f32_16x16x32_bf16 v[4:7], v[144:147], a[212:215], v[4:7]
    v_mfma_f32_16x16x32_bf16 v[8:11], v[144:147], a[216:219], v[8:11]
    v_mfma_f32_16x16x32_bf16 v[12:15], v[144:147], a[220:223], v[12:15]
    v_mfma_f32_16x16x32_bf16 v[28:31], v[148:151], a[220:223], v[28:31]
    ds_read_b64_tr_b16 v[128:129], v222 offset:57344
    ds_read_b64_tr_b16 v[130:131], v222 offset:57856
    v_mfma_f32_16x16x32_bf16 v[24:27], v[148:151], a[216:219], v[24:27]
    v_mfma_f32_16x16x32_bf16 v[20:23], v[148:151], a[212:215], v[20:23]
    v_mfma_f32_16x16x32_bf16 v[16:19], v[148:151], a[208:211], v[16:19]
    s_waitcnt lgkmcnt(2)
    v_mfma_f32_16x16x32_bf16 v[32:35], v[152:155], a[208:211], v[32:35]
    ds_read_b64_tr_b16 v[132:133], v223 offset:57344
    ds_read_b64_tr_b16 v[134:135], v223 offset:57856
    v_mfma_f32_16x16x32_bf16 v[36:39], v[152:155], a[212:215], v[36:39]
    v_mfma_f32_16x16x32_bf16 v[40:43], v[152:155], a[216:219], v[40:43]
    v_mfma_f32_16x16x32_bf16 v[44:47], v[152:155], a[220:223], v[44:47]
    v_mfma_f32_16x16x32_bf16 v[60:63], v[156:159], a[220:223], v[60:63]
    ds_read_b64_tr_b16 v[136:137], v224 offset:57344
    ds_read_b64_tr_b16 v[138:139], v224 offset:57856
    v_mfma_f32_16x16x32_bf16 v[56:59], v[156:159], a[216:219], v[56:59]
    v_mfma_f32_16x16x32_bf16 v[52:55], v[156:159], a[212:215], v[52:55]
    v_mfma_f32_16x16x32_bf16 v[48:51], v[156:159], a[208:211], v[48:51]
    s_waitcnt lgkmcnt(2)
    v_mfma_f32_16x16x32_bf16 v[0:3], v[128:131], a[224:227], v[0:3]
    ds_read_b64_tr_b16 v[140:141], v225 offset:57344
    ds_read_b64_tr_b16 v[142:143], v225 offset:57856
    v_mfma_f32_16x16x32_bf16 v[4:7], v[128:131], a[228:231], v[4:7]
    v_mfma_f32_16x16x32_bf16 v[8:11], v[128:131], a[232:235], v[8:11]
    v_mfma_f32_16x16x32_bf16 v[12:15], v[128:131], a[236:239], v[12:15]
    v_mfma_f32_16x16x32_bf16 v[28:31], v[132:135], a[236:239], v[28:31]
    ds_read_b64_tr_b16 v[144:145], v222 offset:61440
    ds_read_b64_tr_b16 v[146:147], v222 offset:61952
    v_mfma_f32_16x16x32_bf16 v[24:27], v[132:135], a[232:235], v[24:27]
    v_mfma_f32_16x16x32_bf16 v[20:23], v[132:135], a[228:231], v[20:23]
    v_mfma_f32_16x16x32_bf16 v[16:19], v[132:135], a[224:227], v[16:19]
    s_waitcnt lgkmcnt(2)
    v_mfma_f32_16x16x32_bf16 v[32:35], v[136:139], a[224:227], v[32:35]
    ds_read_b64_tr_b16 v[148:149], v223 offset:61440
    ds_read_b64_tr_b16 v[150:151], v223 offset:61952
    v_mfma_f32_16x16x32_bf16 v[36:39], v[136:139], a[228:231], v[36:39]
    v_mfma_f32_16x16x32_bf16 v[40:43], v[136:139], a[232:235], v[40:43]
    v_mfma_f32_16x16x32_bf16 v[44:47], v[136:139], a[236:239], v[44:47]
    v_mfma_f32_16x16x32_bf16 v[60:63], v[140:143], a[236:239], v[60:63]
    ds_read_b64_tr_b16 v[152:153], v224 offset:61440
    ds_read_b64_tr_b16 v[154:155], v224 offset:61952
    v_mfma_f32_16x16x32_bf16 v[56:59], v[140:143], a[232:235], v[56:59]
    v_mfma_f32_16x16x32_bf16 v[52:55], v[140:143], a[228:231], v[52:55]
    v_mfma_f32_16x16x32_bf16 v[48:51], v[140:143], a[224:227], v[48:51]
    s_waitcnt lgkmcnt(2)
    v_mfma_f32_16x16x32_bf16 v[0:3], v[144:147], a[240:243], v[0:3]
    ds_read_b64_tr_b16 v[156:157], v225 offset:61440
    ds_read_b64_tr_b16 v[158:159], v225 offset:61952
    v_mfma_f32_16x16x32_bf16 v[4:7], v[144:147], a[244:247], v[4:7]
    v_mfma_f32_16x16x32_bf16 v[8:11], v[144:147], a[248:251], v[8:11]
    v_mfma_f32_16x16x32_bf16 v[12:15], v[144:147], a[252:255], v[12:15]
    v_mfma_f32_16x16x32_bf16 v[28:31], v[148:151], a[252:255], v[28:31]
    v_mfma_f32_16x16x32_bf16 v[24:27], v[148:151], a[248:251], v[24:27]
    v_mfma_f32_16x16x32_bf16 v[20:23], v[148:151], a[244:247], v[20:23]
    v_mfma_f32_16x16x32_bf16 v[16:19], v[148:151], a[240:243], v[16:19]
    s_waitcnt lgkmcnt(0)
    v_mfma_f32_16x16x32_bf16 v[32:35], v[152:155], a[240:243], v[32:35]
    v_mfma_f32_16x16x32_bf16 v[36:39], v[152:155], a[244:247], v[36:39]
    v_mfma_f32_16x16x32_bf16 v[40:43], v[152:155], a[248:251], v[40:43]
    v_mfma_f32_16x16x32_bf16 v[44:47], v[152:155], a[252:255], v[44:47]
    v_mfma_f32_16x16x32_bf16 v[60:63], v[156:159], a[252:255], v[60:63]
    v_mfma_f32_16x16x32_bf16 v[56:59], v[156:159], a[248:251], v[56:59]
    v_mfma_f32_16x16x32_bf16 v[52:55], v[156:159], a[244:247], v[52:55]
    v_mfma_f32_16x16x32_bf16 v[48:51], v[156:159], a[240:243], v[48:51]
    s_lshl_b32 s26, s19, 19
    s_lshr_b32 s27, s32, 2
    s_add_u32 s26, s26, s27
    s_add_u32 s26, s26, 55574528
    s_nop 3
    v_cvt_pk_bf16_f32 v136, v0, v1
    v_cvt_pk_bf16_f32 v137, v2, v3
    v_cvt_pk_bf16_f32 v138, v16, v17
    v_cvt_pk_bf16_f32 v139, v18, v19
    v_cvt_pk_bf16_f32 v140, v32, v33
    v_cvt_pk_bf16_f32 v141, v34, v35
    v_cvt_pk_bf16_f32 v142, v48, v49
    v_cvt_pk_bf16_f32 v143, v50, v51
    s_nop 1
    v_mfma_f32_16x16x32_bf16 v[64:67], v[160:163], v[136:139], 0
    v_mfma_f32_16x16x32_bf16 v[68:71], v[168:171], v[136:139], 0
    v_mfma_f32_16x16x32_bf16 v[72:75], v[176:179], v[136:139], 0
    v_mfma_f32_16x16x32_bf16 v[76:79], v[184:187], v[136:139], 0
    v_mfma_f32_16x16x32_bf16 v[64:67], v[164:167], v[140:143], v[64:67]
    v_mfma_f32_16x16x32_bf16 v[68:71], v[172:175], v[140:143], v[68:71]
    v_mfma_f32_16x16x32_bf16 v[72:75], v[180:183], v[140:143], v[72:75]
    v_mfma_f32_16x16x32_bf16 v[76:79], v[188:191], v[140:143], v[76:79]
    v_cvt_pk_bf16_f32 v136, v4, v5
    v_cvt_pk_bf16_f32 v137, v6, v7
    v_cvt_pk_bf16_f32 v138, v20, v21
    v_cvt_pk_bf16_f32 v139, v22, v23
    v_cvt_pk_bf16_f32 v140, v36, v37
    v_cvt_pk_bf16_f32 v141, v38, v39
    v_cvt_pk_bf16_f32 v142, v52, v53
    v_cvt_pk_bf16_f32 v143, v54, v55
    s_call_b64 s[62:63], K1_sm16_16
    buffer_store_dwordx4 v[112:115], v230, s[12:15], s26 offen offset:0 sc1
    buffer_store_dwordx4 v[116:119], v230, s[12:15], s26 offen offset:256 sc1
    buffer_store_dwordx4 v[120:123], v230, s[12:15], s26 offen offset:512 sc1
    buffer_store_dwordx4 v[124:127], v230, s[12:15], s26 offen offset:768 sc1
    v_cvt_pk_bf16_f32 v136, v8, v9
    v_cvt_pk_bf16_f32 v137, v10, v11
    v_cvt_pk_bf16_f32 v138, v24, v25
    v_cvt_pk_bf16_f32 v139, v26, v27
    v_cvt_pk_bf16_f32 v140, v40, v41
    v_cvt_pk_bf16_f32 v141, v42, v43
    v_cvt_pk_bf16_f32 v142, v56, v57
    v_cvt_pk_bf16_f32 v143, v58, v59
    s_call_b64 s[62:63], K1_sm16_16
    buffer_store_dwordx4 v[112:115], v230, s[12:15], s26 offen offset:1024 sc1
    buffer_store_dwordx4 v[116:119], v230, s[12:15], s26 offen offset:1280 sc1
    buffer_store_dwordx4 v[120:123], v230, s[12:15], s26 offen offset:1536 sc1
    buffer_store_dwordx4 v[124:127], v230, s[12:15], s26 offen offset:1792 sc1
    v_cvt_pk_bf16_f32 v136, v12, v13
    v_cvt_pk_bf16_f32 v137, v14, v15
    v_cvt_pk_bf16_f32 v138, v28, v29
    v_cvt_pk_bf16_f32 v139, v30, v31
    v_cvt_pk_bf16_f32 v140, v44, v45
    v_cvt_pk_bf16_f32 v141, v46, v47
    v_cvt_pk_bf16_f32 v142, v60, v61
    v_cvt_pk_bf16_f32 v143, v62, v63
    s_call_b64 s[62:63], K1_sm16_16
    buffer_store_dwordx4 v[112:115], v230, s[12:15], s26 offen offset:2048 sc1
    buffer_store_dwordx4 v[116:119], v230, s[12:15], s26 offen offset:2304 sc1
    buffer_store_dwordx4 v[120:123], v230, s[12:15], s26 offen offset:2560 sc1
    buffer_store_dwordx4 v[124:127], v230, s[12:15], s26 offen offset:2816 sc1
    v_cvt_pk_bf16_f32 v136, v12, v13
    v_cvt_pk_bf16_f32 v137, v14, v15
    v_cvt_pk_bf16_f32 v138, v28, v29
    v_cvt_pk_bf16_f32 v139, v30, v31
    v_cvt_pk_bf16_f32 v140, v44, v45
    v_cvt_pk_bf16_f32 v141, v46, v47
    v_cvt_pk_bf16_f32 v142, v60, v61
    v_cvt_pk_bf16_f32 v143, v62, v63
    s_call_b64 s[62:63], K1_sm16_16
    buffer_store_dwordx4 v[112:115], v230, s[12:15], s26 offen offset:3072 sc1
    buffer_store_dwordx4 v[116:119], v230, s[12:15], s26 offen offset:3328 sc1
    buffer_store_dwordx4 v[120:123], v230, s[12:15], s26 offen offset:3584 sc1
    buffer_store_dwordx4 v[124:127], v230, s[12:15], s26 offen offset:3840 sc1
    s_branch K2_fused_entry
K1_end_1:
    s_endpgm
K1_sm16_16:
    v_max3_f32 v128, v64, v65, v66
    v_min3_f32 v129, v64, v65, v66
    v_max3_f32 v128, v128, v67, v68
    v_min3_f32 v129, v129, v67, v68
    v_max3_f32 v128, v128, v69, v70
    v_min3_f32 v129, v129, v69, v70
    v_max3_f32 v128, v128, v71, v72
    v_min3_f32 v129, v129, v71, v72
    v_max3_f32 v128, v128, v73, v74
    v_min3_f32 v129, v129, v73, v74
    v_max3_f32 v128, v128, v75, v76
    v_min3_f32 v129, v129, v75, v76
    v_max3_f32 v128, v128, v77, v78
    v_min3_f32 v129, v129, v77, v78
    v_max_f32 v128, v128, v79
    v_min_f32 v129, v129, v79
    v_pk_mul_f32 v[128:129], v[128:129], s[60:61] op_sel_hi:[1,0]
    v_pk_fma_f32 v[80:81], v[64:65], s[60:61], v[128:129] op_sel_hi:[1,0,0] neg_lo:[0,0,1] neg_hi:[0,0,1]
    v_pk_fma_f32 v[96:97], v[64:65], s[60:61], v[128:129] op_sel:[0,0,1] op_sel_hi:[1,0,1] neg_lo:[1,0,0] neg_hi:[1,0,0]
    v_pk_fma_f32 v[82:83], v[66:67], s[60:61], v[128:129] op_sel_hi:[1,0,0] neg_lo:[0,0,1] neg_hi:[0,0,1]
    v_pk_fma_f32 v[98:99], v[66:67], s[60:61], v[128:129] op_sel:[0,0,1] op_sel_hi:[1,0,1] neg_lo:[1,0,0] neg_hi:[1,0,0]
    v_pk_fma_f32 v[84:85], v[68:69], s[60:61], v[128:129] op_sel_hi:[1,0,0] neg_lo:[0,0,1] neg_hi:[0,0,1]
    v_pk_fma_f32 v[100:101], v[68:69], s[60:61], v[128:129] op_sel:[0,0,1] op_sel_hi:[1,0,1] neg_lo:[1,0,0] neg_hi:[1,0,0]
    v_pk_fma_f32 v[86:87], v[70:71], s[60:61], v[128:129] op_sel_hi:[1,0,0] neg_lo:[0,0,1] neg_hi:[0,0,1]
    v_pk_fma_f32 v[102:103], v[70:71], s[60:61], v[128:129] op_sel:[0,0,1] op_sel_hi:[1,0,1] neg_lo:[1,0,0] neg_hi:[1,0,0]
    v_pk_fma_f32 v[88:89], v[72:73], s[60:61], v[128:129] op_sel_hi:[1,0,0] neg_lo:[0,0,1] neg_hi:[0,0,1]
    v_pk_fma_f32 v[104:105], v[72:73], s[60:61], v[128:129] op_sel:[0,0,1] op_sel_hi:[1,0,1] neg_lo:[1,0,0] neg_hi:[1,0,0]
    v_pk_fma_f32 v[90:91], v[74:75], s[60:61], v[128:129] op_sel_hi:[1,0,0] neg_lo:[0,0,1] neg_hi:[0,0,1]
    v_pk_fma_f32 v[106:107], v[74:75], s[60:61], v[128:129] op_sel:[0,0,1] op_sel_hi:[1,0,1] neg_lo:[1,0,0] neg_hi:[1,0,0]
    v_pk_fma_f32 v[92:93], v[76:77], s[60:61], v[128:129] op_sel_hi:[1,0,0] neg_lo:[0,0,1] neg_hi:[0,0,1]
    v_pk_fma_f32 v[108:109], v[76:77], s[60:61], v[128:129] op_sel:[0,0,1] op_sel_hi:[1,0,1] neg_lo:[1,0,0] neg_hi:[1,0,0]
    v_pk_fma_f32 v[94:95], v[78:79], s[60:61], v[128:129] op_sel_hi:[1,0,0] neg_lo:[0,0,1] neg_hi:[0,0,1]
    v_pk_fma_f32 v[110:111], v[78:79], s[60:61], v[128:129] op_sel:[0,0,1] op_sel_hi:[1,0,1] neg_lo:[1,0,0] neg_hi:[1,0,0]
    v_mfma_f32_16x16x32_bf16 v[64:67], v[160:163], v[136:139], 0
    v_exp_f32 v80, v80
    v_exp_f32 v96, v96
    v_exp_f32 v81, v81
    v_exp_f32 v97, v97
    v_mfma_f32_16x16x32_bf16 v[68:71], v[168:171], v[136:139], 0
    v_exp_f32 v82, v82
    v_exp_f32 v98, v98
    v_exp_f32 v83, v83
    v_exp_f32 v99, v99
    v_mfma_f32_16x16x32_bf16 v[72:75], v[176:179], v[136:139], 0
    v_exp_f32 v84, v84
    v_exp_f32 v100, v100
    v_exp_f32 v85, v85
    v_exp_f32 v101, v101
    v_mfma_f32_16x16x32_bf16 v[76:79], v[184:187], v[136:139], 0
    v_exp_f32 v86, v86
    v_exp_f32 v102, v102
    v_exp_f32 v87, v87
    v_exp_f32 v103, v103
    v_mfma_f32_16x16x32_bf16 v[64:67], v[164:167], v[140:143], v[64:67]
    v_exp_f32 v88, v88
    v_exp_f32 v104, v104
    v_exp_f32 v89, v89
    v_exp_f32 v105, v105
    v_mfma_f32_16x16x32_bf16 v[68:71], v[172:175], v[140:143], v[68:71]
    v_exp_f32 v90, v90
    v_exp_f32 v106, v106
    v_exp_f32 v91, v91
    v_exp_f32 v107, v107
    v_mfma_f32_16x16x32_bf16 v[72:75], v[180:183], v[140:143], v[72:75]
    v_exp_f32 v92, v92
    v_exp_f32 v108, v108
    v_exp_f32 v93, v93
    v_exp_f32 v109, v109
    v_mfma_f32_16x16x32_bf16 v[76:79], v[188:191], v[140:143], v[76:79]
    v_exp_f32 v94, v94
    v_exp_f32 v110, v110
    v_exp_f32 v95, v95
    v_exp_f32 v111, v111
    v_pk_add_f32 v[130:131], v[80:81], v[82:83]
    v_pk_add_f32 v[132:133], v[96:97], v[98:99]
    v_pk_add_f32 v[130:131], v[130:131], v[84:85]
    v_pk_add_f32 v[132:133], v[132:133], v[100:101]
    v_pk_add_f32 v[130:131], v[130:131], v[86:87]
    v_pk_add_f32 v[132:133], v[132:133], v[102:103]
    v_pk_add_f32 v[130:131], v[130:131], v[88:89]
    v_pk_add_f32 v[132:133], v[132:133], v[104:105]
    v_pk_add_f32 v[130:131], v[130:131], v[90:91]
    v_pk_add_f32 v[132:133], v[132:133], v[106:107]
    v_pk_add_f32 v[130:131], v[130:131], v[92:93]
    v_pk_add_f32 v[132:133], v[132:133], v[108:109]
    v_pk_add_f32 v[130:131], v[130:131], v[94:95]
    v_pk_add_f32 v[132:133], v[132:133], v[110:111]
    v_add_f32 v130, v130, v131
    v_add_f32 v132, v132, v133
    v_rcp_f32 v130, v130
    v_rcp_f32 v132, v132
    s_nop 0
    v_pk_mul_f32 v[80:81], v[80:81], v[130:131] op_sel_hi:[1,0]
    v_pk_mul_f32 v[96:97], v[96:97], v[132:133] op_sel_hi:[1,0]
    v_pk_mul_f32 v[82:83], v[82:83], v[130:131] op_sel_hi:[1,0]
    v_pk_mul_f32 v[98:99], v[98:99], v[132:133] op_sel_hi:[1,0]
    v_pk_mul_f32 v[84:85], v[84:85], v[130:131] op_sel_hi:[1,0]
    v_pk_mul_f32 v[100:101], v[100:101], v[132:133] op_sel_hi:[1,0]
    v_pk_mul_f32 v[86:87], v[86:87], v[130:131] op_sel_hi:[1,0]
    v_pk_mul_f32 v[102:103], v[102:103], v[132:133] op_sel_hi:[1,0]
    v_pk_mul_f32 v[88:89], v[88:89], v[130:131] op_sel_hi:[1,0]
    v_pk_mul_f32 v[104:105], v[104:105], v[132:133] op_sel_hi:[1,0]
    v_pk_mul_f32 v[90:91], v[90:91], v[130:131] op_sel_hi:[1,0]
    v_pk_mul_f32 v[106:107], v[106:107], v[132:133] op_sel_hi:[1,0]
    v_pk_mul_f32 v[92:93], v[92:93], v[130:131] op_sel_hi:[1,0]
    v_pk_mul_f32 v[108:109], v[108:109], v[132:133] op_sel_hi:[1,0]
    v_pk_mul_f32 v[94:95], v[94:95], v[130:131] op_sel_hi:[1,0]
    v_pk_mul_f32 v[110:111], v[110:111], v[132:133] op_sel_hi:[1,0]
    v_cvt_pk_bf16_f32 v112, v80, v81
    v_cvt_pk_bf16_f32 v114, v96, v97
    v_cvt_pk_bf16_f32 v113, v82, v83
    v_cvt_pk_bf16_f32 v115, v98, v99
    v_cvt_pk_bf16_f32 v116, v84, v85
    v_cvt_pk_bf16_f32 v118, v100, v101
    v_cvt_pk_bf16_f32 v117, v86, v87
    v_cvt_pk_bf16_f32 v119, v102, v103
    v_cvt_pk_bf16_f32 v120, v88, v89
    v_cvt_pk_bf16_f32 v122, v104, v105
    v_cvt_pk_bf16_f32 v121, v90, v91
    v_cvt_pk_bf16_f32 v123, v106, v107
    v_cvt_pk_bf16_f32 v124, v92, v93
    v_cvt_pk_bf16_f32 v126, v108, v109
    v_cvt_pk_bf16_f32 v125, v94, v95
    v_cvt_pk_bf16_f32 v127, v110, v111
    s_setpc_b64 s[62:63]
K1_code_end:
K2_fused_entry:
    v_mov_b32 v215, v240
    s_load_dwordx2 s[56:57], s[0:1], 0
    s_load_dwordx2 s[58:59], s[0:1], 16
    s_load_dwordx2 s[60:61], s[0:1], 96
    s_load_dwordx2 s[88:89], s[0:1], 40
    s_load_dwordx2 s[92:93], s[0:1], 72
    s_load_dwordx2 s[52:53], s[0:1], 88
    s_lshr_b32 s23, s2, 3
    s_and_b32 s18, s23, 7
    s_lshr_b32 s23, s23, 3
    s_and_b32 s17, s2, 7
    s_lshl_b32 s17, s17, 2
    s_add_u32 s17, s17, s23
    s_mov_b32 s19, 8192
    s_mov_b32 s29, 32768
    s_mov_b32 s30, 4096
    s_lshl_b32 s46, s23, 1
    s_add_u32 s46, s46, s18
    s_and_b32 s46, s46, 0
    s_lshl_b32 s46, s46, 7
    s_sub_u32 s46, s46, 128
    s_sub_u32 s22, 15, s18
    s_lshl_b32 s36, s22, 2
    s_add_u32 s36, s36, s16
    s_lshl_b32 s37, s18, 2
    s_add_u32 s37, s37, s16
    s_lshl_b32 s20, s36, 15
    s_lshl_b32 s21, s37, 15
    s_lshl_b32 s26, s16, 14
    s_add_u32 s26, s26, 98304
    s_lshl_b32 s43, s16, 12
    s_add_u32 s27, s43, 0
    s_lshl_b32 s47, s16, 17
    s_lshl_b32 s22, s17, 8
    s_add_u32 s47, s47, s22
    s_lshl_b32 s31, s17, 19
    s_add_u32 s31, s31, s43
    s_add_u32 s32, s31, 18874368
    s_mov_b32 s6, 0x200000
    s_mov_b32 s7, 0x20000
    s_mov_b32 s10, 0x400000
    s_mov_b32 s11, 0x20000
    s_mov_b32 s14, 83886080
    s_mov_b32 s15, 0x20000
    v_lshrrev_b32 v216, 3, v215
    v_lshlrev_b32 v216, 10, v216
    v_and_b32 v217, 7, v215
    v_lshrrev_b32 v235, 4, v215
    v_xor_b32 v217, v217, v235
    v_lshl_add_u32 v202, v217, 4, v216
    v_xor_b32 v203, 64, v202
    v_add_u32 v203, 7168, v203
    v_add_u32 v204, 14336, v202
    v_add_u32 v205, 14336, v203
    v_mul_lo_u32 v216, v235, s19
    v_and_b32 v217, 15, v215
    v_lshlrev_b32 v235, 1, v235
    v_xor_b32 v217, v217, v235
    v_lshl_add_u32 v206, v217, 4, v216
    v_xor_b32 v235, 8, v217
    v_lshl_add_u32 v208, v235, 4, v216
    s_sub_u32 s24, s29, 1024
    v_add_u32 v207, s24, v206
    v_add_u32 v208, s24, v208
    v_add_u32 v208, s24, v208
    v_add_u32 v209, s24, v208
    s_waitcnt lgkmcnt(0)
    s_mov_b32 s4, s56
    s_mov_b32 s5, s57
    s_mov_b32 s8, s58
    s_mov_b32 s9, s59
    s_mov_b32 s12, s60
    s_mov_b32 s13, s61
    s_mov_b32 s54, 256
    s_mov_b32 s55, 0x20000
    s_add_u32 s51, s99, 60325888
    s_cmp_eq_u32 s16, 0
    s_cselect_b32 s62, 256, 0
    s_cselect_b32 s50, 60325888, s14
    s_cselect_b32 s22, 1, 0
    v_mov_b32 v221, s22
    v_mov_b32 v216, 0
    buffer_load_dword v235, v216, s[52:55], s43 offen sc1
    s_barrier
    s_add_u32 s46, s46, 128
    s_and_b32 s46, s46, 0x3ff
    s_mul_i32 s28, s46, s30
    s_add_u32 m0, s27, 0
    s_add_u32 s28, s28, s47
    buffer_load_dwordx4 v206, s[8:11], s28 offen offset:0 lds
    buffer_load_dwordx4 v207, s[8:11], s28 offen offset:1024 lds
    buffer_load_dwordx4 v208, s[8:11], s28 offen offset:2048 lds
    buffer_load_dwordx4 v209, s[8:11], s28 offen offset:3072 lds
    s_add_u32 m0, s26, 0
    s_add_u32 s24, s20, s46
    buffer_load_dwordx4 v202, s[4:7], s24 offen offset:0 lds
    buffer_load_dwordx4 v203, s[4:7], s24 offen offset:1024 lds
    buffer_load_dwordx4 v204, s[4:7], s24 offen offset:2048 lds
    buffer_load_dwordx4 v205, s[4:7], s24 offen offset:3072 lds
    s_add_u32 m0, s26, 4096
    s_add_u32 s24, s21, s46
    buffer_load_dwordx4 v202, s[4:7], s24 offen offset:0 lds
    buffer_load_dwordx4 v203, s[4:7], s24 offen offset:1024 lds
    buffer_load_dwordx4 v204, s[4:7], s24 offen offset:2048 lds
    buffer_load_dwordx4 v205, s[4:7], s24 offen offset:3072 lds
    v_lshrrev_b32 v216, 4, v215
    v_bfe_u32 v217, v215, 2, 2
    v_lshl_add_u32 v222, v216, 3, v217
    v_lshlrev_b32 v222, 8, v222
    v_and_b32 v216, 1, v216
    v_lshl_add_u32 v217, v216, 2, v217
    v_and_b32 v216, 3, v215
    v_lshl_add_u32 v222, v216, 3, v222
    v_xor_b32 v216, 0, v217
    v_lshl_add_u32 v192, v216, 5, v222
    v_xor_b32 v216, 1, v217
    v_lshl_add_u32 v193, v216, 5, v222
    v_xor_b32 v216, 2, v217
    v_lshl_add_u32 v194, v216, 5, v222
    v_xor_b32 v216, 3, v217
    v_lshl_add_u32 v195, v216, 5, v222
    v_xor_b32 v216, 4, v217
    v_lshl_add_u32 v196, v216, 5, v222
    v_xor_b32 v216, 5, v217
    v_lshl_add_u32 v197, v216, 5, v222
    v_xor_b32 v216, 6, v217
    v_lshl_add_u32 v198, v216, 5, v222
    v_xor_b32 v216, 7, v217
    v_lshl_add_u32 v199, v216, 5, v222
    v_and_b32 v216, 15, v215
    v_lshlrev_b32 v216, 7, v216
    v_add_u32 v216, s26, v216
    v_bfe_u32 v217, v215, 1, 3
    v_lshrrev_b32 v222, 4, v215
    v_xor_b32 v217, v217, v222
    v_lshl_add_u32 v200, v217, 4, v216
    v_xor_b32 v217, 4, v217
    v_lshl_add_u32 v201, v217, 4, v216
    s_lshr_b32 s22, s17, 3
    s_mul_i32 s22, s22, 24
    v_min_u32 v216, 55, v215
    v_add_u32 v220, s22, v216
    v_add_u32 v217, 72, v220
    v_cmp_le_u32 vcc, 24, v216
    s_lshr_b32 s22, s17, 2
    s_lshl_b32 s22, s22, 3
    s_add_u32 s22, s22, 144
    v_cndmask_b32 v220, v220, v217, vcc
    v_add_u32 v217, s22, v216
    v_cmp_le_u32 vcc, 48, v216
    s_nop 1
    v_cndmask_b32 v220, v220, v217, vcc
    v_lshlrev_b32 v220, 7, v220
    v_mov_b32 v236, 0
    v_mov_b32 v237, 0
    v_mov_b32 v238, 0
    v_mov_b32 v239, 0
    s_nop 1
    v_mfma_f32_32x32x16_bf16 a[0:15], v[236:239], v[236:239], 0
    v_mfma_f32_32x32x16_bf16 a[16:31], v[236:239], v[236:239], 0
    v_mfma_f32_32x32x16_bf16 a[32:47], v[236:239], v[236:239], 0
    v_mfma_f32_32x32x16_bf16 a[48:63], v[236:239], v[236:239], 0
    v_mfma_f32_32x32x16_bf16 a[64:79], v[236:239], v[236:239], 0
    v_mfma_f32_32x32x16_bf16 a[80:95], v[236:239], v[236:239], 0
    v_mfma_f32_32x32x16_bf16 a[96:111], v[236:239], v[236:239], 0
    v_mfma_f32_32x32x16_bf16 a[112:127], v[236:239], v[236:239], 0
    v_mfma_f32_32x32x16_bf16 a[192:207], v[236:239], v[236:239], 0
    s_add_u32 s46, s46, 128
    s_and_b32 s46, s46, 0x3ff
    s_mul_i32 s28, s46, s30
    s_add_u32 m0, s27, 16384
    s_add_u32 s28, s28, s47
    buffer_load_dwordx4 v206, s[8:11], s28 offen offset:0 lds
    buffer_load_dwordx4 v207, s[8:11], s28 offen offset:1024 lds
    buffer_load_dwordx4 v208, s[8:11], s28 offen offset:2048 lds
    buffer_load_dwordx4 v209, s[8:11], s28 offen offset:3072 lds
    s_waitcnt vmcnt(4)
    s_barrier
    ds_read_b128 a[128:131], v200 offset:0
    ds_read_b128 a[132:135], v200 offset:2048
    ds_read_b128 a[136:139], v200 offset:4096
    ds_read_b128 a[140:143], v200 offset:6144
    ds_read_b64_tr_b16 v[0:1], v192 offset:0
    ds_read_b64_tr_b16 v[2:3], v192 offset:1024
    ds_read_b64_tr_b16 v[4:5], v193 offset:0
    ds_read_b64_tr_b16 v[6:7], v193 offset:1024
    ds_read_b64_tr_b16 v[8:9], v194 offset:0
    ds_read_b64_tr_b16 v[10:11], v194 offset:1024
    ds_read_b64_tr_b16 v[12:13], v195 offset:0
    ds_read_b64_tr_b16 v[14:15], v195 offset:1024
    s_cmp_lg_u32 s16, 0
    s_cbranch_scc1 K2_sig_20
    s_mov_b64 exec, 1
    buffer_store_dword v221, v236, s[12:15], s51 offen sc1
    s_mov_b64 exec, -1
K2_sig_20:
    v_readfirstlane_b32 s51, v235
    s_waitcnt lgkmcnt(4)
    v_mfma_f32_16x16x32_bf16 v[64:67], v[0:3], a[128:131], 0
    ds_read_b128 a[144:147], v201 offset:0
    ds_read_b128 a[148:151], v201 offset:2048
    ds_read_b64_tr_b16 v[16:17], v196 offset:0
    ds_read_b64_tr_b16 v[18:19], v196 offset:1024
    v_mfma_f32_16x16x32_bf16 v[68:71], v[0:3], a[132:135], 0
    s_add_u32 m0, s26, 8192
    ds_read_b128 a[152:155], v201 offset:4096
    ds_read_b128 a[156:159], v201 offset:6144
    v_mfma_f32_16x16x32_bf16 v[72:75], v[0:3], a[136:139], 0
    s_add_u32 s24, s20, s46
    v_mfma_f32_16x16x32_bf16 v[76:79], v[0:3], a[140:143], 0
    buffer_load_dwordx4 v202, s[4:7], s24 offen offset:0 lds
    v_mfma_f32_16x16x32_bf16 v[92:95], v[4:7], a[140:143], 0
    ds_read_b64_tr_b16 v[20:21], v197 offset:0
    ds_read_b64_tr_b16 v[22:23], v197 offset:1024
    v_mfma_f32_16x16x32_bf16 v[88:91], v[4:7], a[136:139], 0
    buffer_load_dwordx4 v203, s[4:7], s24 offen offset:1024 lds
    v_mfma_f32_16x16x32_bf16 v[84:87], v[4:7], a[132:135], 0
    buffer_load_dwordx4 v204, s[4:7], s24 offen offset:2048 lds
    v_mfma_f32_16x16x32_bf16 v[80:83], v[4:7], a[128:131], 0
    s_waitcnt lgkmcnt(8)
    v_mfma_f32_16x16x32_bf16 v[96:99], v[8:11], a[128:131], 0
    ds_read_b64_tr_b16 v[24:25], v198 offset:0
    ds_read_b64_tr_b16 v[26:27], v198 offset:1024
    v_mfma_f32_16x16x32_bf16 v[100:103], v[8:11], a[132:135], 0
    buffer_load_dwordx4 v205, s[4:7], s24 offen offset:3072 lds
    v_mfma_f32_16x16x32_bf16 v[104:107], v[8:11], a[136:139], 0
    s_add_u32 m0, s26, 12288
    s_add_u32 s24, s21, s46
    v_mfma_f32_16x16x32_bf16 v[108:111], v[8:11], a[140:143], 0
    buffer_load_dwordx4 v202, s[4:7], s24 offen offset:0 lds
    v_mfma_f32_16x16x32_bf16 v[124:127], v[12:15], a[140:143], 0
    ds_read_b64_tr_b16 v[28:29], v199 offset:0
    ds_read_b64_tr_b16 v[30:31], v199 offset:1024
    v_mfma_f32_16x16x32_bf16 v[120:123], v[12:15], a[136:139], 0
    buffer_load_dwordx4 v203, s[4:7], s24 offen offset:1024 lds
    v_mfma_f32_16x16x32_bf16 v[116:119], v[12:15], a[132:135], 0
    buffer_load_dwordx4 v204, s[4:7], s24 offen offset:2048 lds
    v_mfma_f32_16x16x32_bf16 v[112:115], v[12:15], a[128:131], 0
    s_waitcnt lgkmcnt(4)
    buffer_load_dwordx4 v205, s[4:7], s24 offen offset:3072 lds
    v_mfma_f32_16x16x32_bf16 v[128:131], v[16:19], a[128:131], 0
    s_add_u32 s46, s46, 128
    ds_read_b64_tr_b16 v[32:33], v192 offset:8192
    ds_read_b64_tr_b16 v[34:35], v192 offset:9216
    v_mfma_f32_16x16x32_bf16 v[132:135], v[16:19], a[132:135], 0
    s_and_b32 s46, s46, 0x3ff
    s_mul_i32 s28, s46, s30
    v_mfma_f32_16x16x32_bf16 v[136:139], v[16:19], a[136:139], 0
    s_add_u32 m0, s27, 32768
    v_mfma_f32_16x16x32_bf16 v[140:143], v[16:19], a[140:143], 0
    s_add_u32 s28, s28, s47
    v_mfma_f32_16x16x32_bf16 v[156:159], v[20:23], a[140:143], 0
    ds_read_b64_tr_b16 v[36:37], v193 offset:8192
    ds_read_b64_tr_b16 v[38:39], v193 offset:9216
    v_mfma_f32_16x16x32_bf16 v[152:155], v[20:23], a[136:139], 0
    buffer_load_dwordx4 v206, s[8:11], s28 offen offset:0 lds
    v_mfma_f32_16x16x32_bf16 v[148:151], v[20:23], a[132:135], 0
    buffer_load_dwordx4 v207, s[8:11], s28 offen offset:1024 lds
    v_mfma_f32_16x16x32_bf16 v[144:147], v[20:23], a[128:131], 0
    s_waitcnt lgkmcnt(4)
    v_mfma_f32_16x16x32_bf16 v[160:163], v[24:27], a[128:131], 0
    ds_read_b64_tr_b16 v[40:41], v194 offset:8192
    ds_read_b64_tr_b16 v[42:43], v194 offset:9216
    v_mfma_f32_16x16x32_bf16 v[164:167], v[24:27], a[132:135], 0
    buffer_load_dwordx4 v208, s[8:11], s28 offen offset:2048 lds
    buffer_load_dwordx4 v209, s[8:11], s28 offen offset:3072 lds
    v_mfma_f32_16x16x32_bf16 v[168:171], v[24:27], a[136:139], 0
    s_add_u32 m0, s26, 0
    s_add_u32 s24, s20, s46
    v_mfma_f32_16x16x32_bf16 v[172:175], v[24:27], a[140:143], 0
    buffer_load_dwordx4 v202, s[4:7], s24 offen offset:0 lds
    v_mfma_f32_16x16x32_bf16 v[188:191], v[28:31], a[140:143], 0
    ds_read_b64_tr_b16 v[44:45], v195 offset:8192
    ds_read_b64_tr_b16 v[46:47], v195 offset:9216
    v_mfma_f32_16x16x32_bf16 v[184:187], v[28:31], a[136:139], 0
    buffer_load_dwordx4 v203, s[4:7], s24 offen offset:1024 lds
    v_mfma_f32_16x16x32_bf16 v[180:183], v[28:31], a[132:135], 0
    v_mfma_f32_16x16x32_bf16 v[176:179], v[28:31], a[128:131], 0
    s_waitcnt lgkmcnt(4)
    v_mfma_f32_16x16x32_bf16 v[64:67], v[32:35], a[144:147], v[64:67]
    ds_read_b64_tr_b16 v[48:49], v196 offset:8192
    ds_read_b64_tr_b16 v[50:51], v196 offset:9216
    v_mfma_f32_16x16x32_bf16 v[68:71], v[32:35], a[148:151], v[68:71]
    buffer_load_dwordx4 v204, s[4:7], s24 offen offset:2048 lds
    v_mfma_f32_16x16x32_bf16 v[72:75], v[32:35], a[152:155], v[72:75]
    buffer_load_dwordx4 v205, s[4:7], s24 offen offset:3072 lds
    v_mfma_f32_16x16x32_bf16 v[76:79], v[32:35], a[156:159], v[76:79]
    s_add_u32 m0, s26, 4096
    s_add_u32 s24, s21, s46
    v_mfma_f32_16x16x32_bf16 v[92:95], v[36:39], a[156:159], v[92:95]
    ds_read_b64_tr_b16 v[52:53], v197 offset:8192
    ds_read_b64_tr_b16 v[54:55], v197 offset:9216
    v_mfma_f32_16x16x32_bf16 v[88:91], v[36:39], a[152:155], v[88:91]
    buffer_load_dwordx4 v202, s[4:7], s24 offen offset:0 lds
    v_mfma_f32_16x16x32_bf16 v[84:87], v[36:39], a[148:151], v[84:87]
    buffer_load_dwordx4 v203, s[4:7], s24 offen offset:1024 lds
    v_mfma_f32_16x16x32_bf16 v[80:83], v[36:39], a[144:147], v[80:83]
    s_waitcnt lgkmcnt(4)
    v_mfma_f32_16x16x32_bf16 v[96:99], v[40:43], a[144:147], v[96:99]
    ds_read_b64_tr_b16 v[56:57], v198 offset:8192
    ds_read_b64_tr_b16 v[58:59], v198 offset:9216
    v_mfma_f32_16x16x32_bf16 v[100:103], v[40:43], a[148:151], v[100:103]
    buffer_load_dwordx4 v204, s[4:7], s24 offen offset:2048 lds
    v_mfma_f32_16x16x32_bf16 v[104:107], v[40:43], a[152:155], v[104:107]
    buffer_load_dwordx4 v205, s[4:7], s24 offen offset:3072 lds
    v_mfma_f32_16x16x32_bf16 v[108:111], v[40:43], a[156:159], v[108:111]
    v_mfma_f32_16x16x32_bf16 v[124:127], v[44:47], a[156:159], v[124:127]
    s_waitcnt vmcnt(12)
    ds_read_b64_tr_b16 v[60:61], v199 offset:8192
    ds_read_b64_tr_b16 v[62:63], v199 offset:9216
    s_barrier
    v_mfma_f32_16x16x32_bf16 v[120:123], v[44:47], a[152:155], v[120:123]
    ds_read_b128 a[160:163], v200 offset:8192
    ds_read_b128 a[164:167], v200 offset:10240
    v_mfma_f32_16x16x32_bf16 v[116:119], v[44:47], a[148:151], v[116:119]
    ds_read_b128 a[168:171], v200 offset:12288
    ds_read_b128 a[172:175], v200 offset:14336
    v_mfma_f32_16x16x32_bf16 v[112:115], v[44:47], a[144:147], v[112:115]
    s_waitcnt lgkmcnt(8)
    s_add_u32 s46, s46, 128
    v_mfma_f32_16x16x32_bf16 v[128:131], v[48:51], a[144:147], v[128:131]
    ds_read_b64_tr_b16 v[0:1], v192 offset:16384
    ds_read_b64_tr_b16 v[2:3], v192 offset:17408
    v_mfma_f32_16x16x32_bf16 v[132:135], v[48:51], a[148:151], v[132:135]
    s_and_b32 s46, s46, 0x3ff
    v_mfma_f32_16x16x32_bf16 v[136:139], v[48:51], a[152:155], v[136:139]
    ds_read_b128 a[176:179], v201 offset:8192
    ds_read_b128 a[180:183], v201 offset:10240
    v_mfma_f32_16x16x32_bf16 v[140:143], v[48:51], a[156:159], v[140:143]
    s_mul_i32 s28, s46, s30
    s_getpc_b64 s[96:97]
CPF_19:
    s_add_u32 s96, s96, K2_after - CPF_19
    s_addc_u32 s97, s97, 0
    v_mfma_f32_16x16x32_bf16 v[156:159], v[52:55], a[156:159], v[156:159]
    ds_read_b64_tr_b16 v[4:5], v193 offset:16384
    ds_read_b64_tr_b16 v[6:7], v193 offset:17408
    v_mfma_f32_16x16x32_bf16 v[152:155], v[52:55], a[152:155], v[152:155]
    s_add_u32 m0, s27, 49152
    v_mfma_f32_16x16x32_bf16 v[148:151], v[52:55], a[148:151], v[148:151]
    ds_read_b128 a[184:187], v201 offset:12288
    ds_read_b128 a[188:191], v201 offset:14336
    v_mfma_f32_16x16x32_bf16 v[144:147], v[52:55], a[144:147], v[144:147]
    s_waitcnt lgkmcnt(12)
    s_add_u32 s28, s28, s47
    v_mfma_f32_16x16x32_bf16 v[160:163], v[56:59], a[144:147], v[160:163]
    ds_read_b64_tr_b16 v[8:9], v194 offset:16384
    ds_read_b64_tr_b16 v[10:11], v194 offset:17408
    v_mfma_f32_16x16x32_bf16 v[164:167], v[56:59], a[148:151], v[164:167]
    buffer_load_dwordx4 v206, s[8:11], s28 offen offset:0 lds
    v_mfma_f32_16x16x32_bf16 v[168:171], v[56:59], a[152:155], v[168:171]
    v_mfma_f32_16x16x32_bf16 v[172:175], v[56:59], a[156:159], v[172:175]
    v_mfma_f32_16x16x32_bf16 v[188:191], v[60:63], a[156:159], v[188:191]
    ds_read_b64_tr_b16 v[12:13], v195 offset:16384
    ds_read_b64_tr_b16 v[14:15], v195 offset:17408
    v_mfma_f32_16x16x32_bf16 v[184:187], v[60:63], a[152:155], v[184:187]
    buffer_load_dwordx4 v207, s[8:11], s28 offen offset:1024 lds
    v_mfma_f32_16x16x32_bf16 v[180:183], v[60:63], a[148:151], v[180:183]
    v_mfma_f32_16x16x32_bf16 v[176:179], v[60:63], a[144:147], v[176:179]
    s_waitcnt lgkmcnt(6)
    v_mfma_f32_16x16x32_bf16 v[64:67], v[0:3], a[160:163], v[64:67]
    s_lshr_b32 s22, s2, 3
    ds_read_b64_tr_b16 v[16:17], v196 offset:16384
    ds_read_b64_tr_b16 v[18:19], v196 offset:17408
    v_mfma_f32_16x16x32_bf16 v[68:71], v[0:3], a[164:167], v[68:71]
    buffer_load_dwordx4 v208, s[8:11], s28 offen offset:2048 lds
    v_mfma_f32_16x16x32_bf16 v[72:75], v[0:3], a[168:171], v[72:75]
    v_mfma_f32_16x16x32_bf16 v[76:79], v[0:3], a[172:175], v[76:79]
    v_mfma_f32_16x16x32_bf16 v[92:95], v[4:7], a[172:175], v[92:95]
    s_lshl_b32 s22, s22, 2
    ds_read_b64_tr_b16 v[20:21], v197 offset:16384
    ds_read_b64_tr_b16 v[22:23], v197 offset:17408
    v_mfma_f32_16x16x32_bf16 v[88:91], v[4:7], a[168:171], v[88:91]
    buffer_load_dwordx4 v209, s[8:11], s28 offen offset:3072 lds
    v_mfma_f32_16x16x32_bf16 v[84:87], v[4:7], a[164:167], v[84:87]
    v_mfma_f32_16x16x32_bf16 v[80:83], v[4:7], a[160:163], v[80:83]
    s_waitcnt lgkmcnt(4)
    v_mfma_f32_16x16x32_bf16 v[96:99], v[8:11], a[160:163], v[96:99]
    ds_read_b64_tr_b16 v[24:25], v198 offset:16384
    ds_read_b64_tr_b16 v[26:27], v198 offset:17408
    v_mfma_f32_16x16x32_bf16 v[100:103], v[8:11], a[164:167], v[100:103]
    s_add_u32 m0, s26, 8192
    s_add_u32 s22, s22, s16
    v_mfma_f32_16x16x32_bf16 v[104:107], v[8:11], a[168:171], v[104:107]
    s_add_u32 s24, s20, s46
    v_mfma_f32_16x16x32_bf16 v[108:111], v[8:11], a[172:175], v[108:111]
    v_mfma_f32_16x16x32_bf16 v[124:127], v[12:15], a[172:175], v[124:127]
    ds_read_b64_tr_b16 v[28:29], v199 offset:16384
    ds_read_b64_tr_b16 v[30:31], v199 offset:17408
    v_mfma_f32_16x16x32_bf16 v[120:123], v[12:15], a[168:171], v[120:123]
    buffer_load_dwordx4 v202, s[4:7], s24 offen offset:0 lds
    v_mfma_f32_16x16x32_bf16 v[116:119], v[12:15], a[164:167], v[116:119]
    s_lshl_b32 s22, s22, 10
    v_mfma_f32_16x16x32_bf16 v[112:115], v[12:15], a[160:163], v[112:115]
    s_waitcnt lgkmcnt(4)
    v_mfma_f32_16x16x32_bf16 v[128:131], v[16:19], a[160:163], v[128:131]
    ds_read_b64_tr_b16 v[32:33], v192 offset:24576
    ds_read_b64_tr_b16 v[34:35], v192 offset:25600
    v_mfma_f32_16x16x32_bf16 v[132:135], v[16:19], a[164:167], v[132:135]
    buffer_load_dwordx4 v203, s[4:7], s24 offen offset:1024 lds
    v_mfma_f32_16x16x32_bf16 v[136:139], v[16:19], a[168:171], v[136:139]
    v_mfma_f32_16x16x32_bf16 v[140:143], v[16:19], a[172:175], v[140:143]
    buffer_load_dwordx4 v204, s[4:7], s24 offen offset:2048 lds
    v_mfma_f32_16x16x32_bf16 v[156:159], v[20:23], a[172:175], v[156:159]
    ds_read_b64_tr_b16 v[36:37], v193 offset:24576
    ds_read_b64_tr_b16 v[38:39], v193 offset:25600
    v_mfma_f32_16x16x32_bf16 v[152:155], v[20:23], a[168:171], v[152:155]
    v_and_b32 v216, 7, v215
    v_mfma_f32_16x16x32_bf16 v[148:151], v[20:23], a[164:167], v[148:151]
    buffer_load_dwordx4 v205, s[4:7], s24 offen offset:3072 lds
    v_mfma_f32_16x16x32_bf16 v[144:147], v[20:23], a[160:163], v[144:147]
    s_waitcnt lgkmcnt(4)
    v_lshlrev_b32 v216, 7, v216
    v_mfma_f32_16x16x32_bf16 v[160:163], v[24:27], a[160:163], v[160:163]
    ds_read_b64_tr_b16 v[40:41], v194 offset:24576
    ds_read_b64_tr_b16 v[42:43], v194 offset:25600
    v_mfma_f32_16x16x32_bf16 v[164:167], v[24:27], a[164:167], v[164:167]
    v_mfma_f32_16x16x32_bf16 v[168:171], v[24:27], a[168:171], v[168:171]
    s_add_u32 m0, s26, 12288
    v_mfma_f32_16x16x32_bf16 v[172:175], v[24:27], a[172:175], v[172:175]
    s_add_u32 s24, s21, s46
    v_mfma_f32_16x16x32_bf16 v[188:191], v[28:31], a[172:175], v[188:191]
    ds_read_b64_tr_b16 v[44:45], v195 offset:24576
    ds_read_b64_tr_b16 v[46:47], v195 offset:25600
    v_mfma_f32_16x16x32_bf16 v[184:187], v[28:31], a[168:171], v[184:187]
    buffer_load_dwordx4 v202, s[4:7], s24 offen offset:0 lds
    v_mfma_f32_16x16x32_bf16 v[180:183], v[28:31], a[164:167], v[180:183]
    v_add_u32 v216, s22, v216
    v_mfma_f32_16x16x32_bf16 v[176:179], v[28:31], a[160:163], v[176:179]
    s_waitcnt lgkmcnt(4)
    v_mfma_f32_16x16x32_bf16 v[64:67], v[32:35], a[176:179], v[64:67]
    ds_read_b64_tr_b16 v[48:49], v196 offset:24576
    ds_read_b64_tr_b16 v[50:51], v196 offset:25600
    v_mfma_f32_16x16x32_bf16 v[68:71], v[32:35], a[180:183], v[68:71]
    buffer_load_dwordx4 v203, s[4:7], s24 offen offset:1024 lds
    v_mfma_f32_16x16x32_bf16 v[72:75], v[32:35], a[184:187], v[72:75]
    v_min_u32 v216, K3_code_end - K2_after - 4, v216
    v_mfma_f32_16x16x32_bf16 v[76:79], v[32:35], a[188:191], v[76:79]
    v_mfma_f32_16x16x32_bf16 v[92:95], v[36:39], a[188:191], v[92:95]
    ds_read_b64_tr_b16 v[52:53], v197 offset:24576
    ds_read_b64_tr_b16 v[54:55], v197 offset:25600
    v_mfma_f32_16x16x32_bf16 v[88:91], v[36:39], a[184:187], v[88:91]
    buffer_load_dwordx4 v204, s[4:7], s24 offen offset:2048 lds
    v_mfma_f32_16x16x32_bf16 v[84:87], v[36:39], a[180:183], v[84:87]
    global_load_dword v245, v216, s[96:97]
    v_mfma_f32_16x16x32_bf16 v[80:83], v[36:39], a[176:179], v[80:83]
    s_waitcnt lgkmcnt(4)
    v_mfma_f32_16x16x32_bf16 v[96:99], v[40:43], a[176:179], v[96:99]
    ds_read_b64_tr_b16 v[56:57], v198 offset:24576
    ds_read_b64_tr_b16 v[58:59], v198 offset:25600
    v_mfma_f32_16x16x32_bf16 v[100:103], v[40:43], a[180:183], v[100:103]
    buffer_load_dwordx4 v205, s[4:7], s24 offen offset:3072 lds
    v_mfma_f32_16x16x32_bf16 v[104:107], v[40:43], a[184:187], v[104:107]
    v_mfma_f32_16x16x32_bf16 v[108:111], v[40:43], a[188:191], v[108:111]
    v_mfma_f32_16x16x32_bf16 v[124:127], v[44:47], a[188:191], v[124:127]
    s_waitcnt vmcnt(13)
    ds_read_b64_tr_b16 v[60:61], v199 offset:24576
    ds_read_b64_tr_b16 v[62:63], v199 offset:25600
    s_barrier
    v_mfma_f32_16x16x32_bf16 v[120:123], v[44:47], a[184:187], v[120:123]
    ds_read_b128 a[128:131], v200 offset:0
    ds_read_b128 a[132:135], v200 offset:2048
    v_mfma_f32_16x16x32_bf16 v[116:119], v[44:47], a[180:183], v[116:119]
    ds_read_b128 a[136:139], v200 offset:4096
    ds_read_b128 a[140:143], v200 offset:6144
    v_mfma_f32_16x16x32_bf16 v[112:115], v[44:47], a[176:179], v[112:115]
    s_waitcnt lgkmcnt(8)
    v_lshlrev_b32 v214, 4, v215
    s_add_u32 s46, s46, 128
    v_mfma_f32_16x16x32_bf16 v[128:131], v[48:51], a[176:179], v[128:131]
    ds_read_b64_tr_b16 v[0:1], v192 offset:32768
    ds_read_b64_tr_b16 v[2:3], v192 offset:33792
    v_mfma_f32_16x16x32_bf16 v[132:135], v[48:51], a[180:183], v[132:135]
    s_and_b32 s46, s46, 0x3ff
    v_mfma_f32_16x16x32_bf16 v[136:139], v[48:51], a[184:187], v[136:139]
    ds_read_b128 a[144:147], v201 offset:0
    ds_read_b128 a[148:151], v201 offset:2048
    v_mfma_f32_16x16x32_bf16 v[140:143], v[48:51], a[188:191], v[140:143]
    s_mul_i32 s28, s46, s30
    v_mfma_f32_16x16x32_bf16 v[156:159], v[52:55], a[188:191], v[156:159]
    ds_read_b64_tr_b16 v[4:5], v193 offset:32768
    ds_read_b64_tr_b16 v[6:7], v193 offset:33792
    v_mfma_f32_16x16x32_bf16 v[152:155], v[52:55], a[184:187], v[152:155]
    s_add_u32 m0, s27, 0
    v_mov_b32 v222, 0xf149f2ca
    v_mfma_f32_16x16x32_bf16 v[148:151], v[52:55], a[180:183], v[148:151]
    ds_read_b128 a[152:155], v201 offset:4096
    ds_read_b128 a[156:159], v201 offset:6144
    v_mfma_f32_16x16x32_bf16 v[144:147], v[52:55], a[176:179], v[144:147]
    s_waitcnt lgkmcnt(12)
    s_add_u32 s28, s28, s47
    v_mfma_f32_16x16x32_bf16 v[160:163], v[56:59], a[176:179], v[160:163]
    ds_read_b64_tr_b16 v[8:9], v194 offset:32768
    ds_read_b64_tr_b16 v[10:11], v194 offset:33792
    v_mfma_f32_16x16x32_bf16 v[164:167], v[56:59], a[180:183], v[164:167]
    buffer_load_dwordx4 v206, s[8:11], s28 offen offset:0 lds
    v_mfma_f32_16x16x32_bf16 v[168:171], v[56:59], a[184:187], v[168:171]
    v_mov_b32 v218, 0x41800000
    v_mfma_f32_16x16x32_bf16 v[172:175], v[56:59], a[188:191], v[172:175]
    v_mfma_f32_16x16x32_bf16 v[188:191], v[60:63], a[188:191], v[188:191]
    ds_read_b64_tr_b16 v[12:13], v195 offset:32768
    ds_read_b64_tr_b16 v[14:15], v195 offset:33792
    v_mfma_f32_16x16x32_bf16 v[184:187], v[60:63], a[184:187], v[184:187]
    buffer_load_dwordx4 v207, s[8:11], s28 offen offset:1024 lds
    v_mfma_f32_16x16x32_bf16 v[180:183], v[60:63], a[180:183], v[180:183]
    v_and_b32 v216, 15, v215
    v_mfma_f32_16x16x32_bf16 v[176:179], v[60:63], a[176:179], v[176:179]
    s_waitcnt lgkmcnt(6)
    v_mfma_f32_16x16x32_bf16 v[64:67], v[0:3], a[128:131], v[64:67]
    ds_read_b64_tr_b16 v[16:17], v196 offset:32768
    ds_read_b64_tr_b16 v[18:19], v196 offset:33792
    v_mfma_f32_16x16x32_bf16 v[68:71], v[0:3], a[132:135], v[68:71]
    buffer_load_dwordx4 v208, s[8:11], s28 offen offset:2048 lds
    v_mfma_f32_16x16x32_bf16 v[72:75], v[0:3], a[136:139], v[72:75]
    v_lshrrev_b32 v217, 4, v215
    v_mfma_f32_16x16x32_bf16 v[76:79], v[0:3], a[140:143], v[76:79]
    v_mfma_f32_16x16x32_bf16 v[92:95], v[4:7], a[140:143], v[92:95]
    ds_read_b64_tr_b16 v[20:21], v197 offset:32768
    ds_read_b64_tr_b16 v[22:23], v197 offset:33792
    v_mfma_f32_16x16x32_bf16 v[88:91], v[4:7], a[136:139], v[88:91]
    buffer_load_dwordx4 v209, s[8:11], s28 offen offset:3072 lds
    v_mfma_f32_16x16x32_bf16 v[84:87], v[4:7], a[132:135], v[84:87]
    v_lshlrev_b32 v217, 2, v217
    v_mfma_f32_16x16x32_bf16 v[80:83], v[4:7], a[128:131], v[80:83]
    s_waitcnt lgkmcnt(4)
    v_mfma_f32_16x16x32_bf16 v[96:99], v[8:11], a[128:131], v[96:99]
    ds_read_b64_tr_b16 v[24:25], v198 offset:32768
    ds_read_b64_tr_b16 v[26:27], v198 offset:33792
    v_mfma_f32_16x16x32_bf16 v[100:103], v[8:11], a[132:135], v[100:103]
    s_add_u32 m0, s26, 0
    v_mfma_f32_16x16x32_bf16 v[104:107], v[8:11], a[136:139], v[104:107]
    s_add_u32 s24, s20, s46
    v_mfma_f32_16x16x32_bf16 v[108:111], v[8:11], a[140:143], v[108:111]
    v_sub_u32 v223, v216, v217
    v_mfma_f32_16x16x32_bf16 v[124:127], v[12:15], a[140:143], v[124:127]
    ds_read_b64_tr_b16 v[28:29], v199 offset:32768
    ds_read_b64_tr_b16 v[30:31], v199 offset:33792
    v_mfma_f32_16x16x32_bf16 v[120:123], v[12:15], a[136:139], v[120:123]
    buffer_load_dwordx4 v202, s[4:7], s24 offen offset:0 lds
    v_mfma_f32_16x16x32_bf16 v[116:119], v[12:15], a[132:135], v[116:119]
    v_mfma_f32_16x16x32_bf16 v[112:115], v[12:15], a[128:131], v[112:115]
    s_waitcnt lgkmcnt(4)
    v_mfma_f32_16x16x32_bf16 v[128:131], v[16:19], a[128:131], v[128:131]
    ds_read_b64_tr_b16 v[32:33], v192 offset:40960
    ds_read_b64_tr_b16 v[34:35], v192 offset:41984
    v_mfma_f32_16x16x32_bf16 v[132:135], v[16:19], a[132:135], v[132:135]
    buffer_load_dwordx4 v203, s[4:7], s24 offen offset:1024 lds
    v_mfma_f32_16x16x32_bf16 v[136:139], v[16:19], a[136:139], v[136:139]
    v_mov_b32 v232, v214
    v_mfma_f32_16x16x32_bf16 v[140:143], v[16:19], a[140:143], v[140:143]
    buffer_load_dwordx4 v204, s[4:7], s24 offen offset:2048 lds
    v_mfma_f32_16x16x32_bf16 v[156:159], v[20:23], a[140:143], v[156:159]
    ds_read_b64_tr_b16 v[36:37], v193 offset:40960
    ds_read_b64_tr_b16 v[38:39], v193 offset:41984
    v_mfma_f32_16x16x32_bf16 v[152:155], v[20:23], a[136:139], v[152:155]
    v_add_u32 v233, 147456, v214
    v_mfma_f32_16x16x32_bf16 v[148:151], v[20:23], a[132:135], v[148:151]
    buffer_load_dwordx4 v205, s[4:7], s24 offen offset:3072 lds
    v_mfma_f32_16x16x32_bf16 v[144:147], v[20:23], a[128:131], v[144:147]
    s_waitcnt lgkmcnt(4)
    v_mfma_f32_16x16x32_bf16 v[160:163], v[24:27], a[128:131], v[160:163]
    ds_read_b64_tr_b16 v[40:41], v194 offset:40960
    ds_read_b64_tr_b16 v[42:43], v194 offset:41984
    v_mfma_f32_16x16x32_bf16 v[164:167], v[24:27], a[132:135], v[164:167]
    v_mov_b32 v216, 0x3f803f80
    v_mfma_f32_16x16x32_bf16 v[168:171], v[24:27], a[136:139], v[168:171]
    s_add_u32 m0, s26, 4096
    v_mfma_f32_16x16x32_bf16 v[172:175], v[24:27], a[140:143], v[172:175]
    s_add_u32 s24, s21, s46
    v_mfma_f32_16x16x32_bf16 v[188:191], v[28:31], a[140:143], v[188:191]
    ds_read_b64_tr_b16 v[44:45], v195 offset:40960
    ds_read_b64_tr_b16 v[46:47], v195 offset:41984
    v_mfma_f32_16x16x32_bf16 v[184:187], v[28:31], a[136:139], v[184:187]
    buffer_load_dwordx4 v202, s[4:7], s24 offen offset:0 lds
    v_mfma_f32_16x16x32_bf16 v[180:183], v[28:31], a[132:135], v[180:183]
    s_and_b32 s42, s16, 1
    v_mfma_f32_16x16x32_bf16 v[176:179], v[28:31], a[128:131], v[176:179]
    s_waitcnt lgkmcnt(4)
    v_mfma_f32_16x16x32_bf16 v[64:67], v[32:35], a[144:147], v[64:67]
    ds_read_b64_tr_b16 v[48:49], v196 offset:40960
    ds_read_b64_tr_b16 v[50:51], v196 offset:41984
    v_mfma_f32_16x16x32_bf16 v[68:71], v[32:35], a[148:151], v[68:71]
    buffer_load_dwordx4 v203, s[4:7], s24 offen offset:1024 lds
    v_mfma_f32_16x16x32_bf16 v[72:75], v[32:35], a[152:155], v[72:75]
    v_mfma_f32_16x16x32_bf16 v[76:79], v[32:35], a[156:159], v[76:79]
    s_mul_i32 s40, s36, 294912
    v_mfma_f32_16x16x32_bf16 v[92:95], v[36:39], a[156:159], v[92:95]
    ds_read_b64_tr_b16 v[52:53], v197 offset:40960
    ds_read_b64_tr_b16 v[54:55], v197 offset:41984
    v_mfma_f32_16x16x32_bf16 v[88:91], v[36:39], a[152:155], v[88:91]
    buffer_load_dwordx4 v204, s[4:7], s24 offen offset:2048 lds
    v_mfma_f32_16x16x32_bf16 v[84:87], v[36:39], a[148:151], v[84:87]
    v_mfma_f32_16x16x32_bf16 v[80:83], v[36:39], a[144:147], v[80:83]
    s_waitcnt lgkmcnt(4)
    s_mul_i32 s41, s37, 294912
    v_mfma_f32_16x16x32_bf16 v[96:99], v[40:43], a[144:147], v[96:99]
    ds_read_b64_tr_b16 v[56:57], v198 offset:40960
    ds_read_b64_tr_b16 v[58:59], v198 offset:41984
    v_mfma_f32_16x16x32_bf16 v[100:103], v[40:43], a[148:151], v[100:103]
    buffer_load_dwordx4 v205, s[4:7], s24 offen offset:3072 lds
    v_mfma_f32_16x16x32_bf16 v[104:107], v[40:43], a[152:155], v[104:107]
    v_mfma_f32_16x16x32_bf16 v[108:111], v[40:43], a[156:159], v[108:111]
    v_mfma_f32_16x16x32_bf16 v[124:127], v[44:47], a[156:159], v[124:127]
    s_waitcnt vmcnt(12)
    ds_read_b64_tr_b16 v[60:61], v199 offset:40960
    ds_read_b64_tr_b16 v[62:63], v199 offset:41984
    s_barrier
    v_mfma_f32_16x16x32_bf16 v[120:123], v[44:47], a[152:155], v[120:123]
    s_lshl_b32 s22, s17, 12
    ds_read_b128 a[160:163], v200 offset:8192
    ds_read_b128 a[164:167], v200 offset:10240
    v_mfma_f32_16x16x32_bf16 v[116:119], v[44:47], a[148:151], v[116:119]
    ds_read_b128 a[168:171], v200 offset:12288
    ds_read_b128 a[172:175], v200 offset:14336
    v_mfma_f32_16x16x32_bf16 v[112:115], v[44:47], a[144:147], v[112:115]
    s_waitcnt lgkmcnt(8)
    s_add_u32 s46, s46, 128
    v_mfma_f32_16x16x32_bf16 v[128:131], v[48:51], a[144:147], v[128:131]
    ds_read_b64_tr_b16 v[0:1], v192 offset:49152
    ds_read_b64_tr_b16 v[2:3], v192 offset:50176
    v_mfma_f32_16x16x32_bf16 v[132:135], v[48:51], a[148:151], v[132:135]
    s_and_b32 s46, s46, 0x3ff
    s_add_u32 s22, s22, 35651584
    v_mfma_f32_16x16x32_bf16 v[136:139], v[48:51], a[152:155], v[136:139]
    ds_read_b128 a[176:179], v201 offset:8192
    ds_read_b128 a[180:183], v201 offset:10240
    v_mfma_f32_16x16x32_bf16 v[140:143], v[48:51], a[156:159], v[140:143]
    s_mul_i32 s28, s46, s30
    v_mfma_f32_16x16x32_bf16 v[156:159], v[52:55], a[156:159], v[156:159]
    ds_read_b64_tr_b16 v[4:5], v193 offset:49152
    ds_read_b64_tr_b16 v[6:7], v193 offset:50176
    v_mfma_f32_16x16x32_bf16 v[152:155], v[52:55], a[152:155], v[152:155]
    s_add_u32 m0, s27, 16384
    v_mfma_f32_16x16x32_bf16 v[148:151], v[52:55], a[148:151], v[148:151]
    s_add_u32 s40, s40, s22
    ds_read_b128 a[184:187], v201 offset:12288
    ds_read_b128 a[188:191], v201 offset:14336
    v_mfma_f32_16x16x32_bf16 v[144:147], v[52:55], a[144:147], v[144:147]
    s_waitcnt lgkmcnt(12)
    s_add_u32 s28, s28, s47
    v_mfma_f32_16x16x32_bf16 v[160:163], v[56:59], a[144:147], v[160:163]
    ds_read_b64_tr_b16 v[8:9], v194 offset:49152
    ds_read_b64_tr_b16 v[10:11], v194 offset:50176
    v_mfma_f32_16x16x32_bf16 v[164:167], v[56:59], a[148:151], v[164:167]
    buffer_load_dwordx4 v206, s[8:11], s28 offen offset:0 lds
    v_mfma_f32_16x16x32_bf16 v[168:171], v[56:59], a[152:155], v[168:171]
    s_add_u32 s41, s41, s22
    v_mfma_f32_16x16x32_bf16 v[172:175], v[56:59], a[156:159], v[172:175]
    v_mfma_f32_16x16x32_bf16 v[188:191], v[60:63], a[156:159], v[188:191]
    ds_read_b64_tr_b16 v[12:13], v195 offset:49152
    ds_read_b64_tr_b16 v[14:15], v195 offset:50176
    v_mfma_f32_16x16x32_bf16 v[184:187], v[60:63], a[152:155], v[184:187]
    buffer_load_dwordx4 v207, s[8:11], s28 offen offset:1024 lds
    v_mfma_f32_16x16x32_bf16 v[180:183], v[60:63], a[148:151], v[180:183]
    v_mfma_f32_16x16x32_bf16 v[176:179], v[60:63], a[144:147], v[176:179]
    s_waitcnt lgkmcnt(6)
    v_add_u32 v212, 0x10000, v214
    v_mfma_f32_16x16x32_bf16 v[64:67], v[0:3], a[160:163], v[64:67]
    ds_read_b64_tr_b16 v[16:17], v196 offset:49152
    ds_read_b64_tr_b16 v[18:19], v196 offset:50176
    v_mfma_f32_16x16x32_bf16 v[68:71], v[0:3], a[164:167], v[68:71]
    buffer_load_dwordx4 v208, s[8:11], s28 offen offset:2048 lds
    v_mfma_f32_16x16x32_bf16 v[72:75], v[0:3], a[168:171], v[72:75]
    v_mfma_f32_16x16x32_bf16 v[76:79], v[0:3], a[172:175], v[76:79]
    v_mfma_f32_16x16x32_bf16 v[92:95], v[4:7], a[172:175], v[92:95]
    ds_read_b64_tr_b16 v[20:21], v197 offset:49152
    ds_read_b64_tr_b16 v[22:23], v197 offset:50176
    v_mfma_f32_16x16x32_bf16 v[88:91], v[4:7], a[168:171], v[88:91]
    buffer_load_dwordx4 v209, s[8:11], s28 offen offset:3072 lds
    v_mfma_f32_16x16x32_bf16 v[84:87], v[4:7], a[164:167], v[84:87]
    v_add_u32 v213, 0x10000, v214
    v_mfma_f32_16x16x32_bf16 v[80:83], v[4:7], a[160:163], v[80:83]
    s_waitcnt lgkmcnt(4)
    v_mfma_f32_16x16x32_bf16 v[96:99], v[8:11], a[160:163], v[96:99]
    s_lshl_b32 s22, s16, 13
    ds_read_b64_tr_b16 v[24:25], v198 offset:49152
    ds_read_b64_tr_b16 v[26:27], v198 offset:50176
    v_mfma_f32_16x16x32_bf16 v[100:103], v[8:11], a[164:167], v[100:103]
    s_add_u32 m0, s26, 8192
    v_mfma_f32_16x16x32_bf16 v[104:107], v[8:11], a[168:171], v[104:107]
    s_add_u32 s24, s20, s46
    v_mfma_f32_16x16x32_bf16 v[108:111], v[8:11], a[172:175], v[108:111]
    v_mfma_f32_16x16x32_bf16 v[124:127], v[12:15], a[172:175], v[124:127]
    ds_read_b64_tr_b16 v[28:29], v199 offset:49152
    ds_read_b64_tr_b16 v[30:31], v199 offset:50176
    v_mfma_f32_16x16x32_bf16 v[120:123], v[12:15], a[168:171], v[120:123]
    buffer_load_dwordx4 v202, s[4:7], s24 offen offset:0 lds
    v_mfma_f32_16x16x32_bf16 v[116:119], v[12:15], a[164:167], v[116:119]
    s_add_u32 s22, s22, 131072
    v_mfma_f32_16x16x32_bf16 v[112:115], v[12:15], a[160:163], v[112:115]
    s_waitcnt lgkmcnt(4)
    v_mfma_f32_16x16x32_bf16 v[128:131], v[16:19], a[160:163], v[128:131]
    ds_read_b64_tr_b16 v[32:33], v192 offset:57344
    ds_read_b64_tr_b16 v[34:35], v192 offset:58368
    v_mfma_f32_16x16x32_bf16 v[132:135], v[16:19], a[164:167], v[132:135]
    buffer_load_dwordx4 v203, s[4:7], s24 offen offset:1024 lds
    v_mfma_f32_16x16x32_bf16 v[136:139], v[16:19], a[168:171], v[136:139]
    v_add_u32 v219, s22, v214
    v_mfma_f32_16x16x32_bf16 v[140:143], v[16:19], a[172:175], v[140:143]
    buffer_load_dwordx4 v204, s[4:7], s24 offen offset:2048 lds
    v_mfma_f32_16x16x32_bf16 v[156:159], v[20:23], a[172:175], v[156:159]
    ds_read_b64_tr_b16 v[36:37], v193 offset:57344
    ds_read_b64_tr_b16 v[38:39], v193 offset:58368
    v_mfma_f32_16x16x32_bf16 v[152:155], v[20:23], a[168:171], v[152:155]
    v_mfma_f32_16x16x32_bf16 v[148:151], v[20:23], a[164:167], v[148:151]
    buffer_load_dwordx4 v205, s[4:7], s24 offen offset:3072 lds
    v_mfma_f32_16x16x32_bf16 v[144:147], v[20:23], a[160:163], v[144:147]
    s_waitcnt lgkmcnt(4)
    s_lshl_b32 s22, s16, 9
    v_mfma_f32_16x16x32_bf16 v[160:163], v[24:27], a[160:163], v[160:163]
    ds_read_b64_tr_b16 v[40:41], v194 offset:57344
    ds_read_b64_tr_b16 v[42:43], v194 offset:58368
    v_mfma_f32_16x16x32_bf16 v[164:167], v[24:27], a[164:167], v[164:167]
    v_mfma_f32_16x16x32_bf16 v[168:171], v[24:27], a[168:171], v[168:171]
    s_add_u32 m0, s26, 12288
    v_mfma_f32_16x16x32_bf16 v[172:175], v[24:27], a[172:175], v[172:175]
    s_add_u32 s24, s21, s46
    s_add_u32 s22, s22, 49152
    v_mfma_f32_16x16x32_bf16 v[188:191], v[28:31], a[172:175], v[188:191]
    ds_read_b64_tr_b16 v[44:45], v195 offset:57344
    ds_read_b64_tr_b16 v[46:47], v195 offset:58368
    v_mfma_f32_16x16x32_bf16 v[184:187], v[28:31], a[168:171], v[184:187]
    buffer_load_dwordx4 v202, s[4:7], s24 offen offset:0 lds
    v_mfma_f32_16x16x32_bf16 v[180:183], v[28:31], a[164:167], v[180:183]
    v_mfma_f32_16x16x32_bf16 v[176:179], v[28:31], a[160:163], v[176:179]
    s_waitcnt lgkmcnt(4)
    v_mfma_f32_16x16x32_bf16 v[64:67], v[32:35], a[176:179], v[64:67]
    ds_read_b64_tr_b16 v[48:49], v196 offset:57344
    ds_read_b64_tr_b16 v[50:51], v196 offset:58368
    v_mfma_f32_16x16x32_bf16 v[68:71], v[32:35], a[180:183], v[68:71]
    buffer_load_dwordx4 v203, s[4:7], s24 offen offset:1024 lds
    v_mfma_f32_16x16x32_bf16 v[72:75], v[32:35], a[184:187], v[72:75]
    v_lshlrev_b32 v234, 3, v215
    v_mfma_f32_16x16x32_bf16 v[76:79], v[32:35], a[188:191], v[76:79]
    v_mfma_f32_16x16x32_bf16 v[92:95], v[36:39], a[188:191], v[92:95]
    ds_read_b64_tr_b16 v[52:53], v197 offset:57344
    ds_read_b64_tr_b16 v[54:55], v197 offset:58368
    v_mfma_f32_16x16x32_bf16 v[88:91], v[36:39], a[184:187], v[88:91]
    buffer_load_dwordx4 v204, s[4:7], s24 offen offset:2048 lds
    v_mfma_f32_16x16x32_bf16 v[84:87], v[36:39], a[180:183], v[84:87]
    v_add_u32 v234, s22, v234
    v_mfma_f32_16x16x32_bf16 v[80:83], v[36:39], a[176:179], v[80:83]
    s_waitcnt lgkmcnt(4)
    v_mfma_f32_16x16x32_bf16 v[96:99], v[40:43], a[176:179], v[96:99]
    ds_read_b64_tr_b16 v[56:57], v198 offset:57344
    ds_read_b64_tr_b16 v[58:59], v198 offset:58368
    v_mfma_f32_16x16x32_bf16 v[100:103], v[40:43], a[180:183], v[100:103]
    buffer_load_dwordx4 v205, s[4:7], s24 offen offset:3072 lds
    v_mfma_f32_16x16x32_bf16 v[104:107], v[40:43], a[184:187], v[104:107]
    s_add_u32 s33, s43, 0x10000
    v_mfma_f32_16x16x32_bf16 v[108:111], v[40:43], a[188:191], v[108:111]
    v_mfma_f32_16x16x32_bf16 v[124:127], v[44:47], a[188:191], v[124:127]
    s_waitcnt vmcnt(12)
    ds_read_b64_tr_b16 v[60:61], v199 offset:57344
    ds_read_b64_tr_b16 v[62:63], v199 offset:58368
    s_barrier
    v_mfma_f32_16x16x32_bf16 v[120:123], v[44:47], a[184:187], v[120:123]
    ds_read_b128 a[128:131], v200 offset:0
    ds_read_b128 a[132:135], v200 offset:2048
    v_mfma_f32_16x16x32_bf16 v[116:119], v[44:47], a[180:183], v[116:119]
    s_add_u32 s34, s43, 0x4000
    ds_read_b128 a[136:139], v200 offset:4096
    ds_read_b128 a[140:143], v200 offset:6144
    v_mfma_f32_16x16x32_bf16 v[112:115], v[44:47], a[176:179], v[112:115]
    s_waitcnt lgkmcnt(8)
    s_add_u32 s46, s46, 128
    v_mfma_f32_16x16x32_bf16 v[128:131], v[48:51], a[176:179], v[128:131]
    ds_read_b64_tr_b16 v[0:1], v192 offset:0
    ds_read_b64_tr_b16 v[2:3], v192 offset:1024
    v_mfma_f32_16x16x32_bf16 v[132:135], v[48:51], a[180:183], v[132:135]
    s_and_b32 s46, s46, 0x3ff
    v_mfma_f32_16x16x32_bf16 v[136:139], v[48:51], a[184:187], v[136:139]
    ds_read_b128 a[144:147], v201 offset:0
    ds_read_b128 a[148:151], v201 offset:2048
    v_mfma_f32_16x16x32_bf16 v[140:143], v[48:51], a[188:191], v[140:143]
    s_mul_i32 s28, s46, s30
    s_mov_b32 s35, -1
    v_mfma_f32_16x16x32_bf16 v[156:159], v[52:55], a[188:191], v[156:159]
    ds_read_b64_tr_b16 v[4:5], v193 offset:0
    ds_read_b64_tr_b16 v[6:7], v193 offset:1024
    v_mfma_f32_16x16x32_bf16 v[152:155], v[52:55], a[184:187], v[152:155]
    s_add_u32 m0, s27, 32768
    v_mfma_f32_16x16x32_bf16 v[148:151], v[52:55], a[180:183], v[148:151]
    ds_read_b128 a[152:155], v201 offset:4096
    ds_read_b128 a[156:159], v201 offset:6144
    v_mfma_f32_16x16x32_bf16 v[144:147], v[52:55], a[176:179], v[144:147]
    s_waitcnt lgkmcnt(12)
    s_add_u32 s28, s28, s47
    v_mfma_f32_16x16x32_bf16 v[160:163], v[56:59], a[176:179], v[160:163]
    s_min_u32 s38, s36, s37
    ds_read_b64_tr_b16 v[8:9], v194 offset:0
    ds_read_b64_tr_b16 v[10:11], v194 offset:1024
    v_mfma_f32_16x16x32_bf16 v[164:167], v[56:59], a[180:183], v[164:167]
    buffer_load_dwordx4 v206, s[8:11], s28 offen offset:0 lds
    v_mfma_f32_16x16x32_bf16 v[168:171], v[56:59], a[184:187], v[168:171]
    v_mfma_f32_16x16x32_bf16 v[172:175], v[56:59], a[188:191], v[172:175]
    v_mfma_f32_16x16x32_bf16 v[188:191], v[60:63], a[188:191], v[188:191]
    s_mov_b32 s98, s36
    ds_read_b64_tr_b16 v[12:13], v195 offset:0
    ds_read_b64_tr_b16 v[14:15], v195 offset:1024
    v_mfma_f32_16x16x32_bf16 v[184:187], v[60:63], a[184:187], v[184:187]
    buffer_load_dwordx4 v207, s[8:11], s28 offen offset:1024 lds
    v_mfma_f32_16x16x32_bf16 v[180:183], v[60:63], a[180:183], v[180:183]
    v_mfma_f32_16x16x32_bf16 v[176:179], v[60:63], a[176:179], v[176:179]
    s_waitcnt lgkmcnt(6)
    v_mfma_f32_16x16x32_bf16 v[64:67], v[0:3], a[128:131], v[64:67]
    ds_read_b64_tr_b16 v[16:17], v196 offset:0
    ds_read_b64_tr_b16 v[18:19], v196 offset:1024
    v_mfma_f32_16x16x32_bf16 v[68:71], v[0:3], a[132:135], v[68:71]
    buffer_load_dwordx4 v208, s[8:11], s28 offen offset:2048 lds
    v_mfma_f32_16x16x32_bf16 v[72:75], v[0:3], a[136:139], v[72:75]
    s_mov_b32 s99, s37
    v_mfma_f32_16x16x32_bf16 v[76:79], v[0:3], a[140:143], v[76:79]
    v_mfma_f32_16x16x32_bf16 v[92:95], v[4:7], a[140:143], v[92:95]
    ds_read_b64_tr_b16 v[20:21], v197 offset:0
    ds_read_b64_tr_b16 v[22:23], v197 offset:1024
    v_mfma_f32_16x16x32_bf16 v[88:91], v[4:7], a[136:139], v[88:91]
    buffer_load_dwordx4 v209, s[8:11], s28 offen offset:3072 lds
    v_mfma_f32_16x16x32_bf16 v[84:87], v[4:7], a[132:135], v[84:87]
    s_mov_b32 s90, 0x400000
    v_mfma_f32_16x16x32_bf16 v[80:83], v[4:7], a[128:131], v[80:83]
    s_waitcnt lgkmcnt(4)
    v_mfma_f32_16x16x32_bf16 v[96:99], v[8:11], a[128:131], v[96:99]
    ds_read_b64_tr_b16 v[24:25], v198 offset:0
    ds_read_b64_tr_b16 v[26:27], v198 offset:1024
    v_mfma_f32_16x16x32_bf16 v[100:103], v[8:11], a[132:135], v[100:103]
    s_add_u32 m0, s26, 0
    v_mfma_f32_16x16x32_bf16 v[104:107], v[8:11], a[136:139], v[104:107]
    s_add_u32 s24, s20, s46
    s_mov_b32 s91, 0x20000
    v_mfma_f32_16x16x32_bf16 v[108:111], v[8:11], a[140:143], v[108:111]
    v_mfma_f32_16x16x32_bf16 v[124:127], v[12:15], a[140:143], v[124:127]
    ds_read_b64_tr_b16 v[28:29], v199 offset:0
    ds_read_b64_tr_b16 v[30:31], v199 offset:1024
    v_mfma_f32_16x16x32_bf16 v[120:123], v[12:15], a[136:139], v[120:123]
    buffer_load_dwordx4 v202, s[4:7], s24 offen offset:0 lds
    v_mfma_f32_16x16x32_bf16 v[116:119], v[12:15], a[132:135], v[116:119]
    v_mfma_f32_16x16x32_bf16 v[112:115], v[12:15], a[128:131], v[112:115]
    s_waitcnt lgkmcnt(4)
    s_mov_b32 s94, 0x80000
    v_mfma_f32_16x16x32_bf16 v[128:131], v[16:19], a[128:131], v[128:131]
    ds_read_b64_tr_b16 v[32:33], v192 offset:8192
    ds_read_b64_tr_b16 v[34:35], v192 offset:9216
    v_mfma_f32_16x16x32_bf16 v[132:135], v[16:19], a[132:135], v[132:135]
    buffer_load_dwordx4 v203, s[4:7], s24 offen offset:1024 lds
    v_mfma_f32_16x16x32_bf16 v[136:139], v[16:19], a[136:139], v[136:139]
    v_mfma_f32_16x16x32_bf16 v[140:143], v[16:19], a[140:143], v[140:143]
    buffer_load_dwordx4 v204, s[4:7], s24 offen offset:2048 lds
    v_mfma_f32_16x16x32_bf16 v[156:159], v[20:23], a[140:143], v[156:159]
    s_mov_b32 s95, 0x20000
    ds_read_b64_tr_b16 v[36:37], v193 offset:8192
    ds_read_b64_tr_b16 v[38:39], v193 offset:9216
    v_mfma_f32_16x16x32_bf16 v[152:155], v[20:23], a[136:139], v[152:155]
    v_mfma_f32_16x16x32_bf16 v[148:151], v[20:23], a[132:135], v[148:151]
    buffer_load_dwordx4 v205, s[4:7], s24 offen offset:3072 lds
    v_mfma_f32_16x16x32_bf16 v[144:147], v[20:23], a[128:131], v[144:147]
    s_waitcnt lgkmcnt(4)
    v_mfma_f32_16x16x32_bf16 v[160:163], v[24:27], a[128:131], v[160:163]
    ds_read_b64_tr_b16 v[40:41], v194 offset:8192
    ds_read_b64_tr_b16 v[42:43], v194 offset:9216
    v_mfma_f32_16x16x32_bf16 v[164:167], v[24:27], a[132:135], v[164:167]
    v_accvgpr_write_b32 a208, v216
    v_mfma_f32_16x16x32_bf16 v[168:171], v[24:27], a[136:139], v[168:171]
    s_add_u32 m0, s26, 4096
    v_mfma_f32_16x16x32_bf16 v[172:175], v[24:27], a[140:143], v[172:175]
    s_add_u32 s24, s21, s46
    v_mfma_f32_16x16x32_bf16 v[188:191], v[28:31], a[140:143], v[188:191]
    ds_read_b64_tr_b16 v[44:45], v195 offset:8192
    ds_read_b64_tr_b16 v[46:47], v195 offset:9216
    v_mfma_f32_16x16x32_bf16 v[184:187], v[28:31], a[136:139], v[184:187]
    buffer_load_dwordx4 v202, s[4:7], s24 offen offset:0 lds
    v_mfma_f32_16x16x32_bf16 v[180:183], v[28:31], a[132:135], v[180:183]
    v_accvgpr_write_b32 a209, v216
    v_mfma_f32_16x16x32_bf16 v[176:179], v[28:31], a[128:131], v[176:179]
    s_waitcnt lgkmcnt(4)
    v_mfma_f32_16x16x32_bf16 v[64:67], v[32:35], a[144:147], v[64:67]
    ds_read_b64_tr_b16 v[48:49], v196 offset:8192
    ds_read_b64_tr_b16 v[50:51], v196 offset:9216
    v_mfma_f32_16x16x32_bf16 v[68:71], v[32:35], a[148:151], v[68:71]
    buffer_load_dwordx4 v203, s[4:7], s24 offen offset:1024 lds
    v_mfma_f32_16x16x32_bf16 v[72:75], v[32:35], a[152:155], v[72:75]
    v_accvgpr_write_b32 a210, v216
    v_mfma_f32_16x16x32_bf16 v[76:79], v[32:35], a[156:159], v[76:79]
    v_mfma_f32_16x16x32_bf16 v[92:95], v[36:39], a[156:159], v[92:95]
    ds_read_b64_tr_b16 v[52:53], v197 offset:8192
    ds_read_b64_tr_b16 v[54:55], v197 offset:9216
    v_mfma_f32_16x16x32_bf16 v[88:91], v[36:39], a[152:155], v[88:91]
    buffer_load_dwordx4 v204, s[4:7], s24 offen offset:2048 lds
    v_mfma_f32_16x16x32_bf16 v[84:87], v[36:39], a[148:151], v[84:87]
    v_mfma_f32_16x16x32_bf16 v[80:83], v[36:39], a[144:147], v[80:83]
    s_waitcnt lgkmcnt(4)
    v_accvgpr_write_b32 a211, v216
    v_mfma_f32_16x16x32_bf16 v[96:99], v[40:43], a[144:147], v[96:99]
    ds_read_b64_tr_b16 v[56:57], v198 offset:8192
    ds_read_b64_tr_b16 v[58:59], v198 offset:9216
    v_mfma_f32_16x16x32_bf16 v[100:103], v[40:43], a[148:151], v[100:103]
    buffer_load_dwordx4 v205, s[4:7], s24 offen offset:3072 lds
    v_mfma_f32_16x16x32_bf16 v[104:107], v[40:43], a[152:155], v[104:107]
    v_mfma_f32_16x16x32_bf16 v[108:111], v[40:43], a[156:159], v[108:111]
    v_mfma_f32_16x16x32_bf16 v[124:127], v[44:47], a[156:159], v[124:127]
    s_waitcnt vmcnt(12)
    ds_read_b64_tr_b16 v[60:61], v199 offset:8192
    ds_read_b64_tr_b16 v[62:63], v199 offset:9216
    s_barrier
    v_mfma_f32_16x16x32_bf16 v[120:123], v[44:47], a[152:155], v[120:123]
    ds_read_b128 a[160:163], v200 offset:8192
    ds_read_b128 a[164:167], v200 offset:10240
    v_mfma_f32_16x16x32_bf16 v[116:119], v[44:47], a[148:151], v[116:119]
    ds_read_b128 a[168:171], v200 offset:12288
    ds_read_b128 a[172:175], v200 offset:14336
    v_mfma_f32_16x16x32_bf16 v[112:115], v[44:47], a[144:147], v[112:115]
    s_waitcnt lgkmcnt(8)
    s_add_u32 s46, s46, 128
    v_mfma_f32_16x16x32_bf16 v[128:131], v[48:51], a[144:147], v[128:131]
    ds_read_b64_tr_b16 v[0:1], v192 offset:16384
    ds_read_b64_tr_b16 v[2:3], v192 offset:17408
    v_mfma_f32_16x16x32_bf16 v[132:135], v[48:51], a[148:151], v[132:135]
    s_and_b32 s46, s46, 0x3ff
    v_mfma_f32_16x16x32_bf16 v[136:139], v[48:51], a[152:155], v[136:139]
    ds_read_b128 a[176:179], v201 offset:8192
    ds_read_b128 a[180:183], v201 offset:10240
    v_mfma_f32_16x16x32_bf16 v[140:143], v[48:51], a[156:159], v[140:143]
    s_mul_i32 s28, s46, s30
    v_mfma_f32_16x16x32_bf16 v[156:159], v[52:55], a[156:159], v[156:159]
    ds_read_b64_tr_b16 v[4:5], v193 offset:16384
    ds_read_b64_tr_b16 v[6:7], v193 offset:17408
    v_mfma_f32_16x16x32_bf16 v[152:155], v[52:55], a[152:155], v[152:155]
    s_add_u32 m0, s27, 49152
    v_mfma_f32_16x16x32_bf16 v[148:151], v[52:55], a[148:151], v[148:151]
    ds_read_b128 a[184:187], v201 offset:12288
    ds_read_b128 a[188:191], v201 offset:14336
    v_mfma_f32_16x16x32_bf16 v[144:147], v[52:55], a[144:147], v[144:147]
    s_waitcnt lgkmcnt(12)
    s_add_u32 s28, s28, s47
    v_mfma_f32_16x16x32_bf16 v[160:163], v[56:59], a[144:147], v[160:163]
    ds_read_b64_tr_b16 v[8:9], v194 offset:16384
    ds_read_b64_tr_b16 v[10:11], v194 offset:17408
    v_mfma_f32_16x16x32_bf16 v[164:167], v[56:59], a[148:151], v[164:167]
    buffer_load_dwordx4 v206, s[8:11], s28 offen offset:0 lds
    v_mfma_f32_16x16x32_bf16 v[168:171], v[56:59], a[152:155], v[168:171]
    buffer_load_dword v235, v220, s[12:15], s50 offen sc1
    v_mfma_f32_16x16x32_bf16 v[172:175], v[56:59], a[156:159], v[172:175]
    v_mfma_f32_16x16x32_bf16 v[188:191], v[60:63], a[156:159], v[188:191]
    ds_read_b64_tr_b16 v[12:13], v195 offset:16384
    ds_read_b64_tr_b16 v[14:15], v195 offset:17408
    v_mfma_f32_16x16x32_bf16 v[184:187], v[60:63], a[152:155], v[184:187]
    buffer_load_dwordx4 v207, s[8:11], s28 offen offset:1024 lds
    v_mfma_f32_16x16x32_bf16 v[180:183], v[60:63], a[148:151], v[180:183]
    v_mfma_f32_16x16x32_bf16 v[176:179], v[60:63], a[144:147], v[176:179]
    s_waitcnt lgkmcnt(6)
    v_mfma_f32_16x16x32_bf16 v[64:67], v[0:3], a[160:163], v[64:67]
    ds_read_b64_tr_b16 v[16:17], v196 offset:16384
    ds_read_b64_tr_b16 v[18:19], v196 offset:17408
    v_mfma_f32_16x16x32_bf16 v[68:71], v[0:3], a[164:167], v[68:71]
    buffer_load_dwordx4 v208, s[8:11], s28 offen offset:2048 lds
    v_mfma_f32_16x16x32_bf16 v[72:75], v[0:3], a[168:171], v[72:75]
    v_mfma_f32_16x16x32_bf16 v[76:79], v[0:3], a[172:175], v[76:79]
    v_mfma_f32_16x16x32_bf16 v[92:95], v[4:7], a[172:175], v[92:95]
    ds_read_b64_tr_b16 v[20:21], v197 offset:16384
    ds_read_b64_tr_b16 v[22:23], v197 offset:17408
    v_mfma_f32_16x16x32_bf16 v[88:91], v[4:7], a[168:171], v[88:91]
    buffer_load_dwordx4 v209, s[8:11], s28 offen offset:3072 lds
    v_mfma_f32_16x16x32_bf16 v[84:87], v[4:7], a[164:167], v[84:87]
    v_mfma_f32_16x16x32_bf16 v[80:83], v[4:7], a[160:163], v[80:83]
    s_waitcnt lgkmcnt(4)
    v_mfma_f32_16x16x32_bf16 v[96:99], v[8:11], a[160:163], v[96:99]
    ds_read_b64_tr_b16 v[24:25], v198 offset:16384
    ds_read_b64_tr_b16 v[26:27], v198 offset:17408
    v_mfma_f32_16x16x32_bf16 v[100:103], v[8:11], a[164:167], v[100:103]
    s_add_u32 m0, s26, 8192
    v_mfma_f32_16x16x32_bf16 v[104:107], v[8:11], a[168:171], v[104:107]
    s_add_u32 s24, s20, s46
    v_mfma_f32_16x16x32_bf16 v[108:111], v[8:11], a[172:175], v[108:111]
    v_mfma_f32_16x16x32_bf16 v[124:127], v[12:15], a[172:175], v[124:127]
    ds_read_b64_tr_b16 v[28:29], v199 offset:16384
    ds_read_b64_tr_b16 v[30:31], v199 offset:17408
    v_mfma_f32_16x16x32_bf16 v[120:123], v[12:15], a[168:171], v[120:123]
    buffer_load_dwordx4 v202, s[4:7], s24 offen offset:0 lds
    v_mfma_f32_16x16x32_bf16 v[116:119], v[12:15], a[164:167], v[116:119]
    v_mfma_f32_16x16x32_bf16 v[112:115], v[12:15], a[160:163], v[112:115]
    s_waitcnt lgkmcnt(4)
    v_mfma_f32_16x16x32_bf16 v[128:131], v[16:19], a[160:163], v[128:131]
    ds_read_b64_tr_b16 v[32:33], v192 offset:24576
    ds_read_b64_tr_b16 v[34:35], v192 offset:25600
    v_mfma_f32_16x16x32_bf16 v[132:135], v[16:19], a[164:167], v[132:135]
    buffer_load_dwordx4 v203, s[4:7], s24 offen offset:1024 lds
    v_mfma_f32_16x16x32_bf16 v[136:139], v[16:19], a[168:171], v[136:139]
    v_mfma_f32_16x16x32_bf16 v[140:143], v[16:19], a[172:175], v[140:143]
    buffer_load_dwordx4 v204, s[4:7], s24 offen offset:2048 lds
    v_mfma_f32_16x16x32_bf16 v[156:159], v[20:23], a[172:175], v[156:159]
    ds_read_b64_tr_b16 v[36:37], v193 offset:24576
    ds_read_b64_tr_b16 v[38:39], v193 offset:25600
    v_mfma_f32_16x16x32_bf16 v[152:155], v[20:23], a[168:171], v[152:155]
    v_mfma_f32_16x16x32_bf16 v[148:151], v[20:23], a[164:167], v[148:151]
    buffer_load_dwordx4 v205, s[4:7], s24 offen offset:3072 lds
    v_mfma_f32_16x16x32_bf16 v[144:147], v[20:23], a[160:163], v[144:147]
    s_waitcnt lgkmcnt(4)
    v_mfma_f32_16x16x32_bf16 v[160:163], v[24:27], a[160:163], v[160:163]
    ds_read_b64_tr_b16 v[40:41], v194 offset:24576
    ds_read_b64_tr_b16 v[42:43], v194 offset:25600
    v_mfma_f32_16x16x32_bf16 v[164:167], v[24:27], a[164:167], v[164:167]
    v_mfma_f32_16x16x32_bf16 v[168:171], v[24:27], a[168:171], v[168:171]
    s_add_u32 m0, s26, 12288
    v_mfma_f32_16x16x32_bf16 v[172:175], v[24:27], a[172:175], v[172:175]
    s_add_u32 s24, s21, s46
    v_mfma_f32_16x16x32_bf16 v[188:191], v[28:31], a[172:175], v[188:191]
    ds_read_b64_tr_b16 v[44:45], v195 offset:24576
    ds_read_b64_tr_b16 v[46:47], v195 offset:25600
    v_mfma_f32_16x16x32_bf16 v[184:187], v[28:31], a[168:171], v[184:187]
    buffer_load_dwordx4 v202, s[4:7], s24 offen offset:0 lds
    v_mfma_f32_16x16x32_bf16 v[180:183], v[28:31], a[164:167], v[180:183]
    v_mfma_f32_16x16x32_bf16 v[176:179], v[28:31], a[160:163], v[176:179]
    s_waitcnt lgkmcnt(4)
    v_mfma_f32_16x16x32_bf16 v[64:67], v[32:35], a[176:179], v[64:67]
    ds_read_b64_tr_b16 v[48:49], v196 offset:24576
    ds_read_b64_tr_b16 v[50:51], v196 offset:25600
    v_mfma_f32_16x16x32_bf16 v[68:71], v[32:35], a[180:183], v[68:71]
    buffer_load_dwordx4 v203, s[4:7], s24 offen offset:1024 lds
    v_mfma_f32_16x16x32_bf16 v[72:75], v[32:35], a[184:187], v[72:75]
    v_mfma_f32_16x16x32_bf16 v[76:79], v[32:35], a[188:191], v[76:79]
    v_mfma_f32_16x16x32_bf16 v[92:95], v[36:39], a[188:191], v[92:95]
    ds_read_b64_tr_b16 v[52:53], v197 offset:24576
    ds_read_b64_tr_b16 v[54:55], v197 offset:25600
    v_mfma_f32_16x16x32_bf16 v[88:91], v[36:39], a[184:187], v[88:91]
    buffer_load_dwordx4 v204, s[4:7], s24 offen offset:2048 lds
    v_mfma_f32_16x16x32_bf16 v[84:87], v[36:39], a[180:183], v[84:87]
    v_mfma_f32_16x16x32_bf16 v[80:83], v[36:39], a[176:179], v[80:83]
    s_waitcnt lgkmcnt(4)
    v_mfma_f32_16x16x32_bf16 v[96:99], v[40:43], a[176:179], v[96:99]
    ds_read_b64_tr_b16 v[56:57], v198 offset:24576
    ds_read_b64_tr_b16 v[58:59], v198 offset:25600
    v_mfma_f32_16x16x32_bf16 v[100:103], v[40:43], a[180:183], v[100:103]
    buffer_load_dwordx4 v205, s[4:7], s24 offen offset:3072 lds
    v_mfma_f32_16x16x32_bf16 v[104:107], v[40:43], a[184:187], v[104:107]
    v_mfma_f32_16x16x32_bf16 v[108:111], v[40:43], a[188:191], v[108:111]
    s_waitcnt vmcnt(11)
    v_cmp_ne_u32 vcc, v221, v235
    s_cmp_lt_u32 s51, s62
    s_cbranch_scc1 K2_spin_21
    s_cbranch_vccnz K2_spin_21
K2_spun_22:
    v_mfma_f32_16x16x32_bf16 v[124:127], v[44:47], a[188:191], v[124:127]
    s_waitcnt vmcnt(11)
    ds_read_b64_tr_b16 v[60:61], v199 offset:24576
    ds_read_b64_tr_b16 v[62:63], v199 offset:25600
    s_barrier
    v_mfma_f32_16x16x32_bf16 v[120:123], v[44:47], a[184:187], v[120:123]
    ds_read_b128 a[128:131], v200 offset:0
    ds_read_b128 a[132:135], v200 offset:2048
    v_mfma_f32_16x16x32_bf16 v[116:119], v[44:47], a[180:183], v[116:119]
    ds_read_b128 a[136:139], v200 offset:4096
    ds_read_b128 a[140:143], v200 offset:6144
    v_mfma_f32_16x16x32_bf16 v[112:115], v[44:47], a[176:179], v[112:115]
    s_waitcnt lgkmcnt(8)
    v_mfma_f32_16x16x32_bf16 v[128:131], v[48:51], a[176:179], v[128:131]
    ds_read_b64_tr_b16 v[0:1], v192 offset:32768
    ds_read_b64_tr_b16 v[2:3], v192 offset:33792
    v_mfma_f32_16x16x32_bf16 v[132:135], v[48:51], a[180:183], v[132:135]
    v_mfma_f32_16x16x32_bf16 v[136:139], v[48:51], a[184:187], v[136:139]
    s_add_u32 m0, s43, 65536
    ds_read_b128 a[144:147], v201 offset:0
    ds_read_b128 a[148:151], v201 offset:2048
    v_mfma_f32_16x16x32_bf16 v[140:143], v[48:51], a[188:191], v[140:143]
    s_nop 0
    v_mfma_f32_16x16x32_bf16 v[156:159], v[52:55], a[188:191], v[156:159]
    ds_read_b64_tr_b16 v[4:5], v193 offset:32768
    ds_read_b64_tr_b16 v[6:7], v193 offset:33792
    v_mfma_f32_16x16x32_bf16 v[152:155], v[52:55], a[184:187], v[152:155]
    buffer_load_dwordx4 v214, s[12:15], s31 offen offset:0 sc1 lds
    v_mfma_f32_16x16x32_bf16 v[148:151], v[52:55], a[180:183], v[148:151]
    ds_read_b128 a[152:155], v201 offset:4096
    ds_read_b128 a[156:159], v201 offset:6144
    v_mfma_f32_16x16x32_bf16 v[144:147], v[52:55], a[176:179], v[144:147]
    s_waitcnt lgkmcnt(12)
    v_mfma_f32_16x16x32_bf16 v[160:163], v[56:59], a[176:179], v[160:163]
    ds_read_b64_tr_b16 v[8:9], v194 offset:32768
    ds_read_b64_tr_b16 v[10:11], v194 offset:33792
    v_mfma_f32_16x16x32_bf16 v[164:167], v[56:59], a[180:183], v[164:167]
    buffer_load_dwordx4 v214, s[12:15], s31 offen offset:1024 sc1 lds
    v_mfma_f32_16x16x32_bf16 v[168:171], v[56:59], a[184:187], v[168:171]
    v_mfma_f32_16x16x32_bf16 v[172:175], v[56:59], a[188:191], v[172:175]
    v_mfma_f32_16x16x32_bf16 v[188:191], v[60:63], a[188:191], v[188:191]
    ds_read_b64_tr_b16 v[12:13], v195 offset:32768
    ds_read_b64_tr_b16 v[14:15], v195 offset:33792
    v_mfma_f32_16x16x32_bf16 v[184:187], v[60:63], a[184:187], v[184:187]
    buffer_load_dwordx4 v214, s[12:15], s31 offen offset:2048 sc1 lds
    v_mfma_f32_16x16x32_bf16 v[180:183], v[60:63], a[180:183], v[180:183]
    v_mfma_f32_16x16x32_bf16 v[176:179], v[60:63], a[176:179], v[176:179]
    s_waitcnt lgkmcnt(6)
    v_mfma_f32_16x16x32_bf16 v[64:67], v[0:3], a[128:131], v[64:67]
    ds_read_b64_tr_b16 v[16:17], v196 offset:32768
    ds_read_b64_tr_b16 v[18:19], v196 offset:33792
    v_mfma_f32_16x16x32_bf16 v[68:71], v[0:3], a[132:135], v[68:71]
    buffer_load_dwordx4 v214, s[12:15], s31 offen offset:3072 sc1 lds
    v_mfma_f32_16x16x32_bf16 v[72:75], v[0:3], a[136:139], v[72:75]
    v_mfma_f32_16x16x32_bf16 v[76:79], v[0:3], a[140:143], v[76:79]
    v_mfma_f32_16x16x32_bf16 v[92:95], v[4:7], a[140:143], v[92:95]
    s_add_u32 m0, s43, 81920
    ds_read_b64_tr_b16 v[20:21], v197 offset:32768
    ds_read_b64_tr_b16 v[22:23], v197 offset:33792
    v_mfma_f32_16x16x32_bf16 v[88:91], v[4:7], a[136:139], v[88:91]
    v_mfma_f32_16x16x32_bf16 v[84:87], v[4:7], a[132:135], v[84:87]
    s_nop 0
    v_mfma_f32_16x16x32_bf16 v[80:83], v[4:7], a[128:131], v[80:83]
    s_waitcnt lgkmcnt(4)
    v_mfma_f32_16x16x32_bf16 v[96:99], v[8:11], a[128:131], v[96:99]
    ds_read_b64_tr_b16 v[24:25], v198 offset:32768
    ds_read_b64_tr_b16 v[26:27], v198 offset:33792
    v_mfma_f32_16x16x32_bf16 v[100:103], v[8:11], a[132:135], v[100:103]
    buffer_load_dwordx4 v214, s[12:15], s32 offen offset:0 sc1 lds
    v_mfma_f32_16x16x32_bf16 v[104:107], v[8:11], a[136:139], v[104:107]
    v_mfma_f32_16x16x32_bf16 v[108:111], v[8:11], a[140:143], v[108:111]
    v_mfma_f32_16x16x32_bf16 v[124:127], v[12:15], a[140:143], v[124:127]
    ds_read_b64_tr_b16 v[28:29], v199 offset:32768
    ds_read_b64_tr_b16 v[30:31], v199 offset:33792
    v_mfma_f32_16x16x32_bf16 v[120:123], v[12:15], a[136:139], v[120:123]
    buffer_load_dwordx4 v214, s[12:15], s32 offen offset:1024 sc1 lds
    v_mfma_f32_16x16x32_bf16 v[116:119], v[12:15], a[132:135], v[116:119]
    v_mfma_f32_16x16x32_bf16 v[112:115], v[12:15], a[128:131], v[112:115]
    s_waitcnt lgkmcnt(4)
    v_mfma_f32_16x16x32_bf16 v[128:131], v[16:19], a[128:131], v[128:131]
    ds_read_b64_tr_b16 v[32:33], v192 offset:40960
    ds_read_b64_tr_b16 v[34:35], v192 offset:41984
    v_mfma_f32_16x16x32_bf16 v[132:135], v[16:19], a[132:135], v[132:135]
    buffer_load_dwordx4 v214, s[12:15], s32 offen offset:2048 sc1 lds
    v_mfma_f32_16x16x32_bf16 v[136:139], v[16:19], a[136:139], v[136:139]
    v_mfma_f32_16x16x32_bf16 v[140:143], v[16:19], a[140:143], v[140:143]
    buffer_load_dwordx4 v214, s[12:15], s32 offen offset:3072 sc1 lds
    v_mfma_f32_16x16x32_bf16 v[156:159], v[20:23], a[140:143], v[156:159]
    ds_read_b64_tr_b16 v[36:37], v193 offset:40960
    ds_read_b64_tr_b16 v[38:39], v193 offset:41984
    v_mfma_f32_16x16x32_bf16 v[152:155], v[20:23], a[136:139], v[152:155]
    v_mfma_f32_16x16x32_bf16 v[148:151], v[20:23], a[132:135], v[148:151]
    v_mfma_f32_16x16x32_bf16 v[144:147], v[20:23], a[128:131], v[144:147]
    s_waitcnt lgkmcnt(4)
    s_add_u32 m0, s43, 0
    v_mfma_f32_16x16x32_bf16 v[160:163], v[24:27], a[128:131], v[160:163]
    ds_read_b64_tr_b16 v[40:41], v194 offset:40960
    ds_read_b64_tr_b16 v[42:43], v194 offset:41984
    v_mfma_f32_16x16x32_bf16 v[164:167], v[24:27], a[132:135], v[164:167]
    s_add_u32 s23, s31, 16384
    v_mfma_f32_16x16x32_bf16 v[168:171], v[24:27], a[136:139], v[168:171]
    v_mfma_f32_16x16x32_bf16 v[172:175], v[24:27], a[140:143], v[172:175]
    buffer_load_dwordx4 v214, s[12:15], s23 offen offset:0 sc1 lds
    v_mfma_f32_16x16x32_bf16 v[188:191], v[28:31], a[140:143], v[188:191]
    ds_read_b64_tr_b16 v[44:45], v195 offset:40960
    ds_read_b64_tr_b16 v[46:47], v195 offset:41984
    v_mfma_f32_16x16x32_bf16 v[184:187], v[28:31], a[136:139], v[184:187]
    v_mfma_f32_16x16x32_bf16 v[180:183], v[28:31], a[132:135], v[180:183]
    buffer_load_dwordx4 v214, s[12:15], s23 offen offset:1024 sc1 lds
    v_mfma_f32_16x16x32_bf16 v[176:179], v[28:31], a[128:131], v[176:179]
    s_waitcnt lgkmcnt(4)
    v_mfma_f32_16x16x32_bf16 v[64:67], v[32:35], a[144:147], v[64:67]
    ds_read_b64_tr_b16 v[48:49], v196 offset:40960
    ds_read_b64_tr_b16 v[50:51], v196 offset:41984
    v_mfma_f32_16x16x32_bf16 v[68:71], v[32:35], a[148:151], v[68:71]
    v_mfma_f32_16x16x32_bf16 v[72:75], v[32:35], a[152:155], v[72:75]
    buffer_load_dwordx4 v214, s[12:15], s23 offen offset:2048 sc1 lds
    v_mfma_f32_16x16x32_bf16 v[76:79], v[32:35], a[156:159], v[76:79]
    v_mfma_f32_16x16x32_bf16 v[92:95], v[36:39], a[156:159], v[92:95]
    ds_read_b64_tr_b16 v[52:53], v197 offset:40960
    ds_read_b64_tr_b16 v[54:55], v197 offset:41984
    v_mfma_f32_16x16x32_bf16 v[88:91], v[36:39], a[152:155], v[88:91]
    v_mfma_f32_16x16x32_bf16 v[84:87], v[36:39], a[148:151], v[84:87]
    buffer_load_dwordx4 v214, s[12:15], s23 offen offset:3072 sc1 lds
    v_mfma_f32_16x16x32_bf16 v[80:83], v[36:39], a[144:147], v[80:83]
    s_waitcnt lgkmcnt(4)
    v_mfma_f32_16x16x32_bf16 v[96:99], v[40:43], a[144:147], v[96:99]
    ds_read_b64_tr_b16 v[56:57], v198 offset:40960
    ds_read_b64_tr_b16 v[58:59], v198 offset:41984
    v_mfma_f32_16x16x32_bf16 v[100:103], v[40:43], a[148:151], v[100:103]
    v_mfma_f32_16x16x32_bf16 v[104:107], v[40:43], a[152:155], v[104:107]
    v_mfma_f32_16x16x32_bf16 v[108:111], v[40:43], a[156:159], v[108:111]
    v_mfma_f32_16x16x32_bf16 v[124:127], v[44:47], a[156:159], v[124:127]
    s_waitcnt vmcnt(12)
    ds_read_b64_tr_b16 v[60:61], v199 offset:40960
    ds_read_b64_tr_b16 v[62:63], v199 offset:41984
    s_barrier
    v_mfma_f32_16x16x32_bf16 v[120:123], v[44:47], a[152:155], v[120:123]
    ds_read_b128 a[160:163], v200 offset:8192
    ds_read_b128 a[164:167], v200 offset:10240
    v_mfma_f32_16x16x32_bf16 v[116:119], v[44:47], a[148:151], v[116:119]
    ds_read_b128 a[168:171], v200 offset:12288
    ds_read_b128 a[172:175], v200 offset:14336
    v_mfma_f32_16x16x32_bf16 v[112:115], v[44:47], a[144:147], v[112:115]
    s_waitcnt lgkmcnt(8)
    v_mfma_f32_16x16x32_bf16 v[128:131], v[48:51], a[144:147], v[128:131]
    ds_read_b64_tr_b16 v[0:1], v192 offset:49152
    ds_read_b64_tr_b16 v[2:3], v192 offset:50176
    v_mfma_f32_16x16x32_bf16 v[132:135], v[48:51], a[148:151], v[132:135]
    v_mfma_f32_16x16x32_bf16 v[136:139], v[48:51], a[152:155], v[136:139]
    ds_read_b128 a[176:179], v201 offset:8192
    ds_read_b128 a[180:183], v201 offset:10240
    v_mfma_f32_16x16x32_bf16 v[140:143], v[48:51], a[156:159], v[140:143]
    v_mfma_f32_16x16x32_bf16 v[156:159], v[52:55], a[156:159], v[156:159]
    ds_read_b64_tr_b16 v[4:5], v193 offset:49152
    ds_read_b64_tr_b16 v[6:7], v193 offset:50176
    v_mfma_f32_16x16x32_bf16 v[152:155], v[52:55], a[152:155], v[152:155]
    v_mfma_f32_16x16x32_bf16 v[148:151], v[52:55], a[148:151], v[148:151]
    ds_read_b128 a[184:187], v201 offset:12288
    ds_read_b128 a[188:191], v201 offset:14336
    v_mfma_f32_16x16x32_bf16 v[144:147], v[52:55], a[144:147], v[144:147]
    s_waitcnt lgkmcnt(12)
    v_mfma_f32_16x16x32_bf16 v[160:163], v[56:59], a[144:147], v[160:163]
    ds_read_b64_tr_b16 v[8:9], v194 offset:49152
    ds_read_b64_tr_b16 v[10:11], v194 offset:50176
    v_mfma_f32_16x16x32_bf16 v[164:167], v[56:59], a[148:151], v[164:167]
    v_mfma_f32_16x16x32_bf16 v[168:171], v[56:59], a[152:155], v[168:171]
    v_mfma_f32_16x16x32_bf16 v[172:175], v[56:59], a[156:159], v[172:175]
    v_mfma_f32_16x16x32_bf16 v[188:191], v[60:63], a[156:159], v[188:191]
    ds_read_b64_tr_b16 v[12:13], v195 offset:49152
    ds_read_b64_tr_b16 v[14:15], v195 offset:50176
    v_mfma_f32_16x16x32_bf16 v[184:187], v[60:63], a[152:155], v[184:187]
    v_mfma_f32_16x16x32_bf16 v[180:183], v[60:63], a[148:151], v[180:183]
    v_mfma_f32_16x16x32_bf16 v[176:179], v[60:63], a[144:147], v[176:179]
    s_waitcnt lgkmcnt(6)
    v_mfma_f32_16x16x32_bf16 v[64:67], v[0:3], a[160:163], v[64:67]
    ds_read_b64_tr_b16 v[16:17], v196 offset:49152
    ds_read_b64_tr_b16 v[18:19], v196 offset:50176
    v_mfma_f32_16x16x32_bf16 v[68:71], v[0:3], a[164:167], v[68:71]
    v_mfma_f32_16x16x32_bf16 v[72:75], v[0:3], a[168:171], v[72:75]
    v_mfma_f32_16x16x32_bf16 v[76:79], v[0:3], a[172:175], v[76:79]
    v_mfma_f32_16x16x32_bf16 v[92:95], v[4:7], a[172:175], v[92:95]
    ds_read_b64_tr_b16 v[20:21], v197 offset:49152
    ds_read_b64_tr_b16 v[22:23], v197 offset:50176
    v_mfma_f32_16x16x32_bf16 v[88:91], v[4:7], a[168:171], v[88:91]
    v_mfma_f32_16x16x32_bf16 v[84:87], v[4:7], a[164:167], v[84:87]
    v_mfma_f32_16x16x32_bf16 v[80:83], v[4:7], a[160:163], v[80:83]
    s_waitcnt lgkmcnt(4)
    v_mfma_f32_16x16x32_bf16 v[96:99], v[8:11], a[160:163], v[96:99]
    ds_read_b64_tr_b16 v[24:25], v198 offset:49152
    ds_read_b64_tr_b16 v[26:27], v198 offset:50176
    v_mfma_f32_16x16x32_bf16 v[100:103], v[8:11], a[164:167], v[100:103]
    v_mfma_f32_16x16x32_bf16 v[104:107], v[8:11], a[168:171], v[104:107]
    v_mfma_f32_16x16x32_bf16 v[108:111], v[8:11], a[172:175], v[108:111]
    v_mfma_f32_16x16x32_bf16 v[124:127], v[12:15], a[172:175], v[124:127]
    ds_read_b64_tr_b16 v[28:29], v199 offset:49152
    ds_read_b64_tr_b16 v[30:31], v199 offset:50176
    v_mfma_f32_16x16x32_bf16 v[120:123], v[12:15], a[168:171], v[120:123]
    v_mfma_f32_16x16x32_bf16 v[116:119], v[12:15], a[164:167], v[116:119]
    v_mfma_f32_16x16x32_bf16 v[112:115], v[12:15], a[160:163], v[112:115]
    s_waitcnt lgkmcnt(4)
    v_mfma_f32_16x16x32_bf16 v[128:131], v[16:19], a[160:163], v[128:131]
    ds_read_b64_tr_b16 v[32:33], v192 offset:57344
    ds_read_b64_tr_b16 v[34:35], v192 offset:58368
    v_mfma_f32_16x16x32_bf16 v[132:135], v[16:19], a[164:167], v[132:135]
    v_mfma_f32_16x16x32_bf16 v[136:139], v[16:19], a[168:171], v[136:139]
    v_mfma_f32_16x16x32_bf16 v[140:143], v[16:19], a[172:175], v[140:143]
    v_mfma_f32_16x16x32_bf16 v[156:159], v[20:23], a[172:175], v[156:159]
    ds_read_b64_tr_b16 v[36:37], v193 offset:57344
    ds_read_b64_tr_b16 v[38:39], v193 offset:58368
    v_mfma_f32_16x16x32_bf16 v[152:155], v[20:23], a[168:171], v[152:155]
    v_mfma_f32_16x16x32_bf16 v[148:151], v[20:23], a[164:167], v[148:151]
    v_mfma_f32_16x16x32_bf16 v[144:147], v[20:23], a[160:163], v[144:147]
    s_waitcnt lgkmcnt(4)
    v_mfma_f32_16x16x32_bf16 v[160:163], v[24:27], a[160:163], v[160:163]
    ds_read_b64_tr_b16 v[40:41], v194 offset:57344
    ds_read_b64_tr_b16 v[42:43], v194 offset:58368
    v_mfma_f32_16x16x32_bf16 v[164:167], v[24:27], a[164:167], v[164:167]
    v_mfma_f32_16x16x32_bf16 v[168:171], v[24:27], a[168:171], v[168:171]
    v_mfma_f32_16x16x32_bf16 v[172:175], v[24:27], a[172:175], v[172:175]
    v_mfma_f32_16x16x32_bf16 v[188:191], v[28:31], a[172:175], v[188:191]
    ds_read_b64_tr_b16 v[44:45], v195 offset:57344
    ds_read_b64_tr_b16 v[46:47], v195 offset:58368
    v_mfma_f32_16x16x32_bf16 v[184:187], v[28:31], a[168:171], v[184:187]
    v_mfma_f32_16x16x32_bf16 v[180:183], v[28:31], a[164:167], v[180:183]
    v_mfma_f32_16x16x32_bf16 v[176:179], v[28:31], a[160:163], v[176:179]
    s_waitcnt lgkmcnt(4)
    v_mfma_f32_16x16x32_bf16 v[64:67], v[32:35], a[176:179], v[64:67]
    ds_read_b64_tr_b16 v[48:49], v196 offset:57344
    ds_read_b64_tr_b16 v[50:51], v196 offset:58368
    v_mfma_f32_16x16x32_bf16 v[68:71], v[32:35], a[180:183], v[68:71]
    v_mfma_f32_16x16x32_bf16 v[72:75], v[32:35], a[184:187], v[72:75]
    v_mfma_f32_16x16x32_bf16 v[76:79], v[32:35], a[188:191], v[76:79]
    v_mfma_f32_16x16x32_bf16 v[92:95], v[36:39], a[188:191], v[92:95]
    ds_read_b64_tr_b16 v[52:53], v197 offset:57344
    ds_read_b64_tr_b16 v[54:55], v197 offset:58368
    v_mfma_f32_16x16x32_bf16 v[88:91], v[36:39], a[184:187], v[88:91]
    v_mfma_f32_16x16x32_bf16 v[84:87], v[36:39], a[180:183], v[84:87]
    v_mfma_f32_16x16x32_bf16 v[80:83], v[36:39], a[176:179], v[80:83]
    s_waitcnt lgkmcnt(4)
    v_mfma_f32_16x16x32_bf16 v[96:99], v[40:43], a[176:179], v[96:99]
    ds_read_b64_tr_b16 v[56:57], v198 offset:57344
    ds_read_b64_tr_b16 v[58:59], v198 offset:58368
    v_mfma_f32_16x16x32_bf16 v[100:103], v[40:43], a[180:183], v[100:103]
    v_mfma_f32_16x16x32_bf16 v[104:107], v[40:43], a[184:187], v[104:107]
    v_mfma_f32_16x16x32_bf16 v[108:111], v[40:43], a[188:191], v[108:111]
    v_mfma_f32_16x16x32_bf16 v[124:127], v[44:47], a[188:191], v[124:127]
    ds_read_b64_tr_b16 v[60:61], v199 offset:57344
    ds_read_b64_tr_b16 v[62:63], v199 offset:58368
    v_mfma_f32_16x16x32_bf16 v[120:123], v[44:47], a[184:187], v[120:123]
    v_mfma_f32_16x16x32_bf16 v[116:119], v[44:47], a[180:183], v[116:119]
    v_cvt_pk_bf16_f32 v0, v64, v65
    v_mfma_f32_16x16x32_bf16 v[112:115], v[44:47], a[176:179], v[112:115]
    s_waitcnt lgkmcnt(4)
    v_cvt_pk_bf16_f32 v1, v66, v67
    v_mfma_f32_16x16x32_bf16 v[128:131], v[48:51], a[176:179], v[128:131]
    v_cvt_pk_bf16_f32 v2, v80, v81
    v_mfma_f32_16x16x32_bf16 v[132:135], v[48:51], a[180:183], v[132:135]
    v_cvt_pk_bf16_f32 v3, v82, v83
    v_mfma_f32_16x16x32_bf16 v[136:139], v[48:51], a[184:187], v[136:139]
    v_cvt_pk_bf16_f32 v16, v68, v69
    v_mfma_f32_16x16x32_bf16 v[140:143], v[48:51], a[188:191], v[140:143]
    v_cvt_pk_bf16_f32 v17, v70, v71
    v_mfma_f32_16x16x32_bf16 v[156:159], v[52:55], a[188:191], v[156:159]
    v_cvt_pk_bf16_f32 v18, v84, v85
    v_mfma_f32_16x16x32_bf16 v[152:155], v[52:55], a[184:187], v[152:155]
    v_cvt_pk_bf16_f32 v19, v86, v87
    v_mfma_f32_16x16x32_bf16 v[148:151], v[52:55], a[180:183], v[148:151]
    v_cvt_pk_bf16_f32 v4, v96, v97
    v_mfma_f32_16x16x32_bf16 v[144:147], v[52:55], a[176:179], v[144:147]
    s_waitcnt lgkmcnt(0)
    v_cvt_pk_bf16_f32 v5, v98, v99
    v_mfma_f32_16x16x32_bf16 v[160:163], v[56:59], a[176:179], v[160:163]
    v_cvt_pk_bf16_f32 v6, v112, v113
    v_mfma_f32_16x16x32_bf16 v[164:167], v[56:59], a[180:183], v[164:167]
    v_cvt_pk_bf16_f32 v7, v114, v115
    v_mfma_f32_16x16x32_bf16 v[168:171], v[56:59], a[184:187], v[168:171]
    v_cvt_pk_bf16_f32 v20, v100, v101
    v_mfma_f32_16x16x32_bf16 v[172:175], v[56:59], a[188:191], v[172:175]
    v_cvt_pk_bf16_f32 v21, v102, v103
    v_mfma_f32_16x16x32_bf16 v[188:191], v[60:63], a[188:191], v[188:191]
    v_cvt_pk_bf16_f32 v22, v116, v117
    v_mfma_f32_16x16x32_bf16 v[184:187], v[60:63], a[184:187], v[184:187]
    v_cvt_pk_bf16_f32 v23, v118, v119
    v_mfma_f32_16x16x32_bf16 v[180:183], v[60:63], a[180:183], v[180:183]
    v_mfma_f32_16x16x32_bf16 v[176:179], v[60:63], a[176:179], v[176:179]
K2_after:
    s_waitcnt vmcnt(0)
    s_barrier
    ds_read_b128 a[128:131], v212 offset:0
    ds_read_b128 a[132:135], v212 offset:1024
    ds_read_b128 a[136:139], v212 offset:4096
    ds_read_b128 a[140:143], v212 offset:5120
    ds_read_b128 a[144:147], v212 offset:8192
    ds_read_b128 a[148:151], v212 offset:9216
    v_cvt_pk_bf16_f32 v8, v128, v129
    v_cvt_pk_bf16_f32 v9, v130, v131
    v_cvt_pk_bf16_f32 v10, v144, v145
    v_cvt_pk_bf16_f32 v11, v146, v147
    v_cvt_pk_bf16_f32 v12, v160, v161
    v_cvt_pk_bf16_f32 v13, v162, v163
    v_cvt_pk_bf16_f32 v14, v176, v177
    v_cvt_pk_bf16_f32 v15, v178, v179
    v_cvt_pk_bf16_f32 v24, v132, v133
    v_cvt_pk_bf16_f32 v25, v134, v135
    v_cvt_pk_bf16_f32 v26, v148, v149
    v_cvt_pk_bf16_f32 v27, v150, v151
    v_cvt_pk_bf16_f32 v28, v164, v165
    v_cvt_pk_bf16_f32 v29, v166, v167
    v_cvt_pk_bf16_f32 v30, v180, v181
    v_cvt_pk_bf16_f32 v31, v182, v183
    v_cvt_pk_bf16_f32 v32, v72, v73
    v_cvt_pk_bf16_f32 v33, v74, v75
    v_cvt_pk_bf16_f32 v34, v88, v89
    v_cvt_pk_bf16_f32 v35, v90, v91
    v_cvt_pk_bf16_f32 v36, v104, v105
    v_cvt_pk_bf16_f32 v37, v106, v107
    v_cvt_pk_bf16_f32 v38, v120, v121
    v_cvt_pk_bf16_f32 v39, v122, v123
    v_cvt_pk_bf16_f32 v40, v136, v137
    v_cvt_pk_bf16_f32 v41, v138, v139
    v_cvt_pk_bf16_f32 v42, v152, v153
    v_cvt_pk_bf16_f32 v43, v154, v155
    v_cvt_pk_bf16_f32 v44, v168, v169
    v_cvt_pk_bf16_f32 v45, v170, v171
    v_cvt_pk_bf16_f32 v46, v184, v185
    v_cvt_pk_bf16_f32 v47, v186, v187
    v_cvt_pk_bf16_f32 v48, v76, v77
    v_cvt_pk_bf16_f32 v49, v78, v79
    v_cvt_pk_bf16_f32 v50, v92, v93
    v_cvt_pk_bf16_f32 v51, v94, v95
    v_cvt_pk_bf16_f32 v52, v108, v109
    v_cvt_pk_bf16_f32 v53, v110, v111
    v_cvt_pk_bf16_f32 v54, v124, v125
    v_cvt_pk_bf16_f32 v55, v126, v127
    v_cvt_pk_bf16_f32 v56, v140, v141
    v_cvt_pk_bf16_f32 v57, v142, v143
    v_cvt_pk_bf16_f32 v58, v156, v157
    v_cvt_pk_bf16_f32 v59, v158, v159
    v_cvt_pk_bf16_f32 v60, v172, v173
    v_cvt_pk_bf16_f32 v61, v174, v175
    v_cvt_pk_bf16_f32 v62, v188, v189
    v_cvt_pk_bf16_f32 v63, v190, v191
    v_mfma_f32_32x32x16_bf16 v[160:175], v[236:239], v[236:239], 0
    v_mfma_f32_32x32x16_bf16 v[176:191], v[236:239], v[236:239], 0
    v_cmp_gt_i32 s[46:47], 0, v223
    v_cmp_gt_i32 s[48:49], 1, v223
    v_cmp_gt_i32 s[50:51], 2, v223
    v_cmp_gt_i32 s[52:53], 3, v223
    s_add_u32 s31, s31, 32768
    s_add_u32 s32, s32, 16384
    s_lshl_b32 s39, s18, 15
    s_sub_u32 s39, 245760, s39
    s_add_u32 s22, s31, 245760
    ds_write_b128 v219, v[0:3] offset:0
    ds_write_b128 v219, v[4:7] offset:1024
    ds_write_b128 v219, v[8:11] offset:2048
    ds_write_b128 v219, v[12:15] offset:3072
    ds_write_b128 v219, v[16:19] offset:4096
    ds_write_b128 v219, v[20:23] offset:5120
    ds_write_b128 v219, v[24:27] offset:6144
    ds_write_b128 v219, v[28:31] offset:7168
    s_add_u32 s35, s35, 1
    s_cmp_ge_u32 s35, s38
    s_getpc_b64 s[44:45]
    s_cbranch_scc1 K2_mask_25
    s_waitcnt lgkmcnt(12)
    v_mfma_f32_16x16x32_bf16 v[88:91], a[128:131], v[48:51], v[184:187]
    ds_read_b128 a[152:155], v212 offset:12288
    v_mfma_f32_16x16x32_bf16 v[80:83], a[128:131], v[32:35], v[176:179]
    s_add_u32 m0, s43, 98304
    s_lshl_b32 s56, s2, 2
    v_mfma_f32_16x16x32_bf16 v[72:75], a[128:131], v[16:19], v[168:171]
    s_nop 0
    s_add_u32 s56, s56, s16
    v_mfma_f32_16x16x32_bf16 v[64:67], a[128:131], v[0:3], v[160:163]
    buffer_load_dwordx4 v214, s[12:15], s22 offen offset:0 sc1 lds
    v_mfma_f32_16x16x32_bf16 v[68:71], a[132:135], v[0:3], v[164:167]
    s_mul_i32 s57, s56, 6144
    ds_read_b128 a[156:159], v212 offset:13312
    v_mfma_f32_16x16x32_bf16 v[76:79], a[132:135], v[16:19], v[172:175]
    buffer_load_dwordx4 v214, s[12:15], s22 offen offset:1024 sc1 lds
    v_mfma_f32_16x16x32_bf16 v[84:87], a[132:135], v[32:35], v[180:183]
    s_add_u32 s57, s57, 67108864
    v_mfma_f32_16x16x32_bf16 v[92:95], a[132:135], v[48:51], v[188:191]
    s_waitcnt lgkmcnt(12)
    v_mfma_f32_16x16x32_bf16 v[88:91], a[136:139], v[52:55], v[88:91]
    s_add_u32 s58, s57, 6144
    ds_read_b128 a[128:131], v212 offset:2048
    v_mfma_f32_16x16x32_bf16 v[80:83], a[136:139], v[36:39], v[80:83]
    buffer_load_dwordx4 v214, s[12:15], s22 offen offset:2048 sc1 lds
    v_mfma_f32_16x16x32_bf16 v[72:75], a[136:139], v[20:23], v[72:75]
    buffer_load_dwordx4 v214, s[12:15], s22 offen offset:3072 sc1 lds
    v_mfma_f32_16x16x32_bf16 v[64:67], a[136:139], v[4:7], v[64:67]
    s_lshl_b32 s59, s56, 9
    v_mfma_f32_16x16x32_bf16 v[68:71], a[140:143], v[4:7], v[68:71]
    s_lshl_b32 s56, s56, 12
    ds_read_b128 a[132:135], v212 offset:3072
    v_mfma_f32_16x16x32_bf16 v[76:79], a[140:143], v[20:23], v[76:79]
    s_add_u32 m0, s43, 32768
    v_mfma_f32_16x16x32_bf16 v[84:87], a[140:143], v[36:39], v[84:87]
    s_add_u32 s23, s22, 16384
    v_and_b32 v220, 3, v215
    v_mfma_f32_16x16x32_bf16 v[92:95], a[140:143], v[52:55], v[92:95]
    s_waitcnt lgkmcnt(12)
    v_mfma_f32_16x16x32_bf16 v[88:91], a[144:147], v[56:59], v[88:91]
    ds_read_b128 a[136:139], v212 offset:6144
    v_lshlrev_b32 v220, 7, v220
    v_mfma_f32_16x16x32_bf16 v[80:83], a[144:147], v[40:43], v[80:83]
    buffer_load_dwordx4 v214, s[12:15], s23 offen offset:0 sc1 lds
    v_mfma_f32_16x16x32_bf16 v[72:75], a[144:147], v[24:27], v[72:75]
    buffer_load_dwordx4 v214, s[12:15], s23 offen offset:1024 sc1 lds
    v_mfma_f32_16x16x32_bf16 v[64:67], a[144:147], v[8:11], v[64:67]
    buffer_load_dword v235, v220, s[92:95], s59 offen
    v_mfma_f32_16x16x32_bf16 v[68:71], a[148:151], v[8:11], v[68:71]
    ds_read_b128 a[140:143], v212 offset:7168
    v_mfma_f32_16x16x32_bf16 v[76:79], a[148:151], v[24:27], v[76:79]
    buffer_load_dwordx4 v214, s[12:15], s23 offen offset:2048 sc1 lds
    v_mfma_f32_16x16x32_bf16 v[84:87], a[148:151], v[40:43], v[84:87]
    buffer_load_dwordx4 v214, s[12:15], s23 offen offset:3072 sc1 lds
    v_mfma_f32_16x16x32_bf16 v[92:95], a[148:151], v[56:59], v[92:95]
    s_waitcnt lgkmcnt(4)
    v_min_u32 v220, 0x100, v220
    v_accvgpr_write_b32 a236, -1
    v_mfma_f32_16x16x32_bf16 v[88:91], a[152:155], v[60:63], v[88:91]
    ds_read_b128 a[144:147], v212 offset:10240
    v_mfma_f32_16x16x32_bf16 v[80:83], a[152:155], v[44:47], v[80:83]
    s_add_u32 s35, s35, 1
    v_accvgpr_write_b32 a237, -1
    v_mfma_f32_16x16x32_bf16 v[72:75], a[152:155], v[28:31], v[72:75]
    s_cmp_ge_u32 s35, s38
    s_getpc_b64 s[44:45]
    s_cbranch_scc1 K2_mask_25
    v_mfma_f32_16x16x32_bf16 v[64:67], a[152:155], v[12:15], v[64:67]
    v_accvgpr_write_b32 a238, -1
    v_mfma_f32_16x16x32_bf16 v[68:71], a[156:159], v[12:15], v[68:71]
    ds_read_b128 a[148:151], v212 offset:11264
    v_mfma_f32_16x16x32_bf16 v[76:79], a[156:159], v[28:31], v[76:79]
    v_accvgpr_write_b32 a239, -1
    v_mfma_f32_16x16x32_bf16 v[84:87], a[156:159], v[44:47], v[84:87]
    v_mfma_f32_16x16x32_bf16 v[92:95], a[156:159], v[60:63], v[92:95]
    ds_read_b128 a[152:155], v212 offset:14336
    ds_read_b128 a[156:159], v212 offset:15360
    v_xor_b32 v212, 0x10000, v212
    s_nop 4
    v_max3_f32 v224, v64, v65, v66
    v_max3_f32 v192, v67, v68, v69
    v_max3_f32 v226, v72, v73, v74
    v_max3_f32 v193, v75, v76, v77
    v_max3_f32 v228, v80, v81, v82
    v_max3_f32 v194, v83, v84, v85
    v_max3_f32 v230, v88, v89, v90
    v_max3_f32 v195, v91, v92, v93
    v_max3_f32 v224, v224, v70, v71
    v_max3_f32 v226, v226, v78, v79
    v_max3_f32 v228, v228, v86, v87
    v_max3_f32 v230, v230, v94, v95
    v_max_f32 v224, v224, v192
    v_max_f32 v226, v226, v193
    v_max_f32 v228, v228, v194
    v_max_f32 v230, v230, v195
    v_mov_b32 v192, v224
    v_mov_b32 v193, v226
    v_mov_b32 v194, v228
    v_mov_b32 v195, v230
    v_permlane16_swap_b32 v224, v192
    v_permlane16_swap_b32 v226, v193
    v_permlane16_swap_b32 v228, v194
    v_permlane16_swap_b32 v230, v195
    v_max_f32 v224, v224, v192
    v_max_f32 v226, v226, v193
    v_max_f32 v228, v228, v194
    v_max_f32 v230, v230, v195
    v_mov_b32 v192, v224
    v_mov_b32 v193, v226
    v_mov_b32 v194, v228
    v_mov_b32 v195, v230
    v_permlane32_swap_b32 v224, v192
    v_permlane32_swap_b32 v226, v193
    v_permlane32_swap_b32 v228, v194
    v_permlane32_swap_b32 v230, v195
    v_max_f32 v224, v224, v192
    v_max_f32 v226, v226, v193
    v_max_f32 v228, v228, v194
    v_max_f32 v230, v230, v195
    v_add_f32 v224, 0x42c00000, v224
    v_add_f32 v226, 0x42c00000, v226
    v_add_f32 v228, 0x42c00000, v228
    v_add_f32 v230, 0x42c00000, v230
    v_mov_b32 v208, v224
    v_pk_add_f32 v[160:161], v[160:161], v[224:225] op_sel_hi:[1,0] neg_lo:[0,1] neg_hi:[0,1]
    v_pk_add_f32 v[162:163], v[162:163], v[224:225] op_sel_hi:[1,0] neg_lo:[0,1] neg_hi:[0,1]
    v_pk_add_f32 v[164:165], v[164:165], v[224:225] op_sel_hi:[1,0] neg_lo:[0,1] neg_hi:[0,1]
    v_pk_add_f32 v[166:167], v[166:167], v[224:225] op_sel_hi:[1,0] neg_lo:[0,1] neg_hi:[0,1]
    v_mov_b32 v209, v226
    v_pk_add_f32 v[168:169], v[168:169], v[226:227] op_sel_hi:[1,0] neg_lo:[0,1] neg_hi:[0,1]
    v_pk_add_f32 v[170:171], v[170:171], v[226:227] op_sel_hi:[1,0] neg_lo:[0,1] neg_hi:[0,1]
    v_pk_add_f32 v[172:173], v[172:173], v[226:227] op_sel_hi:[1,0] neg_lo:[0,1] neg_hi:[0,1]
    v_pk_add_f32 v[174:175], v[174:175], v[226:227] op_sel_hi:[1,0] neg_lo:[0,1] neg_hi:[0,1]
    v_mov_b32 v210, v228
    v_pk_add_f32 v[176:177], v[176:177], v[228:229] op_sel_hi:[1,0] neg_lo:[0,1] neg_hi:[0,1]
    v_pk_add_f32 v[178:179], v[178:179], v[228:229] op_sel_hi:[1,0] neg_lo:[0,1] neg_hi:[0,1]
    v_pk_add_f32 v[180:181], v[180:181], v[228:229] op_sel_hi:[1,0] neg_lo:[0,1] neg_hi:[0,1]
    v_pk_add_f32 v[182:183], v[182:183], v[228:229] op_sel_hi:[1,0] neg_lo:[0,1] neg_hi:[0,1]
    v_mov_b32 v211, v230
    v_pk_add_f32 v[184:185], v[184:185], v[230:231] op_sel_hi:[1,0] neg_lo:[0,1] neg_hi:[0,1]
    v_pk_add_f32 v[186:187], v[186:187], v[230:231] op_sel_hi:[1,0] neg_lo:[0,1] neg_hi:[0,1]
    v_pk_add_f32 v[188:189], v[188:189], v[230:231] op_sel_hi:[1,0] neg_lo:[0,1] neg_hi:[0,1]
    v_pk_add_f32 v[190:191], v[190:191], v[230:231] op_sel_hi:[1,0] neg_lo:[0,1] neg_hi:[0,1]
    v_pk_add_f32 v[64:65], v[64:65], v[224:225] op_sel_hi:[1,0] neg_lo:[0,1] neg_hi:[0,1]
    v_pk_add_f32 v[66:67], v[66:67], v[224:225] op_sel_hi:[1,0] neg_lo:[0,1] neg_hi:[0,1]
    v_pk_add_f32 v[68:69], v[68:69], v[224:225] op_sel_hi:[1,0] neg_lo:[0,1] neg_hi:[0,1]
    v_pk_add_f32 v[70:71], v[70:71], v[224:225] op_sel_hi:[1,0] neg_lo:[0,1] neg_hi:[0,1]
    v_pk_add_f32 v[72:73], v[72:73], v[226:227] op_sel_hi:[1,0] neg_lo:[0,1] neg_hi:[0,1]
    v_pk_add_f32 v[74:75], v[74:75], v[226:227] op_sel_hi:[1,0] neg_lo:[0,1] neg_hi:[0,1]
    v_pk_add_f32 v[76:77], v[76:77], v[226:227] op_sel_hi:[1,0] neg_lo:[0,1] neg_hi:[0,1]
    v_pk_add_f32 v[78:79], v[78:79], v[226:227] op_sel_hi:[1,0] neg_lo:[0,1] neg_hi:[0,1]
    v_pk_add_f32 v[80:81], v[80:81], v[228:229] op_sel_hi:[1,0] neg_lo:[0,1] neg_hi:[0,1]
    v_pk_add_f32 v[82:83], v[82:83], v[228:229] op_sel_hi:[1,0] neg_lo:[0,1] neg_hi:[0,1]
    v_pk_add_f32 v[84:85], v[84:85], v[228:229] op_sel_hi:[1,0] neg_lo:[0,1] neg_hi:[0,1]
    v_pk_add_f32 v[86:87], v[86:87], v[228:229] op_sel_hi:[1,0] neg_lo:[0,1] neg_hi:[0,1]
    v_pk_add_f32 v[88:89], v[88:89], v[230:231] op_sel_hi:[1,0] neg_lo:[0,1] neg_hi:[0,1]
    v_pk_add_f32 v[90:91], v[90:91], v[230:231] op_sel_hi:[1,0] neg_lo:[0,1] neg_hi:[0,1]
    v_pk_add_f32 v[92:93], v[92:93], v[230:231] op_sel_hi:[1,0] neg_lo:[0,1] neg_hi:[0,1]
    v_pk_add_f32 v[94:95], v[94:95], v[230:231] op_sel_hi:[1,0] neg_lo:[0,1] neg_hi:[0,1]
    s_waitcnt lgkmcnt(0)
    v_mfma_f32_16x16x32_bf16 v[120:123], a[128:131], v[48:51], v[184:187]
    v_exp_f32 v192, v64
    v_mfma_f32_16x16x32_bf16 v[112:115], a[128:131], v[32:35], v[176:179]
    s_waitcnt vmcnt(9) lgkmcnt(0)
    s_barrier
    v_mfma_f32_16x16x32_bf16 v[104:107], a[128:131], v[16:19], v[168:171]
    v_exp_f32 v193, v65
    v_mfma_f32_16x16x32_bf16 v[96:99], a[128:131], v[0:3], v[160:163]
    v_exp_f32 v194, v66
    v_mfma_f32_16x16x32_bf16 v[100:103], a[132:135], v[0:3], v[164:167]
    v_cvt_pk_bf16_f32 v128, v192, v193
    v_mfma_f32_16x16x32_bf16 v[108:111], a[132:135], v[16:19], v[172:175]
    v_exp_f32 v195, v67
    v_mfma_f32_16x16x32_bf16 v[116:119], a[132:135], v[32:35], v[180:183]
    v_exp_f32 v196, v68
    v_mfma_f32_16x16x32_bf16 v[124:127], a[132:135], v[48:51], v[188:191]
    v_cvt_pk_bf16_f32 v129, v194, v195
    v_exp_f32 v197, v69
    v_mfma_f32_16x16x32_bf16 v[120:123], a[136:139], v[52:55], v[120:123]
    ds_read_b128 a[128:131], v212 offset:0
    v_mfma_f32_16x16x32_bf16 v[112:115], a[136:139], v[36:39], v[112:115]
    v_exp_f32 v198, v70
    v_cvt_pk_bf16_f32 v130, v196, v197
    v_exp_f32 v199, v71
    v_mfma_f32_16x16x32_bf16 v[104:107], a[136:139], v[20:23], v[104:107]
    v_exp_f32 v192, v72
    v_cvt_pk_bf16_f32 v131, v198, v199
    v_mfma_f32_16x16x32_bf16 v[96:99], a[136:139], v[4:7], v[96:99]
    v_exp_f32 v193, v73
    v_exp_f32 v194, v74
    v_cvt_pk_bf16_f32 v132, v192, v193
    v_mfma_f32_16x16x32_bf16 v[100:103], a[140:143], v[4:7], v[100:103]
    ds_read_b128 a[132:135], v212 offset:1024
    v_mfma_f32_16x16x32_bf16 a[192:195], a[208:211], v[128:131], a[192:195]
    v_mfma_f32_16x16x32_bf16 v[108:111], a[140:143], v[20:23], v[108:111]
    v_exp_f32 v195, v75
    v_exp_f32 v196, v76
    v_cvt_pk_bf16_f32 v133, v194, v195
    v_mfma_f32_16x16x32_bf16 v[116:119], a[140:143], v[36:39], v[116:119]
    v_exp_f32 v197, v77
    v_exp_f32 v198, v78
    v_mfma_f32_16x16x32_bf16 v[124:127], a[140:143], v[52:55], v[124:127]
    v_cvt_pk_bf16_f32 v134, v196, v197
    v_exp_f32 v199, v79
    v_mfma_f32_16x16x32_bf16 v[120:123], a[144:147], v[56:59], v[120:123]
    ds_read_b128 a[136:139], v212 offset:4096
    v_exp_f32 v192, v80
    v_cvt_pk_bf16_f32 v135, v198, v199
    v_exp_f32 v193, v81
    v_mfma_f32_16x16x32_bf16 v[112:115], a[144:147], v[40:43], v[112:115]
    v_exp_f32 v194, v82
    v_cvt_pk_bf16_f32 v136, v192, v193
    v_mfma_f32_16x16x32_bf16 v[104:107], a[144:147], v[24:27], v[104:107]
    v_mfma_f32_16x16x32_bf16 a[196:199], a[208:211], v[132:135], a[196:199]
    v_exp_f32 v195, v83
    v_mfma_f32_16x16x32_bf16 v[96:99], a[144:147], v[8:11], v[96:99]
    v_exp_f32 v196, v84
    v_cvt_pk_bf16_f32 v137, v194, v195
    v_accvgpr_read_b32 v200, a192
    v_mfma_f32_16x16x32_bf16 v[100:103], a[148:151], v[8:11], v[100:103]
    ds_read_b128 a[140:143], v212 offset:5120
    v_exp_f32 v197, v85
    v_exp_f32 v198, v86
    v_mfma_f32_16x16x32_bf16 v[108:111], a[148:151], v[24:27], v[108:111]
    v_cvt_pk_bf16_f32 v138, v196, v197
    v_exp_f32 v199, v87
    v_mfma_f32_16x16x32_bf16 v[116:119], a[148:151], v[40:43], v[116:119]
    v_exp_f32 v192, v88
    v_cvt_pk_bf16_f32 v139, v198, v199
    v_exp_f32 v193, v89
    v_exp_f32 v194, v90
    v_cvt_pk_bf16_f32 v140, v192, v193
    v_mfma_f32_16x16x32_bf16 a[200:203], a[208:211], v[136:139], a[200:203]
    v_exp_f32 v195, v91
    v_exp_f32 v196, v92
    v_cvt_pk_bf16_f32 v141, v194, v195
    v_accvgpr_read_b32 v201, a196
    v_exp_f32 v197, v93
    v_exp_f32 v198, v94
    v_cvt_pk_bf16_f32 v142, v196, v197
    v_exp_f32 v199, v95
    v_nop
    v_cvt_pk_bf16_f32 v143, v198, v199
    v_mfma_f32_16x16x32_bf16 v[124:127], a[148:151], v[56:59], v[124:127]
    v_nop
    v_mfma_f32_16x16x32_bf16 a[204:207], a[208:211], v[140:143], a[204:207]
    v_mfma_f32_16x16x32_bf16 v[120:123], a[152:155], v[60:63], v[120:123]
    s_add_u32 s35, s35, 1
    ds_read_b128 a[144:147], v212 offset:8192
    s_add_u32 m0, s33, 0
    v_mfma_f32_16x16x32_bf16 v[112:115], a[152:155], v[44:47], v[112:115]
    s_cmp_ge_u32 s35, s38
    v_accvgpr_read_b32 v202, a200
    s_getpc_b64 s[44:45]
    s_cbranch_scc1 K2_mask_25
    v_mfma_f32_16x16x32_bf16 v[104:107], a[152:155], v[28:31], v[104:107]
    s_nop 0
    v_mfma_f32_16x16x32_bf16 v[96:99], a[152:155], v[12:15], v[96:99]
    buffer_load_dwordx4 v214, s[12:15], s31 offen offset:0 sc1 lds
    v_mfma_f32_16x16x32_bf16 v[100:103], a[156:159], v[12:15], v[100:103]
    ds_read_b128 a[148:151], v212 offset:9216
    v_mfma_f32_16x16x32_bf16 v[108:111], a[156:159], v[28:31], v[108:111]
    buffer_load_dwordx4 v214, s[12:15], s31 offen offset:1024 sc1 lds
    v_mfma_f32_16x16x32_bf16 v[116:119], a[156:159], v[44:47], v[116:119]
    v_accvgpr_read_b32 v203, a204
    v_mfma_f32_16x16x32_bf16 v[124:127], a[156:159], v[60:63], v[124:127]
    buffer_load_dwordx4 v214, s[12:15], s31 offen offset:2048 sc1 lds
    buffer_load_dwordx4 v214, s[12:15], s31 offen offset:3072 sc1 lds
    s_add_u32 s31, s31, 16384
    s_xor_b32 s33, s33, 0x10000
    s_nop 3
    v_exp_f32 v192, v96
    v_exp_f32 v193, v97
    v_exp_f32 v194, v98
    v_cvt_pk_bf16_f32 v144, v192, v193
    v_exp_f32 v195, v99
    v_exp_f32 v196, v100
    v_cvt_pk_bf16_f32 v145, v194, v195
    v_exp_f32 v197, v101
    s_lshl_b32 s25, s18, 1
    s_add_u32 s25, s25, 1
    .p2align 3
K2_dual_28:
    s_waitcnt lgkmcnt(2)
    v_mfma_f32_16x16x32_bf16 v[88:91], a[128:131], v[48:51], v[184:187]
    s_add_u32 m0, s34, 0
    v_exp_f32 v198, v102
    v_mfma_f32_16x16x32_bf16 v[80:83], a[128:131], v[32:35], v[176:179]
    s_nop 0
    ds_read_b128 a[152:155], v212 offset:12288
    v_cvt_pk_bf16_f32 v146, v196, v197
    v_mfma_f32_16x16x32_bf16 v[72:75], a[128:131], v[16:19], v[168:171]
    v_exp_f32 v199, v103
    v_mfma_f32_16x16x32_bf16 v[64:67], a[128:131], v[0:3], v[160:163]
    buffer_load_dwordx4 v214, s[12:15], s32 offen offset:0 sc1 lds
    v_mfma_f32_16x16x32_bf16 v[68:71], a[132:135], v[0:3], v[164:167]
    v_exp_f32 v192, v104
    v_mfma_f32_16x16x32_bf16 v[76:79], a[132:135], v[16:19], v[172:175]
    ds_read_b128 a[156:159], v212 offset:13312
    v_cvt_pk_bf16_f32 v147, v198, v199
    v_mfma_f32_16x16x32_bf16 v[84:87], a[132:135], v[32:35], v[180:183]
    v_exp_f32 v193, v105
    v_mfma_f32_16x16x32_bf16 v[92:95], a[132:135], v[48:51], v[188:191]
    buffer_load_dwordx4 v214, s[12:15], s32 offen offset:1024 sc1 lds
    v_mfma_f32_16x16x32_bf16 a[192:195], a[208:211], v[144:147], a[192:195]
    buffer_load_dwordx4 v214, s[12:15], s32 offen offset:2048 sc1 lds
    v_mfma_f32_16x16x32_bf16 v[88:91], a[136:139], v[52:55], v[88:91]
    v_exp_f32 v194, v106
    v_mfma_f32_16x16x32_bf16 v[80:83], a[136:139], v[36:39], v[80:83]
    ds_read_b128 a[160:163], v213 offset:16384
    v_cvt_pk_bf16_f32 v148, v192, v193
    v_mfma_f32_16x16x32_bf16 v[72:75], a[136:139], v[20:23], v[72:75]
    v_exp_f32 v195, v107
    v_mfma_f32_16x16x32_bf16 v[64:67], a[136:139], v[4:7], v[64:67]
    ds_read_b128 a[164:167], v213 offset:17408
    v_accvgpr_read_b32 v204, a192
    v_mfma_f32_16x16x32_bf16 v[68:71], a[140:143], v[4:7], v[68:71]
    v_exp_f32 v196, v108
    v_mfma_f32_16x16x32_bf16 v[76:79], a[140:143], v[20:23], v[76:79]
    ds_read_b128 a[168:171], v213 offset:20480
    v_cvt_pk_bf16_f32 v149, v194, v195
    v_mfma_f32_16x16x32_bf16 v[84:87], a[140:143], v[36:39], v[84:87]
    v_exp_f32 v197, v109
    v_mfma_f32_16x16x32_bf16 v[92:95], a[140:143], v[52:55], v[92:95]
    s_waitcnt lgkmcnt(3)
    v_mfma_f32_16x16x32_bf16 v[88:91], a[144:147], v[56:59], v[88:91]
    v_exp_f32 v198, v110
    v_mfma_f32_16x16x32_bf16 v[80:83], a[144:147], v[40:43], v[80:83]
    ds_read_b128 a[172:175], v213 offset:21504
    v_cvt_pk_bf16_f32 v150, v196, v197
    v_mfma_f32_16x16x32_bf16 v[72:75], a[144:147], v[24:27], v[72:75]
    v_exp_f32 v199, v111
    v_mfma_f32_16x16x32_bf16 v[64:67], a[144:147], v[8:11], v[64:67]
    buffer_load_dwordx4 v214, s[12:15], s32 offen offset:3072 sc1 lds
    v_mfma_f32_16x16x32_bf16 v[68:71], a[148:151], v[8:11], v[68:71]
    s_add_u32 s32, s32, 16384
    v_exp_f32 v192, v112
    v_mfma_f32_16x16x32_bf16 v[76:79], a[148:151], v[24:27], v[76:79]
    s_xor_b32 s34, s34, 0x10000
    ds_read_b128 a[176:179], v213 offset:24576
    v_cvt_pk_bf16_f32 v151, v198, v199
    v_mfma_f32_16x16x32_bf16 v[84:87], a[148:151], v[40:43], v[84:87]
    v_exp_f32 v193, v113
    v_mfma_f32_16x16x32_bf16 v[92:95], a[148:151], v[56:59], v[92:95]
    v_mfma_f32_16x16x32_bf16 a[196:199], a[208:211], v[148:151], a[196:199]
    v_mfma_f32_16x16x32_bf16 v[88:91], a[152:155], v[60:63], v[88:91]
    v_exp_f32 v194, v114
    v_mfma_f32_16x16x32_bf16 v[80:83], a[152:155], v[44:47], v[80:83]
    ds_read_b128 a[180:183], v213 offset:25600
    v_cvt_pk_bf16_f32 v152, v192, v193
    v_mfma_f32_16x16x32_bf16 v[72:75], a[152:155], v[28:31], v[72:75]
    v_exp_f32 v195, v115
    v_mfma_f32_16x16x32_bf16 v[64:67], a[152:155], v[12:15], v[64:67]
    ds_read_b128 a[184:187], v213 offset:28672
    v_accvgpr_read_b32 v205, a196
    v_mfma_f32_16x16x32_bf16 v[68:71], a[156:159], v[12:15], v[68:71]
    v_exp_f32 v196, v116
    v_mfma_f32_16x16x32_bf16 v[76:79], a[156:159], v[28:31], v[76:79]
    ds_read_b128 a[188:191], v213 offset:29696
    v_cvt_pk_bf16_f32 v153, v194, v195
    v_mfma_f32_16x16x32_bf16 v[84:87], a[156:159], v[44:47], v[84:87]
    v_exp_f32 v197, v117
    v_mfma_f32_16x16x32_bf16 v[92:95], a[156:159], v[60:63], v[92:95]
    s_waitcnt lgkmcnt(4)
    v_mfma_f32_16x16x32_bf16 a[0:3], a[160:163], v[128:131], a[0:3]
    v_exp_f32 v198, v118
    v_mfma_f32_16x16x32_bf16 a[4:7], a[164:167], v[128:131], a[4:7]
    ds_read_b128 a[128:131], v212 offset:2048
    v_cvt_pk_bf16_f32 v154, v196, v197
    v_mfma_f32_16x16x32_bf16 a[8:11], a[168:171], v[128:131], a[8:11]
    v_exp_f32 v199, v119
    v_mfma_f32_16x16x32_bf16 a[12:15], a[172:175], v[128:131], a[12:15]
    s_waitcnt lgkmcnt(1)
    v_mfma_f32_16x16x32_bf16 a[16:19], a[176:179], v[128:131], a[16:19]
    v_exp_f32 v192, v120
    v_mfma_f32_16x16x32_bf16 a[20:23], a[180:183], v[128:131], a[20:23]
    ds_read_b128 a[132:135], v212 offset:3072
    v_cvt_pk_bf16_f32 v155, v198, v199
    v_mfma_f32_16x16x32_bf16 a[24:27], a[184:187], v[128:131], a[24:27]
    v_exp_f32 v193, v121
    v_mfma_f32_16x16x32_bf16 a[28:31], a[188:191], v[128:131], a[28:31]
    v_mfma_f32_16x16x32_bf16 a[200:203], a[208:211], v[152:155], a[200:203]
    v_mfma_f32_16x16x32_bf16 a[60:63], a[188:191], v[132:135], a[60:63]
    v_exp_f32 v194, v122
    v_mfma_f32_16x16x32_bf16 a[56:59], a[184:187], v[132:135], a[56:59]
    ds_read_b128 a[136:139], v212 offset:6144
    v_cvt_pk_bf16_f32 v156, v192, v193
    v_mfma_f32_16x16x32_bf16 a[52:55], a[180:183], v[132:135], a[52:55]
    v_exp_f32 v195, v123
    v_mfma_f32_16x16x32_bf16 a[48:51], a[176:179], v[132:135], a[48:51]
    v_accvgpr_read_b32 v206, a200
    v_max3_f32 v216, v204, v205, v206
    v_mfma_f32_16x16x32_bf16 a[44:47], a[172:175], v[132:135], a[44:47]
    v_exp_f32 v196, v124
    v_mfma_f32_16x16x32_bf16 a[40:43], a[168:171], v[132:135], a[40:43]
    ds_read_b128 a[140:143], v212 offset:7168
    v_cvt_pk_bf16_f32 v157, v194, v195
    v_mfma_f32_16x16x32_bf16 a[36:39], a[164:167], v[132:135], a[36:39]
    v_exp_f32 v197, v125
    v_mfma_f32_16x16x32_bf16 a[32:35], a[160:163], v[132:135], a[32:35]
    ds_read_b128 a[144:147], v212 offset:10240
    v_mfma_f32_16x16x32_bf16 a[64:67], a[160:163], v[136:139], a[64:67]
    v_exp_f32 v198, v126
    v_mfma_f32_16x16x32_bf16 a[68:71], a[164:167], v[136:139], a[68:71]
    ds_read_b128 a[148:151], v212 offset:11264
    v_cvt_pk_bf16_f32 v158, v196, v197
    v_mfma_f32_16x16x32_bf16 a[72:75], a[168:171], v[136:139], a[72:75]
    s_add_u32 s35, s35, 1
    v_exp_f32 v199, v127
    v_mfma_f32_16x16x32_bf16 a[76:79], a[172:175], v[136:139], a[76:79]
    s_cmp_ge_u32 s35, s38
    s_getpc_b64 s[44:45]
    s_cbranch_scc1 K2_mask_25
    v_mfma_f32_16x16x32_bf16 a[80:83], a[176:179], v[136:139], a[80:83]
    v_exp_f32 v192, v64
    v_mfma_f32_16x16x32_bf16 a[84:87], a[180:183], v[136:139], a[84:87]
    ds_read_b128 a[152:155], v212 offset:14336
    v_cvt_pk_bf16_f32 v159, v198, v199
    v_mfma_f32_16x16x32_bf16 a[88:91], a[184:187], v[136:139], a[88:91]
    v_exp_f32 v193, v65
    v_mfma_f32_16x16x32_bf16 a[92:95], a[188:191], v[136:139], a[92:95]
    buffer_load_dword v235, v220, s[88:91], s56 offen
    v_mfma_f32_16x16x32_bf16 a[204:207], a[208:211], v[156:159], a[204:207]
    s_add_u32 s56, s56, 384
    v_mfma_f32_16x16x32_bf16 a[124:127], a[188:191], v[140:143], a[124:127]
    v_exp_f32 v194, v66
    v_mfma_f32_16x16x32_bf16 a[120:123], a[184:187], v[140:143], a[120:123]
    ds_read_b128 a[156:159], v212 offset:15360
    v_cvt_pk_bf16_f32 v128, v192, v193
    v_mfma_f32_16x16x32_bf16 a[116:119], a[180:183], v[140:143], a[116:119]
    v_exp_f32 v195, v67
    v_mfma_f32_16x16x32_bf16 a[112:115], a[176:179], v[140:143], a[112:115]
    v_accvgpr_read_b32 v207, a204
    v_max_f32 v216, v216, v207
    v_mfma_f32_16x16x32_bf16 a[108:111], a[172:175], v[140:143], a[108:111]
    v_exp_f32 v196, v68
    v_mfma_f32_16x16x32_bf16 a[104:107], a[168:171], v[140:143], a[104:107]
    v_cmp_nle_f32 vcc, v216, v218
    v_cvt_pk_bf16_f32 v129, v194, v195
    v_mfma_f32_16x16x32_bf16 a[100:103], a[164:167], v[140:143], a[100:103]
    v_exp_f32 v197, v69
    v_mfma_f32_16x16x32_bf16 a[96:99], a[160:163], v[140:143], a[96:99]
    s_waitcnt lgkmcnt(4)
    v_xor_b32 v212, 0x10000, v212
    s_cbranch_vccnz K2_st_29
K2_rt_30:
    v_mfma_f32_16x16x32_bf16 v[120:123], a[128:131], v[48:51], v[184:187]
    v_exp_f32 v198, v70
    v_mfma_f32_16x16x32_bf16 v[112:115], a[128:131], v[32:35], v[176:179]
    ds_read_b128 a[160:163], v213 offset:18432
    v_cvt_pk_bf16_f32 v130, v196, v197
    v_mfma_f32_16x16x32_bf16 v[104:107], a[128:131], v[16:19], v[168:171]
    v_exp_f32 v199, v71
    v_mfma_f32_16x16x32_bf16 v[96:99], a[128:131], v[0:3], v[160:163]
    buffer_store_dwordx4 a[236:239], v214, s[12:15], s57 offen sc1
    v_mfma_f32_16x16x32_bf16 v[100:103], a[132:135], v[0:3], v[164:167]
    s_add_u32 s57, s57, 1024
    v_exp_f32 v192, v72
    v_mfma_f32_16x16x32_bf16 v[108:111], a[132:135], v[16:19], v[172:175]
    ds_read_b128 a[164:167], v213 offset:19456
    v_cvt_pk_bf16_f32 v131, v198, v199
    v_mfma_f32_16x16x32_bf16 v[116:119], a[132:135], v[32:35], v[180:183]
    v_exp_f32 v193, v73
    v_mfma_f32_16x16x32_bf16 v[124:127], a[132:135], v[48:51], v[188:191]
    s_cmp_ge_u32 s57, s58
    s_cselect_b32 s57, s14, s57
    v_mfma_f32_16x16x32_bf16 a[192:195], a[208:211], v[128:131], a[192:195]
    v_mfma_f32_16x16x32_bf16 v[120:123], a[136:139], v[52:55], v[120:123]
    v_exp_f32 v194, v74
    v_mfma_f32_16x16x32_bf16 v[112:115], a[136:139], v[36:39], v[112:115]
    ds_read_b128 a[168:171], v213 offset:22528
    v_cvt_pk_bf16_f32 v132, v192, v193
    v_mfma_f32_16x16x32_bf16 v[104:107], a[136:139], v[20:23], v[104:107]
    v_exp_f32 v195, v75
    v_mfma_f32_16x16x32_bf16 v[96:99], a[136:139], v[4:7], v[96:99]
    ds_read_b128 a[172:175], v213 offset:23552
    v_accvgpr_read_b32 v200, a192
    v_mfma_f32_16x16x32_bf16 v[100:103], a[140:143], v[4:7], v[100:103]
    v_exp_f32 v196, v76
    v_mfma_f32_16x16x32_bf16 v[108:111], a[140:143], v[20:23], v[108:111]
    ds_read_b128 a[176:179], v213 offset:26624
    v_cvt_pk_bf16_f32 v133, v194, v195
    v_mfma_f32_16x16x32_bf16 v[116:119], a[140:143], v[36:39], v[116:119]
    v_exp_f32 v197, v77
    v_mfma_f32_16x16x32_bf16 v[124:127], a[140:143], v[52:55], v[124:127]
    s_waitcnt lgkmcnt(5)
    v_mfma_f32_16x16x32_bf16 v[120:123], a[144:147], v[56:59], v[120:123]
    v_exp_f32 v198, v78
    v_mfma_f32_16x16x32_bf16 v[112:115], a[144:147], v[40:43], v[112:115]
    ds_read_b128 a[180:183], v213 offset:27648
    v_cvt_pk_bf16_f32 v134, v196, v197
    v_mfma_f32_16x16x32_bf16 v[104:107], a[144:147], v[24:27], v[104:107]
    v_exp_f32 v199, v79
    v_mfma_f32_16x16x32_bf16 v[96:99], a[144:147], v[8:11], v[96:99]
    v_mfma_f32_16x16x32_bf16 v[100:103], a[148:151], v[8:11], v[100:103]
    s_sub_u32 s25, s25, 1
    v_exp_f32 v192, v80
    v_mfma_f32_16x16x32_bf16 v[108:111], a[148:151], v[24:27], v[108:111]
    ds_read_b128 a[184:187], v213 offset:30720
    v_cvt_pk_bf16_f32 v135, v198, v199
    v_mfma_f32_16x16x32_bf16 v[116:119], a[148:151], v[40:43], v[116:119]
    s_add_u32 s35, s35, 1
    v_exp_f32 v193, v81
    v_mfma_f32_16x16x32_bf16 v[124:127], a[148:151], v[56:59], v[124:127]
    s_cmp_ge_u32 s35, s38
    s_getpc_b64 s[44:45]
    s_cbranch_scc1 K2_mask_25
    v_mfma_f32_16x16x32_bf16 a[196:199], a[208:211], v[132:135], a[196:199]
    v_mfma_f32_16x16x32_bf16 v[120:123], a[152:155], v[60:63], v[120:123]
    v_exp_f32 v194, v82
    v_mfma_f32_16x16x32_bf16 v[112:115], a[152:155], v[44:47], v[112:115]
    ds_read_b128 a[188:191], v213 offset:31744
    v_cvt_pk_bf16_f32 v136, v192, v193
    v_mfma_f32_16x16x32_bf16 v[104:107], a[152:155], v[28:31], v[104:107]
    v_exp_f32 v195, v83
    v_mfma_f32_16x16x32_bf16 v[96:99], a[152:155], v[12:15], v[96:99]
    v_accvgpr_read_b32 v201, a196
    v_xor_b32 v213, 0x10000, v213
    v_mfma_f32_16x16x32_bf16 v[100:103], a[156:159], v[12:15], v[100:103]
    v_exp_f32 v196, v84
    v_mfma_f32_16x16x32_bf16 v[108:111], a[156:159], v[28:31], v[108:111]
    v_cvt_pk_bf16_f32 v137, v194, v195
    v_mfma_f32_16x16x32_bf16 v[116:119], a[156:159], v[44:47], v[116:119]
    v_exp_f32 v197, v85
    v_mfma_f32_16x16x32_bf16 v[124:127], a[156:159], v[60:63], v[124:127]
    s_waitcnt lgkmcnt(0)
    s_waitcnt vmcnt(2) lgkmcnt(0)
    s_barrier
    v_mfma_f32_16x16x32_bf16 a[0:3], a[160:163], v[144:147], a[0:3]
    s_add_u32 m0, s33, 0
    v_exp_f32 v198, v86
    v_mfma_f32_16x16x32_bf16 a[4:7], a[164:167], v[144:147], a[4:7]
    s_nop 0
    v_cvt_pk_bf16_f32 v138, v196, v197
    v_mfma_f32_16x16x32_bf16 a[8:11], a[168:171], v[144:147], a[8:11]
    v_exp_f32 v199, v87
    v_mfma_f32_16x16x32_bf16 a[12:15], a[172:175], v[144:147], a[12:15]
    buffer_load_dwordx4 v214, s[12:15], s31 offen offset:0 sc1 lds
    v_mfma_f32_16x16x32_bf16 a[16:19], a[176:179], v[144:147], a[16:19]
    v_exp_f32 v192, v88
    v_mfma_f32_16x16x32_bf16 a[20:23], a[180:183], v[144:147], a[20:23]
    ds_read_b128 a[128:131], v212 offset:0
    v_cvt_pk_bf16_f32 v139, v198, v199
    v_mfma_f32_16x16x32_bf16 a[24:27], a[184:187], v[144:147], a[24:27]
    v_exp_f32 v193, v89
    v_mfma_f32_16x16x32_bf16 a[28:31], a[188:191], v[144:147], a[28:31]
    buffer_load_dwordx4 v214, s[12:15], s31 offen offset:1024 sc1 lds
    v_mfma_f32_16x16x32_bf16 a[200:203], a[208:211], v[136:139], a[200:203]
    buffer_load_dwordx4 v214, s[12:15], s31 offen offset:2048 sc1 lds
    v_mfma_f32_16x16x32_bf16 a[60:63], a[188:191], v[148:151], a[60:63]
    v_exp_f32 v194, v90
    v_mfma_f32_16x16x32_bf16 a[56:59], a[184:187], v[148:151], a[56:59]
    ds_read_b128 a[132:135], v212 offset:1024
    v_cvt_pk_bf16_f32 v140, v192, v193
    v_mfma_f32_16x16x32_bf16 a[52:55], a[180:183], v[148:151], a[52:55]
    v_exp_f32 v195, v91
    v_mfma_f32_16x16x32_bf16 a[48:51], a[176:179], v[148:151], a[48:51]
    v_accvgpr_read_b32 v202, a200
    v_max3_f32 v216, v200, v201, v202
    v_mfma_f32_16x16x32_bf16 a[44:47], a[172:175], v[148:151], a[44:47]
    v_exp_f32 v196, v92
    v_mfma_f32_16x16x32_bf16 a[40:43], a[168:171], v[148:151], a[40:43]
    ds_read_b128 a[136:139], v212 offset:4096
    v_cvt_pk_bf16_f32 v141, v194, v195
    v_mfma_f32_16x16x32_bf16 a[36:39], a[164:167], v[148:151], a[36:39]
    v_exp_f32 v197, v93
    v_mfma_f32_16x16x32_bf16 a[32:35], a[160:163], v[148:151], a[32:35]
    buffer_load_dwordx4 v214, s[12:15], s31 offen offset:3072 sc1 lds
    v_mfma_f32_16x16x32_bf16 a[64:67], a[160:163], v[152:155], a[64:67]
    s_add_u32 s31, s31, 16384
    v_exp_f32 v198, v94
    v_mfma_f32_16x16x32_bf16 a[68:71], a[164:167], v[152:155], a[68:71]
    s_xor_b32 s33, s33, 0x10000
    ds_read_b128 a[140:143], v212 offset:5120
    v_cvt_pk_bf16_f32 v142, v196, v197
    v_mfma_f32_16x16x32_bf16 a[72:75], a[168:171], v[152:155], a[72:75]
    v_exp_f32 v199, v95
    v_mfma_f32_16x16x32_bf16 a[76:79], a[172:175], v[152:155], a[76:79]
    v_mfma_f32_16x16x32_bf16 a[80:83], a[176:179], v[152:155], a[80:83]
    v_exp_f32 v192, v96
    v_mfma_f32_16x16x32_bf16 a[84:87], a[180:183], v[152:155], a[84:87]
    ds_read_b128 a[144:147], v212 offset:8192
    v_cvt_pk_bf16_f32 v143, v198, v199
    v_mfma_f32_16x16x32_bf16 a[88:91], a[184:187], v[152:155], a[88:91]
    v_exp_f32 v193, v97
    v_mfma_f32_16x16x32_bf16 a[92:95], a[188:191], v[152:155], a[92:95]
    v_mfma_f32_16x16x32_bf16 a[204:207], a[208:211], v[140:143], a[204:207]
    v_mfma_f32_16x16x32_bf16 a[124:127], a[188:191], v[156:159], a[124:127]
    v_exp_f32 v194, v98
    v_mfma_f32_16x16x32_bf16 a[120:123], a[184:187], v[156:159], a[120:123]
    ds_read_b128 a[148:151], v212 offset:9216
    v_cvt_pk_bf16_f32 v144, v192, v193
    v_mfma_f32_16x16x32_bf16 a[116:119], a[180:183], v[156:159], a[116:119]
    v_exp_f32 v195, v99
    v_mfma_f32_16x16x32_bf16 a[112:115], a[176:179], v[156:159], a[112:115]
    v_accvgpr_read_b32 v203, a204
    v_max_f32 v216, v216, v203
    v_mfma_f32_16x16x32_bf16 a[108:111], a[172:175], v[156:159], a[108:111]
    v_exp_f32 v196, v100
    v_mfma_f32_16x16x32_bf16 a[104:107], a[168:171], v[156:159], a[104:107]
    v_cmp_nle_f32 vcc, v216, v218
    v_cvt_pk_bf16_f32 v145, v194, v195
    v_mfma_f32_16x16x32_bf16 a[100:103], a[164:167], v[156:159], a[100:103]
    v_exp_f32 v197, v101
    v_mfma_f32_16x16x32_bf16 a[96:99], a[160:163], v[156:159], a[96:99]
    s_cbranch_vccnz K2_st_31
K2_rt_32:
    s_cmp_lg_u32 s25, 0
    s_cbranch_scc1 K2_dual_28
    ds_read_b128 a[160:163], v213 offset:16384
    ds_read_b128 a[164:167], v213 offset:17408
    ds_read_b128 a[168:171], v213 offset:20480
    ds_read_b128 a[172:175], v213 offset:21504
    ds_read_b128 a[176:179], v213 offset:24576
    ds_read_b128 a[180:183], v213 offset:25600
    s_waitcnt lgkmcnt(4)
    v_mfma_f32_16x16x32_bf16 a[0:3], a[160:163], v[128:131], a[0:3]
    ds_read_b128 a[184:187], v213 offset:28672
    v_mfma_f32_16x16x32_bf16 a[32:35], a[160:163], v[132:135], a[32:35]
    v_exp_f32 v198, v102
    v_mfma_f32_16x16x32_bf16 a[64:67], a[160:163], v[136:139], a[64:67]
    v_cvt_pk_bf16_f32 v146, v196, v197
    v_mfma_f32_16x16x32_bf16 a[96:99], a[160:163], v[140:143], a[96:99]
    ds_read_b128 a[188:191], v213 offset:29696
    v_mfma_f32_16x16x32_bf16 a[4:7], a[164:167], v[128:131], a[4:7]
    ds_read_b128 a[160:163], v213 offset:18432
    v_mfma_f32_16x16x32_bf16 a[36:39], a[164:167], v[132:135], a[36:39]
    v_exp_f32 v199, v103
    v_mfma_f32_16x16x32_bf16 a[68:71], a[164:167], v[136:139], a[68:71]
    v_exp_f32 v192, v104
    v_mfma_f32_16x16x32_bf16 a[100:103], a[164:167], v[140:143], a[100:103]
    s_waitcnt lgkmcnt(5)
    v_cvt_pk_bf16_f32 v147, v198, v199
    v_exp_f32 v193, v105
    v_mfma_f32_16x16x32_bf16 a[8:11], a[168:171], v[128:131], a[8:11]
    ds_read_b128 a[164:167], v213 offset:19456
    v_exp_f32 v194, v106
    v_cvt_pk_bf16_f32 v148, v192, v193
    v_mfma_f32_16x16x32_bf16 a[40:43], a[168:171], v[132:135], a[40:43]
    v_mfma_f32_16x16x32_bf16 a[192:195], a[208:211], v[144:147], a[192:195]
    v_exp_f32 v195, v107
    v_mfma_f32_16x16x32_bf16 a[72:75], a[168:171], v[136:139], a[72:75]
    v_exp_f32 v196, v108
    v_cvt_pk_bf16_f32 v149, v194, v195
    v_mfma_f32_16x16x32_bf16 a[104:107], a[168:171], v[140:143], a[104:107]
    v_exp_f32 v197, v109
    v_exp_f32 v198, v110
    v_mfma_f32_16x16x32_bf16 a[12:15], a[172:175], v[128:131], a[12:15]
    ds_read_b128 a[168:171], v213 offset:22528
    v_cvt_pk_bf16_f32 v150, v196, v197
    v_exp_f32 v199, v111
    v_mfma_f32_16x16x32_bf16 a[44:47], a[172:175], v[132:135], a[44:47]
    v_exp_f32 v192, v112
    v_cvt_pk_bf16_f32 v151, v198, v199
    v_exp_f32 v193, v113
    v_mfma_f32_16x16x32_bf16 a[76:79], a[172:175], v[136:139], a[76:79]
    v_exp_f32 v194, v114
    v_cvt_pk_bf16_f32 v152, v192, v193
    v_mfma_f32_16x16x32_bf16 a[108:111], a[172:175], v[140:143], a[108:111]
    s_waitcnt lgkmcnt(5)
    v_mfma_f32_16x16x32_bf16 a[196:199], a[208:211], v[148:151], a[196:199]
    v_exp_f32 v195, v115
    v_mfma_f32_16x16x32_bf16 a[16:19], a[176:179], v[128:131], a[16:19]
    ds_read_b128 a[172:175], v213 offset:23552
    v_exp_f32 v196, v116
    v_cvt_pk_bf16_f32 v153, v194, v195
    v_mfma_f32_16x16x32_bf16 a[48:51], a[176:179], v[132:135], a[48:51]
    v_accvgpr_read_b32 v204, a192
    v_exp_f32 v197, v117
    v_mfma_f32_16x16x32_bf16 a[80:83], a[176:179], v[136:139], a[80:83]
    v_exp_f32 v198, v118
    v_cvt_pk_bf16_f32 v154, v196, v197
    v_mfma_f32_16x16x32_bf16 a[112:115], a[176:179], v[140:143], a[112:115]
    v_exp_f32 v199, v119
    v_exp_f32 v192, v120
    v_cvt_pk_bf16_f32 v155, v198, v199
    v_mfma_f32_16x16x32_bf16 a[20:23], a[180:183], v[128:131], a[20:23]
    ds_read_b128 a[176:179], v213 offset:26624
    v_exp_f32 v193, v121
    v_exp_f32 v194, v122
    v_cvt_pk_bf16_f32 v156, v192, v193
    v_mfma_f32_16x16x32_bf16 a[200:203], a[208:211], v[152:155], a[200:203]
    v_exp_f32 v195, v123
    v_exp_f32 v196, v124
    v_cvt_pk_bf16_f32 v157, v194, v195
    v_accvgpr_read_b32 v205, a196
    v_exp_f32 v197, v125
    v_exp_f32 v198, v126
    v_cvt_pk_bf16_f32 v158, v196, v197
    v_exp_f32 v199, v127
    v_nop
    v_cvt_pk_bf16_f32 v159, v198, v199
    v_mfma_f32_16x16x32_bf16 a[52:55], a[180:183], v[132:135], a[52:55]
    v_nop
    v_mfma_f32_16x16x32_bf16 a[204:207], a[208:211], v[156:159], a[204:207]
    v_mfma_f32_16x16x32_bf16 a[84:87], a[180:183], v[136:139], a[84:87]
    s_add_u32 m0, s34, 0
    v_mfma_f32_16x16x32_bf16 a[116:119], a[180:183], v[140:143], a[116:119]
    s_waitcnt lgkmcnt(5)
    v_accvgpr_read_b32 v206, a200
    s_nop 0
    v_mfma_f32_16x16x32_bf16 a[24:27], a[184:187], v[128:131], a[24:27]
    ds_read_b128 a[180:183], v213 offset:27648
    v_max3_f32 v216, v204, v205, v206
    v_mfma_f32_16x16x32_bf16 a[56:59], a[184:187], v[132:135], a[56:59]
    buffer_load_dwordx4 v214, s[12:15], s32 offen offset:0 sc1 lds
    v_mfma_f32_16x16x32_bf16 a[88:91], a[184:187], v[136:139], a[88:91]
    v_mfma_f32_16x16x32_bf16 a[120:123], a[184:187], v[140:143], a[120:123]
    v_mfma_f32_16x16x32_bf16 a[28:31], a[188:191], v[128:131], a[28:31]
    ds_read_b128 a[184:187], v213 offset:30720
    v_accvgpr_read_b32 v207, a204
    v_mfma_f32_16x16x32_bf16 a[60:63], a[188:191], v[132:135], a[60:63]
    v_max_f32 v216, v216, v207
    v_cmp_nle_f32 vcc, v216, v218
    v_mfma_f32_16x16x32_bf16 a[92:95], a[188:191], v[136:139], a[92:95]
    buffer_load_dwordx4 v214, s[12:15], s32 offen offset:1024 sc1 lds
    v_mfma_f32_16x16x32_bf16 a[124:127], a[188:191], v[140:143], a[124:127]
    s_waitcnt lgkmcnt(5)
    ds_read_b128 a[188:191], v213 offset:31744
    s_cbranch_vccnz K2_st_33
K2_rt_34:
    v_mfma_f32_16x16x32_bf16 a[64:67], a[160:163], v[152:155], a[64:67]
    ds_write_b64 v234, v[208:209]
    v_xor_b32 v234, 512, v234
    v_xor_b32 v219, 0x2000, v219
    v_rcp_f32 v228, v206
    v_rcp_f32 v229, v207
    v_mfma_f32_16x16x32_bf16 a[96:99], a[160:163], v[156:159], a[96:99]
    buffer_load_dwordx4 v214, s[12:15], s32 offen offset:2048 sc1 lds
    v_xor_b32 v213, 0x10000, v213
    v_mfma_f32_16x16x32_bf16 a[68:71], a[164:167], v[152:155], a[68:71]
    s_xor_b32 s37, s36, 1
    s_mov_b32 s99, s37
    s_min_u32 s38, s98, s99
    s_sub_u32 s35, s35, 1
    s_cmp_eq_u32 s42, 1
    s_cselect_b32 s35, 33, s35
    s_lshl_b32 s22, s42, 15
    v_add_u32 v212, s22, v212
    v_add_u32 v213, s22, v213
    v_mfma_f32_16x16x32_bf16 a[100:103], a[164:167], v[156:159], a[100:103]
    s_waitcnt lgkmcnt(5)
    v_mul_f32 v228, 0x23800000, v228
    v_mul_f32 v229, 0x23800000, v229
    v_mfma_f32_16x16x32_bf16 a[72:75], a[168:171], v[152:155], a[72:75]
    s_waitcnt lgkmcnt(0)
    s_barrier
    ds_read_b64 v[210:211], v234
    v_mfma_f32_16x16x32_bf16 a[104:107], a[168:171], v[156:159], a[104:107]
    ds_read_b128 v[32:35], v219 offset:0
    buffer_load_dwordx4 v214, s[12:15], s32 offen offset:3072 sc1 lds
    v_mfma_f32_16x16x32_bf16 a[76:79], a[172:175], v[152:155], a[76:79]
    s_add_u32 m0, s34, 32768
    ds_read_b128 v[36:39], v219 offset:1024
    v_mfma_f32_16x16x32_bf16 a[108:111], a[172:175], v[156:159], a[108:111]
    s_waitcnt lgkmcnt(3)
    ds_read_b128 v[40:43], v219 offset:2048
    s_add_u32 s23, s32, s39
    v_mfma_f32_16x16x32_bf16 a[80:83], a[176:179], v[152:155], a[80:83]
    ds_read_b128 v[44:47], v219 offset:3072
    buffer_load_dwordx4 v214, s[12:15], s23 offen offset:0 sc1 lds
    v_mfma_f32_16x16x32_bf16 a[112:115], a[176:179], v[156:159], a[112:115]
    ds_read_b128 v[48:51], v219 offset:4096
    v_mfma_f32_16x16x32_bf16 a[84:87], a[180:183], v[152:155], a[84:87]
    ds_read_b128 v[52:55], v219 offset:5120
    v_mfma_f32_16x16x32_bf16 a[116:119], a[180:183], v[156:159], a[116:119]
    s_waitcnt lgkmcnt(7)
    ds_read_b128 v[56:59], v219 offset:6144
    v_mfma_f32_16x16x32_bf16 a[88:91], a[184:187], v[152:155], a[88:91]
    ds_read_b128 v[60:63], v219 offset:7168
    buffer_load_dwordx4 v214, s[12:15], s23 offen offset:1024 sc1 lds
    v_mfma_f32_16x16x32_bf16 a[120:123], a[184:187], v[156:159], a[120:123]
    s_waitcnt lgkmcnt(8)
    v_mfma_f32_16x16x32_bf16 a[92:95], a[188:191], v[152:155], a[92:95]
    ds_read_b128 a[128:131], v212 offset:0
    buffer_load_dwordx4 v214, s[12:15], s23 offen offset:2048 sc1 lds
    v_sub_f32 v176, 0, v210
    v_mfma_f32_16x16x32_bf16 a[124:127], a[188:191], v[156:159], a[124:127]
    v_sub_f32 v177, 0, v210
    v_sub_f32 v178, 0, v210
    v_mfma_f32_16x16x32_bf16 a[0:3], a[160:163], v[144:147], a[0:3]
    ds_read_b128 a[132:135], v212 offset:1024
    v_sub_f32 v179, 0, v210
    v_mfma_f32_16x16x32_bf16 a[32:35], a[160:163], v[148:151], a[32:35]
    buffer_load_dwordx4 v214, s[12:15], s23 offen offset:3072 sc1 lds
    v_sub_f32 v180, 0, v210
    v_sub_f32 v181, 0, v210
    v_mfma_f32_16x16x32_bf16 a[4:7], a[164:167], v[144:147], a[4:7]
    ds_read_b128 a[136:139], v212 offset:4096
    v_sub_f32 v182, 0, v210
    v_mfma_f32_16x16x32_bf16 a[36:39], a[164:167], v[148:151], a[36:39]
    v_sub_f32 v183, 0, v210
    v_mov_b32 v206, 0
    v_mfma_f32_16x16x32_bf16 a[8:11], a[168:171], v[144:147], a[8:11]
    s_add_u32 s32, s32, 16384
    ds_read_b128 a[140:143], v212 offset:5120
    v_accvgpr_write_b32 a200, 0
    v_mfma_f32_16x16x32_bf16 a[40:43], a[168:171], v[148:151], a[40:43]
    v_sub_f32 v184, 0, v211
    v_sub_f32 v185, 0, v211
    v_mfma_f32_16x16x32_bf16 a[12:15], a[172:175], v[144:147], a[12:15]
    s_xor_b32 s34, s34, 0x10000
    ds_read_b128 a[144:147], v212 offset:8192
    v_sub_f32 v186, 0, v211
    v_mfma_f32_16x16x32_bf16 a[44:47], a[172:175], v[148:151], a[44:47]
    v_sub_f32 v187, 0, v211
    v_sub_f32 v188, 0, v211
    v_sub_f32 v189, 0, v211
    v_sub_f32 v190, 0, v211
    v_sub_f32 v191, 0, v211
    v_mov_b32 v207, 0
    v_accvgpr_write_b32 a204, 0
    v_mfma_f32_16x16x32_bf16 a[16:19], a[176:179], v[144:147], a[16:19]
    ds_read_b128 a[148:151], v212 offset:9216
    v_accvgpr_read_b32 v96, a64
    v_mfma_f32_16x16x32_bf16 a[48:51], a[176:179], v[148:151], a[48:51]
    v_accvgpr_read_b32 v97, a65
    v_mul_f32 v96, v96, v228
    v_mfma_f32_16x16x32_bf16 a[20:23], a[180:183], v[144:147], a[20:23]
    ds_read_b128 a[152:155], v212 offset:12288
    v_mul_f32 v97, v97, v228
    v_mfma_f32_16x16x32_bf16 a[52:55], a[180:183], v[148:151], a[52:55]
    s_add_u32 s35, s35, 1
    v_cvt_pk_bf16_f32 v240, v96, v97
    v_accvgpr_read_b32 v98, a66
    v_mfma_f32_16x16x32_bf16 a[24:27], a[184:187], v[144:147], a[24:27]
    s_cmp_ge_u32 s35, s38
    ds_read_b128 a[156:159], v212 offset:13312
    s_getpc_b64 s[44:45]
    s_cbranch_scc1 K2_mask_25
    v_mfma_f32_16x16x32_bf16 a[56:59], a[184:187], v[148:151], a[56:59]
    v_accvgpr_read_b32 v99, a67
    v_mul_f32 v98, v98, v228
    v_mfma_f32_16x16x32_bf16 a[28:31], a[188:191], v[144:147], a[28:31]
    v_mul_f32 v99, v99, v228
    v_cvt_pk_bf16_f32 v241, v98, v99
    v_mfma_f32_16x16x32_bf16 a[60:63], a[188:191], v[148:151], a[60:63]
    s_waitcnt lgkmcnt(4)
    v_accvgpr_read_b32 v100, a68
    v_accvgpr_read_b32 v101, a69
    v_mul_f32 v100, v100, v228
    v_mfma_f32_16x16x32_bf16 v[88:91], a[128:131], v[48:51], v[184:187]
    v_mul_f32 v101, v101, v228
    v_cvt_pk_bf16_f32 v242, v100, v101
    v_accvgpr_read_b32 v102, a70
    v_accvgpr_read_b32 v103, a71
    v_mul_f32 v102, v102, v228
    v_mfma_f32_16x16x32_bf16 v[80:83], a[128:131], v[32:35], v[176:179]
    v_mul_f32 v103, v103, v228
    v_cvt_pk_bf16_f32 v243, v102, v103
    buffer_store_dwordx4 v[240:243], v232, s[12:15], s41 offen offset:0 sc1
    v_mfma_f32_16x16x32_bf16 v[72:75], a[128:131], v[16:19], v[168:171]
    v_accvgpr_read_b32 v96, a72
    v_accvgpr_read_b32 v97, a73
    v_mul_f32 v96, v96, v228
    v_mul_f32 v97, v97, v228
    v_cvt_pk_bf16_f32 v244, v96, v97
    v_mfma_f32_16x16x32_bf16 v[64:67], a[128:131], v[0:3], v[160:163]
    v_accvgpr_read_b32 v98, a74
    v_accvgpr_read_b32 v99, a75
    v_mul_f32 v98, v98, v228
    v_mul_f32 v99, v99, v228
    v_mfma_f32_16x16x32_bf16 v[68:71], a[132:135], v[0:3], v[164:167]
    ds_read_b128 a[128:131], v212 offset:2048
    v_cvt_pk_bf16_f32 v245, v98, v99
    v_accvgpr_read_b32 v100, a76
    v_accvgpr_read_b32 v101, a77
    v_mul_f32 v100, v100, v228
    v_mul_f32 v101, v101, v228
    v_mfma_f32_16x16x32_bf16 v[76:79], a[132:135], v[16:19], v[172:175]
    v_cvt_pk_bf16_f32 v246, v100, v101
    v_accvgpr_read_b32 v102, a78
    v_accvgpr_read_b32 v103, a79
    v_mul_f32 v102, v102, v228
    v_mfma_f32_16x16x32_bf16 v[84:87], a[132:135], v[32:35], v[180:183]
    v_mul_f32 v103, v103, v228
    v_cvt_pk_bf16_f32 v247, v102, v103
    buffer_store_dwordx4 v[244:247], v232, s[12:15], s41 offen offset:1024 sc1
    v_accvgpr_read_b32 v96, a80
    v_mfma_f32_16x16x32_bf16 v[92:95], a[132:135], v[48:51], v[188:191]
    v_accvgpr_read_b32 v97, a81
    v_mul_f32 v96, v96, v228
    v_mul_f32 v97, v97, v228
    v_cvt_pk_bf16_f32 v248, v96, v97
    v_mfma_f32_16x16x32_bf16 v[88:91], a[136:139], v[52:55], v[88:91]
    ds_read_b128 a[132:135], v212 offset:3072
    v_accvgpr_read_b32 v98, a82
    v_accvgpr_read_b32 v99, a83
    v_mul_f32 v98, v98, v228
    v_mul_f32 v99, v99, v228
    v_cvt_pk_bf16_f32 v249, v98, v99
    v_mfma_f32_16x16x32_bf16 v[80:83], a[136:139], v[36:39], v[80:83]
    v_accvgpr_read_b32 v100, a84
    v_accvgpr_read_b32 v101, a85
    v_mul_f32 v100, v100, v228
    v_mul_f32 v101, v101, v228
    v_mfma_f32_16x16x32_bf16 v[72:75], a[136:139], v[20:23], v[72:75]
    v_cvt_pk_bf16_f32 v250, v100, v101
    v_accvgpr_read_b32 v102, a86
    v_accvgpr_read_b32 v103, a87
    v_mul_f32 v102, v102, v228
    v_mul_f32 v103, v103, v228
    v_mfma_f32_16x16x32_bf16 v[64:67], a[136:139], v[4:7], v[64:67]
    v_cvt_pk_bf16_f32 v251, v102, v103
    buffer_store_dwordx4 v[248:251], v232, s[12:15], s41 offen offset:2048 sc1
    v_accvgpr_read_b32 v96, a88
    v_mfma_f32_16x16x32_bf16 v[68:71], a[140:143], v[4:7], v[68:71]
    ds_read_b128 a[136:139], v212 offset:6144
    v_accvgpr_read_b32 v97, a89
    v_mul_f32 v96, v96, v228
    v_mul_f32 v97, v97, v228
    v_cvt_pk_bf16_f32 v252, v96, v97
    v_accvgpr_read_b32 v98, a90
    v_mfma_f32_16x16x32_bf16 v[76:79], a[140:143], v[20:23], v[76:79]
    v_accvgpr_read_b32 v99, a91
    v_mul_f32 v98, v98, v228
    v_mul_f32 v99, v99, v228
    v_cvt_pk_bf16_f32 v253, v98, v99
    v_mfma_f32_16x16x32_bf16 v[84:87], a[140:143], v[36:39], v[84:87]
    v_accvgpr_read_b32 v100, a92
    v_accvgpr_read_b32 v101, a93
    v_mul_f32 v100, v100, v228
    v_mul_f32 v101, v101, v228
    v_cvt_pk_bf16_f32 v254, v100, v101
    v_mfma_f32_16x16x32_bf16 v[92:95], a[140:143], v[52:55], v[92:95]
    s_waitcnt lgkmcnt(3)
    v_accvgpr_read_b32 v102, a94
    v_accvgpr_read_b32 v103, a95
    v_mul_f32 v102, v102, v228
    v_mul_f32 v103, v103, v228
    v_mfma_f32_16x16x32_bf16 v[88:91], a[144:147], v[56:59], v[88:91]
    ds_read_b128 a[140:143], v212 offset:7168
    v_cvt_pk_bf16_f32 v255, v102, v103
    buffer_store_dwordx4 v[252:255], v232, s[12:15], s41 offen offset:3072 sc1
    v_accvgpr_read_b32 v96, a96
    v_accvgpr_read_b32 v97, a97
    v_mfma_f32_16x16x32_bf16 v[80:83], a[144:147], v[40:43], v[80:83]
    v_mul_f32 v96, v96, v229
    v_mul_f32 v97, v97, v229
    v_cvt_pk_bf16_f32 v240, v96, v97
    v_accvgpr_read_b32 v98, a98
    v_mfma_f32_16x16x32_bf16 v[72:75], a[144:147], v[24:27], v[72:75]
    v_accvgpr_read_b32 v99, a99
    v_mul_f32 v98, v98, v229
    v_mul_f32 v99, v99, v229
    v_cvt_pk_bf16_f32 v241, v98, v99
    v_accvgpr_read_b32 v100, a100
    v_mfma_f32_16x16x32_bf16 v[64:67], a[144:147], v[8:11], v[64:67]
    v_accvgpr_read_b32 v101, a101
    v_mul_f32 v100, v100, v229
    v_mul_f32 v101, v101, v229
    v_cvt_pk_bf16_f32 v242, v100, v101
    v_mfma_f32_16x16x32_bf16 v[68:71], a[148:151], v[8:11], v[68:71]
    ds_read_b128 a[144:147], v212 offset:10240
    v_accvgpr_read_b32 v102, a102
    v_accvgpr_read_b32 v103, a103
    v_mul_f32 v102, v102, v229
    v_mul_f32 v103, v103, v229
    v_cvt_pk_bf16_f32 v243, v102, v103
    v_mfma_f32_16x16x32_bf16 v[76:79], a[148:151], v[24:27], v[76:79]
    buffer_store_dwordx4 v[240:243], v233, s[12:15], s41 offen offset:0 sc1
    v_accvgpr_read_b32 v96, a104
    v_accvgpr_read_b32 v97, a105
    v_mfma_f32_16x16x32_bf16 v[84:87], a[148:151], v[40:43], v[84:87]
    v_mul_f32 v96, v96, v229
    v_mul_f32 v97, v97, v229
    v_cvt_pk_bf16_f32 v244, v96, v97
    v_accvgpr_read_b32 v98, a106
    v_accvgpr_read_b32 v99, a107
    v_mfma_f32_16x16x32_bf16 v[92:95], a[148:151], v[56:59], v[92:95]
    v_mul_f32 v98, v98, v229
    v_mul_f32 v99, v99, v229
    v_cvt_pk_bf16_f32 v245, v98, v99
    v_accvgpr_read_b32 v100, a108
    v_mfma_f32_16x16x32_bf16 v[88:91], a[152:155], v[60:63], v[88:91]
    ds_read_b128 a[148:151], v212 offset:11264
    v_accvgpr_read_b32 v101, a109
    v_mul_f32 v100, v100, v229
    v_mul_f32 v101, v101, v229
    v_cvt_pk_bf16_f32 v246, v100, v101
    v_accvgpr_read_b32 v102, a110
    v_mfma_f32_16x16x32_bf16 v[80:83], a[152:155], v[44:47], v[80:83]
    v_accvgpr_read_b32 v103, a111
    v_mul_f32 v102, v102, v229
    v_mul_f32 v103, v103, v229
    v_cvt_pk_bf16_f32 v247, v102, v103
    v_mfma_f32_16x16x32_bf16 v[72:75], a[152:155], v[28:31], v[72:75]
    buffer_store_dwordx4 v[244:247], v233, s[12:15], s41 offen offset:1024 sc1
    v_accvgpr_read_b32 v96, a112
    v_accvgpr_read_b32 v97, a113
    v_mul_f32 v96, v96, v229
    v_mfma_f32_16x16x32_bf16 v[64:67], a[152:155], v[12:15], v[64:67]
    s_add_u32 s35, s35, 1
    v_mul_f32 v97, v97, v229
    v_cvt_pk_bf16_f32 v248, v96, v97
    v_accvgpr_read_b32 v98, a114
    v_accvgpr_read_b32 v99, a115
    v_mfma_f32_16x16x32_bf16 v[68:71], a[156:159], v[12:15], v[68:71]
    s_cmp_ge_u32 s35, s38
    ds_read_b128 a[152:155], v212 offset:14336
    v_mul_f32 v98, v98, v229
    v_mul_f32 v99, v99, v229
    v_cvt_pk_bf16_f32 v249, v98, v99
    v_accvgpr_read_b32 v100, a116
    v_accvgpr_read_b32 v101, a117
    s_getpc_b64 s[44:45]
    s_cbranch_scc1 K2_mask_25
    v_mfma_f32_16x16x32_bf16 v[76:79], a[156:159], v[28:31], v[76:79]
    v_mul_f32 v100, v100, v229
    v_mul_f32 v101, v101, v229
    v_cvt_pk_bf16_f32 v250, v100, v101
    v_accvgpr_read_b32 v102, a118
    v_mfma_f32_16x16x32_bf16 v[84:87], a[156:159], v[44:47], v[84:87]
    v_accvgpr_read_b32 v103, a119
    v_mul_f32 v102, v102, v229
    v_mul_f32 v103, v103, v229
    v_cvt_pk_bf16_f32 v251, v102, v103
    buffer_store_dwordx4 v[248:251], v233, s[12:15], s41 offen offset:2048 sc1
    v_accvgpr_read_b32 v96, a120
    v_accvgpr_read_b32 v97, a121
    v_mul_f32 v96, v96, v229
    v_mul_f32 v97, v97, v229
    v_cvt_pk_bf16_f32 v252, v96, v97
    v_accvgpr_read_b32 v98, a122
    v_accvgpr_read_b32 v99, a123
    v_mul_f32 v98, v98, v229
    v_mul_f32 v99, v99, v229
    v_cvt_pk_bf16_f32 v253, v98, v99
    v_accvgpr_read_b32 v100, a124
    v_accvgpr_read_b32 v101, a125
    v_mul_f32 v100, v100, v229
    v_mul_f32 v101, v101, v229
    v_cvt_pk_bf16_f32 v254, v100, v101
    v_accvgpr_read_b32 v102, a126
    v_accvgpr_read_b32 v103, a127
    v_mul_f32 v102, v102, v229
    v_mul_f32 v103, v103, v229
    v_cvt_pk_bf16_f32 v255, v102, v103
    buffer_store_dwordx4 v[252:255], v233, s[12:15], s41 offen offset:3072 sc1
    v_mfma_f32_16x16x32_bf16 v[92:95], a[156:159], v[60:63], v[92:95]
    s_waitcnt lgkmcnt(3)
    v_mfma_f32_16x16x32_bf16 v[120:123], a[128:131], v[48:51], v[184:187]
    ds_read_b128 a[156:159], v212 offset:15360
    v_mfma_f32_32x32x16_bf16 a[64:79], v[236:239], v[236:239], 0
    v_mfma_f32_16x16x32_bf16 v[112:115], a[128:131], v[32:35], v[176:179]
    v_xor_b32 v212, 0x10000, v212
    v_mfma_f32_32x32x16_bf16 a[80:95], v[236:239], v[236:239], 0
    v_mfma_f32_16x16x32_bf16 v[104:107], a[128:131], v[16:19], v[168:171]
    v_mfma_f32_32x32x16_bf16 a[96:111], v[236:239], v[236:239], 0
    v_mfma_f32_16x16x32_bf16 v[96:99], a[128:131], v[0:3], v[160:163]
    v_mfma_f32_32x32x16_bf16 a[112:127], v[236:239], v[236:239], 0
    v_mfma_f32_16x16x32_bf16 v[100:103], a[132:135], v[0:3], v[164:167]
    v_exp_f32 v192, v64
    v_mfma_f32_16x16x32_bf16 v[108:111], a[132:135], v[16:19], v[172:175]
    v_exp_f32 v193, v65
    v_mfma_f32_16x16x32_bf16 v[116:119], a[132:135], v[32:35], v[180:183]
    v_exp_f32 v194, v66
    v_mfma_f32_16x16x32_bf16 v[124:127], a[132:135], v[48:51], v[188:191]
    v_cvt_pk_bf16_f32 v128, v192, v193
    v_mfma_f32_16x16x32_bf16 v[120:123], a[136:139], v[52:55], v[120:123]
    s_waitcnt vmcnt(8) lgkmcnt(0)
    s_barrier
    v_mfma_f32_16x16x32_bf16 v[112:115], a[136:139], v[36:39], v[112:115]
    v_exp_f32 v195, v67
    v_mfma_f32_16x16x32_bf16 v[104:107], a[136:139], v[20:23], v[104:107]
    ds_read_b128 a[128:131], v212 offset:0
    v_mfma_f32_16x16x32_bf16 v[96:99], a[136:139], v[4:7], v[96:99]
    v_exp_f32 v196, v68
    v_cvt_pk_bf16_f32 v129, v194, v195
    v_exp_f32 v197, v69
    v_mfma_f32_16x16x32_bf16 v[100:103], a[140:143], v[4:7], v[100:103]
    s_add_u32 m0, s33, 0
    v_exp_f32 v198, v70
    v_cvt_pk_bf16_f32 v130, v196, v197
    v_exp_f32 v199, v71
    v_mfma_f32_16x16x32_bf16 v[108:111], a[140:143], v[20:23], v[108:111]
    v_exp_f32 v192, v72
    v_cvt_pk_bf16_f32 v131, v198, v199
    v_exp_f32 v193, v73
    v_exp_f32 v194, v74
    v_mfma_f32_16x16x32_bf16 v[116:119], a[140:143], v[36:39], v[116:119]
    ds_read_b128 a[132:135], v212 offset:1024
    v_cvt_pk_bf16_f32 v132, v192, v193
    v_mfma_f32_16x16x32_bf16 a[192:195], a[208:211], v[128:131], a[192:195]
    v_exp_f32 v195, v75
    v_mfma_f32_16x16x32_bf16 v[124:127], a[140:143], v[52:55], v[124:127]
    s_waitcnt lgkmcnt(2)
    v_exp_f32 v196, v76
    v_cvt_pk_bf16_f32 v133, v194, v195
    v_exp_f32 v197, v77
    v_mfma_f32_16x16x32_bf16 v[120:123], a[144:147], v[56:59], v[120:123]
    s_nop 0
    v_exp_f32 v198, v78
    v_cvt_pk_bf16_f32 v134, v196, v197
    v_exp_f32 v199, v79
    v_mfma_f32_16x16x32_bf16 v[112:115], a[144:147], v[40:43], v[112:115]
    buffer_load_dwordx4 v214, s[12:15], s31 offen offset:0 sc1 lds
    v_exp_f32 v192, v80
    v_cvt_pk_bf16_f32 v135, v198, v199
    v_exp_f32 v193, v81
    v_mfma_f32_16x16x32_bf16 v[104:107], a[144:147], v[24:27], v[104:107]
    ds_read_b128 a[136:139], v212 offset:4096
    v_exp_f32 v194, v82
    v_cvt_pk_bf16_f32 v136, v192, v193
    v_mfma_f32_16x16x32_bf16 a[196:199], a[208:211], v[132:135], a[196:199]
    v_mfma_f32_16x16x32_bf16 v[96:99], a[144:147], v[8:11], v[96:99]
    v_exp_f32 v195, v83
    v_exp_f32 v196, v84
    v_cvt_pk_bf16_f32 v137, v194, v195
    v_accvgpr_read_b32 v200, a192
    v_mfma_f32_16x16x32_bf16 v[100:103], a[148:151], v[8:11], v[100:103]
    v_exp_f32 v197, v85
    v_exp_f32 v198, v86
    v_cvt_pk_bf16_f32 v138, v196, v197
    v_exp_f32 v199, v87
    v_exp_f32 v192, v88
    v_cvt_pk_bf16_f32 v139, v198, v199
    v_exp_f32 v193, v89
    v_exp_f32 v194, v90
    v_cvt_pk_bf16_f32 v140, v192, v193
    v_mfma_f32_16x16x32_bf16 a[200:203], a[208:211], v[136:139], a[200:203]
    v_exp_f32 v195, v91
    v_exp_f32 v196, v92
    v_cvt_pk_bf16_f32 v141, v194, v195
    v_accvgpr_read_b32 v201, a196
    v_exp_f32 v197, v93
    v_exp_f32 v198, v94
    v_cvt_pk_bf16_f32 v142, v196, v197
    v_exp_f32 v199, v95
    v_nop
    v_cvt_pk_bf16_f32 v143, v198, v199
    v_mfma_f32_16x16x32_bf16 v[108:111], a[148:151], v[24:27], v[108:111]
    v_nop
    v_mfma_f32_16x16x32_bf16 a[204:207], a[208:211], v[140:143], a[204:207]
    v_mfma_f32_16x16x32_bf16 v[116:119], a[148:151], v[40:43], v[116:119]
    ds_read_b128 a[140:143], v212 offset:5120
    buffer_load_dwordx4 v214, s[12:15], s31 offen offset:1024 sc1 lds
    v_mfma_f32_16x16x32_bf16 v[124:127], a[148:151], v[56:59], v[124:127]
    buffer_load_dwordx4 v214, s[12:15], s31 offen offset:2048 sc1 lds
    v_accvgpr_read_b32 v202, a200
    v_mfma_f32_16x16x32_bf16 v[120:123], a[152:155], v[60:63], v[120:123]
    s_add_u32 s35, s35, 1
    buffer_load_dwordx4 v214, s[12:15], s31 offen offset:3072 sc1 lds
    v_max3_f32 v216, v200, v201, v202
    v_mfma_f32_16x16x32_bf16 v[112:115], a[152:155], v[44:47], v[112:115]
    s_cmp_ge_u32 s35, s38
    s_getpc_b64 s[44:45]
    s_cbranch_scc1 K2_mask_25
    v_mfma_f32_16x16x32_bf16 v[104:107], a[152:155], v[28:31], v[104:107]
    s_add_u32 m0, s33, 32768
    ds_read_b128 a[144:147], v212 offset:8192
    s_add_u32 s23, s31, s39
    v_mfma_f32_16x16x32_bf16 v[96:99], a[152:155], v[12:15], v[96:99]
    buffer_load_dwordx4 v214, s[12:15], s23 offen offset:0 sc1 lds
    v_mfma_f32_16x16x32_bf16 v[100:103], a[156:159], v[12:15], v[100:103]
    buffer_load_dwordx4 v214, s[12:15], s23 offen offset:1024 sc1 lds
    v_accvgpr_read_b32 v203, a204
    v_mfma_f32_16x16x32_bf16 v[108:111], a[156:159], v[28:31], v[108:111]
    v_max_f32 v216, v216, v203
    v_cmp_nle_f32 vcc, v216, v218
    v_mfma_f32_16x16x32_bf16 v[116:119], a[156:159], v[44:47], v[116:119]
    ds_read_b128 a[148:151], v212 offset:9216
    buffer_load_dwordx4 v214, s[12:15], s23 offen offset:2048 sc1 lds
    buffer_load_dwordx4 v214, s[12:15], s23 offen offset:3072 sc1 lds
    s_add_u32 s31, s31, 16384
    s_xor_b32 s33, s33, 0x10000
    v_mfma_f32_16x16x32_bf16 v[124:127], a[156:159], v[60:63], v[124:127]
    s_cbranch_vccnz K2_st_35
K2_rt_36:
    s_nop 2
    v_exp_f32 v192, v96
    v_exp_f32 v193, v97
    v_exp_f32 v194, v98
    v_cvt_pk_bf16_f32 v144, v192, v193
    v_exp_f32 v195, v99
    v_exp_f32 v196, v100
    v_cvt_pk_bf16_f32 v145, v194, v195
    v_exp_f32 v197, v101
    s_lshl_b32 s63, s2, 7
    s_add_u32 s63, s63, 60293120
    s_cmp_eq_u32 s16, 0
    s_cselect_b32 s63, s63, s14
    s_lshl_b32 s25, s18, 1
    s_sub_u32 s25, 14, s25
    s_cmp_eq_u32 s25, 0
    s_cbranch_scc1 K2_sdone_38
    .p2align 3
K2_single_37:
    s_waitcnt lgkmcnt(2)
    v_mfma_f32_16x16x32_bf16 v[88:91], a[128:131], v[48:51], v[184:187]
    s_add_u32 m0, s34, 0
    v_exp_f32 v198, v102
    v_mfma_f32_16x16x32_bf16 v[80:83], a[128:131], v[32:35], v[176:179]
    s_nop 0
    ds_read_b128 a[152:155], v212 offset:12288
    v_cvt_pk_bf16_f32 v146, v196, v197
    v_mfma_f32_16x16x32_bf16 v[72:75], a[128:131], v[16:19], v[168:171]
    v_exp_f32 v199, v103
    v_mfma_f32_16x16x32_bf16 v[64:67], a[128:131], v[0:3], v[160:163]
    buffer_load_dwordx4 v214, s[12:15], s32 offen offset:0 sc1 lds
    v_mfma_f32_16x16x32_bf16 v[68:71], a[132:135], v[0:3], v[164:167]
    v_exp_f32 v192, v104
    v_mfma_f32_16x16x32_bf16 v[76:79], a[132:135], v[16:19], v[172:175]
    ds_read_b128 a[156:159], v212 offset:13312
    v_cvt_pk_bf16_f32 v147, v198, v199
    v_mfma_f32_16x16x32_bf16 v[84:87], a[132:135], v[32:35], v[180:183]
    v_exp_f32 v193, v105
    v_mfma_f32_16x16x32_bf16 v[92:95], a[132:135], v[48:51], v[188:191]
    buffer_load_dwordx4 v214, s[12:15], s32 offen offset:1024 sc1 lds
    v_mfma_f32_16x16x32_bf16 a[192:195], a[208:211], v[144:147], a[192:195]
    buffer_load_dwordx4 v214, s[12:15], s32 offen offset:2048 sc1 lds
    v_mfma_f32_16x16x32_bf16 v[88:91], a[136:139], v[52:55], v[88:91]
    v_exp_f32 v194, v106
    v_mfma_f32_16x16x32_bf16 v[80:83], a[136:139], v[36:39], v[80:83]
    ds_read_b128 a[160:163], v213 offset:16384
    v_cvt_pk_bf16_f32 v148, v192, v193
    v_mfma_f32_16x16x32_bf16 v[72:75], a[136:139], v[20:23], v[72:75]
    v_exp_f32 v195, v107
    v_mfma_f32_16x16x32_bf16 v[64:67], a[136:139], v[4:7], v[64:67]
    ds_read_b128 a[164:167], v213 offset:17408
    v_accvgpr_read_b32 v204, a192
    v_mfma_f32_16x16x32_bf16 v[68:71], a[140:143], v[4:7], v[68:71]
    v_exp_f32 v196, v108
    v_mfma_f32_16x16x32_bf16 v[76:79], a[140:143], v[20:23], v[76:79]
    ds_read_b128 a[168:171], v213 offset:20480
    v_cvt_pk_bf16_f32 v149, v194, v195
    v_mfma_f32_16x16x32_bf16 v[84:87], a[140:143], v[36:39], v[84:87]
    v_exp_f32 v197, v109
    v_mfma_f32_16x16x32_bf16 v[92:95], a[140:143], v[52:55], v[92:95]
    s_waitcnt lgkmcnt(3)
    v_mfma_f32_16x16x32_bf16 v[88:91], a[144:147], v[56:59], v[88:91]
    v_exp_f32 v198, v110
    v_mfma_f32_16x16x32_bf16 v[80:83], a[144:147], v[40:43], v[80:83]
    ds_read_b128 a[172:175], v213 offset:21504
    v_cvt_pk_bf16_f32 v150, v196, v197
    v_mfma_f32_16x16x32_bf16 v[72:75], a[144:147], v[24:27], v[72:75]
    v_exp_f32 v199, v111
    v_mfma_f32_16x16x32_bf16 v[64:67], a[144:147], v[8:11], v[64:67]
    buffer_load_dwordx4 v214, s[12:15], s32 offen offset:3072 sc1 lds
    v_mfma_f32_16x16x32_bf16 v[68:71], a[148:151], v[8:11], v[68:71]
    s_add_u32 m0, s34, 32768
    v_exp_f32 v192, v112
    v_mfma_f32_16x16x32_bf16 v[76:79], a[148:151], v[24:27], v[76:79]
    s_add_u32 s23, s32, s39
    ds_read_b128 a[176:179], v213 offset:24576
    v_cvt_pk_bf16_f32 v151, v198, v199
    v_mfma_f32_16x16x32_bf16 v[84:87], a[148:151], v[40:43], v[84:87]
    v_exp_f32 v193, v113
    v_mfma_f32_16x16x32_bf16 v[92:95], a[148:151], v[56:59], v[92:95]
    buffer_load_dwordx4 v214, s[12:15], s23 offen offset:0 sc1 lds
    v_mfma_f32_16x16x32_bf16 a[196:199], a[208:211], v[148:151], a[196:199]
    buffer_load_dwordx4 v214, s[12:15], s23 offen offset:1024 sc1 lds
    v_mfma_f32_16x16x32_bf16 v[88:91], a[152:155], v[60:63], v[88:91]
    v_exp_f32 v194, v114
    v_mfma_f32_16x16x32_bf16 v[80:83], a[152:155], v[44:47], v[80:83]
    ds_read_b128 a[180:183], v213 offset:25600
    v_cvt_pk_bf16_f32 v152, v192, v193
    v_mfma_f32_16x16x32_bf16 v[72:75], a[152:155], v[28:31], v[72:75]
    v_exp_f32 v195, v115
    v_mfma_f32_16x16x32_bf16 v[64:67], a[152:155], v[12:15], v[64:67]
    ds_read_b128 a[184:187], v213 offset:28672
    v_accvgpr_read_b32 v205, a196
    v_mfma_f32_16x16x32_bf16 v[68:71], a[156:159], v[12:15], v[68:71]
    v_exp_f32 v196, v116
    v_mfma_f32_16x16x32_bf16 v[76:79], a[156:159], v[28:31], v[76:79]
    ds_read_b128 a[188:191], v213 offset:29696
    v_cvt_pk_bf16_f32 v153, v194, v195
    v_mfma_f32_16x16x32_bf16 v[84:87], a[156:159], v[44:47], v[84:87]
    v_exp_f32 v197, v117
    v_mfma_f32_16x16x32_bf16 v[92:95], a[156:159], v[60:63], v[92:95]
    s_waitcnt lgkmcnt(4)
    v_mfma_f32_16x16x32_bf16 a[0:3], a[160:163], v[128:131], a[0:3]
    v_exp_f32 v198, v118
    v_mfma_f32_16x16x32_bf16 a[4:7], a[164:167], v[128:131], a[4:7]
    ds_read_b128 a[128:131], v212 offset:2048
    v_cvt_pk_bf16_f32 v154, v196, v197
    v_mfma_f32_16x16x32_bf16 a[8:11], a[168:171], v[128:131], a[8:11]
    v_exp_f32 v199, v119
    v_mfma_f32_16x16x32_bf16 a[12:15], a[172:175], v[128:131], a[12:15]
    s_waitcnt lgkmcnt(1)
    v_mfma_f32_16x16x32_bf16 a[16:19], a[176:179], v[128:131], a[16:19]
    v_exp_f32 v192, v120
    v_mfma_f32_16x16x32_bf16 a[20:23], a[180:183], v[128:131], a[20:23]
    ds_read_b128 a[132:135], v212 offset:3072
    v_cvt_pk_bf16_f32 v155, v198, v199
    v_mfma_f32_16x16x32_bf16 a[24:27], a[184:187], v[128:131], a[24:27]
    v_exp_f32 v193, v121
    v_mfma_f32_16x16x32_bf16 a[28:31], a[188:191], v[128:131], a[28:31]
    buffer_load_dwordx4 v214, s[12:15], s23 offen offset:2048 sc1 lds
    v_mfma_f32_16x16x32_bf16 a[200:203], a[208:211], v[152:155], a[200:203]
    buffer_load_dwordx4 v214, s[12:15], s23 offen offset:3072 sc1 lds
    v_mfma_f32_16x16x32_bf16 a[60:63], a[188:191], v[132:135], a[60:63]
    s_add_u32 s32, s32, 16384
    v_exp_f32 v194, v122
    v_mfma_f32_16x16x32_bf16 a[56:59], a[184:187], v[132:135], a[56:59]
    s_xor_b32 s34, s34, 0x10000
    ds_read_b128 a[136:139], v212 offset:6144
    v_cvt_pk_bf16_f32 v156, v192, v193
    v_mfma_f32_16x16x32_bf16 a[52:55], a[180:183], v[132:135], a[52:55]
    v_exp_f32 v195, v123
    v_mfma_f32_16x16x32_bf16 a[48:51], a[176:179], v[132:135], a[48:51]
    v_accvgpr_read_b32 v206, a200
    v_max3_f32 v216, v204, v205, v206
    v_mfma_f32_16x16x32_bf16 a[44:47], a[172:175], v[132:135], a[44:47]
    v_exp_f32 v196, v124
    v_mfma_f32_16x16x32_bf16 a[40:43], a[168:171], v[132:135], a[40:43]
    ds_read_b128 a[140:143], v212 offset:7168
    v_cvt_pk_bf16_f32 v157, v194, v195
    v_mfma_f32_16x16x32_bf16 a[36:39], a[164:167], v[132:135], a[36:39]
    v_exp_f32 v197, v125
    v_mfma_f32_16x16x32_bf16 a[32:35], a[160:163], v[132:135], a[32:35]
    ds_read_b128 a[144:147], v212 offset:10240
    v_mfma_f32_16x16x32_bf16 a[64:67], a[160:163], v[136:139], a[64:67]
    v_exp_f32 v198, v126
    v_mfma_f32_16x16x32_bf16 a[68:71], a[164:167], v[136:139], a[68:71]
    ds_read_b128 a[148:151], v212 offset:11264
    v_cvt_pk_bf16_f32 v158, v196, v197
    v_mfma_f32_16x16x32_bf16 a[72:75], a[168:171], v[136:139], a[72:75]
    s_add_u32 s35, s35, 1
    v_exp_f32 v199, v127
    v_mfma_f32_16x16x32_bf16 a[76:79], a[172:175], v[136:139], a[76:79]
    s_cmp_ge_u32 s35, s38
    s_getpc_b64 s[44:45]
    s_cbranch_scc1 K2_mask_25
    v_mfma_f32_16x16x32_bf16 a[80:83], a[176:179], v[136:139], a[80:83]
    v_exp_f32 v192, v64
    v_mfma_f32_16x16x32_bf16 a[84:87], a[180:183], v[136:139], a[84:87]
    ds_read_b128 a[152:155], v212 offset:14336
    v_cvt_pk_bf16_f32 v159, v198, v199
    v_mfma_f32_16x16x32_bf16 a[88:91], a[184:187], v[136:139], a[88:91]
    v_exp_f32 v193, v65
    v_mfma_f32_16x16x32_bf16 a[92:95], a[188:191], v[136:139], a[92:95]
    buffer_load_dword v235, v220, s[88:91], s56 offen
    v_mfma_f32_16x16x32_bf16 a[204:207], a[208:211], v[156:159], a[204:207]
    s_add_u32 s56, s56, 384
    v_mfma_f32_16x16x32_bf16 a[124:127], a[188:191], v[140:143], a[124:127]
    v_exp_f32 v194, v66
    v_mfma_f32_16x16x32_bf16 a[120:123], a[184:187], v[140:143], a[120:123]
    ds_read_b128 a[156:159], v212 offset:15360
    v_cvt_pk_bf16_f32 v128, v192, v193
    v_mfma_f32_16x16x32_bf16 a[116:119], a[180:183], v[140:143], a[116:119]
    v_exp_f32 v195, v67
    v_mfma_f32_16x16x32_bf16 a[112:115], a[176:179], v[140:143], a[112:115]
    v_accvgpr_read_b32 v207, a204
    v_max_f32 v216, v216, v207
    v_mfma_f32_16x16x32_bf16 a[108:111], a[172:175], v[140:143], a[108:111]
    v_exp_f32 v196, v68
    v_mfma_f32_16x16x32_bf16 a[104:107], a[168:171], v[140:143], a[104:107]
    v_cmp_nle_f32 vcc, v216, v218
    v_cvt_pk_bf16_f32 v129, v194, v195
    v_mfma_f32_16x16x32_bf16 a[100:103], a[164:167], v[140:143], a[100:103]
    v_exp_f32 v197, v69
    v_mfma_f32_16x16x32_bf16 a[96:99], a[160:163], v[140:143], a[96:99]
    s_waitcnt lgkmcnt(4)
    v_xor_b32 v212, 0x10000, v212
    s_cbranch_vccnz K2_st_39
K2_rt_40:
    v_mfma_f32_16x16x32_bf16 v[120:123], a[128:131], v[48:51], v[184:187]
    v_exp_f32 v198, v70
    v_mfma_f32_16x16x32_bf16 v[112:115], a[128:131], v[32:35], v[176:179]
    ds_read_b128 a[160:163], v213 offset:18432
    v_cvt_pk_bf16_f32 v130, v196, v197
    v_mfma_f32_16x16x32_bf16 v[104:107], a[128:131], v[16:19], v[168:171]
    v_exp_f32 v199, v71
    v_mfma_f32_16x16x32_bf16 v[96:99], a[128:131], v[0:3], v[160:163]
    buffer_store_dwordx4 a[236:239], v214, s[12:15], s57 offen sc1
    v_mfma_f32_16x16x32_bf16 v[100:103], a[132:135], v[0:3], v[164:167]
    s_add_u32 s57, s57, 1024
    v_exp_f32 v192, v72
    v_mfma_f32_16x16x32_bf16 v[108:111], a[132:135], v[16:19], v[172:175]
    ds_read_b128 a[164:167], v213 offset:19456
    v_cvt_pk_bf16_f32 v131, v198, v199
    v_mfma_f32_16x16x32_bf16 v[116:119], a[132:135], v[32:35], v[180:183]
    v_exp_f32 v193, v73
    v_mfma_f32_16x16x32_bf16 v[124:127], a[132:135], v[48:51], v[188:191]
    s_cmp_ge_u32 s57, s58
    s_cselect_b32 s57, s14, s57
    v_mfma_f32_16x16x32_bf16 a[192:195], a[208:211], v[128:131], a[192:195]
    v_mfma_f32_16x16x32_bf16 v[120:123], a[136:139], v[52:55], v[120:123]
    v_exp_f32 v194, v74
    v_mfma_f32_16x16x32_bf16 v[112:115], a[136:139], v[36:39], v[112:115]
    ds_read_b128 a[168:171], v213 offset:22528
    v_cvt_pk_bf16_f32 v132, v192, v193
    v_mfma_f32_16x16x32_bf16 v[104:107], a[136:139], v[20:23], v[104:107]
    v_exp_f32 v195, v75
    v_mfma_f32_16x16x32_bf16 v[96:99], a[136:139], v[4:7], v[96:99]
    ds_read_b128 a[172:175], v213 offset:23552
    v_accvgpr_read_b32 v200, a192
    v_mfma_f32_16x16x32_bf16 v[100:103], a[140:143], v[4:7], v[100:103]
    v_exp_f32 v196, v76
    v_mfma_f32_16x16x32_bf16 v[108:111], a[140:143], v[20:23], v[108:111]
    ds_read_b128 a[176:179], v213 offset:26624
    v_cvt_pk_bf16_f32 v133, v194, v195
    v_mfma_f32_16x16x32_bf16 v[116:119], a[140:143], v[36:39], v[116:119]
    v_exp_f32 v197, v77
    v_mfma_f32_16x16x32_bf16 v[124:127], a[140:143], v[52:55], v[124:127]
    s_waitcnt lgkmcnt(5)
    v_mfma_f32_16x16x32_bf16 v[120:123], a[144:147], v[56:59], v[120:123]
    v_exp_f32 v198, v78
    v_mfma_f32_16x16x32_bf16 v[112:115], a[144:147], v[40:43], v[112:115]
    ds_read_b128 a[180:183], v213 offset:27648
    v_cvt_pk_bf16_f32 v134, v196, v197
    v_mfma_f32_16x16x32_bf16 v[104:107], a[144:147], v[24:27], v[104:107]
    v_exp_f32 v199, v79
    v_mfma_f32_16x16x32_bf16 v[96:99], a[144:147], v[8:11], v[96:99]
    v_mfma_f32_16x16x32_bf16 v[100:103], a[148:151], v[8:11], v[100:103]
    s_sub_u32 s25, s25, 1
    v_exp_f32 v192, v80
    v_mfma_f32_16x16x32_bf16 v[108:111], a[148:151], v[24:27], v[108:111]
    ds_read_b128 a[184:187], v213 offset:30720
    v_cvt_pk_bf16_f32 v135, v198, v199
    v_mfma_f32_16x16x32_bf16 v[116:119], a[148:151], v[40:43], v[116:119]
    s_add_u32 s35, s35, 1
    v_exp_f32 v193, v81
    v_mfma_f32_16x16x32_bf16 v[124:127], a[148:151], v[56:59], v[124:127]
    s_cmp_ge_u32 s35, s38
    s_getpc_b64 s[44:45]
    s_cbranch_scc1 K2_mask_25
    v_mfma_f32_16x16x32_bf16 a[196:199], a[208:211], v[132:135], a[196:199]
    v_mfma_f32_16x16x32_bf16 v[120:123], a[152:155], v[60:63], v[120:123]
    v_exp_f32 v194, v82
    v_mfma_f32_16x16x32_bf16 v[112:115], a[152:155], v[44:47], v[112:115]
    ds_read_b128 a[188:191], v213 offset:31744
    v_cvt_pk_bf16_f32 v136, v192, v193
    v_mfma_f32_16x16x32_bf16 v[104:107], a[152:155], v[28:31], v[104:107]
    v_exp_f32 v195, v83
    v_mfma_f32_16x16x32_bf16 v[96:99], a[152:155], v[12:15], v[96:99]
    v_accvgpr_read_b32 v201, a196
    v_xor_b32 v213, 0x10000, v213
    v_mfma_f32_16x16x32_bf16 v[100:103], a[156:159], v[12:15], v[100:103]
    v_exp_f32 v196, v84
    v_mfma_f32_16x16x32_bf16 v[108:111], a[156:159], v[28:31], v[108:111]
    v_cvt_pk_bf16_f32 v137, v194, v195
    v_mfma_f32_16x16x32_bf16 v[116:119], a[156:159], v[44:47], v[116:119]
    v_exp_f32 v197, v85
    v_mfma_f32_16x16x32_bf16 v[124:127], a[156:159], v[60:63], v[124:127]
    s_waitcnt lgkmcnt(0)
    s_waitcnt vmcnt(2) lgkmcnt(0)
    s_barrier
    v_mfma_f32_16x16x32_bf16 a[0:3], a[160:163], v[144:147], a[0:3]
    v_exp_f32 v198, v86
    v_mfma_f32_16x16x32_bf16 a[4:7], a[164:167], v[144:147], a[4:7]
    v_cvt_pk_bf16_f32 v138, v196, v197
    v_mfma_f32_16x16x32_bf16 a[8:11], a[168:171], v[144:147], a[8:11]
    v_exp_f32 v199, v87
    v_mfma_f32_16x16x32_bf16 a[12:15], a[172:175], v[144:147], a[12:15]
    buffer_store_dword v221, v236, s[12:15], s63 offen sc1
    v_mfma_f32_16x16x32_bf16 a[16:19], a[176:179], v[144:147], a[16:19]
    s_add_u32 m0, s33, 0
    v_exp_f32 v192, v88
    v_mfma_f32_16x16x32_bf16 a[20:23], a[180:183], v[144:147], a[20:23]
    s_nop 0
    ds_read_b128 a[128:131], v212 offset:0
    v_cvt_pk_bf16_f32 v139, v198, v199
    v_mfma_f32_16x16x32_bf16 a[24:27], a[184:187], v[144:147], a[24:27]
    v_exp_f32 v193, v89
    v_mfma_f32_16x16x32_bf16 a[28:31], a[188:191], v[144:147], a[28:31]
    buffer_load_dwordx4 v214, s[12:15], s31 offen offset:0 sc1 lds
    v_mfma_f32_16x16x32_bf16 a[200:203], a[208:211], v[136:139], a[200:203]
    buffer_load_dwordx4 v214, s[12:15], s31 offen offset:1024 sc1 lds
    v_mfma_f32_16x16x32_bf16 a[60:63], a[188:191], v[148:151], a[60:63]
    v_exp_f32 v194, v90
    v_mfma_f32_16x16x32_bf16 a[56:59], a[184:187], v[148:151], a[56:59]
    ds_read_b128 a[132:135], v212 offset:1024
    v_cvt_pk_bf16_f32 v140, v192, v193
    v_mfma_f32_16x16x32_bf16 a[52:55], a[180:183], v[148:151], a[52:55]
    v_exp_f32 v195, v91
    v_mfma_f32_16x16x32_bf16 a[48:51], a[176:179], v[148:151], a[48:51]
    v_accvgpr_read_b32 v202, a200
    v_max3_f32 v216, v200, v201, v202
    v_mfma_f32_16x16x32_bf16 a[44:47], a[172:175], v[148:151], a[44:47]
    v_exp_f32 v196, v92
    v_mfma_f32_16x16x32_bf16 a[40:43], a[168:171], v[148:151], a[40:43]
    ds_read_b128 a[136:139], v212 offset:4096
    v_cvt_pk_bf16_f32 v141, v194, v195
    v_mfma_f32_16x16x32_bf16 a[36:39], a[164:167], v[148:151], a[36:39]
    v_exp_f32 v197, v93
    v_mfma_f32_16x16x32_bf16 a[32:35], a[160:163], v[148:151], a[32:35]
    buffer_load_dwordx4 v214, s[12:15], s31 offen offset:2048 sc1 lds
    v_mfma_f32_16x16x32_bf16 a[64:67], a[160:163], v[152:155], a[64:67]
    v_exp_f32 v198, v94
    v_mfma_f32_16x16x32_bf16 a[68:71], a[164:167], v[152:155], a[68:71]
    ds_read_b128 a[140:143], v212 offset:5120
    v_cvt_pk_bf16_f32 v142, v196, v197
    v_mfma_f32_16x16x32_bf16 a[72:75], a[168:171], v[152:155], a[72:75]
    v_exp_f32 v199, v95
    v_mfma_f32_16x16x32_bf16 a[76:79], a[172:175], v[152:155], a[76:79]
    buffer_load_dwordx4 v214, s[12:15], s31 offen offset:3072 sc1 lds
    v_mfma_f32_16x16x32_bf16 a[80:83], a[176:179], v[152:155], a[80:83]
    s_add_u32 m0, s33, 32768
    v_exp_f32 v192, v96
    v_mfma_f32_16x16x32_bf16 a[84:87], a[180:183], v[152:155], a[84:87]
    s_add_u32 s23, s31, s39
    ds_read_b128 a[144:147], v212 offset:8192
    v_cvt_pk_bf16_f32 v143, v198, v199
    v_mfma_f32_16x16x32_bf16 a[88:91], a[184:187], v[152:155], a[88:91]
    v_exp_f32 v193, v97
    v_mfma_f32_16x16x32_bf16 a[92:95], a[188:191], v[152:155], a[92:95]
    buffer_load_dwordx4 v214, s[12:15], s23 offen offset:0 sc1 lds
    v_mfma_f32_16x16x32_bf16 a[204:207], a[208:211], v[140:143], a[204:207]
    buffer_load_dwordx4 v214, s[12:15], s23 offen offset:1024 sc1 lds
    buffer_load_dwordx4 v214, s[12:15], s23 offen offset:2048 sc1 lds
    v_mfma_f32_16x16x32_bf16 a[124:127], a[188:191], v[156:159], a[124:127]
    buffer_load_dwordx4 v214, s[12:15], s23 offen offset:3072 sc1 lds
    v_exp_f32 v194, v98
    v_mfma_f32_16x16x32_bf16 a[120:123], a[184:187], v[156:159], a[120:123]
    s_add_u32 s31, s31, 16384
    ds_read_b128 a[148:151], v212 offset:9216
    v_cvt_pk_bf16_f32 v144, v192, v193
    v_mfma_f32_16x16x32_bf16 a[116:119], a[180:183], v[156:159], a[116:119]
    s_xor_b32 s33, s33, 0x10000
    v_exp_f32 v195, v99
    v_mfma_f32_16x16x32_bf16 a[112:115], a[176:179], v[156:159], a[112:115]
    v_accvgpr_read_b32 v203, a204
    v_max_f32 v216, v216, v203
    v_mfma_f32_16x16x32_bf16 a[108:111], a[172:175], v[156:159], a[108:111]
    v_exp_f32 v196, v100
    v_mfma_f32_16x16x32_bf16 a[104:107], a[168:171], v[156:159], a[104:107]
    v_cmp_nle_f32 vcc, v216, v218
    v_cvt_pk_bf16_f32 v145, v194, v195
    v_mfma_f32_16x16x32_bf16 a[100:103], a[164:167], v[156:159], a[100:103]
    v_exp_f32 v197, v101
    v_mfma_f32_16x16x32_bf16 a[96:99], a[160:163], v[156:159], a[96:99]
    s_cbranch_vccnz K2_st_41
K2_rt_42:
    s_cmp_lg_u32 s25, 0
    s_cbranch_scc1 K2_single_37
K2_sdone_38:
    s_mul_i32 s54, s17, 18432
    s_add_u32 s54, s54, 54525952
    s_lshl_b32 s55, s17, 17
    s_lshl_b32 s24, s18, 14
    s_add_u32 s55, s55, s24
    s_add_u32 s55, s55, s43
    s_add_u32 s55, s55, 55574528
    s_lshl_b32 s22, s16, 15
    v_add_u32 v212, s22, v214
    v_lshrrev_b32 v217, 4, v215
    v_and_b32 v234, 7, v215
    v_mul_u32_u24 v234, 2304, v234
    v_lshl_add_u32 v234, v217, 4, v234
    v_xor_b32 v219, 0x2000, v219
    ds_read_b128 a[160:163], v213 offset:16384
    ds_read_b128 a[164:167], v213 offset:17408
    ds_read_b128 a[168:171], v213 offset:20480
    ds_read_b128 a[172:175], v213 offset:21504
    ds_read_b128 a[176:179], v213 offset:24576
    ds_read_b128 a[180:183], v213 offset:25600
    s_waitcnt lgkmcnt(4)
    v_mfma_f32_16x16x32_bf16 a[0:3], a[160:163], v[128:131], a[0:3]
    ds_read_b128 a[184:187], v213 offset:28672
    v_mfma_f32_16x16x32_bf16 a[32:35], a[160:163], v[132:135], a[32:35]
    s_getpc_b64 s[96:97]
CPF_43:
    s_add_u32 s96, s96, K3_fused_entry - CPF_43
    s_addc_u32 s97, s97, 0
    v_mfma_f32_16x16x32_bf16 a[64:67], a[160:163], v[136:139], a[64:67]
    s_lshr_b32 s22, s2, 3
    v_exp_f32 v198, v102
    v_mfma_f32_16x16x32_bf16 a[96:99], a[160:163], v[140:143], a[96:99]
    s_lshl_b32 s22, s22, 2
    ds_read_b128 a[188:191], v213 offset:29696
    v_cvt_pk_bf16_f32 v146, v196, v197
    v_mfma_f32_16x16x32_bf16 a[4:7], a[164:167], v[128:131], a[4:7]
    s_add_u32 s22, s22, s16
    ds_read_b128 a[160:163], v213 offset:18432
    v_mfma_f32_16x16x32_bf16 a[36:39], a[164:167], v[132:135], a[36:39]
    s_lshl_b32 s22, s22, 10
    v_exp_f32 v199, v103
    v_mfma_f32_16x16x32_bf16 a[68:71], a[164:167], v[136:139], a[68:71]
    v_and_b32 v220, 7, v215
    v_exp_f32 v192, v104
    v_mfma_f32_16x16x32_bf16 a[100:103], a[164:167], v[140:143], a[100:103]
    s_waitcnt lgkmcnt(5)
    v_lshlrev_b32 v220, 7, v220
    v_cvt_pk_bf16_f32 v147, v198, v199
    v_exp_f32 v193, v105
    v_mfma_f32_16x16x32_bf16 a[8:11], a[168:171], v[128:131], a[8:11]
    ds_read_b128 a[164:167], v213 offset:19456
    v_add_u32 v220, s22, v220
    v_exp_f32 v194, v106
    v_cvt_pk_bf16_f32 v148, v192, v193
    v_mfma_f32_16x16x32_bf16 a[40:43], a[168:171], v[132:135], a[40:43]
    v_min_u32 v220, K3_code_end - K3_fused_entry - 4, v220
    v_mfma_f32_16x16x32_bf16 a[192:195], a[208:211], v[144:147], a[192:195]
    v_exp_f32 v195, v107
    v_mfma_f32_16x16x32_bf16 a[72:75], a[168:171], v[136:139], a[72:75]
    global_load_dword v235, v220, s[96:97]
    v_exp_f32 v196, v108
    v_cvt_pk_bf16_f32 v149, v194, v195
    v_mfma_f32_16x16x32_bf16 a[104:107], a[168:171], v[140:143], a[104:107]
    v_exp_f32 v197, v109
    v_exp_f32 v198, v110
    v_mfma_f32_16x16x32_bf16 a[12:15], a[172:175], v[128:131], a[12:15]
    ds_read_b128 a[168:171], v213 offset:22528
    v_cvt_pk_bf16_f32 v150, v196, v197
    v_exp_f32 v199, v111
    v_mfma_f32_16x16x32_bf16 a[44:47], a[172:175], v[132:135], a[44:47]
    buffer_load_dwordx4 a[212:215], v234, s[12:15], s54 offen offset:2048 sc1
    v_exp_f32 v192, v112
    v_cvt_pk_bf16_f32 v151, v198, v199
    v_exp_f32 v193, v113
    v_mfma_f32_16x16x32_bf16 a[76:79], a[172:175], v[136:139], a[76:79]
    buffer_load_dwordx4 a[216:219], v234, s[12:15], s54 offen offset:2112 sc1
    v_exp_f32 v194, v114
    v_cvt_pk_bf16_f32 v152, v192, v193
    v_mfma_f32_16x16x32_bf16 a[108:111], a[172:175], v[140:143], a[108:111]
    s_waitcnt lgkmcnt(5)
    v_mfma_f32_16x16x32_bf16 a[196:199], a[208:211], v[148:151], a[196:199]
    v_exp_f32 v195, v115
    v_mfma_f32_16x16x32_bf16 a[16:19], a[176:179], v[128:131], a[16:19]
    ds_read_b128 a[172:175], v213 offset:23552
    v_exp_f32 v196, v116
    v_cvt_pk_bf16_f32 v153, v194, v195
    v_mfma_f32_16x16x32_bf16 a[48:51], a[176:179], v[132:135], a[48:51]
    buffer_load_dwordx4 a[220:223], v214, s[12:15], s55 offen offset:0 sc1
    v_accvgpr_read_b32 v204, a192
    v_exp_f32 v197, v117
    v_mfma_f32_16x16x32_bf16 a[80:83], a[176:179], v[136:139], a[80:83]
    buffer_load_dwordx4 a[224:227], v214, s[12:15], s55 offen offset:1024 sc1
    v_exp_f32 v198, v118
    v_cvt_pk_bf16_f32 v154, v196, v197
    v_mfma_f32_16x16x32_bf16 a[112:115], a[176:179], v[140:143], a[112:115]
    buffer_load_dwordx4 a[228:231], v214, s[12:15], s55 offen offset:2048 sc1
    v_exp_f32 v199, v119
    v_exp_f32 v192, v120
    v_cvt_pk_bf16_f32 v155, v198, v199
    v_mfma_f32_16x16x32_bf16 a[20:23], a[180:183], v[128:131], a[20:23]
    ds_read_b128 a[176:179], v213 offset:26624
    v_exp_f32 v193, v121
    v_exp_f32 v194, v122
    v_cvt_pk_bf16_f32 v156, v192, v193
    v_mfma_f32_16x16x32_bf16 a[200:203], a[208:211], v[152:155], a[200:203]
    v_exp_f32 v195, v123
    v_exp_f32 v196, v124
    v_cvt_pk_bf16_f32 v157, v194, v195
    v_accvgpr_read_b32 v205, a196
    v_exp_f32 v197, v125
    v_exp_f32 v198, v126
    v_cvt_pk_bf16_f32 v158, v196, v197
    v_exp_f32 v199, v127
    v_nop
    v_cvt_pk_bf16_f32 v159, v198, v199
    v_mfma_f32_16x16x32_bf16 a[52:55], a[180:183], v[132:135], a[52:55]
    v_nop
    v_mfma_f32_16x16x32_bf16 a[204:207], a[208:211], v[156:159], a[204:207]
    v_mfma_f32_16x16x32_bf16 a[84:87], a[180:183], v[136:139], a[84:87]
    buffer_load_dwordx4 a[232:235], v214, s[12:15], s55 offen offset:3072 sc1
    v_mfma_f32_16x16x32_bf16 a[116:119], a[180:183], v[140:143], a[116:119]
    s_waitcnt lgkmcnt(5)
    v_accvgpr_read_b32 v206, a200
    v_mfma_f32_16x16x32_bf16 a[24:27], a[184:187], v[128:131], a[24:27]
    ds_read_b128 a[180:183], v213 offset:27648
    v_max3_f32 v216, v204, v205, v206
    v_mfma_f32_16x16x32_bf16 a[56:59], a[184:187], v[132:135], a[56:59]
    buffer_load_dwordx4 v[0:3], v214, s[12:15], s54 offen offset:0 sc1
    v_mfma_f32_16x16x32_bf16 a[88:91], a[184:187], v[136:139], a[88:91]
    buffer_load_dwordx4 v[4:7], v214, s[12:15], s54 offen offset:1024 sc1
    v_mfma_f32_16x16x32_bf16 a[120:123], a[184:187], v[140:143], a[120:123]
    s_add_u32 s54, s54, 2304
    v_mfma_f32_16x16x32_bf16 a[28:31], a[188:191], v[128:131], a[28:31]
    ds_read_b128 a[184:187], v213 offset:30720
    v_accvgpr_read_b32 v207, a204
    v_mfma_f32_16x16x32_bf16 a[60:63], a[188:191], v[132:135], a[60:63]
    v_max_f32 v216, v216, v207
    v_cmp_nle_f32 vcc, v216, v218
    v_mfma_f32_16x16x32_bf16 a[92:95], a[188:191], v[136:139], a[92:95]
    buffer_load_dwordx4 v[8:11], v214, s[12:15], s54 offen offset:0 sc1
    v_mfma_f32_16x16x32_bf16 a[124:127], a[188:191], v[140:143], a[124:127]
    s_waitcnt lgkmcnt(5)
    ds_read_b128 a[188:191], v213 offset:31744
    s_cbranch_vccnz K2_st_44
K2_rt_45:
    v_mfma_f32_16x16x32_bf16 a[64:67], a[160:163], v[152:155], a[64:67]
    buffer_load_dwordx4 v[12:15], v214, s[12:15], s54 offen offset:1024 sc1
    v_mov_b32 v224, v210
    v_mov_b32 v225, v211
    v_mov_b32 v226, v206
    v_mov_b32 v227, v207
    ds_write_b128 v219, v[224:227]
    v_xor_b32 v219, 0x2000, v219
    v_mfma_f32_16x16x32_bf16 a[96:99], a[160:163], v[156:159], a[96:99]
    s_add_u32 s54, s54, 2304
    v_mfma_f32_16x16x32_bf16 a[68:71], a[164:167], v[152:155], a[68:71]
    buffer_load_dwordx4 v[16:19], v214, s[12:15], s54 offen offset:0 sc1
    v_mfma_f32_16x16x32_bf16 a[100:103], a[164:167], v[156:159], a[100:103]
    s_waitcnt lgkmcnt(5)
    v_mfma_f32_16x16x32_bf16 a[72:75], a[168:171], v[152:155], a[72:75]
    buffer_load_dwordx4 v[20:23], v214, s[12:15], s54 offen offset:1024 sc1
    v_mfma_f32_16x16x32_bf16 a[104:107], a[168:171], v[156:159], a[104:107]
    s_add_u32 s54, s54, 2304
    v_mfma_f32_16x16x32_bf16 a[76:79], a[172:175], v[152:155], a[76:79]
    buffer_load_dwordx4 v[24:27], v214, s[12:15], s54 offen offset:0 sc1
    s_waitcnt vmcnt(14)
    s_waitcnt lgkmcnt(0)
    s_barrier
    ds_read_b128 v[224:227], v219
    buffer_store_dword v221, v236, s[12:15], s63 offen sc1
    v_mfma_f32_16x16x32_bf16 a[108:111], a[172:175], v[156:159], a[108:111]
    s_waitcnt lgkmcnt(1)
    v_mfma_f32_16x16x32_bf16 a[80:83], a[176:179], v[152:155], a[80:83]
    buffer_load_dwordx4 v[28:31], v214, s[12:15], s54 offen offset:1024 sc1
    v_mfma_f32_16x16x32_bf16 a[112:115], a[176:179], v[156:159], a[112:115]
    s_add_u32 s54, s54, 2304
    v_mfma_f32_16x16x32_bf16 a[84:87], a[180:183], v[152:155], a[84:87]
    buffer_load_dwordx4 v[32:35], v214, s[12:15], s54 offen offset:0 sc1
    ds_write_b128 v212, a[64:67] offset:0
    v_mfma_f32_16x16x32_bf16 a[116:119], a[180:183], v[156:159], a[116:119]
    s_waitcnt lgkmcnt(2)
    ds_write_b128 v212, a[96:99] offset:8192
    v_mfma_f32_16x16x32_bf16 a[88:91], a[184:187], v[152:155], a[88:91]
    buffer_load_dwordx4 v[36:39], v214, s[12:15], s54 offen offset:1024 sc1
    ds_write_b128 v212, a[68:71] offset:1024
    v_mfma_f32_16x16x32_bf16 a[120:123], a[184:187], v[156:159], a[120:123]
    s_add_u32 s54, s54, 2304
    ds_write_b128 v212, a[100:103] offset:9216
    v_mfma_f32_16x16x32_bf16 a[92:95], a[188:191], v[152:155], a[92:95]
    buffer_load_dwordx4 v[40:43], v214, s[12:15], s54 offen offset:0 sc1
    ds_write_b128 v212, a[72:75] offset:2048
    s_waitcnt lgkmcnt(5)
    v_max_f32 v217, v208, v224
    v_sub_f32 v228, v208, v217
    v_sub_f32 v192, v224, v217
    v_max_f32 v217, v209, v225
    v_sub_f32 v230, v209, v217
    v_sub_f32 v194, v225, v217
    v_exp_f32 v228, v228
    v_exp_f32 v192, v192
    v_exp_f32 v230, v230
    v_exp_f32 v194, v194
    v_mfma_f32_16x16x32_bf16 a[124:127], a[188:191], v[156:159], a[124:127]
    ds_write_b128 v212, a[104:107] offset:10240
    v_mfma_f32_16x16x32_bf16 a[0:3], a[160:163], v[144:147], a[0:3]
    buffer_load_dwordx4 v[44:47], v214, s[12:15], s54 offen offset:1024 sc1
    ds_write_b128 v212, a[76:79] offset:3072
    v_mfma_f32_16x16x32_bf16 a[32:35], a[160:163], v[148:151], a[32:35]
    s_add_u32 s54, s54, 2304
    ds_write_b128 v212, a[108:111] offset:11264
    v_mfma_f32_16x16x32_bf16 a[4:7], a[164:167], v[144:147], a[4:7]
    buffer_load_dwordx4 v[48:51], v214, s[12:15], s54 offen offset:0 sc1
    ds_write_b128 v212, a[80:83] offset:4096
    v_mul_f32 v204, v204, v228
    v_fmac_f32 v204, v226, v192
    v_mul_f32 v205, v205, v230
    v_fmac_f32 v205, v227, v194
    v_rcp_f32 v204, v204
    v_rcp_f32 v205, v205
    v_mfma_f32_16x16x32_bf16 a[36:39], a[164:167], v[148:151], a[36:39]
    ds_write_b128 v212, a[112:115] offset:12288
    v_mfma_f32_16x16x32_bf16 a[8:11], a[168:171], v[144:147], a[8:11]
    buffer_load_dwordx4 v[52:55], v214, s[12:15], s54 offen offset:1024 sc1
    ds_write_b128 v212, a[84:87] offset:5120
    v_mfma_f32_16x16x32_bf16 a[40:43], a[168:171], v[148:151], a[40:43]
    ds_write_b128 v212, a[116:119] offset:13312
    v_mul_f32 v204, 0x23800000, v204
    v_mul_f32 v205, 0x23800000, v205
    v_mul_f32 v228, v228, v204
    v_mul_f32 v192, v192, v204
    v_mul_f32 v230, v230, v205
    v_mul_f32 v194, v194, v205
    v_mfma_f32_16x16x32_bf16 a[12:15], a[172:175], v[144:147], a[12:15]
    s_add_u32 s54, s54, 2304
    ds_write_b128 v212, a[88:91] offset:6144
    v_mfma_f32_16x16x32_bf16 a[44:47], a[172:175], v[148:151], a[44:47]
    buffer_load_dwordx4 v[56:59], v214, s[12:15], s54 offen offset:0 sc1
    ds_write_b128 v212, a[120:123] offset:14336
    v_mfma_f32_16x16x32_bf16 a[16:19], a[176:179], v[144:147], a[16:19]
    ds_write_b128 v212, a[92:95] offset:7168
    v_mfma_f32_16x16x32_bf16 a[48:51], a[176:179], v[148:151], a[48:51]
    buffer_load_dwordx4 v[60:63], v214, s[12:15], s54 offen offset:1024 sc1
    ds_write_b128 v212, a[124:127] offset:15360
    v_mfma_f32_16x16x32_bf16 a[20:23], a[180:183], v[144:147], a[20:23]
    v_mfma_f32_16x16x32_bf16 a[52:55], a[180:183], v[148:151], a[52:55]
    s_add_u32 s54, s54, 2304
    v_mfma_f32_16x16x32_bf16 a[24:27], a[184:187], v[144:147], a[24:27]
    v_mfma_f32_16x16x32_bf16 a[56:59], a[184:187], v[148:151], a[56:59]
    v_mfma_f32_16x16x32_bf16 a[28:31], a[188:191], v[144:147], a[28:31]
    v_mfma_f32_16x16x32_bf16 a[60:63], a[188:191], v[148:151], a[60:63]
    v_xor_b32 v212, 0x8000, v212
    s_waitcnt lgkmcnt(0)
    s_barrier
    ds_read_b128 v[64:67], v212 offset:0
    ds_read_b128 v[68:71], v212 offset:1024
    ds_read_b128 v[72:75], v212 offset:2048
    ds_read_b128 v[76:79], v212 offset:3072
    ds_read_b128 v[80:83], v212 offset:4096
    ds_read_b128 v[84:87], v212 offset:5120
    ds_read_b128 v[88:91], v212 offset:6144
    ds_read_b128 v[92:95], v212 offset:7168
    ds_read_b128 v[96:99], v212 offset:8192
    ds_read_b128 v[100:103], v212 offset:9216
    ds_read_b128 v[104:107], v212 offset:10240
    ds_read_b128 v[108:111], v212 offset:11264
    ds_read_b128 v[112:115], v212 offset:12288
    ds_read_b128 v[116:119], v212 offset:13312
    ds_read_b128 v[120:123], v212 offset:14336
    v_accvgpr_read_b32 v128, a0
    v_accvgpr_read_b32 v129, a1
    v_accvgpr_read_b32 v130, a2
    v_accvgpr_read_b32 v131, a3
    v_accvgpr_read_b32 v132, a4
    v_accvgpr_read_b32 v133, a5
    v_accvgpr_read_b32 v134, a6
    v_accvgpr_read_b32 v135, a7
    v_accvgpr_read_b32 v136, a8
    v_accvgpr_read_b32 v137, a9
    v_accvgpr_read_b32 v138, a10
    v_accvgpr_read_b32 v139, a11
    v_accvgpr_read_b32 v140, a12
    v_accvgpr_read_b32 v141, a13
    v_accvgpr_read_b32 v142, a14
    v_accvgpr_read_b32 v143, a15
    v_accvgpr_read_b32 v144, a16
    v_accvgpr_read_b32 v145, a17
    v_accvgpr_read_b32 v146, a18
    v_accvgpr_read_b32 v147, a19
    v_accvgpr_read_b32 v148, a20
    v_accvgpr_read_b32 v149, a21
    v_accvgpr_read_b32 v150, a22
    v_accvgpr_read_b32 v151, a23
    v_accvgpr_read_b32 v152, a24
    v_accvgpr_read_b32 v153, a25
    v_accvgpr_read_b32 v154, a26
    v_accvgpr_read_b32 v155, a27
    v_accvgpr_read_b32 v156, a28
    v_accvgpr_read_b32 v157, a29
    v_accvgpr_read_b32 v158, a30
    v_accvgpr_read_b32 v159, a31
    ds_read_b128 v[124:127], v212 offset:15360
    v_pk_mul_f32 v[128:129], v[128:129], v[228:229] op_sel_hi:[1,0]
    v_pk_mul_f32 v[130:131], v[130:131], v[228:229] op_sel_hi:[1,0]
    v_pk_mul_f32 v[132:133], v[132:133], v[228:229] op_sel_hi:[1,0]
    v_pk_mul_f32 v[134:135], v[134:135], v[228:229] op_sel_hi:[1,0]
    v_pk_mul_f32 v[136:137], v[136:137], v[228:229] op_sel_hi:[1,0]
    v_pk_mul_f32 v[138:139], v[138:139], v[228:229] op_sel_hi:[1,0]
    v_pk_mul_f32 v[140:141], v[140:141], v[228:229] op_sel_hi:[1,0]
    v_pk_mul_f32 v[142:143], v[142:143], v[228:229] op_sel_hi:[1,0]
    v_pk_mul_f32 v[144:145], v[144:145], v[228:229] op_sel_hi:[1,0]
    v_pk_mul_f32 v[146:147], v[146:147], v[228:229] op_sel_hi:[1,0]
    v_pk_mul_f32 v[148:149], v[148:149], v[228:229] op_sel_hi:[1,0]
    v_pk_mul_f32 v[150:151], v[150:151], v[228:229] op_sel_hi:[1,0]
    v_pk_mul_f32 v[152:153], v[152:153], v[228:229] op_sel_hi:[1,0]
    v_pk_mul_f32 v[154:155], v[154:155], v[228:229] op_sel_hi:[1,0]
    v_pk_mul_f32 v[156:157], v[156:157], v[228:229] op_sel_hi:[1,0]
    v_pk_mul_f32 v[158:159], v[158:159], v[228:229] op_sel_hi:[1,0]
    s_waitcnt lgkmcnt(8)
    v_pk_fma_f32 v[128:129], v[64:65], v[192:193], v[128:129] op_sel_hi:[1,0,1]
    v_pk_fma_f32 v[130:131], v[66:67], v[192:193], v[130:131] op_sel_hi:[1,0,1]
    v_pk_fma_f32 v[132:133], v[68:69], v[192:193], v[132:133] op_sel_hi:[1,0,1]
    v_pk_fma_f32 v[134:135], v[70:71], v[192:193], v[134:135] op_sel_hi:[1,0,1]
    v_cvt_pk_bf16_f32 v240, v128, v129
    v_cvt_pk_bf16_f32 v241, v130, v131
    v_cvt_pk_bf16_f32 v242, v132, v133
    v_cvt_pk_bf16_f32 v243, v134, v135
    buffer_store_dwordx4 v[240:243], v232, s[12:15], s40 offen offset:0 sc1
    v_pk_fma_f32 v[136:137], v[72:73], v[192:193], v[136:137] op_sel_hi:[1,0,1]
    v_pk_fma_f32 v[138:139], v[74:75], v[192:193], v[138:139] op_sel_hi:[1,0,1]
    v_pk_fma_f32 v[140:141], v[76:77], v[192:193], v[140:141] op_sel_hi:[1,0,1]
    v_pk_fma_f32 v[142:143], v[78:79], v[192:193], v[142:143] op_sel_hi:[1,0,1]
    v_cvt_pk_bf16_f32 v244, v136, v137
    v_cvt_pk_bf16_f32 v245, v138, v139
    v_cvt_pk_bf16_f32 v246, v140, v141
    v_cvt_pk_bf16_f32 v247, v142, v143
    buffer_store_dwordx4 v[244:247], v232, s[12:15], s40 offen offset:1024 sc1
    v_pk_fma_f32 v[144:145], v[80:81], v[192:193], v[144:145] op_sel_hi:[1,0,1]
    v_pk_fma_f32 v[146:147], v[82:83], v[192:193], v[146:147] op_sel_hi:[1,0,1]
    v_pk_fma_f32 v[148:149], v[84:85], v[192:193], v[148:149] op_sel_hi:[1,0,1]
    v_pk_fma_f32 v[150:151], v[86:87], v[192:193], v[150:151] op_sel_hi:[1,0,1]
    v_cvt_pk_bf16_f32 v248, v144, v145
    v_cvt_pk_bf16_f32 v249, v146, v147
    v_cvt_pk_bf16_f32 v250, v148, v149
    v_cvt_pk_bf16_f32 v251, v150, v151
    buffer_store_dwordx4 v[248:251], v232, s[12:15], s40 offen offset:2048 sc1
    v_pk_fma_f32 v[152:153], v[88:89], v[192:193], v[152:153] op_sel_hi:[1,0,1]
    v_pk_fma_f32 v[154:155], v[90:91], v[192:193], v[154:155] op_sel_hi:[1,0,1]
    v_pk_fma_f32 v[156:157], v[92:93], v[192:193], v[156:157] op_sel_hi:[1,0,1]
    v_pk_fma_f32 v[158:159], v[94:95], v[192:193], v[158:159] op_sel_hi:[1,0,1]
    v_cvt_pk_bf16_f32 v252, v152, v153
    v_cvt_pk_bf16_f32 v253, v154, v155
    v_cvt_pk_bf16_f32 v254, v156, v157
    v_cvt_pk_bf16_f32 v255, v158, v159
    buffer_store_dwordx4 v[252:255], v232, s[12:15], s40 offen offset:3072 sc1
    v_accvgpr_read_b32 v128, a32
    v_accvgpr_read_b32 v129, a33
    v_accvgpr_read_b32 v130, a34
    v_accvgpr_read_b32 v131, a35
    v_accvgpr_read_b32 v132, a36
    v_accvgpr_read_b32 v133, a37
    v_accvgpr_read_b32 v134, a38
    v_accvgpr_read_b32 v135, a39
    v_accvgpr_read_b32 v136, a40
    v_accvgpr_read_b32 v137, a41
    v_accvgpr_read_b32 v138, a42
    v_accvgpr_read_b32 v139, a43
    v_accvgpr_read_b32 v140, a44
    v_accvgpr_read_b32 v141, a45
    v_accvgpr_read_b32 v142, a46
    v_accvgpr_read_b32 v143, a47
    v_accvgpr_read_b32 v144, a48
    v_accvgpr_read_b32 v145, a49
    v_accvgpr_read_b32 v146, a50
    v_accvgpr_read_b32 v147, a51
    v_accvgpr_read_b32 v148, a52
    v_accvgpr_read_b32 v149, a53
    v_accvgpr_read_b32 v150, a54
    v_accvgpr_read_b32 v151, a55
    v_accvgpr_read_b32 v152, a56
    v_accvgpr_read_b32 v153, a57
    v_accvgpr_read_b32 v154, a58
    v_accvgpr_read_b32 v155, a59
    v_accvgpr_read_b32 v156, a60
    v_accvgpr_read_b32 v157, a61
    v_accvgpr_read_b32 v158, a62
    v_accvgpr_read_b32 v159, a63
    v_pk_mul_f32 v[128:129], v[128:129], v[230:231] op_sel_hi:[1,0]
    v_pk_mul_f32 v[130:131], v[130:131], v[230:231] op_sel_hi:[1,0]
    v_pk_mul_f32 v[132:133], v[132:133], v[230:231] op_sel_hi:[1,0]
    v_pk_mul_f32 v[134:135], v[134:135], v[230:231] op_sel_hi:[1,0]
    v_pk_mul_f32 v[136:137], v[136:137], v[230:231] op_sel_hi:[1,0]
    v_pk_mul_f32 v[138:139], v[138:139], v[230:231] op_sel_hi:[1,0]
    v_pk_mul_f32 v[140:141], v[140:141], v[230:231] op_sel_hi:[1,0]
    v_pk_mul_f32 v[142:143], v[142:143], v[230:231] op_sel_hi:[1,0]
    v_pk_mul_f32 v[144:145], v[144:145], v[230:231] op_sel_hi:[1,0]
    v_pk_mul_f32 v[146:147], v[146:147], v[230:231] op_sel_hi:[1,0]
    v_pk_mul_f32 v[148:149], v[148:149], v[230:231] op_sel_hi:[1,0]
    v_pk_mul_f32 v[150:151], v[150:151], v[230:231] op_sel_hi:[1,0]
    v_pk_mul_f32 v[152:153], v[152:153], v[230:231] op_sel_hi:[1,0]
    v_pk_mul_f32 v[154:155], v[154:155], v[230:231] op_sel_hi:[1,0]
    v_pk_mul_f32 v[156:157], v[156:157], v[230:231] op_sel_hi:[1,0]
    v_pk_mul_f32 v[158:159], v[158:159], v[230:231] op_sel_hi:[1,0]
    s_waitcnt lgkmcnt(0)
    v_pk_fma_f32 v[128:129], v[96:97], v[194:195], v[128:129] op_sel_hi:[1,0,1]
    v_pk_fma_f32 v[130:131], v[98:99], v[194:195], v[130:131] op_sel_hi:[1,0,1]
    v_pk_fma_f32 v[132:133], v[100:101], v[194:195], v[132:133] op_sel_hi:[1,0,1]
    v_pk_fma_f32 v[134:135], v[102:103], v[194:195], v[134:135] op_sel_hi:[1,0,1]
    v_cvt_pk_bf16_f32 v240, v128, v129
    v_cvt_pk_bf16_f32 v241, v130, v131
    v_cvt_pk_bf16_f32 v242, v132, v133
    v_cvt_pk_bf16_f32 v243, v134, v135
    buffer_store_dwordx4 v[240:243], v233, s[12:15], s40 offen offset:0 sc1
    v_pk_fma_f32 v[136:137], v[104:105], v[194:195], v[136:137] op_sel_hi:[1,0,1]
    v_pk_fma_f32 v[138:139], v[106:107], v[194:195], v[138:139] op_sel_hi:[1,0,1]
    v_pk_fma_f32 v[140:141], v[108:109], v[194:195], v[140:141] op_sel_hi:[1,0,1]
    v_pk_fma_f32 v[142:143], v[110:111], v[194:195], v[142:143] op_sel_hi:[1,0,1]
    v_cvt_pk_bf16_f32 v244, v136, v137
    v_cvt_pk_bf16_f32 v245, v138, v139
    v_cvt_pk_bf16_f32 v246, v140, v141
    v_cvt_pk_bf16_f32 v247, v142, v143
    buffer_store_dwordx4 v[244:247], v233, s[12:15], s40 offen offset:1024 sc1
    v_pk_fma_f32 v[144:145], v[112:113], v[194:195], v[144:145] op_sel_hi:[1,0,1]
    v_pk_fma_f32 v[146:147], v[114:115], v[194:195], v[146:147] op_sel_hi:[1,0,1]
    v_pk_fma_f32 v[148:149], v[116:117], v[194:195], v[148:149] op_sel_hi:[1,0,1]
    v_pk_fma_f32 v[150:151], v[118:119], v[194:195], v[150:151] op_sel_hi:[1,0,1]
    v_cvt_pk_bf16_f32 v248, v144, v145
    v_cvt_pk_bf16_f32 v249, v146, v147
    v_cvt_pk_bf16_f32 v250, v148, v149
    v_cvt_pk_bf16_f32 v251, v150, v151
    buffer_store_dwordx4 v[248:251], v233, s[12:15], s40 offen offset:2048 sc1
    v_pk_fma_f32 v[152:153], v[120:121], v[194:195], v[152:153] op_sel_hi:[1,0,1]
    v_pk_fma_f32 v[154:155], v[122:123], v[194:195], v[154:155] op_sel_hi:[1,0,1]
    v_pk_fma_f32 v[156:157], v[124:125], v[194:195], v[156:157] op_sel_hi:[1,0,1]
    v_pk_fma_f32 v[158:159], v[126:127], v[194:195], v[158:159] op_sel_hi:[1,0,1]
    v_cvt_pk_bf16_f32 v252, v152, v153
    v_cvt_pk_bf16_f32 v253, v154, v155
    v_cvt_pk_bf16_f32 v254, v156, v157
    v_cvt_pk_bf16_f32 v255, v158, v159
    buffer_store_dwordx4 v[252:255], v233, s[12:15], s40 offen offset:3072 sc1
    s_waitcnt vmcnt(8)
    v_accvgpr_read_b32 v144, a212
    v_accvgpr_read_b32 v145, a213
    v_accvgpr_read_b32 v146, a214
    v_accvgpr_read_b32 v147, a215
    v_accvgpr_read_b32 v148, a216
    v_accvgpr_read_b32 v149, a217
    v_accvgpr_read_b32 v150, a218
    v_accvgpr_read_b32 v151, a219
    v_pk_add_f32 v[0:1], v[0:1], v[32:33]
    v_pk_add_f32 v[2:3], v[2:3], v[34:35]
    v_pk_add_f32 v[4:5], v[4:5], v[36:37]
    v_pk_add_f32 v[6:7], v[6:7], v[38:39]
    v_pk_add_f32 v[8:9], v[8:9], v[40:41]
    v_pk_add_f32 v[10:11], v[10:11], v[42:43]
    v_pk_add_f32 v[12:13], v[12:13], v[44:45]
    v_pk_add_f32 v[14:15], v[14:15], v[46:47]
    v_pk_add_f32 v[16:17], v[16:17], v[48:49]
    v_pk_add_f32 v[18:19], v[18:19], v[50:51]
    v_pk_add_f32 v[20:21], v[20:21], v[52:53]
    v_pk_add_f32 v[22:23], v[22:23], v[54:55]
    v_pk_add_f32 v[24:25], v[24:25], v[56:57]
    v_pk_add_f32 v[26:27], v[26:27], v[58:59]
    v_pk_add_f32 v[28:29], v[28:29], v[60:61]
    v_pk_add_f32 v[30:31], v[30:31], v[62:63]
    v_pk_add_f32 v[0:1], v[0:1], v[16:17]
    v_pk_add_f32 v[2:3], v[2:3], v[18:19]
    v_pk_add_f32 v[4:5], v[4:5], v[20:21]
    v_pk_add_f32 v[6:7], v[6:7], v[22:23]
    v_pk_add_f32 v[8:9], v[8:9], v[24:25]
    v_pk_add_f32 v[10:11], v[10:11], v[26:27]
    v_pk_add_f32 v[12:13], v[12:13], v[28:29]
    v_pk_add_f32 v[14:15], v[14:15], v[30:31]
    v_pk_add_f32 v[0:1], v[0:1], v[8:9]
    v_pk_add_f32 v[2:3], v[2:3], v[10:11]
    v_pk_add_f32 v[4:5], v[4:5], v[12:13]
    v_pk_add_f32 v[6:7], v[6:7], v[14:15]
    v_add_f32_dpp v144, v144, v144 quad_perm:[1,0,3,2] row_mask:0xf bank_mask:0xf
    v_add_f32_dpp v145, v145, v145 quad_perm:[1,0,3,2] row_mask:0xf bank_mask:0xf
    v_add_f32_dpp v146, v146, v146 quad_perm:[1,0,3,2] row_mask:0xf bank_mask:0xf
    v_add_f32_dpp v147, v147, v147 quad_perm:[1,0,3,2] row_mask:0xf bank_mask:0xf
    v_add_f32_dpp v148, v148, v148 quad_perm:[1,0,3,2] row_mask:0xf bank_mask:0xf
    v_add_f32_dpp v149, v149, v149 quad_perm:[1,0,3,2] row_mask:0xf bank_mask:0xf
    v_add_f32_dpp v150, v150, v150 quad_perm:[1,0,3,2] row_mask:0xf bank_mask:0xf
    v_add_f32_dpp v151, v151, v151 quad_perm:[1,0,3,2] row_mask:0xf bank_mask:0xf
    v_add_f32_dpp v144, v144, v144 quad_perm:[2,3,0,1] row_mask:0xf bank_mask:0xf
    v_add_f32_dpp v145, v145, v145 quad_perm:[2,3,0,1] row_mask:0xf bank_mask:0xf
    v_add_f32_dpp v146, v146, v146 quad_perm:[2,3,0,1] row_mask:0xf bank_mask:0xf
    v_add_f32_dpp v147, v147, v147 quad_perm:[2,3,0,1] row_mask:0xf bank_mask:0xf
    v_add_f32_dpp v148, v148, v148 quad_perm:[2,3,0,1] row_mask:0xf bank_mask:0xf
    v_add_f32_dpp v149, v149, v149 quad_perm:[2,3,0,1] row_mask:0xf bank_mask:0xf
    v_add_f32_dpp v150, v150, v150 quad_perm:[2,3,0,1] row_mask:0xf bank_mask:0xf
    v_add_f32_dpp v151, v151, v151 quad_perm:[2,3,0,1] row_mask:0xf bank_mask:0xf
    v_add_f32_dpp v144, v144, v144 row_half_mirror row_mask:0xf bank_mask:0xf
    v_add_f32_dpp v145, v145, v145 row_half_mirror row_mask:0xf bank_mask:0xf
    v_add_f32_dpp v146, v146, v146 row_half_mirror row_mask:0xf bank_mask:0xf
    v_add_f32_dpp v147, v147, v147 row_half_mirror row_mask:0xf bank_mask:0xf
    v_add_f32_dpp v148, v148, v148 row_half_mirror row_mask:0xf bank_mask:0xf
    v_add_f32_dpp v149, v149, v149 row_half_mirror row_mask:0xf bank_mask:0xf
    v_add_f32_dpp v150, v150, v150 row_half_mirror row_mask:0xf bank_mask:0xf
    v_add_f32_dpp v151, v151, v151 row_half_mirror row_mask:0xf bank_mask:0xf
    v_cvt_pk_bf16_f32 v8, v0, v1
    v_cvt_pk_bf16_f32 v12, v144, v145
    v_cvt_pk_bf16_f32 v9, v2, v3
    v_cvt_pk_bf16_f32 v13, v146, v147
    v_cvt_pk_bf16_f32 v10, v4, v5
    v_cvt_pk_bf16_f32 v14, v148, v149
    v_cvt_pk_bf16_f32 v11, v6, v7
    v_cvt_pk_bf16_f32 v15, v150, v151
    s_nop 1
    v_mfma_f32_16x16x32_bf16 v[16:19], v[8:11], a[220:223], 0
    v_mfma_f32_16x16x32_bf16 v[32:35], v[12:15], a[220:223], 0
    v_mfma_f32_16x16x32_bf16 v[20:23], v[8:11], a[224:227], 0
    v_mfma_f32_16x16x32_bf16 v[36:39], v[12:15], a[224:227], 0
    v_mfma_f32_16x16x32_bf16 v[24:27], v[8:11], a[228:231], 0
    v_mfma_f32_16x16x32_bf16 v[40:43], v[12:15], a[228:231], 0
    v_mfma_f32_16x16x32_bf16 v[28:31], v[8:11], a[232:235], 0
    v_mfma_f32_16x16x32_bf16 v[44:47], v[12:15], a[232:235], 0
    s_lshl_b32 s22, s18, 2
    s_add_u32 s22, s22, s16
    s_mul_i32 s22, s22, 589824
    s_lshr_b32 s23, s17, 1
    s_lshl_b32 s23, s23, 10
    s_add_u32 s22, s22, s23
    s_and_b32 s24, s17, 1
    s_lshl_b32 s24, s24, 3
    s_add_u32 s22, s22, s24
    s_add_u32 s22, s22, 35782656
    v_add_f32 v192, 0x358637bd, v32
    v_add_f32 v193, 0x358637bd, v36
    v_add_f32 v194, 0x358637bd, v40
    v_add_f32 v195, 0x358637bd, v44
    v_rcp_f32 v192, v192
    v_rcp_f32 v193, v193
    v_rcp_f32 v194, v194
    v_rcp_f32 v195, v195
    v_mul_f32 v16, v16, v192
    v_mul_f32 v17, v17, v192
    v_mul_f32 v18, v18, v192
    v_mul_f32 v19, v19, v192
    v_cvt_pk_bf16_f32 v16, v16, v17
    v_cvt_pk_bf16_f32 v17, v18, v19
    buffer_store_dwordx2 v[16:17], v214, s[12:15], s22 offen sc1
    s_add_u32 s22, s22, 147456
    v_mul_f32 v20, v20, v193
    v_mul_f32 v21, v21, v193
    v_mul_f32 v22, v22, v193
    v_mul_f32 v23, v23, v193
    v_cvt_pk_bf16_f32 v20, v20, v21
    v_cvt_pk_bf16_f32 v21, v22, v23
    buffer_store_dwordx2 v[20:21], v214, s[12:15], s22 offen sc1
    s_add_u32 s22, s22, 147456
    v_mul_f32 v24, v24, v194
    v_mul_f32 v25, v25, v194
    v_mul_f32 v26, v26, v194
    v_mul_f32 v27, v27, v194
    v_cvt_pk_bf16_f32 v24, v24, v25
    v_cvt_pk_bf16_f32 v25, v26, v27
    buffer_store_dwordx2 v[24:25], v214, s[12:15], s22 offen sc1
    s_add_u32 s22, s22, 147456
    v_mul_f32 v28, v28, v195
    v_mul_f32 v29, v29, v195
    v_mul_f32 v30, v30, v195
    v_mul_f32 v31, v31, v195
    v_cvt_pk_bf16_f32 v28, v28, v29
    v_cvt_pk_bf16_f32 v29, v30, v31
    buffer_store_dwordx2 v[28:29], v214, s[12:15], s22 offen sc1
    s_add_u32 s22, s22, 147456
    s_lshl_b32 s99, s17, 3
    s_add_u32 s99, s99, s18
    s_lshl_b32 s99, s99, 7
    s_branch K3_fused_entry
K2_end_18:
    s_endpgm
K2_spin_21:
    s_mov_b32 s23, 0x40000
K2_spl_23:
    s_cmp_ge_u32 s51, 256
    s_cbranch_scc1 K2_spq_24
    s_sleep 12
    buffer_load_dword v235, v236, s[52:55], 0 offen sc1
    s_waitcnt vmcnt(0)
    v_readfirstlane_b32 s51, v235
    s_sub_u32 s23, s23, 1
    s_cmp_lg_u32 s23, 0
    s_cbranch_scc1 K2_spl_23
    s_branch K2_spun_22
K2_spq_24:
    buffer_load_dword v235, v220, s[12:15], s50 offen sc1
    s_waitcnt vmcnt(0)
    v_cmp_ne_u32 vcc, 1, v235
    s_sub_u32 s23, s23, 1
    s_cmp_eq_u32 s23, 0
    s_cbranch_scc1 K2_spun_22
    s_cbranch_vccz K2_spun_22
    s_sleep 2
    s_branch K2_spq_24
K2_st_29:
    s_call_b64 s[44:45], K2_adj1_27
    s_branch K2_rt_30
K2_st_31:
    s_call_b64 s[44:45], K2_adj0_26
    s_branch K2_rt_32
K2_st_33:
    s_call_b64 s[44:45], K2_adj1_27
    s_branch K2_rt_34
K2_st_35:
    s_call_b64 s[44:45], K2_adj0_26
    s_branch K2_rt_36
K2_st_39:
    s_call_b64 s[44:45], K2_adj1_27
    s_branch K2_rt_40
K2_st_41:
    s_call_b64 s[44:45], K2_adj0_26
    s_branch K2_rt_42
K2_st_44:
    s_call_b64 s[44:45], K2_adj1_27
    s_branch K2_rt_45
K2_mask_25:
    s_add_u32 s44, s44, 4
    s_addc_u32 s45, s45, 0
    s_cmp_lt_u32 s35, s98
    s_cbranch_scc1 K2_m2_47
    s_cmp_eq_u32 s35, s36
    s_cbranch_scc1 K2_m1_46
    s_mov_b32 s98, 0x7fffffff
    v_pk_mov_b32 v[160:161], v[222:223], v[222:223] op_sel:[0,0]
    v_pk_mov_b32 v[162:163], v[222:223], v[222:223] op_sel:[0,0]
    v_pk_mov_b32 v[164:165], v[222:223], v[222:223] op_sel:[0,0]
    v_pk_mov_b32 v[166:167], v[222:223], v[222:223] op_sel:[0,0]
    v_pk_mov_b32 v[168:169], v[222:223], v[222:223] op_sel:[0,0]
    v_pk_mov_b32 v[170:171], v[222:223], v[222:223] op_sel:[0,0]
    v_pk_mov_b32 v[172:173], v[222:223], v[222:223] op_sel:[0,0]
    v_pk_mov_b32 v[174:175], v[222:223], v[222:223] op_sel:[0,0]
    s_branch K2_m2_47
K2_m1_46:
    s_add_u32 s98, s36, 1
    v_pk_mov_b32 v[164:165], v[222:223], v[222:223] op_sel:[0,0]
    v_pk_mov_b32 v[166:167], v[222:223], v[222:223] op_sel:[0,0]
    v_cndmask_b32 v160, v160, v222, s[46:47]
    v_cndmask_b32 v172, v172, v222, s[46:47]
    v_cndmask_b32 v161, v161, v222, s[48:49]
    v_cndmask_b32 v173, v173, v222, s[48:49]
    v_cndmask_b32 v162, v162, v222, s[50:51]
    v_cndmask_b32 v174, v174, v222, s[50:51]
    v_cndmask_b32 v163, v163, v222, s[52:53]
    v_cndmask_b32 v175, v175, v222, s[52:53]
K2_m2_47:
    s_cmp_lt_u32 s35, s99
    s_cbranch_scc1 K2_m2_49
    s_cmp_eq_u32 s35, s37
    s_cbranch_scc1 K2_m1_48
    s_mov_b32 s99, 0x7fffffff
    v_pk_mov_b32 v[176:177], v[222:223], v[222:223] op_sel:[0,0]
    v_pk_mov_b32 v[178:179], v[222:223], v[222:223] op_sel:[0,0]
    v_pk_mov_b32 v[180:181], v[222:223], v[222:223] op_sel:[0,0]
    v_pk_mov_b32 v[182:183], v[222:223], v[222:223] op_sel:[0,0]
    v_pk_mov_b32 v[184:185], v[222:223], v[222:223] op_sel:[0,0]
    v_pk_mov_b32 v[186:187], v[222:223], v[222:223] op_sel:[0,0]
    v_pk_mov_b32 v[188:189], v[222:223], v[222:223] op_sel:[0,0]
    v_pk_mov_b32 v[190:191], v[222:223], v[222:223] op_sel:[0,0]
    s_branch K2_m2_49
K2_m1_48:
    s_add_u32 s99, s37, 1
    v_pk_mov_b32 v[180:181], v[222:223], v[222:223] op_sel:[0,0]
    v_pk_mov_b32 v[182:183], v[222:223], v[222:223] op_sel:[0,0]
    v_cndmask_b32 v176, v176, v222, s[46:47]
    v_cndmask_b32 v188, v188, v222, s[46:47]
    v_cndmask_b32 v177, v177, v222, s[48:49]
    v_cndmask_b32 v189, v189, v222, s[48:49]
    v_cndmask_b32 v178, v178, v222, s[50:51]
    v_cndmask_b32 v190, v190, v222, s[50:51]
    v_cndmask_b32 v179, v179, v222, s[52:53]
    v_cndmask_b32 v191, v191, v222, s[52:53]
K2_m2_49:
    s_min_u32 s38, s98, s99
    s_setpc_b64 s[44:45]
K2_adj0_26:
    s_nop 15
    v_max3_f32 v224, v64, v65, v66
    v_max3_f32 v192, v67, v68, v69
    v_max3_f32 v225, v72, v73, v74
    v_max3_f32 v193, v75, v76, v77
    v_max3_f32 v226, v80, v81, v82
    v_max3_f32 v194, v83, v84, v85
    v_max3_f32 v227, v88, v89, v90
    v_max3_f32 v195, v91, v92, v93
    v_max3_f32 v224, v224, v70, v71
    v_max3_f32 v225, v225, v78, v79
    v_max3_f32 v226, v226, v86, v87
    v_max3_f32 v227, v227, v94, v95
    v_max_f32 v224, v224, v192
    v_max_f32 v225, v225, v193
    v_max_f32 v226, v226, v194
    v_max_f32 v227, v227, v195
    v_mov_b32 v192, v224
    v_mov_b32 v193, v225
    v_mov_b32 v194, v226
    v_mov_b32 v195, v227
    v_permlane16_swap_b32 v224, v192
    v_permlane16_swap_b32 v225, v193
    v_permlane16_swap_b32 v226, v194
    v_permlane16_swap_b32 v227, v195
    v_max_f32 v224, v224, v192
    v_max_f32 v225, v225, v193
    v_max_f32 v226, v226, v194
    v_max_f32 v227, v227, v195
    v_mov_b32 v192, v224
    v_mov_b32 v193, v225
    v_mov_b32 v194, v226
    v_mov_b32 v195, v227
    v_permlane32_swap_b32 v224, v192
    v_permlane32_swap_b32 v225, v193
    v_permlane32_swap_b32 v226, v194
    v_permlane32_swap_b32 v227, v195
    v_max_f32 v224, v224, v192
    v_max_f32 v225, v225, v193
    v_max_f32 v226, v226, v194
    v_max_f32 v227, v227, v195
    v_add_f32 v224, 0x42c00000, v224
    v_add_f32 v225, 0x42c00000, v225
    v_add_f32 v226, 0x42c00000, v226
    v_add_f32 v227, 0x42c00000, v227
    v_max_f32 v224, 0, v224
    v_max_f32 v225, 0, v225
    v_max_f32 v226, 0, v226
    v_max_f32 v227, 0, v227
    v_exp_f32 v228, -v224
    v_exp_f32 v229, -v225
    v_exp_f32 v230, -v226
    v_exp_f32 v231, -v227
    s_nop 0
    v_mul_f32 v204, v204, v228
    v_accvgpr_write_b32 a192, v204
    v_accvgpr_read_b32 v192, a0
    v_mul_f32 v192, v192, v228
    v_accvgpr_write_b32 a0, v192
    v_accvgpr_read_b32 v193, a1
    v_mul_f32 v193, v193, v228
    v_accvgpr_write_b32 a1, v193
    v_accvgpr_read_b32 v194, a2
    v_mul_f32 v194, v194, v228
    v_accvgpr_write_b32 a2, v194
    v_accvgpr_read_b32 v195, a3
    v_mul_f32 v195, v195, v228
    v_accvgpr_write_b32 a3, v195
    v_accvgpr_read_b32 v196, a4
    v_mul_f32 v196, v196, v228
    v_accvgpr_write_b32 a4, v196
    v_accvgpr_read_b32 v197, a5
    v_mul_f32 v197, v197, v228
    v_accvgpr_write_b32 a5, v197
    v_accvgpr_read_b32 v198, a6
    v_mul_f32 v198, v198, v228
    v_accvgpr_write_b32 a6, v198
    v_accvgpr_read_b32 v199, a7
    v_mul_f32 v199, v199, v228
    v_accvgpr_write_b32 a7, v199
    v_accvgpr_read_b32 v192, a8
    v_mul_f32 v192, v192, v228
    v_accvgpr_write_b32 a8, v192
    v_accvgpr_read_b32 v193, a9
    v_mul_f32 v193, v193, v228
    v_accvgpr_write_b32 a9, v193
    v_accvgpr_read_b32 v194, a10
    v_mul_f32 v194, v194, v228
    v_accvgpr_write_b32 a10, v194
    v_accvgpr_read_b32 v195, a11
    v_mul_f32 v195, v195, v228
    v_accvgpr_write_b32 a11, v195
    v_accvgpr_read_b32 v196, a12
    v_mul_f32 v196, v196, v228
    v_accvgpr_write_b32 a12, v196
    v_accvgpr_read_b32 v197, a13
    v_mul_f32 v197, v197, v228
    v_accvgpr_write_b32 a13, v197
    v_accvgpr_read_b32 v198, a14
    v_mul_f32 v198, v198, v228
    v_accvgpr_write_b32 a14, v198
    v_accvgpr_read_b32 v199, a15
    v_mul_f32 v199, v199, v228
    v_accvgpr_write_b32 a15, v199
    v_accvgpr_read_b32 v192, a16
    v_mul_f32 v192, v192, v228
    v_accvgpr_write_b32 a16, v192
    v_accvgpr_read_b32 v193, a17
    v_mul_f32 v193, v193, v228
    v_accvgpr_write_b32 a17, v193
    v_accvgpr_read_b32 v194, a18
    v_mul_f32 v194, v194, v228
    v_accvgpr_write_b32 a18, v194
    v_accvgpr_read_b32 v195, a19
    v_mul_f32 v195, v195, v228
    v_accvgpr_write_b32 a19, v195
    v_accvgpr_read_b32 v196, a20
    v_mul_f32 v196, v196, v228
    v_accvgpr_write_b32 a20, v196
    v_accvgpr_read_b32 v197, a21
    v_mul_f32 v197, v197, v228
    v_accvgpr_write_b32 a21, v197
    v_accvgpr_read_b32 v198, a22
    v_mul_f32 v198, v198, v228
    v_accvgpr_write_b32 a22, v198
    v_accvgpr_read_b32 v199, a23
    v_mul_f32 v199, v199, v228
    v_accvgpr_write_b32 a23, v199
    v_accvgpr_read_b32 v192, a24
    v_mul_f32 v192, v192, v228
    v_accvgpr_write_b32 a24, v192
    v_accvgpr_read_b32 v193, a25
    v_mul_f32 v193, v193, v228
    v_accvgpr_write_b32 a25, v193
    v_accvgpr_read_b32 v194, a26
    v_mul_f32 v194, v194, v228
    v_accvgpr_write_b32 a26, v194
    v_accvgpr_read_b32 v195, a27
    v_mul_f32 v195, v195, v228
    v_accvgpr_write_b32 a27, v195
    v_accvgpr_read_b32 v196, a28
    v_mul_f32 v196, v196, v228
    v_accvgpr_write_b32 a28, v196
    v_accvgpr_read_b32 v197, a29
    v_mul_f32 v197, v197, v228
    v_accvgpr_write_b32 a29, v197
    v_accvgpr_read_b32 v198, a30
    v_mul_f32 v198, v198, v228
    v_accvgpr_write_b32 a30, v198
    v_accvgpr_read_b32 v199, a31
    v_mul_f32 v199, v199, v228
    v_accvgpr_write_b32 a31, v199
    v_mul_f32 v205, v205, v229
    v_accvgpr_write_b32 a196, v205
    v_accvgpr_read_b32 v192, a32
    v_mul_f32 v192, v192, v229
    v_accvgpr_write_b32 a32, v192
    v_accvgpr_read_b32 v193, a33
    v_mul_f32 v193, v193, v229
    v_accvgpr_write_b32 a33, v193
    v_accvgpr_read_b32 v194, a34
    v_mul_f32 v194, v194, v229
    v_accvgpr_write_b32 a34, v194
    v_accvgpr_read_b32 v195, a35
    v_mul_f32 v195, v195, v229
    v_accvgpr_write_b32 a35, v195
    v_accvgpr_read_b32 v196, a36
    v_mul_f32 v196, v196, v229
    v_accvgpr_write_b32 a36, v196
    v_accvgpr_read_b32 v197, a37
    v_mul_f32 v197, v197, v229
    v_accvgpr_write_b32 a37, v197
    v_accvgpr_read_b32 v198, a38
    v_mul_f32 v198, v198, v229
    v_accvgpr_write_b32 a38, v198
    v_accvgpr_read_b32 v199, a39
    v_mul_f32 v199, v199, v229
    v_accvgpr_write_b32 a39, v199
    v_accvgpr_read_b32 v192, a40
    v_mul_f32 v192, v192, v229
    v_accvgpr_write_b32 a40, v192
    v_accvgpr_read_b32 v193, a41
    v_mul_f32 v193, v193, v229
    v_accvgpr_write_b32 a41, v193
    v_accvgpr_read_b32 v194, a42
    v_mul_f32 v194, v194, v229
    v_accvgpr_write_b32 a42, v194
    v_accvgpr_read_b32 v195, a43
    v_mul_f32 v195, v195, v229
    v_accvgpr_write_b32 a43, v195
    v_accvgpr_read_b32 v196, a44
    v_mul_f32 v196, v196, v229
    v_accvgpr_write_b32 a44, v196
    v_accvgpr_read_b32 v197, a45
    v_mul_f32 v197, v197, v229
    v_accvgpr_write_b32 a45, v197
    v_accvgpr_read_b32 v198, a46
    v_mul_f32 v198, v198, v229
    v_accvgpr_write_b32 a46, v198
    v_accvgpr_read_b32 v199, a47
    v_mul_f32 v199, v199, v229
    v_accvgpr_write_b32 a47, v199
    v_accvgpr_read_b32 v192, a48
    v_mul_f32 v192, v192, v229
    v_accvgpr_write_b32 a48, v192
    v_accvgpr_read_b32 v193, a49
    v_mul_f32 v193, v193, v229
    v_accvgpr_write_b32 a49, v193
    v_accvgpr_read_b32 v194, a50
    v_mul_f32 v194, v194, v229
    v_accvgpr_write_b32 a50, v194
    v_accvgpr_read_b32 v195, a51
    v_mul_f32 v195, v195, v229
    v_accvgpr_write_b32 a51, v195
    v_accvgpr_read_b32 v196, a52
    v_mul_f32 v196, v196, v229
    v_accvgpr_write_b32 a52, v196
    v_accvgpr_read_b32 v197, a53
    v_mul_f32 v197, v197, v229
    v_accvgpr_write_b32 a53, v197
    v_accvgpr_read_b32 v198, a54
    v_mul_f32 v198, v198, v229
    v_accvgpr_write_b32 a54, v198
    v_accvgpr_read_b32 v199, a55
    v_mul_f32 v199, v199, v229
    v_accvgpr_write_b32 a55, v199
    v_accvgpr_read_b32 v192, a56
    v_mul_f32 v192, v192, v229
    v_accvgpr_write_b32 a56, v192
    v_accvgpr_read_b32 v193, a57
    v_mul_f32 v193, v193, v229
    v_accvgpr_write_b32 a57, v193
    v_accvgpr_read_b32 v194, a58
    v_mul_f32 v194, v194, v229
    v_accvgpr_write_b32 a58, v194
    v_accvgpr_read_b32 v195, a59
    v_mul_f32 v195, v195, v229
    v_accvgpr_write_b32 a59, v195
    v_accvgpr_read_b32 v196, a60
    v_mul_f32 v196, v196, v229
    v_accvgpr_write_b32 a60, v196
    v_accvgpr_read_b32 v197, a61
    v_mul_f32 v197, v197, v229
    v_accvgpr_write_b32 a61, v197
    v_accvgpr_read_b32 v198, a62
    v_mul_f32 v198, v198, v229
    v_accvgpr_write_b32 a62, v198
    v_accvgpr_read_b32 v199, a63
    v_mul_f32 v199, v199, v229
    v_accvgpr_write_b32 a63, v199
    v_mul_f32 v206, v206, v230
    v_accvgpr_write_b32 a200, v206
    v_accvgpr_read_b32 v192, a64
    v_mul_f32 v192, v192, v230
    v_accvgpr_write_b32 a64, v192
    v_accvgpr_read_b32 v193, a65
    v_mul_f32 v193, v193, v230
    v_accvgpr_write_b32 a65, v193
    v_accvgpr_read_b32 v194, a66
    v_mul_f32 v194, v194, v230
    v_accvgpr_write_b32 a66, v194
    v_accvgpr_read_b32 v195, a67
    v_mul_f32 v195, v195, v230
    v_accvgpr_write_b32 a67, v195
    v_accvgpr_read_b32 v196, a68
    v_mul_f32 v196, v196, v230
    v_accvgpr_write_b32 a68, v196
    v_accvgpr_read_b32 v197, a69
    v_mul_f32 v197, v197, v230
    v_accvgpr_write_b32 a69, v197
    v_accvgpr_read_b32 v198, a70
    v_mul_f32 v198, v198, v230
    v_accvgpr_write_b32 a70, v198
    v_accvgpr_read_b32 v199, a71
    v_mul_f32 v199, v199, v230
    v_accvgpr_write_b32 a71, v199
    v_accvgpr_read_b32 v192, a72
    v_mul_f32 v192, v192, v230
    v_accvgpr_write_b32 a72, v192
    v_accvgpr_read_b32 v193, a73
    v_mul_f32 v193, v193, v230
    v_accvgpr_write_b32 a73, v193
    v_accvgpr_read_b32 v194, a74
    v_mul_f32 v194, v194, v230
    v_accvgpr_write_b32 a74, v194
    v_accvgpr_read_b32 v195, a75
    v_mul_f32 v195, v195, v230
    v_accvgpr_write_b32 a75, v195
    v_accvgpr_read_b32 v196, a76
    v_mul_f32 v196, v196, v230
    v_accvgpr_write_b32 a76, v196
    v_accvgpr_read_b32 v197, a77
    v_mul_f32 v197, v197, v230
    v_accvgpr_write_b32 a77, v197
    v_accvgpr_read_b32 v198, a78
    v_mul_f32 v198, v198, v230
    v_accvgpr_write_b32 a78, v198
    v_accvgpr_read_b32 v199, a79
    v_mul_f32 v199, v199, v230
    v_accvgpr_write_b32 a79, v199
    v_accvgpr_read_b32 v192, a80
    v_mul_f32 v192, v192, v230
    v_accvgpr_write_b32 a80, v192
    v_accvgpr_read_b32 v193, a81
    v_mul_f32 v193, v193, v230
    v_accvgpr_write_b32 a81, v193
    v_accvgpr_read_b32 v194, a82
    v_mul_f32 v194, v194, v230
    v_accvgpr_write_b32 a82, v194
    v_accvgpr_read_b32 v195, a83
    v_mul_f32 v195, v195, v230
    v_accvgpr_write_b32 a83, v195
    v_accvgpr_read_b32 v196, a84
    v_mul_f32 v196, v196, v230
    v_accvgpr_write_b32 a84, v196
    v_accvgpr_read_b32 v197, a85
    v_mul_f32 v197, v197, v230
    v_accvgpr_write_b32 a85, v197
    v_accvgpr_read_b32 v198, a86
    v_mul_f32 v198, v198, v230
    v_accvgpr_write_b32 a86, v198
    v_accvgpr_read_b32 v199, a87
    v_mul_f32 v199, v199, v230
    v_accvgpr_write_b32 a87, v199
    v_accvgpr_read_b32 v192, a88
    v_mul_f32 v192, v192, v230
    v_accvgpr_write_b32 a88, v192
    v_accvgpr_read_b32 v193, a89
    v_mul_f32 v193, v193, v230
    v_accvgpr_write_b32 a89, v193
    v_accvgpr_read_b32 v194, a90
    v_mul_f32 v194, v194, v230
    v_accvgpr_write_b32 a90, v194
    v_accvgpr_read_b32 v195, a91
    v_mul_f32 v195, v195, v230
    v_accvgpr_write_b32 a91, v195
    v_accvgpr_read_b32 v196, a92
    v_mul_f32 v196, v196, v230
    v_accvgpr_write_b32 a92, v196
    v_accvgpr_read_b32 v197, a93
    v_mul_f32 v197, v197, v230
    v_accvgpr_write_b32 a93, v197
    v_accvgpr_read_b32 v198, a94
    v_mul_f32 v198, v198, v230
    v_accvgpr_write_b32 a94, v198
    v_accvgpr_read_b32 v199, a95
    v_mul_f32 v199, v199, v230
    v_accvgpr_write_b32 a95, v199
    v_mul_f32 v207, v207, v231
    v_accvgpr_write_b32 a204, v207
    v_accvgpr_read_b32 v192, a96
    v_mul_f32 v192, v192, v231
    v_accvgpr_write_b32 a96, v192
    v_accvgpr_read_b32 v193, a97
    v_mul_f32 v193, v193, v231
    v_accvgpr_write_b32 a97, v193
    v_accvgpr_read_b32 v194, a98
    v_mul_f32 v194, v194, v231
    v_accvgpr_write_b32 a98, v194
    v_accvgpr_read_b32 v195, a99
    v_mul_f32 v195, v195, v231
    v_accvgpr_write_b32 a99, v195
    v_accvgpr_read_b32 v196, a100
    v_mul_f32 v196, v196, v231
    v_accvgpr_write_b32 a100, v196
    v_accvgpr_read_b32 v197, a101
    v_mul_f32 v197, v197, v231
    v_accvgpr_write_b32 a101, v197
    v_accvgpr_read_b32 v198, a102
    v_mul_f32 v198, v198, v231
    v_accvgpr_write_b32 a102, v198
    v_accvgpr_read_b32 v199, a103
    v_mul_f32 v199, v199, v231
    v_accvgpr_write_b32 a103, v199
    v_accvgpr_read_b32 v192, a104
    v_mul_f32 v192, v192, v231
    v_accvgpr_write_b32 a104, v192
    v_accvgpr_read_b32 v193, a105
    v_mul_f32 v193, v193, v231
    v_accvgpr_write_b32 a105, v193
    v_accvgpr_read_b32 v194, a106
    v_mul_f32 v194, v194, v231
    v_accvgpr_write_b32 a106, v194
    v_accvgpr_read_b32 v195, a107
    v_mul_f32 v195, v195, v231
    v_accvgpr_write_b32 a107, v195
    v_accvgpr_read_b32 v196, a108
    v_mul_f32 v196, v196, v231
    v_accvgpr_write_b32 a108, v196
    v_accvgpr_read_b32 v197, a109
    v_mul_f32 v197, v197, v231
    v_accvgpr_write_b32 a109, v197
    v_accvgpr_read_b32 v198, a110
    v_mul_f32 v198, v198, v231
    v_accvgpr_write_b32 a110, v198
    v_accvgpr_read_b32 v199, a111
    v_mul_f32 v199, v199, v231
    v_accvgpr_write_b32 a111, v199
    v_accvgpr_read_b32 v192, a112
    v_mul_f32 v192, v192, v231
    v_accvgpr_write_b32 a112, v192
    v_accvgpr_read_b32 v193, a113
    v_mul_f32 v193, v193, v231
    v_accvgpr_write_b32 a113, v193
    v_accvgpr_read_b32 v194, a114
    v_mul_f32 v194, v194, v231
    v_accvgpr_write_b32 a114, v194
    v_accvgpr_read_b32 v195, a115
    v_mul_f32 v195, v195, v231
    v_accvgpr_write_b32 a115, v195
    v_accvgpr_read_b32 v196, a116
    v_mul_f32 v196, v196, v231
    v_accvgpr_write_b32 a116, v196
    v_accvgpr_read_b32 v197, a117
    v_mul_f32 v197, v197, v231
    v_accvgpr_write_b32 a117, v197
    v_accvgpr_read_b32 v198, a118
    v_mul_f32 v198, v198, v231
    v_accvgpr_write_b32 a118, v198
    v_accvgpr_read_b32 v199, a119
    v_mul_f32 v199, v199, v231
    v_accvgpr_write_b32 a119, v199
    v_accvgpr_read_b32 v192, a120
    v_mul_f32 v192, v192, v231
    v_accvgpr_write_b32 a120, v192
    v_accvgpr_read_b32 v193, a121
    v_mul_f32 v193, v193, v231
    v_accvgpr_write_b32 a121, v193
    v_accvgpr_read_b32 v194, a122
    v_mul_f32 v194, v194, v231
    v_accvgpr_write_b32 a122, v194
    v_accvgpr_read_b32 v195, a123
    v_mul_f32 v195, v195, v231
    v_accvgpr_write_b32 a123, v195
    v_accvgpr_read_b32 v196, a124
    v_mul_f32 v196, v196, v231
    v_accvgpr_write_b32 a124, v196
    v_accvgpr_read_b32 v197, a125
    v_mul_f32 v197, v197, v231
    v_accvgpr_write_b32 a125, v197
    v_accvgpr_read_b32 v198, a126
    v_mul_f32 v198, v198, v231
    v_accvgpr_write_b32 a126, v198
    v_accvgpr_read_b32 v199, a127
    v_mul_f32 v199, v199, v231
    v_accvgpr_write_b32 a127, v199
    v_add_f32 v208, v208, v224
    v_sub_f32 v64, v64, v224
    v_sub_f32 v96, v96, v224
    v_sub_f32 v160, v160, v224
    v_sub_f32 v65, v65, v224
    v_sub_f32 v97, v97, v224
    v_sub_f32 v161, v161, v224
    v_sub_f32 v66, v66, v224
    v_sub_f32 v98, v98, v224
    v_sub_f32 v162, v162, v224
    v_sub_f32 v67, v67, v224
    v_sub_f32 v99, v99, v224
    v_sub_f32 v163, v163, v224
    v_sub_f32 v68, v68, v224
    v_sub_f32 v100, v100, v224
    v_sub_f32 v164, v164, v224
    v_sub_f32 v69, v69, v224
    v_sub_f32 v101, v101, v224
    v_sub_f32 v165, v165, v224
    v_sub_f32 v70, v70, v224
    v_sub_f32 v102, v102, v224
    v_sub_f32 v166, v166, v224
    v_sub_f32 v71, v71, v224
    v_sub_f32 v103, v103, v224
    v_sub_f32 v167, v167, v224
    v_add_f32 v209, v209, v225
    v_sub_f32 v72, v72, v225
    v_sub_f32 v104, v104, v225
    v_sub_f32 v168, v168, v225
    v_sub_f32 v73, v73, v225
    v_sub_f32 v105, v105, v225
    v_sub_f32 v169, v169, v225
    v_sub_f32 v74, v74, v225
    v_sub_f32 v106, v106, v225
    v_sub_f32 v170, v170, v225
    v_sub_f32 v75, v75, v225
    v_sub_f32 v107, v107, v225
    v_sub_f32 v171, v171, v225
    v_sub_f32 v76, v76, v225
    v_sub_f32 v108, v108, v225
    v_sub_f32 v172, v172, v225
    v_sub_f32 v77, v77, v225
    v_sub_f32 v109, v109, v225
    v_sub_f32 v173, v173, v225
    v_sub_f32 v78, v78, v225
    v_sub_f32 v110, v110, v225
    v_sub_f32 v174, v174, v225
    v_sub_f32 v79, v79, v225
    v_sub_f32 v111, v111, v225
    v_sub_f32 v175, v175, v225
    v_add_f32 v210, v210, v226
    v_sub_f32 v80, v80, v226
    v_sub_f32 v112, v112, v226
    v_sub_f32 v176, v176, v226
    v_sub_f32 v81, v81, v226
    v_sub_f32 v113, v113, v226
    v_sub_f32 v177, v177, v226
    v_sub_f32 v82, v82, v226
    v_sub_f32 v114, v114, v226
    v_sub_f32 v178, v178, v226
    v_sub_f32 v83, v83, v226
    v_sub_f32 v115, v115, v226
    v_sub_f32 v179, v179, v226
    v_sub_f32 v84, v84, v226
    v_sub_f32 v116, v116, v226
    v_sub_f32 v180, v180, v226
    v_sub_f32 v85, v85, v226
    v_sub_f32 v117, v117, v226
    v_sub_f32 v181, v181, v226
    v_sub_f32 v86, v86, v226
    v_sub_f32 v118, v118, v226
    v_sub_f32 v182, v182, v226
    v_sub_f32 v87, v87, v226
    v_sub_f32 v119, v119, v226
    v_sub_f32 v183, v183, v226
    v_add_f32 v211, v211, v227
    v_sub_f32 v88, v88, v227
    v_sub_f32 v120, v120, v227
    v_sub_f32 v184, v184, v227
    v_sub_f32 v89, v89, v227
    v_sub_f32 v121, v121, v227
    v_sub_f32 v185, v185, v227
    v_sub_f32 v90, v90, v227
    v_sub_f32 v122, v122, v227
    v_sub_f32 v186, v186, v227
    v_sub_f32 v91, v91, v227
    v_sub_f32 v123, v123, v227
    v_sub_f32 v187, v187, v227
    v_sub_f32 v92, v92, v227
    v_sub_f32 v124, v124, v227
    v_sub_f32 v188, v188, v227
    v_sub_f32 v93, v93, v227
    v_sub_f32 v125, v125, v227
    v_sub_f32 v189, v189, v227
    v_sub_f32 v94, v94, v227
    v_sub_f32 v126, v126, v227
    v_sub_f32 v190, v190, v227
    v_sub_f32 v95, v95, v227
    v_sub_f32 v127, v127, v227
    v_sub_f32 v191, v191, v227
    v_exp_f32 v192, v64
    v_exp_f32 v193, v65
    v_exp_f32 v194, v66
    v_cvt_pk_bf16_f32 v128, v192, v193
    v_exp_f32 v195, v67
    v_exp_f32 v196, v68
    v_cvt_pk_bf16_f32 v129, v194, v195
    v_exp_f32 v197, v69
    v_exp_f32 v198, v70
    v_cvt_pk_bf16_f32 v130, v196, v197
    v_exp_f32 v199, v71
    v_exp_f32 v192, v72
    v_cvt_pk_bf16_f32 v131, v198, v199
    v_exp_f32 v193, v73
    v_exp_f32 v194, v74
    v_cvt_pk_bf16_f32 v132, v192, v193
    v_mfma_f32_16x16x32_bf16 a[192:195], a[208:211], v[128:131], a[192:195]
    v_exp_f32 v195, v75
    v_exp_f32 v196, v76
    v_cvt_pk_bf16_f32 v133, v194, v195
    v_exp_f32 v197, v77
    v_exp_f32 v198, v78
    v_cvt_pk_bf16_f32 v134, v196, v197
    v_exp_f32 v199, v79
    v_exp_f32 v192, v80
    v_cvt_pk_bf16_f32 v135, v198, v199
    v_exp_f32 v193, v81
    v_exp_f32 v194, v82
    v_cvt_pk_bf16_f32 v136, v192, v193
    v_mfma_f32_16x16x32_bf16 a[196:199], a[208:211], v[132:135], a[196:199]
    v_exp_f32 v195, v83
    v_exp_f32 v196, v84
    v_cvt_pk_bf16_f32 v137, v194, v195
    v_accvgpr_read_b32 v200, a192
    v_exp_f32 v197, v85
    v_exp_f32 v198, v86
    v_cvt_pk_bf16_f32 v138, v196, v197
    v_exp_f32 v199, v87
    v_exp_f32 v192, v88
    v_cvt_pk_bf16_f32 v139, v198, v199
    v_exp_f32 v193, v89
    v_exp_f32 v194, v90
    v_cvt_pk_bf16_f32 v140, v192, v193
    v_mfma_f32_16x16x32_bf16 a[200:203], a[208:211], v[136:139], a[200:203]
    v_exp_f32 v195, v91
    v_exp_f32 v196, v92
    v_cvt_pk_bf16_f32 v141, v194, v195
    v_accvgpr_read_b32 v201, a196
    v_exp_f32 v197, v93
    v_exp_f32 v198, v94
    v_cvt_pk_bf16_f32 v142, v196, v197
    v_exp_f32 v199, v95
    v_nop
    v_cvt_pk_bf16_f32 v143, v198, v199
    s_nop 1
    v_mfma_f32_16x16x32_bf16 a[204:207], a[208:211], v[140:143], a[204:207]
    s_nop 7
    v_accvgpr_read_b32 v202, a200
    v_accvgpr_read_b32 v203, a204
    v_exp_f32 v192, v96
    v_exp_f32 v193, v97
    v_exp_f32 v194, v98
    v_cvt_pk_bf16_f32 v144, v192, v193
    v_exp_f32 v195, v99
    v_exp_f32 v196, v100
    v_cvt_pk_bf16_f32 v145, v194, v195
    v_exp_f32 v197, v101
    s_nop 1
    s_setpc_b64 s[44:45]
K2_adj1_27:
    s_nop 15
    v_max3_f32 v224, v96, v97, v98
    v_max3_f32 v192, v99, v100, v101
    v_max3_f32 v225, v104, v105, v106
    v_max3_f32 v193, v107, v108, v109
    v_max3_f32 v226, v112, v113, v114
    v_max3_f32 v194, v115, v116, v117
    v_max3_f32 v227, v120, v121, v122
    v_max3_f32 v195, v123, v124, v125
    v_max3_f32 v224, v224, v102, v103
    v_max3_f32 v225, v225, v110, v111
    v_max3_f32 v226, v226, v118, v119
    v_max3_f32 v227, v227, v126, v127
    v_max_f32 v224, v224, v192
    v_max_f32 v225, v225, v193
    v_max_f32 v226, v226, v194
    v_max_f32 v227, v227, v195
    v_mov_b32 v192, v224
    v_mov_b32 v193, v225
    v_mov_b32 v194, v226
    v_mov_b32 v195, v227
    v_permlane16_swap_b32 v224, v192
    v_permlane16_swap_b32 v225, v193
    v_permlane16_swap_b32 v226, v194
    v_permlane16_swap_b32 v227, v195
    v_max_f32 v224, v224, v192
    v_max_f32 v225, v225, v193
    v_max_f32 v226, v226, v194
    v_max_f32 v227, v227, v195
    v_mov_b32 v192, v224
    v_mov_b32 v193, v225
    v_mov_b32 v194, v226
    v_mov_b32 v195, v227
    v_permlane32_swap_b32 v224, v192
    v_permlane32_swap_b32 v225, v193
    v_permlane32_swap_b32 v226, v194
    v_permlane32_swap_b32 v227, v195
    v_max_f32 v224, v224, v192
    v_max_f32 v225, v225, v193
    v_max_f32 v226, v226, v194
    v_max_f32 v227, v227, v195
    v_add_f32 v224, 0x42c00000, v224
    v_add_f32 v225, 0x42c00000, v225
    v_add_f32 v226, 0x42c00000, v226
    v_add_f32 v227, 0x42c00000, v227
    v_max_f32 v224, 0, v224
    v_max_f32 v225, 0, v225
    v_max_f32 v226, 0, v226
    v_max_f32 v227, 0, v227
    v_exp_f32 v228, -v224
    v_exp_f32 v229, -v225
    v_exp_f32 v230, -v226
    v_exp_f32 v231, -v227
    s_nop 0
    v_mul_f32 v200, v200, v228
    v_accvgpr_write_b32 a192, v200
    v_accvgpr_read_b32 v192, a0
    v_mul_f32 v192, v192, v228
    v_accvgpr_write_b32 a0, v192
    v_accvgpr_read_b32 v193, a1
    v_mul_f32 v193, v193, v228
    v_accvgpr_write_b32 a1, v193
    v_accvgpr_read_b32 v194, a2
    v_mul_f32 v194, v194, v228
    v_accvgpr_write_b32 a2, v194
    v_accvgpr_read_b32 v195, a3
    v_mul_f32 v195, v195, v228
    v_accvgpr_write_b32 a3, v195
    v_accvgpr_read_b32 v196, a4
    v_mul_f32 v196, v196, v228
    v_accvgpr_write_b32 a4, v196
    v_accvgpr_read_b32 v197, a5
    v_mul_f32 v197, v197, v228
    v_accvgpr_write_b32 a5, v197
    v_accvgpr_read_b32 v198, a6
    v_mul_f32 v198, v198, v228
    v_accvgpr_write_b32 a6, v198
    v_accvgpr_read_b32 v199, a7
    v_mul_f32 v199, v199, v228
    v_accvgpr_write_b32 a7, v199
    v_accvgpr_read_b32 v192, a8
    v_mul_f32 v192, v192, v228
    v_accvgpr_write_b32 a8, v192
    v_accvgpr_read_b32 v193, a9
    v_mul_f32 v193, v193, v228
    v_accvgpr_write_b32 a9, v193
    v_accvgpr_read_b32 v194, a10
    v_mul_f32 v194, v194, v228
    v_accvgpr_write_b32 a10, v194
    v_accvgpr_read_b32 v195, a11
    v_mul_f32 v195, v195, v228
    v_accvgpr_write_b32 a11, v195
    v_accvgpr_read_b32 v196, a12
    v_mul_f32 v196, v196, v228
    v_accvgpr_write_b32 a12, v196
    v_accvgpr_read_b32 v197, a13
    v_mul_f32 v197, v197, v228
    v_accvgpr_write_b32 a13, v197
    v_accvgpr_read_b32 v198, a14
    v_mul_f32 v198, v198, v228
    v_accvgpr_write_b32 a14, v198
    v_accvgpr_read_b32 v199, a15
    v_mul_f32 v199, v199, v228
    v_accvgpr_write_b32 a15, v199
    v_accvgpr_read_b32 v192, a16
    v_mul_f32 v192, v192, v228
    v_accvgpr_write_b32 a16, v192
    v_accvgpr_read_b32 v193, a17
    v_mul_f32 v193, v193, v228
    v_accvgpr_write_b32 a17, v193
    v_accvgpr_read_b32 v194, a18
    v_mul_f32 v194, v194, v228
    v_accvgpr_write_b32 a18, v194
    v_accvgpr_read_b32 v195, a19
    v_mul_f32 v195, v195, v228
    v_accvgpr_write_b32 a19, v195
    v_accvgpr_read_b32 v196, a20
    v_mul_f32 v196, v196, v228
    v_accvgpr_write_b32 a20, v196
    v_accvgpr_read_b32 v197, a21
    v_mul_f32 v197, v197, v228
    v_accvgpr_write_b32 a21, v197
    v_accvgpr_read_b32 v198, a22
    v_mul_f32 v198, v198, v228
    v_accvgpr_write_b32 a22, v198
    v_accvgpr_read_b32 v199, a23
    v_mul_f32 v199, v199, v228
    v_accvgpr_write_b32 a23, v199
    v_accvgpr_read_b32 v192, a24
    v_mul_f32 v192, v192, v228
    v_accvgpr_write_b32 a24, v192
    v_accvgpr_read_b32 v193, a25
    v_mul_f32 v193, v193, v228
    v_accvgpr_write_b32 a25, v193
    v_accvgpr_read_b32 v194, a26
    v_mul_f32 v194, v194, v228
    v_accvgpr_write_b32 a26, v194
    v_accvgpr_read_b32 v195, a27
    v_mul_f32 v195, v195, v228
    v_accvgpr_write_b32 a27, v195
    v_accvgpr_read_b32 v196, a28
    v_mul_f32 v196, v196, v228
    v_accvgpr_write_b32 a28, v196
    v_accvgpr_read_b32 v197, a29
    v_mul_f32 v197, v197, v228
    v_accvgpr_write_b32 a29, v197
    v_accvgpr_read_b32 v198, a30
    v_mul_f32 v198, v198, v228
    v_accvgpr_write_b32 a30, v198
    v_accvgpr_read_b32 v199, a31
    v_mul_f32 v199, v199, v228
    v_accvgpr_write_b32 a31, v199
    v_mul_f32 v201, v201, v229
    v_accvgpr_write_b32 a196, v201
    v_accvgpr_read_b32 v192, a32
    v_mul_f32 v192, v192, v229
    v_accvgpr_write_b32 a32, v192
    v_accvgpr_read_b32 v193, a33
    v_mul_f32 v193, v193, v229
    v_accvgpr_write_b32 a33, v193
    v_accvgpr_read_b32 v194, a34
    v_mul_f32 v194, v194, v229
    v_accvgpr_write_b32 a34, v194
    v_accvgpr_read_b32 v195, a35
    v_mul_f32 v195, v195, v229
    v_accvgpr_write_b32 a35, v195
    v_accvgpr_read_b32 v196, a36
    v_mul_f32 v196, v196, v229
    v_accvgpr_write_b32 a36, v196
    v_accvgpr_read_b32 v197, a37
    v_mul_f32 v197, v197, v229
    v_accvgpr_write_b32 a37, v197
    v_accvgpr_read_b32 v198, a38
    v_mul_f32 v198, v198, v229
    v_accvgpr_write_b32 a38, v198
    v_accvgpr_read_b32 v199, a39
    v_mul_f32 v199, v199, v229
    v_accvgpr_write_b32 a39, v199
    v_accvgpr_read_b32 v192, a40
    v_mul_f32 v192, v192, v229
    v_accvgpr_write_b32 a40, v192
    v_accvgpr_read_b32 v193, a41
    v_mul_f32 v193, v193, v229
    v_accvgpr_write_b32 a41, v193
    v_accvgpr_read_b32 v194, a42
    v_mul_f32 v194, v194, v229
    v_accvgpr_write_b32 a42, v194
    v_accvgpr_read_b32 v195, a43
    v_mul_f32 v195, v195, v229
    v_accvgpr_write_b32 a43, v195
    v_accvgpr_read_b32 v196, a44
    v_mul_f32 v196, v196, v229
    v_accvgpr_write_b32 a44, v196
    v_accvgpr_read_b32 v197, a45
    v_mul_f32 v197, v197, v229
    v_accvgpr_write_b32 a45, v197
    v_accvgpr_read_b32 v198, a46
    v_mul_f32 v198, v198, v229
    v_accvgpr_write_b32 a46, v198
    v_accvgpr_read_b32 v199, a47
    v_mul_f32 v199, v199, v229
    v_accvgpr_write_b32 a47, v199
    v_accvgpr_read_b32 v192, a48
    v_mul_f32 v192, v192, v229
    v_accvgpr_write_b32 a48, v192
    v_accvgpr_read_b32 v193, a49
    v_mul_f32 v193, v193, v229
    v_accvgpr_write_b32 a49, v193
    v_accvgpr_read_b32 v194, a50
    v_mul_f32 v194, v194, v229
    v_accvgpr_write_b32 a50, v194
    v_accvgpr_read_b32 v195, a51
    v_mul_f32 v195, v195, v229
    v_accvgpr_write_b32 a51, v195
    v_accvgpr_read_b32 v196, a52
    v_mul_f32 v196, v196, v229
    v_accvgpr_write_b32 a52, v196
    v_accvgpr_read_b32 v197, a53
    v_mul_f32 v197, v197, v229
    v_accvgpr_write_b32 a53, v197
    v_accvgpr_read_b32 v198, a54
    v_mul_f32 v198, v198, v229
    v_accvgpr_write_b32 a54, v198
    v_accvgpr_read_b32 v199, a55
    v_mul_f32 v199, v199, v229
    v_accvgpr_write_b32 a55, v199
    v_accvgpr_read_b32 v192, a56
    v_mul_f32 v192, v192, v229
    v_accvgpr_write_b32 a56, v192
    v_accvgpr_read_b32 v193, a57
    v_mul_f32 v193, v193, v229
    v_accvgpr_write_b32 a57, v193
    v_accvgpr_read_b32 v194, a58
    v_mul_f32 v194, v194, v229
    v_accvgpr_write_b32 a58, v194
    v_accvgpr_read_b32 v195, a59
    v_mul_f32 v195, v195, v229
    v_accvgpr_write_b32 a59, v195
    v_accvgpr_read_b32 v196, a60
    v_mul_f32 v196, v196, v229
    v_accvgpr_write_b32 a60, v196
    v_accvgpr_read_b32 v197, a61
    v_mul_f32 v197, v197, v229
    v_accvgpr_write_b32 a61, v197
    v_accvgpr_read_b32 v198, a62
    v_mul_f32 v198, v198, v229
    v_accvgpr_write_b32 a62, v198
    v_accvgpr_read_b32 v199, a63
    v_mul_f32 v199, v199, v229
    v_accvgpr_write_b32 a63, v199
    v_mul_f32 v202, v202, v230
    v_accvgpr_write_b32 a200, v202
    v_accvgpr_read_b32 v192, a64
    v_mul_f32 v192, v192, v230
    v_accvgpr_write_b32 a64, v192
    v_accvgpr_read_b32 v193, a65
    v_mul_f32 v193, v193, v230
    v_accvgpr_write_b32 a65, v193
    v_accvgpr_read_b32 v194, a66
    v_mul_f32 v194, v194, v230
    v_accvgpr_write_b32 a66, v194
    v_accvgpr_read_b32 v195, a67
    v_mul_f32 v195, v195, v230
    v_accvgpr_write_b32 a67, v195
    v_accvgpr_read_b32 v196, a68
    v_mul_f32 v196, v196, v230
    v_accvgpr_write_b32 a68, v196
    v_accvgpr_read_b32 v197, a69
    v_mul_f32 v197, v197, v230
    v_accvgpr_write_b32 a69, v197
    v_accvgpr_read_b32 v198, a70
    v_mul_f32 v198, v198, v230
    v_accvgpr_write_b32 a70, v198
    v_accvgpr_read_b32 v199, a71
    v_mul_f32 v199, v199, v230
    v_accvgpr_write_b32 a71, v199
    v_accvgpr_read_b32 v192, a72
    v_mul_f32 v192, v192, v230
    v_accvgpr_write_b32 a72, v192
    v_accvgpr_read_b32 v193, a73
    v_mul_f32 v193, v193, v230
    v_accvgpr_write_b32 a73, v193
    v_accvgpr_read_b32 v194, a74
    v_mul_f32 v194, v194, v230
    v_accvgpr_write_b32 a74, v194
    v_accvgpr_read_b32 v195, a75
    v_mul_f32 v195, v195, v230
    v_accvgpr_write_b32 a75, v195
    v_accvgpr_read_b32 v196, a76
    v_mul_f32 v196, v196, v230
    v_accvgpr_write_b32 a76, v196
    v_accvgpr_read_b32 v197, a77
    v_mul_f32 v197, v197, v230
    v_accvgpr_write_b32 a77, v197
    v_accvgpr_read_b32 v198, a78
    v_mul_f32 v198, v198, v230
    v_accvgpr_write_b32 a78, v198
    v_accvgpr_read_b32 v199, a79
    v_mul_f32 v199, v199, v230
    v_accvgpr_write_b32 a79, v199
    v_accvgpr_read_b32 v192, a80
    v_mul_f32 v192, v192, v230
    v_accvgpr_write_b32 a80, v192
    v_accvgpr_read_b32 v193, a81
    v_mul_f32 v193, v193, v230
    v_accvgpr_write_b32 a81, v193
    v_accvgpr_read_b32 v194, a82
    v_mul_f32 v194, v194, v230
    v_accvgpr_write_b32 a82, v194
    v_accvgpr_read_b32 v195, a83
    v_mul_f32 v195, v195, v230
    v_accvgpr_write_b32 a83, v195
    v_accvgpr_read_b32 v196, a84
    v_mul_f32 v196, v196, v230
    v_accvgpr_write_b32 a84, v196
    v_accvgpr_read_b32 v197, a85
    v_mul_f32 v197, v197, v230
    v_accvgpr_write_b32 a85, v197
    v_accvgpr_read_b32 v198, a86
    v_mul_f32 v198, v198, v230
    v_accvgpr_write_b32 a86, v198
    v_accvgpr_read_b32 v199, a87
    v_mul_f32 v199, v199, v230
    v_accvgpr_write_b32 a87, v199
    v_accvgpr_read_b32 v192, a88
    v_mul_f32 v192, v192, v230
    v_accvgpr_write_b32 a88, v192
    v_accvgpr_read_b32 v193, a89
    v_mul_f32 v193, v193, v230
    v_accvgpr_write_b32 a89, v193
    v_accvgpr_read_b32 v194, a90
    v_mul_f32 v194, v194, v230
    v_accvgpr_write_b32 a90, v194
    v_accvgpr_read_b32 v195, a91
    v_mul_f32 v195, v195, v230
    v_accvgpr_write_b32 a91, v195
    v_accvgpr_read_b32 v196, a92
    v_mul_f32 v196, v196, v230
    v_accvgpr_write_b32 a92, v196
    v_accvgpr_read_b32 v197, a93
    v_mul_f32 v197, v197, v230
    v_accvgpr_write_b32 a93, v197
    v_accvgpr_read_b32 v198, a94
    v_mul_f32 v198, v198, v230
    v_accvgpr_write_b32 a94, v198
    v_accvgpr_read_b32 v199, a95
    v_mul_f32 v199, v199, v230
    v_accvgpr_write_b32 a95, v199
    v_mul_f32 v203, v203, v231
    v_accvgpr_write_b32 a204, v203
    v_accvgpr_read_b32 v192, a96
    v_mul_f32 v192, v192, v231
    v_accvgpr_write_b32 a96, v192
    v_accvgpr_read_b32 v193, a97
    v_mul_f32 v193, v193, v231
    v_accvgpr_write_b32 a97, v193
    v_accvgpr_read_b32 v194, a98
    v_mul_f32 v194, v194, v231
    v_accvgpr_write_b32 a98, v194
    v_accvgpr_read_b32 v195, a99
    v_mul_f32 v195, v195, v231
    v_accvgpr_write_b32 a99, v195
    v_accvgpr_read_b32 v196, a100
    v_mul_f32 v196, v196, v231
    v_accvgpr_write_b32 a100, v196
    v_accvgpr_read_b32 v197, a101
    v_mul_f32 v197, v197, v231
    v_accvgpr_write_b32 a101, v197
    v_accvgpr_read_b32 v198, a102
    v_mul_f32 v198, v198, v231
    v_accvgpr_write_b32 a102, v198
    v_accvgpr_read_b32 v199, a103
    v_mul_f32 v199, v199, v231
    v_accvgpr_write_b32 a103, v199
    v_accvgpr_read_b32 v192, a104
    v_mul_f32 v192, v192, v231
    v_accvgpr_write_b32 a104, v192
    v_accvgpr_read_b32 v193, a105
    v_mul_f32 v193, v193, v231
    v_accvgpr_write_b32 a105, v193
    v_accvgpr_read_b32 v194, a106
    v_mul_f32 v194, v194, v231
    v_accvgpr_write_b32 a106, v194
    v_accvgpr_read_b32 v195, a107
    v_mul_f32 v195, v195, v231
    v_accvgpr_write_b32 a107, v195
    v_accvgpr_read_b32 v196, a108
    v_mul_f32 v196, v196, v231
    v_accvgpr_write_b32 a108, v196
    v_accvgpr_read_b32 v197, a109
    v_mul_f32 v197, v197, v231
    v_accvgpr_write_b32 a109, v197
    v_accvgpr_read_b32 v198, a110
    v_mul_f32 v198, v198, v231
    v_accvgpr_write_b32 a110, v198
    v_accvgpr_read_b32 v199, a111
    v_mul_f32 v199, v199, v231
    v_accvgpr_write_b32 a111, v199
    v_accvgpr_read_b32 v192, a112
    v_mul_f32 v192, v192, v231
    v_accvgpr_write_b32 a112, v192
    v_accvgpr_read_b32 v193, a113
    v_mul_f32 v193, v193, v231
    v_accvgpr_write_b32 a113, v193
    v_accvgpr_read_b32 v194, a114
    v_mul_f32 v194, v194, v231
    v_accvgpr_write_b32 a114, v194
    v_accvgpr_read_b32 v195, a115
    v_mul_f32 v195, v195, v231
    v_accvgpr_write_b32 a115, v195
    v_accvgpr_read_b32 v196, a116
    v_mul_f32 v196, v196, v231
    v_accvgpr_write_b32 a116, v196
    v_accvgpr_read_b32 v197, a117
    v_mul_f32 v197, v197, v231
    v_accvgpr_write_b32 a117, v197
    v_accvgpr_read_b32 v198, a118
    v_mul_f32 v198, v198, v231
    v_accvgpr_write_b32 a118, v198
    v_accvgpr_read_b32 v199, a119
    v_mul_f32 v199, v199, v231
    v_accvgpr_write_b32 a119, v199
    v_accvgpr_read_b32 v192, a120
    v_mul_f32 v192, v192, v231
    v_accvgpr_write_b32 a120, v192
    v_accvgpr_read_b32 v193, a121
    v_mul_f32 v193, v193, v231
    v_accvgpr_write_b32 a121, v193
    v_accvgpr_read_b32 v194, a122
    v_mul_f32 v194, v194, v231
    v_accvgpr_write_b32 a122, v194
    v_accvgpr_read_b32 v195, a123
    v_mul_f32 v195, v195, v231
    v_accvgpr_write_b32 a123, v195
    v_accvgpr_read_b32 v196, a124
    v_mul_f32 v196, v196, v231
    v_accvgpr_write_b32 a124, v196
    v_accvgpr_read_b32 v197, a125
    v_mul_f32 v197, v197, v231
    v_accvgpr_write_b32 a125, v197
    v_accvgpr_read_b32 v198, a126
    v_mul_f32 v198, v198, v231
    v_accvgpr_write_b32 a126, v198
    v_accvgpr_read_b32 v199, a127
    v_mul_f32 v199, v199, v231
    v_accvgpr_write_b32 a127, v199
    v_add_f32 v208, v208, v224
    v_sub_f32 v64, v64, v224
    v_sub_f32 v96, v96, v224
    v_sub_f32 v160, v160, v224
    v_sub_f32 v65, v65, v224
    v_sub_f32 v97, v97, v224
    v_sub_f32 v161, v161, v224
    v_sub_f32 v66, v66, v224
    v_sub_f32 v98, v98, v224
    v_sub_f32 v162, v162, v224
    v_sub_f32 v67, v67, v224
    v_sub_f32 v99, v99, v224
    v_sub_f32 v163, v163, v224
    v_sub_f32 v68, v68, v224
    v_sub_f32 v100, v100, v224
    v_sub_f32 v164, v164, v224
    v_sub_f32 v69, v69, v224
    v_sub_f32 v101, v101, v224
    v_sub_f32 v165, v165, v224
    v_sub_f32 v70, v70, v224
    v_sub_f32 v102, v102, v224
    v_sub_f32 v166, v166, v224
    v_sub_f32 v71, v71, v224
    v_sub_f32 v103, v103, v224
    v_sub_f32 v167, v167, v224
    v_add_f32 v209, v209, v225
    v_sub_f32 v72, v72, v225
    v_sub_f32 v104, v104, v225
    v_sub_f32 v168, v168, v225
    v_sub_f32 v73, v73, v225
    v_sub_f32 v105, v105, v225
    v_sub_f32 v169, v169, v225
    v_sub_f32 v74, v74, v225
    v_sub_f32 v106, v106, v225
    v_sub_f32 v170, v170, v225
    v_sub_f32 v75, v75, v225
    v_sub_f32 v107, v107, v225
    v_sub_f32 v171, v171, v225
    v_sub_f32 v76, v76, v225
    v_sub_f32 v108, v108, v225
    v_sub_f32 v172, v172, v225
    v_sub_f32 v77, v77, v225
    v_sub_f32 v109, v109, v225
    v_sub_f32 v173, v173, v225
    v_sub_f32 v78, v78, v225
    v_sub_f32 v110, v110, v225
    v_sub_f32 v174, v174, v225
    v_sub_f32 v79, v79, v225
    v_sub_f32 v111, v111, v225
    v_sub_f32 v175, v175, v225
    v_add_f32 v210, v210, v226
    v_sub_f32 v80, v80, v226
    v_sub_f32 v112, v112, v226
    v_sub_f32 v176, v176, v226
    v_sub_f32 v81, v81, v226
    v_sub_f32 v113, v113, v226
    v_sub_f32 v177, v177, v226
    v_sub_f32 v82, v82, v226
    v_sub_f32 v114, v114, v226
    v_sub_f32 v178, v178, v226
    v_sub_f32 v83, v83, v226
    v_sub_f32 v115, v115, v226
    v_sub_f32 v179, v179, v226
    v_sub_f32 v84, v84, v226
    v_sub_f32 v116, v116, v226
    v_sub_f32 v180, v180, v226
    v_sub_f32 v85, v85, v226
    v_sub_f32 v117, v117, v226
    v_sub_f32 v181, v181, v226
    v_sub_f32 v86, v86, v226
    v_sub_f32 v118, v118, v226
    v_sub_f32 v182, v182, v226
    v_sub_f32 v87, v87, v226
    v_sub_f32 v119, v119, v226
    v_sub_f32 v183, v183, v226
    v_add_f32 v211, v211, v227
    v_sub_f32 v88, v88, v227
    v_sub_f32 v120, v120, v227
    v_sub_f32 v184, v184, v227
    v_sub_f32 v89, v89, v227
    v_sub_f32 v121, v121, v227
    v_sub_f32 v185, v185, v227
    v_sub_f32 v90, v90, v227
    v_sub_f32 v122, v122, v227
    v_sub_f32 v186, v186, v227
    v_sub_f32 v91, v91, v227
    v_sub_f32 v123, v123, v227
    v_sub_f32 v187, v187, v227
    v_sub_f32 v92, v92, v227
    v_sub_f32 v124, v124, v227
    v_sub_f32 v188, v188, v227
    v_sub_f32 v93, v93, v227
    v_sub_f32 v125, v125, v227
    v_sub_f32 v189, v189, v227
    v_sub_f32 v94, v94, v227
    v_sub_f32 v126, v126, v227
    v_sub_f32 v190, v190, v227
    v_sub_f32 v95, v95, v227
    v_sub_f32 v127, v127, v227
    v_sub_f32 v191, v191, v227
    v_exp_f32 v192, v96
    v_exp_f32 v193, v97
    v_exp_f32 v194, v98
    v_cvt_pk_bf16_f32 v144, v192, v193
    v_exp_f32 v195, v99
    v_exp_f32 v196, v100
    v_cvt_pk_bf16_f32 v145, v194, v195
    v_exp_f32 v197, v101
    v_exp_f32 v198, v102
    v_cvt_pk_bf16_f32 v146, v196, v197
    v_exp_f32 v199, v103
    v_exp_f32 v192, v104
    v_cvt_pk_bf16_f32 v147, v198, v199
    v_exp_f32 v193, v105
    v_exp_f32 v194, v106
    v_cvt_pk_bf16_f32 v148, v192, v193
    v_mfma_f32_16x16x32_bf16 a[192:195], a[208:211], v[144:147], a[192:195]
    v_exp_f32 v195, v107
    v_exp_f32 v196, v108
    v_cvt_pk_bf16_f32 v149, v194, v195
    v_exp_f32 v197, v109
    v_exp_f32 v198, v110
    v_cvt_pk_bf16_f32 v150, v196, v197
    v_exp_f32 v199, v111
    v_exp_f32 v192, v112
    v_cvt_pk_bf16_f32 v151, v198, v199
    v_exp_f32 v193, v113
    v_exp_f32 v194, v114
    v_cvt_pk_bf16_f32 v152, v192, v193
    v_mfma_f32_16x16x32_bf16 a[196:199], a[208:211], v[148:151], a[196:199]
    v_exp_f32 v195, v115
    v_exp_f32 v196, v116
    v_cvt_pk_bf16_f32 v153, v194, v195
    v_accvgpr_read_b32 v204, a192
    v_exp_f32 v197, v117
    v_exp_f32 v198, v118
    v_cvt_pk_bf16_f32 v154, v196, v197
    v_exp_f32 v199, v119
    v_exp_f32 v192, v120
    v_cvt_pk_bf16_f32 v155, v198, v199
    v_exp_f32 v193, v121
    v_exp_f32 v194, v122
    v_cvt_pk_bf16_f32 v156, v192, v193
    v_mfma_f32_16x16x32_bf16 a[200:203], a[208:211], v[152:155], a[200:203]
    v_exp_f32 v195, v123
    v_exp_f32 v196, v124
    v_cvt_pk_bf16_f32 v157, v194, v195
    v_accvgpr_read_b32 v205, a196
    v_exp_f32 v197, v125
    v_exp_f32 v198, v126
    v_cvt_pk_bf16_f32 v158, v196, v197
    v_exp_f32 v199, v127
    v_nop
    v_cvt_pk_bf16_f32 v159, v198, v199
    s_nop 1
    v_mfma_f32_16x16x32_bf16 a[204:207], a[208:211], v[156:159], a[204:207]
    s_nop 7
    v_accvgpr_read_b32 v206, a200
    v_accvgpr_read_b32 v207, a204
    v_exp_f32 v192, v64
    v_exp_f32 v193, v65
    v_exp_f32 v194, v66
    v_cvt_pk_bf16_f32 v128, v192, v193
    v_exp_f32 v195, v67
    v_exp_f32 v196, v68
    v_cvt_pk_bf16_f32 v129, v194, v195
    v_exp_f32 v197, v69
    s_nop 1
    s_setpc_b64 s[44:45]
K2_code_end:
    s_endpgm
K3_fused_entry:
    v_mov_b32 v194, v215
    s_mov_b32 s24, s16
    s_load_dwordx2 s[50:51], s[0:1], 80
    s_lshr_b32 s26, s2, 6
    s_bfe_u32 s25, s2, 0x30003
    s_sub_u32 s28, 15, s25
    s_and_b32 s47, s2, 1
    s_cselect_b32 s25, s25, s28
    s_lshl_b32 s47, s47, 3
    s_lshl_b32 s46, s26, 1
    s_bfe_u32 s27, s2, 0x20001
    s_lshl_b32 s32, s27, 20
    s_lshl_b32 s28, s24, 14
    s_add_u32 s32, s32, s28
    s_lshl_b32 s28, s26, 8
    s_add_u32 s32, s32, s28
    s_lshl_b32 s33, s24, 12
    s_mov_b32 s4, s88
    s_mov_b32 s5, s89
    s_mov_b32 s6, 0x400000
    s_mov_b32 s7, 0x20000
    v_lshrrev_b32 v197, 4, v194
    v_lshlrev_b32 v195, 10, v197
    v_and_b32 v196, 15, v194
    v_lshlrev_b32 v197, 1, v197
    v_xor_b32 v196, v196, v197
    v_lshl_add_u32 v201, v196, 4, v195
    v_xor_b32 v196, 8, v196
    v_lshl_add_u32 v202, v196, 4, v195
    v_add_u32 v202, 3072, v202
    v_add_u32 v203, 6144, v201
    v_add_u32 v204, 6144, v202
    s_barrier
    s_mov_b32 s52, s32
    s_add_u32 m0, s33, 16384
    s_add_u32 s48, s46, 0
    s_and_b32 s48, s48, 7
    s_or_b32 s48, s48, s47
    s_lshl_b32 s53, s48, 16
    s_add_u32 s32, s52, s53
    buffer_load_dwordx4 v201, s[4:7], s32 offen offset:0 lds
    buffer_load_dwordx4 v202, s[4:7], s32 offen offset:1024 lds
    buffer_load_dwordx4 v203, s[4:7], s32 offen offset:2048 lds
    buffer_load_dwordx4 v204, s[4:7], s32 offen offset:3072 lds
    s_mov_b32 s8, s92
    s_mov_b32 s9, s93
    s_mov_b32 s10, 0x80000
    s_mov_b32 s11, 0x20000
    s_mov_b32 s18, 0x400000
    s_mov_b32 s19, 0x20000
    s_lshr_b32 s37, s24, 1
    s_and_b32 s38, s24, 1
    v_lshlrev_b32 v191, 4, v194
    s_lshl_b32 s28, s25, 1
    s_add_u32 s28, s28, s37
    s_mul_i32 s31, s28, 589824
    s_lshl_b32 s28, s27, 15
    s_add_u32 s31, s31, s28
    s_add_u32 s31, s31, 35649536
    s_mov_b32 s49, s31
    s_lshl_b32 s28, s38, 1
    s_add_u32 s28, s28, s27
    s_and_b32 s29, s28, 3
    s_mul_i32 s29, s29, 147456
    s_add_u32 s29, s29, 2048
    v_add_u32 v192, s29, v191
    s_add_u32 s28, s28, 1
    s_and_b32 s29, s28, 3
    s_mul_i32 s29, s29, 147456
    v_add_u32 v193, s29, v191
    s_waitcnt lgkmcnt(0)
    s_mov_b32 s16, s50
    s_mov_b32 s17, s51
    s_sub_u32 s28, 15, s25
    s_min_u32 s28, s28, s25
    s_lshl_b32 s28, s28, 3
    s_and_b32 s29, s2, 7
    s_add_u32 s28, s28, s29
    s_cmp_ge_u32 s25, 8
    s_cselect_b32 s29, 512, 0
    s_add_u32 s28, s28, s29
    v_and_b32 v197, 3, v194
    v_lshlrev_b32 v196, 6, v197
    v_add_u32 v206, s28, v196
    v_xor_b32 v207, 1, v206
    v_lshlrev_b32 v206, 7, v206
    v_lshlrev_b32 v207, 7, v207
    s_lshr_b32 s28, s25, 1
    s_lshl_b32 s28, s28, 3
    s_add_u32 s28, s28, 512
    v_add_u32 v196, s28, v196
    v_bfe_u32 v195, v194, 2, 3
    v_add_u32 v196, v195, v196
    v_cmp_gt_u32 vcc, 32, v194
    s_and_b32 s28, s2, 0xf9
    s_add_u32 s28, s28, 512
    v_lshl_add_u32 v197, v197, 1, s28
    v_cndmask_b32 v208, v197, v196, vcc
    v_lshlrev_b32 v208, 7, v208
    s_lshl_b32 s99, s2, 7
    s_add_u32 s99, s99, 60358656
    s_cmp_eq_u32 s24, 0
    s_cselect_b32 s44, 60293120, s14
    s_cselect_b32 s99, s99, s14
    s_cselect_b32 s28, 1, 0
    v_mov_b32 v210, s28
    v_lshlrev_b32 v212, 1, v210
    v_cndmask_b32 v211, v210, v212, vcc
    s_waitcnt vmcnt(8)
    s_barrier
    buffer_store_dword v210, v236, s[12:15], s99 offen sc1
    s_add_u32 m0, s33, 0
    s_add_u32 s48, s46, 0
    s_and_b32 s48, s48, 7
    s_or_b32 s48, s48, s47
    s_lshl_b32 s53, s48, 11
    s_add_u32 s31, s49, s53
    buffer_load_dwordx4 v192, s[12:15], s31 offen offset:0 sc1 lds
    buffer_load_dwordx4 v192, s[12:15], s31 offen offset:1024 sc1 lds
    buffer_load_dwordx4 v193, s[12:15], s31 offen offset:2048 sc1 lds
    buffer_load_dwordx4 v193, s[12:15], s31 offen offset:3072 sc1 lds
    s_add_u32 m0, s33, 32768
    s_add_u32 s48, s46, 1
    s_and_b32 s48, s48, 7
    s_or_b32 s48, s48, s47
    s_lshl_b32 s53, s48, 11
    s_add_u32 s31, s49, s53
    buffer_load_dwordx4 v192, s[12:15], s31 offen offset:0 sc1 lds
    buffer_load_dwordx4 v192, s[12:15], s31 offen offset:1024 sc1 lds
    buffer_load_dwordx4 v193, s[12:15], s31 offen offset:2048 sc1 lds
    buffer_load_dwordx4 v193, s[12:15], s31 offen offset:3072 sc1 lds
    s_add_u32 m0, s33, 49152
    s_lshl_b32 s53, s48, 16
    s_add_u32 s32, s52, s53
    buffer_load_dwordx4 v201, s[4:7], s32 offen offset:0 lds
    buffer_load_dwordx4 v202, s[4:7], s32 offen offset:1024 lds
    buffer_load_dwordx4 v203, s[4:7], s32 offen offset:2048 lds
    buffer_load_dwordx4 v204, s[4:7], s32 offen offset:3072 lds
    s_add_u32 m0, s33, 81920
    s_add_u32 s48, s46, 2
    s_and_b32 s48, s48, 7
    s_or_b32 s48, s48, s47
    s_lshl_b32 s53, s48, 16
    s_add_u32 s32, s52, s53
    buffer_load_dwordx4 v201, s[4:7], s32 offen offset:0 lds
    buffer_load_dwordx4 v202, s[4:7], s32 offen offset:1024 lds
    buffer_load_dwordx4 v203, s[4:7], s32 offen offset:2048 lds
    buffer_load_dwordx4 v204, s[4:7], s32 offen offset:3072 lds
    buffer_load_dword v209, v206, s[12:15], s44 offen sc1
    s_lshl_b32 s28, s37, 13
    v_add_u32 v199, s28, v191
    v_add_u32 v200, 0x10000, v199
    v_mov_b32 v156, v199
    v_mov_b32 v157, v200
    v_add_u32 v158, 0x10000, v200
    v_lshrrev_b32 v195, 4, v194
    v_bfe_u32 v196, v194, 2, 2
    v_lshl_add_u32 v197, v195, 2, v196
    v_and_b32 v195, 3, v194
    v_lshlrev_b32 v195, 3, v195
    v_add_u32 v195, 16384, v195
    v_lshl_add_u32 v205, v197, 8, v195
    v_and_b32 v196, 7, v197
    s_lshl_b32 s28, s38, 2
    v_xor_b32 v196, s28, v196
    v_xor_b32 v198, 0, v196
    v_lshl_add_u32 v144, v198, 5, v205
    v_add_u32 v148, 0x10000, v144
    v_xor_b32 v198, 1, v196
    v_lshl_add_u32 v145, v198, 5, v205
    v_add_u32 v149, 0x10000, v145
    v_xor_b32 v198, 2, v196
    v_lshl_add_u32 v146, v198, 5, v205
    v_add_u32 v150, 0x10000, v146
    v_xor_b32 v198, 3, v196
    v_lshl_add_u32 v147, v198, 5, v205
    v_add_u32 v151, 0x10000, v147
    v_lshl_add_u32 v205, v197, 7, v195
    v_bfe_u32 v196, v197, 1, 2
    s_lshl_b32 s28, s38, 1
    v_xor_b32 v196, s28, v196
    v_lshl_add_u32 v159, v196, 5, v205
    v_xor_b32 v196, 1, v196
    v_lshl_add_u32 v160, v196, 5, v205
    v_add_u32 v161, 0x10000, v159
    v_add_u32 v162, 0x10000, v160
    v_add_u32 v163, 0x20000, v159
    v_add_u32 v164, 0x20000, v160
    v_lshrrev_b32 v195, 3, v194
    v_lshlrev_b32 v195, 10, v195
    v_and_b32 v196, 7, v194
    v_lshrrev_b32 v197, 4, v194
    v_lshlrev_b32 v197, 1, v197
    v_xor_b32 v196, v196, v197
    v_lshl_add_u32 v152, v196, 4, v195
    v_add_u32 v153, 7168, v152
    v_add_u32 v154, 14336, v152
    v_add_u32 v155, 21504, v152
    v_and_b32 v195, 15, v194
    v_lshlrev_b32 v195, 11, v195
    v_lshrrev_b32 v196, 4, v194
    v_lshl_add_u32 v198, v196, 3, v195
    v_mov_b32 v205, 0
    s_lshl_b32 s34, s25, 18
    s_lshl_b32 s28, s26, 8
    s_add_u32 s34, s34, s28
    s_mov_b32 s36, s34
    s_lshl_b32 s28, s37, 17
    s_add_u32 s34, s34, s28
    s_lshl_b32 s28, s27, 15
    s_add_u32 s34, s34, s28
    s_lshl_b32 s28, s38, 7
    s_add_u32 s34, s34, s28
    s_lshr_b32 s28, s27, 1
    s_lshl_b32 s28, s28, 17
    s_add_u32 s36, s36, s28
    s_lshl_b32 s28, s37, 16
    s_add_u32 s36, s36, s28
    s_and_b32 s28, s27, 1
    s_lshl_b32 s28, s28, 7
    s_add_u32 s36, s36, s28
    s_lshl_b32 s28, s38, 6
    s_add_u32 s36, s36, s28
    s_lshl_b32 s28, s25, 3
    s_and_b32 s29, s27, 2
    s_lshl_b32 s29, s29, 1
    s_add_u32 s28, s28, s29
    s_add_u32 s28, s28, s24
    s_mul_i32 s39, s28, 147456
    s_add_u32 s39, s39, 35782656
    s_lshl_b32 s40, s24, 15
    s_lshl_b32 s28, s26, 8
    s_add_u32 s40, s40, s28
    s_and_b32 s28, s27, 1
    s_lshl_b32 s28, s28, 7
    s_add_u32 s40, s40, s28
    s_lshl_b32 s28, s2, 2
    s_add_u32 s28, s28, s24
    s_mul_i32 s35, s28, 6144
    s_add_u32 s35, s35, 67108864
    s_sub_u32 s28, s27, 1
    s_and_b32 s28, s28, 3
    s_sub_u32 s28, s28, s27
    s_mul_i32 s28, s28, 49152
    s_add_u32 s41, s35, s28
    s_add_u32 s41, s41, 0
    s_sub_u32 s28, s27, 2
    s_and_b32 s28, s28, 3
    s_sub_u32 s28, s28, s27
    s_mul_i32 s28, s28, 49152
    s_add_u32 s42, s35, s28
    s_add_u32 s42, s42, 2048
    s_sub_u32 s28, s27, 3
    s_and_b32 s28, s28, 3
    s_sub_u32 s28, s28, s27
    s_mul_i32 s28, s28, 49152
    s_add_u32 s43, s35, s28
    s_add_u32 s43, s43, 4096
    v_mfma_f32_32x32x16_bf16 v[0:15], v[236:239], v[236:239], 0
    v_mfma_f32_32x32x16_bf16 v[16:31], v[236:239], v[236:239], 0
    v_mfma_f32_32x32x16_bf16 v[32:47], v[236:239], v[236:239], 0
    v_mfma_f32_32x32x16_bf16 v[48:63], v[236:239], v[236:239], 0
    v_mfma_f32_32x32x16_bf16 v[64:79], v[236:239], v[236:239], 0
    s_waitcnt vmcnt(0)
    v_cmp_gt_u32 vcc, v210, v209
    s_nop 1
    s_cbranch_vccnz K3_sp_54
K3_ok_53:
    s_barrier
    v_mov_b32 v206, v206
    s_add_u32 m0, s33, 65536
    s_add_u32 s48, s46, 2
    s_and_b32 s48, s48, 7
    s_or_b32 s48, s48, s47
    s_lshl_b32 s53, s48, 11
    s_add_u32 s31, s49, s53
    buffer_load_dwordx4 v192, s[12:15], s31 offen offset:0 sc1 lds
    buffer_load_dwordx4 v192, s[12:15], s31 offen offset:1024 sc1 lds
    buffer_load_dwordx4 v193, s[12:15], s31 offen offset:2048 sc1 lds
    buffer_load_dwordx4 v193, s[12:15], s31 offen offset:3072 sc1 lds
    s_barrier
    buffer_store_dword v212, v236, s[12:15], s99 offen sc1
    ds_read_b128 v[80:83], v199 offset:0
    ds_read_b128 v[84:87], v199 offset:2048
    ds_read_b128 v[88:91], v199 offset:4096
    ds_read_b128 v[92:95], v199 offset:6144
    ds_read_b64_tr_b16 v[96:97], v144 offset:0
    ds_read_b64_tr_b16 v[98:99], v144 offset:4096
    ds_read_b64_tr_b16 v[100:101], v145 offset:0
    ds_read_b64_tr_b16 v[102:103], v145 offset:4096
    ds_read_b64_tr_b16 v[104:105], v146 offset:0
    ds_read_b64_tr_b16 v[106:107], v146 offset:4096
    ds_read_b64_tr_b16 v[108:109], v147 offset:0
    ds_read_b64_tr_b16 v[110:111], v147 offset:4096
    s_mov_b32 s30, 3
K3_loop_56:
    s_waitcnt lgkmcnt(4)
    v_mfma_f32_16x16x32_bf16 v[0:3], v[96:99], v[80:83], v[0:3]
    s_add_u32 m0, s33, 98304
    ds_read_b128 v[112:115], v199 offset:1024
    ds_read_b128 v[116:119], v199 offset:3072
    v_mfma_f32_16x16x32_bf16 v[16:19], v[96:99], v[84:87], v[16:19]
    s_add_u32 s48, s46, 3
    v_mfma_f32_16x16x32_bf16 v[32:35], v[96:99], v[88:91], v[32:35]
    s_and_b32 s48, s48, 7
    ds_read_b128 v[120:123], v199 offset:5120
    ds_read_b128 v[124:127], v199 offset:7168
    v_mfma_f32_16x16x32_bf16 v[48:51], v[96:99], v[92:95], v[48:51]
    s_or_b32 s48, s48, s47
    v_mfma_f32_16x16x32_bf16 v[52:55], v[100:103], v[92:95], v[52:55]
    ds_read_b64_tr_b16 v[128:129], v144 offset:8192
    ds_read_b64_tr_b16 v[130:131], v144 offset:12288
    v_mfma_f32_16x16x32_bf16 v[36:39], v[100:103], v[88:91], v[36:39]
    s_lshl_b32 s53, s48, 11
    v_mfma_f32_16x16x32_bf16 v[20:23], v[100:103], v[84:87], v[20:23]
    s_add_u32 s31, s49, s53
    ds_read_b64_tr_b16 v[132:133], v145 offset:8192
    ds_read_b64_tr_b16 v[134:135], v145 offset:12288
    v_mfma_f32_16x16x32_bf16 v[4:7], v[100:103], v[80:83], v[4:7]
    s_waitcnt lgkmcnt(8)
    v_mfma_f32_16x16x32_bf16 v[8:11], v[104:107], v[80:83], v[8:11]
    ds_read_b64_tr_b16 v[136:137], v146 offset:8192
    ds_read_b64_tr_b16 v[138:139], v146 offset:12288
    v_mfma_f32_16x16x32_bf16 v[24:27], v[104:107], v[84:87], v[24:27]
    buffer_load_dwordx4 v192, s[12:15], s31 offen offset:0 sc1 lds
    v_mfma_f32_16x16x32_bf16 v[40:43], v[104:107], v[88:91], v[40:43]
    ds_read_b64_tr_b16 v[140:141], v147 offset:8192
    ds_read_b64_tr_b16 v[142:143], v147 offset:12288
    v_mfma_f32_16x16x32_bf16 v[56:59], v[104:107], v[92:95], v[56:59]
    buffer_load_dwordx4 v192, s[12:15], s31 offen offset:1024 sc1 lds
    v_mfma_f32_16x16x32_bf16 v[60:63], v[108:111], v[92:95], v[60:63]
    buffer_load_dwordx4 v193, s[12:15], s31 offen offset:2048 sc1 lds
    v_mfma_f32_16x16x32_bf16 v[44:47], v[108:111], v[88:91], v[44:47]
    v_mfma_f32_16x16x32_bf16 v[28:31], v[108:111], v[84:87], v[28:31]
    v_mfma_f32_16x16x32_bf16 v[12:15], v[108:111], v[80:83], v[12:15]
    s_waitcnt lgkmcnt(4)
    s_waitcnt vmcnt(8)
    v_cmp_gt_u32 vcc, v210, v209
    s_nop 1
    s_cbranch_vccnz K3_sp_58
K3_ok_57:
    v_mfma_f32_16x16x32_bf16 v[0:3], v[128:131], v[112:115], v[0:3]
    s_waitcnt vmcnt(8) lgkmcnt(0)
    s_barrier
    v_mfma_f32_16x16x32_bf16 v[16:19], v[128:131], v[116:119], v[16:19]
    buffer_load_dwordx4 v193, s[12:15], s31 offen offset:3072 sc1 lds
    v_mfma_f32_16x16x32_bf16 v[32:35], v[128:131], v[120:123], v[32:35]
    s_add_u32 m0, s33, 114688
    ds_read_b128 v[80:83], v199 offset:32768
    ds_read_b128 v[84:87], v199 offset:34816
    v_mfma_f32_16x16x32_bf16 v[48:51], v[128:131], v[124:127], v[48:51]
    s_lshl_b32 s53, s48, 16
    v_mfma_f32_16x16x32_bf16 v[52:55], v[132:135], v[124:127], v[52:55]
    s_add_u32 s32, s52, s53
    ds_read_b128 v[88:91], v199 offset:36864
    ds_read_b128 v[92:95], v199 offset:38912
    v_mfma_f32_16x16x32_bf16 v[36:39], v[132:135], v[120:123], v[36:39]
    buffer_load_dwordx4 v201, s[4:7], s32 offen offset:0 lds
    v_mfma_f32_16x16x32_bf16 v[20:23], v[132:135], v[116:119], v[20:23]
    ds_read_b64_tr_b16 v[96:97], v144 offset:32768
    ds_read_b64_tr_b16 v[98:99], v144 offset:36864
    v_mfma_f32_16x16x32_bf16 v[4:7], v[132:135], v[112:115], v[4:7]
    s_waitcnt lgkmcnt(6)
    v_mfma_f32_16x16x32_bf16 v[8:11], v[136:139], v[112:115], v[8:11]
    ds_read_b64_tr_b16 v[100:101], v145 offset:32768
    ds_read_b64_tr_b16 v[102:103], v145 offset:36864
    v_mfma_f32_16x16x32_bf16 v[24:27], v[136:139], v[116:119], v[24:27]
    buffer_load_dwordx4 v202, s[4:7], s32 offen offset:1024 lds
    v_mfma_f32_16x16x32_bf16 v[40:43], v[136:139], v[120:123], v[40:43]
    ds_read_b64_tr_b16 v[104:105], v146 offset:32768
    ds_read_b64_tr_b16 v[106:107], v146 offset:36864
    v_mfma_f32_16x16x32_bf16 v[56:59], v[136:139], v[124:127], v[56:59]
    buffer_load_dwordx4 v203, s[4:7], s32 offen offset:2048 lds
    v_mfma_f32_16x16x32_bf16 v[60:63], v[140:143], v[124:127], v[60:63]
    ds_read_b64_tr_b16 v[108:109], v147 offset:32768
    ds_read_b64_tr_b16 v[110:111], v147 offset:36864
    v_mfma_f32_16x16x32_bf16 v[44:47], v[140:143], v[120:123], v[44:47]
    buffer_load_dwordx4 v204, s[4:7], s32 offen offset:3072 lds
    v_mfma_f32_16x16x32_bf16 v[28:31], v[140:143], v[116:119], v[28:31]
    v_mfma_f32_16x16x32_bf16 v[12:15], v[140:143], v[112:115], v[12:15]
    s_cmp_eq_u32 s30, 2
    s_cselect_b32 s53, 8, 0
    s_xor_b32 s47, s47, s53
    s_waitcnt lgkmcnt(4)
    v_mfma_f32_16x16x32_bf16 v[0:3], v[96:99], v[80:83], v[0:3]
    s_add_u32 m0, s33, 0
    ds_read_b128 v[112:115], v199 offset:33792
    ds_read_b128 v[116:119], v199 offset:35840
    v_mfma_f32_16x16x32_bf16 v[16:19], v[96:99], v[84:87], v[16:19]
    s_add_u32 s48, s46, 4
    v_mfma_f32_16x16x32_bf16 v[32:35], v[96:99], v[88:91], v[32:35]
    s_and_b32 s48, s48, 7
    ds_read_b128 v[120:123], v199 offset:37888
    ds_read_b128 v[124:127], v199 offset:39936
    v_mfma_f32_16x16x32_bf16 v[48:51], v[96:99], v[92:95], v[48:51]
    s_or_b32 s48, s48, s47
    v_mfma_f32_16x16x32_bf16 v[52:55], v[100:103], v[92:95], v[52:55]
    ds_read_b64_tr_b16 v[128:129], v144 offset:40960
    ds_read_b64_tr_b16 v[130:131], v144 offset:45056
    v_mfma_f32_16x16x32_bf16 v[36:39], v[100:103], v[88:91], v[36:39]
    s_lshl_b32 s53, s48, 11
    v_mfma_f32_16x16x32_bf16 v[20:23], v[100:103], v[84:87], v[20:23]
    s_add_u32 s31, s49, s53
    ds_read_b64_tr_b16 v[132:133], v145 offset:40960
    ds_read_b64_tr_b16 v[134:135], v145 offset:45056
    v_mfma_f32_16x16x32_bf16 v[4:7], v[100:103], v[80:83], v[4:7]
    s_waitcnt lgkmcnt(8)
    v_mfma_f32_16x16x32_bf16 v[8:11], v[104:107], v[80:83], v[8:11]
    ds_read_b64_tr_b16 v[136:137], v146 offset:40960
    ds_read_b64_tr_b16 v[138:139], v146 offset:45056
    v_mfma_f32_16x16x32_bf16 v[24:27], v[104:107], v[84:87], v[24:27]
    buffer_load_dwordx4 v192, s[12:15], s31 offen offset:0 sc1 lds
    v_mfma_f32_16x16x32_bf16 v[40:43], v[104:107], v[88:91], v[40:43]
    ds_read_b64_tr_b16 v[140:141], v147 offset:40960
    ds_read_b64_tr_b16 v[142:143], v147 offset:45056
    v_mfma_f32_16x16x32_bf16 v[56:59], v[104:107], v[92:95], v[56:59]
    buffer_load_dwordx4 v192, s[12:15], s31 offen offset:1024 sc1 lds
    v_mfma_f32_16x16x32_bf16 v[60:63], v[108:111], v[92:95], v[60:63]
    buffer_load_dwordx4 v193, s[12:15], s31 offen offset:2048 sc1 lds
    v_mfma_f32_16x16x32_bf16 v[44:47], v[108:111], v[88:91], v[44:47]
    v_mfma_f32_16x16x32_bf16 v[28:31], v[108:111], v[84:87], v[28:31]
    v_mfma_f32_16x16x32_bf16 v[12:15], v[108:111], v[80:83], v[12:15]
    s_waitcnt lgkmcnt(4)
    v_mfma_f32_16x16x32_bf16 v[0:3], v[128:131], v[112:115], v[0:3]
    s_waitcnt vmcnt(11) lgkmcnt(0)
    s_barrier
    v_mfma_f32_16x16x32_bf16 v[16:19], v[128:131], v[116:119], v[16:19]
    buffer_load_dwordx4 v193, s[12:15], s31 offen offset:3072 sc1 lds
    v_mfma_f32_16x16x32_bf16 v[32:35], v[128:131], v[120:123], v[32:35]
    s_add_u32 m0, s33, 16384
    ds_read_b128 v[80:83], v200 offset:0
    ds_read_b128 v[84:87], v200 offset:2048
    v_mfma_f32_16x16x32_bf16 v[48:51], v[128:131], v[124:127], v[48:51]
    s_lshl_b32 s53, s48, 16
    v_mfma_f32_16x16x32_bf16 v[52:55], v[132:135], v[124:127], v[52:55]
    s_add_u32 s32, s52, s53
    ds_read_b128 v[88:91], v200 offset:4096
    ds_read_b128 v[92:95], v200 offset:6144
    v_mfma_f32_16x16x32_bf16 v[36:39], v[132:135], v[120:123], v[36:39]
    buffer_load_dwordx4 v201, s[4:7], s32 offen offset:0 lds
    v_mfma_f32_16x16x32_bf16 v[20:23], v[132:135], v[116:119], v[20:23]
    ds_read_b64_tr_b16 v[96:97], v148 offset:0
    ds_read_b64_tr_b16 v[98:99], v148 offset:4096
    v_mfma_f32_16x16x32_bf16 v[4:7], v[132:135], v[112:115], v[4:7]
    s_waitcnt lgkmcnt(6)
    v_mfma_f32_16x16x32_bf16 v[8:11], v[136:139], v[112:115], v[8:11]
    ds_read_b64_tr_b16 v[100:101], v149 offset:0
    ds_read_b64_tr_b16 v[102:103], v149 offset:4096
    v_mfma_f32_16x16x32_bf16 v[24:27], v[136:139], v[116:119], v[24:27]
    buffer_load_dwordx4 v202, s[4:7], s32 offen offset:1024 lds
    v_mfma_f32_16x16x32_bf16 v[40:43], v[136:139], v[120:123], v[40:43]
    ds_read_b64_tr_b16 v[104:105], v150 offset:0
    ds_read_b64_tr_b16 v[106:107], v150 offset:4096
    v_mfma_f32_16x16x32_bf16 v[56:59], v[136:139], v[124:127], v[56:59]
    buffer_load_dwordx4 v203, s[4:7], s32 offen offset:2048 lds
    v_mfma_f32_16x16x32_bf16 v[60:63], v[140:143], v[124:127], v[60:63]
    ds_read_b64_tr_b16 v[108:109], v151 offset:0
    ds_read_b64_tr_b16 v[110:111], v151 offset:4096
    v_mfma_f32_16x16x32_bf16 v[44:47], v[140:143], v[120:123], v[44:47]
    buffer_load_dwordx4 v204, s[4:7], s32 offen offset:3072 lds
    v_mfma_f32_16x16x32_bf16 v[28:31], v[140:143], v[116:119], v[28:31]
    v_mfma_f32_16x16x32_bf16 v[12:15], v[140:143], v[112:115], v[12:15]
    s_cmp_eq_u32 s30, 1
    s_cselect_b64 vcc, -1, 0
    v_cndmask_b32 v207, v207, v208, vcc
    v_cndmask_b32 v210, v210, v211, vcc
    s_waitcnt lgkmcnt(4)
    v_mfma_f32_16x16x32_bf16 v[0:3], v[96:99], v[80:83], v[0:3]
    s_add_u32 m0, s33, 32768
    ds_read_b128 v[112:115], v200 offset:1024
    ds_read_b128 v[116:119], v200 offset:3072
    v_mfma_f32_16x16x32_bf16 v[16:19], v[96:99], v[84:87], v[16:19]
    s_add_u32 s48, s46, 5
    v_mov_b32 v206, v207
    v_mfma_f32_16x16x32_bf16 v[32:35], v[96:99], v[88:91], v[32:35]
    s_and_b32 s48, s48, 7
    ds_read_b128 v[120:123], v200 offset:5120
    ds_read_b128 v[124:127], v200 offset:7168
    v_mfma_f32_16x16x32_bf16 v[48:51], v[96:99], v[92:95], v[48:51]
    s_or_b32 s48, s48, s47
    v_mfma_f32_16x16x32_bf16 v[52:55], v[100:103], v[92:95], v[52:55]
    ds_read_b64_tr_b16 v[128:129], v148 offset:8192
    ds_read_b64_tr_b16 v[130:131], v148 offset:12288
    v_mfma_f32_16x16x32_bf16 v[36:39], v[100:103], v[88:91], v[36:39]
    s_lshl_b32 s53, s48, 11
    v_mfma_f32_16x16x32_bf16 v[20:23], v[100:103], v[84:87], v[20:23]
    s_add_u32 s31, s49, s53
    ds_read_b64_tr_b16 v[132:133], v149 offset:8192
    ds_read_b64_tr_b16 v[134:135], v149 offset:12288
    v_mfma_f32_16x16x32_bf16 v[4:7], v[100:103], v[80:83], v[4:7]
    s_waitcnt lgkmcnt(8)
    v_mfma_f32_16x16x32_bf16 v[8:11], v[104:107], v[80:83], v[8:11]
    ds_read_b64_tr_b16 v[136:137], v150 offset:8192
    ds_read_b64_tr_b16 v[138:139], v150 offset:12288
    v_mfma_f32_16x16x32_bf16 v[24:27], v[104:107], v[84:87], v[24:27]
    buffer_load_dwordx4 v192, s[12:15], s31 offen offset:0 sc1 lds
    v_mfma_f32_16x16x32_bf16 v[40:43], v[104:107], v[88:91], v[40:43]
    ds_read_b64_tr_b16 v[140:141], v151 offset:8192
    ds_read_b64_tr_b16 v[142:143], v151 offset:12288
    v_mfma_f32_16x16x32_bf16 v[56:59], v[104:107], v[92:95], v[56:59]
    buffer_load_dwordx4 v192, s[12:15], s31 offen offset:1024 sc1 lds
    v_mfma_f32_16x16x32_bf16 v[60:63], v[108:111], v[92:95], v[60:63]
    buffer_load_dwordx4 v193, s[12:15], s31 offen offset:2048 sc1 lds
    v_mfma_f32_16x16x32_bf16 v[44:47], v[108:111], v[88:91], v[44:47]
    v_mfma_f32_16x16x32_bf16 v[28:31], v[108:111], v[84:87], v[28:31]
    v_mfma_f32_16x16x32_bf16 v[12:15], v[108:111], v[80:83], v[12:15]
    s_waitcnt lgkmcnt(4)
    v_mfma_f32_16x16x32_bf16 v[0:3], v[128:131], v[112:115], v[0:3]
    s_waitcnt vmcnt(11) lgkmcnt(0)
    s_barrier
    v_mfma_f32_16x16x32_bf16 v[16:19], v[128:131], v[116:119], v[16:19]
    buffer_load_dwordx4 v193, s[12:15], s31 offen offset:3072 sc1 lds
    v_mfma_f32_16x16x32_bf16 v[32:35], v[128:131], v[120:123], v[32:35]
    s_add_u32 m0, s33, 49152
    ds_read_b128 v[80:83], v200 offset:32768
    ds_read_b128 v[84:87], v200 offset:34816
    v_mfma_f32_16x16x32_bf16 v[48:51], v[128:131], v[124:127], v[48:51]
    s_lshl_b32 s53, s48, 16
    v_mfma_f32_16x16x32_bf16 v[52:55], v[132:135], v[124:127], v[52:55]
    s_add_u32 s32, s52, s53
    ds_read_b128 v[88:91], v200 offset:36864
    ds_read_b128 v[92:95], v200 offset:38912
    v_mfma_f32_16x16x32_bf16 v[36:39], v[132:135], v[120:123], v[36:39]
    buffer_load_dwordx4 v201, s[4:7], s32 offen offset:0 lds
    v_mfma_f32_16x16x32_bf16 v[20:23], v[132:135], v[116:119], v[20:23]
    ds_read_b64_tr_b16 v[96:97], v148 offset:32768
    ds_read_b64_tr_b16 v[98:99], v148 offset:36864
    v_mfma_f32_16x16x32_bf16 v[4:7], v[132:135], v[112:115], v[4:7]
    s_waitcnt lgkmcnt(6)
    v_mfma_f32_16x16x32_bf16 v[8:11], v[136:139], v[112:115], v[8:11]
    ds_read_b64_tr_b16 v[100:101], v149 offset:32768
    ds_read_b64_tr_b16 v[102:103], v149 offset:36864
    v_mfma_f32_16x16x32_bf16 v[24:27], v[136:139], v[116:119], v[24:27]
    buffer_load_dwordx4 v202, s[4:7], s32 offen offset:1024 lds
    v_mfma_f32_16x16x32_bf16 v[40:43], v[136:139], v[120:123], v[40:43]
    ds_read_b64_tr_b16 v[104:105], v150 offset:32768
    ds_read_b64_tr_b16 v[106:107], v150 offset:36864
    v_mfma_f32_16x16x32_bf16 v[56:59], v[136:139], v[124:127], v[56:59]
    buffer_load_dwordx4 v203, s[4:7], s32 offen offset:2048 lds
    v_mfma_f32_16x16x32_bf16 v[60:63], v[140:143], v[124:127], v[60:63]
    ds_read_b64_tr_b16 v[108:109], v151 offset:32768
    ds_read_b64_tr_b16 v[110:111], v151 offset:36864
    v_mfma_f32_16x16x32_bf16 v[44:47], v[140:143], v[120:123], v[44:47]
    buffer_load_dwordx4 v204, s[4:7], s32 offen offset:3072 lds
    v_mfma_f32_16x16x32_bf16 v[28:31], v[140:143], v[116:119], v[28:31]
    v_mfma_f32_16x16x32_bf16 v[12:15], v[140:143], v[112:115], v[12:15]
    s_waitcnt lgkmcnt(4)
    v_mfma_f32_16x16x32_bf16 v[0:3], v[96:99], v[80:83], v[0:3]
    s_add_u32 m0, s33, 65536
    ds_read_b128 v[112:115], v200 offset:33792
    ds_read_b128 v[116:119], v200 offset:35840
    v_mfma_f32_16x16x32_bf16 v[16:19], v[96:99], v[84:87], v[16:19]
    buffer_load_dword v209, v206, s[12:15], s44 offen sc1
    v_mfma_f32_16x16x32_bf16 v[32:35], v[96:99], v[88:91], v[32:35]
    s_add_u32 s48, s46, 6
    ds_read_b128 v[120:123], v200 offset:37888
    ds_read_b128 v[124:127], v200 offset:39936
    v_mfma_f32_16x16x32_bf16 v[48:51], v[96:99], v[92:95], v[48:51]
    s_and_b32 s48, s48, 7
    s_or_b32 s48, s48, s47
    v_mfma_f32_16x16x32_bf16 v[52:55], v[100:103], v[92:95], v[52:55]
    ds_read_b64_tr_b16 v[128:129], v148 offset:40960
    ds_read_b64_tr_b16 v[130:131], v148 offset:45056
    v_mfma_f32_16x16x32_bf16 v[36:39], v[100:103], v[88:91], v[36:39]
    s_lshl_b32 s53, s48, 11
    v_mfma_f32_16x16x32_bf16 v[20:23], v[100:103], v[84:87], v[20:23]
    s_add_u32 s31, s49, s53
    ds_read_b64_tr_b16 v[132:133], v149 offset:40960
    ds_read_b64_tr_b16 v[134:135], v149 offset:45056
    v_mfma_f32_16x16x32_bf16 v[4:7], v[100:103], v[80:83], v[4:7]
    s_waitcnt lgkmcnt(8)
    v_mfma_f32_16x16x32_bf16 v[8:11], v[104:107], v[80:83], v[8:11]
    ds_read_b64_tr_b16 v[136:137], v150 offset:40960
    ds_read_b64_tr_b16 v[138:139], v150 offset:45056
    v_mfma_f32_16x16x32_bf16 v[24:27], v[104:107], v[84:87], v[24:27]
    buffer_load_dwordx4 v192, s[12:15], s31 offen offset:0 sc1 lds
    v_mfma_f32_16x16x32_bf16 v[40:43], v[104:107], v[88:91], v[40:43]
    ds_read_b64_tr_b16 v[140:141], v151 offset:40960
    ds_read_b64_tr_b16 v[142:143], v151 offset:45056
    v_mfma_f32_16x16x32_bf16 v[56:59], v[104:107], v[92:95], v[56:59]
    buffer_load_dwordx4 v192, s[12:15], s31 offen offset:1024 sc1 lds
    v_mfma_f32_16x16x32_bf16 v[60:63], v[108:111], v[92:95], v[60:63]
    buffer_load_dwordx4 v193, s[12:15], s31 offen offset:2048 sc1 lds
    v_mfma_f32_16x16x32_bf16 v[44:47], v[108:111], v[88:91], v[44:47]
    v_mfma_f32_16x16x32_bf16 v[28:31], v[108:111], v[84:87], v[28:31]
    v_mfma_f32_16x16x32_bf16 v[12:15], v[108:111], v[80:83], v[12:15]
    s_waitcnt lgkmcnt(4)
    v_mfma_f32_16x16x32_bf16 v[0:3], v[128:131], v[112:115], v[0:3]
    s_waitcnt vmcnt(12) lgkmcnt(0)
    s_barrier
    v_mfma_f32_16x16x32_bf16 v[16:19], v[128:131], v[116:119], v[16:19]
    buffer_load_dwordx4 v193, s[12:15], s31 offen offset:3072 sc1 lds
    v_mfma_f32_16x16x32_bf16 v[32:35], v[128:131], v[120:123], v[32:35]
    s_add_u32 m0, s33, 81920
    ds_read_b128 v[80:83], v199 offset:0
    ds_read_b128 v[84:87], v199 offset:2048
    v_mfma_f32_16x16x32_bf16 v[48:51], v[128:131], v[124:127], v[48:51]
    s_lshl_b32 s53, s48, 16
    v_mfma_f32_16x16x32_bf16 v[52:55], v[132:135], v[124:127], v[52:55]
    s_add_u32 s32, s52, s53
    ds_read_b128 v[88:91], v199 offset:4096
    ds_read_b128 v[92:95], v199 offset:6144
    v_mfma_f32_16x16x32_bf16 v[36:39], v[132:135], v[120:123], v[36:39]
    buffer_load_dwordx4 v201, s[4:7], s32 offen offset:0 lds
    v_mfma_f32_16x16x32_bf16 v[20:23], v[132:135], v[116:119], v[20:23]
    ds_read_b64_tr_b16 v[96:97], v144 offset:0
    ds_read_b64_tr_b16 v[98:99], v144 offset:4096
    v_mfma_f32_16x16x32_bf16 v[4:7], v[132:135], v[112:115], v[4:7]
    s_waitcnt lgkmcnt(6)
    v_mfma_f32_16x16x32_bf16 v[8:11], v[136:139], v[112:115], v[8:11]
    ds_read_b64_tr_b16 v[100:101], v145 offset:0
    ds_read_b64_tr_b16 v[102:103], v145 offset:4096
    v_mfma_f32_16x16x32_bf16 v[24:27], v[136:139], v[116:119], v[24:27]
    buffer_load_dwordx4 v202, s[4:7], s32 offen offset:1024 lds
    v_mfma_f32_16x16x32_bf16 v[40:43], v[136:139], v[120:123], v[40:43]
    ds_read_b64_tr_b16 v[104:105], v146 offset:0
    ds_read_b64_tr_b16 v[106:107], v146 offset:4096
    v_mfma_f32_16x16x32_bf16 v[56:59], v[136:139], v[124:127], v[56:59]
    buffer_load_dwordx4 v203, s[4:7], s32 offen offset:2048 lds
    v_mfma_f32_16x16x32_bf16 v[60:63], v[140:143], v[124:127], v[60:63]
    ds_read_b64_tr_b16 v[108:109], v147 offset:0
    ds_read_b64_tr_b16 v[110:111], v147 offset:4096
    v_mfma_f32_16x16x32_bf16 v[44:47], v[140:143], v[120:123], v[44:47]
    buffer_load_dwordx4 v204, s[4:7], s32 offen offset:3072 lds
    v_mfma_f32_16x16x32_bf16 v[28:31], v[140:143], v[116:119], v[28:31]
    v_mfma_f32_16x16x32_bf16 v[12:15], v[140:143], v[112:115], v[12:15]
    s_add_u32 s46, s46, 4
    s_sub_u32 s30, s30, 1
    s_cmp_lg_u32 s30, 0
    s_cbranch_scc1 K3_loop_56
    s_waitcnt lgkmcnt(4)
    v_mfma_f32_16x16x32_bf16 v[0:3], v[96:99], v[80:83], v[0:3]
    s_add_u32 m0, s33, 98304
    ds_read_b128 v[112:115], v199 offset:1024
    ds_read_b128 v[116:119], v199 offset:3072
    v_mfma_f32_16x16x32_bf16 v[16:19], v[96:99], v[84:87], v[16:19]
    s_add_u32 s48, s46, 3
    v_mfma_f32_16x16x32_bf16 v[32:35], v[96:99], v[88:91], v[32:35]
    s_and_b32 s48, s48, 7
    ds_read_b128 v[120:123], v199 offset:5120
    ds_read_b128 v[124:127], v199 offset:7168
    v_mfma_f32_16x16x32_bf16 v[48:51], v[96:99], v[92:95], v[48:51]
    s_or_b32 s48, s48, s47
    v_mfma_f32_16x16x32_bf16 v[52:55], v[100:103], v[92:95], v[52:55]
    s_lshl_b32 s53, s48, 11
    ds_read_b64_tr_b16 v[128:129], v144 offset:8192
    ds_read_b64_tr_b16 v[130:131], v144 offset:12288
    v_mfma_f32_16x16x32_bf16 v[36:39], v[100:103], v[88:91], v[36:39]
    s_add_u32 s31, s49, s53
    v_mfma_f32_16x16x32_bf16 v[20:23], v[100:103], v[84:87], v[20:23]
    ds_read_b64_tr_b16 v[132:133], v145 offset:8192
    ds_read_b64_tr_b16 v[134:135], v145 offset:12288
    v_mfma_f32_16x16x32_bf16 v[4:7], v[100:103], v[80:83], v[4:7]
    s_waitcnt lgkmcnt(8)
    v_mfma_f32_16x16x32_bf16 v[8:11], v[104:107], v[80:83], v[8:11]
    ds_read_b64_tr_b16 v[136:137], v146 offset:8192
    ds_read_b64_tr_b16 v[138:139], v146 offset:12288
    v_mfma_f32_16x16x32_bf16 v[24:27], v[104:107], v[84:87], v[24:27]
    buffer_load_dwordx4 v192, s[12:15], s31 offen offset:0 sc1 lds
    v_mfma_f32_16x16x32_bf16 v[40:43], v[104:107], v[88:91], v[40:43]
    ds_read_b64_tr_b16 v[140:141], v147 offset:8192
    ds_read_b64_tr_b16 v[142:143], v147 offset:12288
    v_mfma_f32_16x16x32_bf16 v[56:59], v[104:107], v[92:95], v[56:59]
    buffer_load_dwordx4 v192, s[12:15], s31 offen offset:1024 sc1 lds
    v_mfma_f32_16x16x32_bf16 v[60:63], v[108:111], v[92:95], v[60:63]
    buffer_load_dwordx4 v193, s[12:15], s31 offen offset:2048 sc1 lds
    v_mfma_f32_16x16x32_bf16 v[44:47], v[108:111], v[88:91], v[44:47]
    v_mfma_f32_16x16x32_bf16 v[28:31], v[108:111], v[84:87], v[28:31]
    buffer_load_dwordx4 v193, s[12:15], s31 offen offset:3072 sc1 lds
    v_mfma_f32_16x16x32_bf16 v[12:15], v[108:111], v[80:83], v[12:15]
    s_waitcnt lgkmcnt(4)
    s_waitcnt vmcnt(12)
    v_cmp_gt_u32 vcc, v210, v209
    s_nop 1
    s_cbranch_vccnz K3_sp_61
K3_ok_60:
    v_mfma_f32_16x16x32_bf16 v[0:3], v[128:131], v[112:115], v[0:3]
    s_add_u32 m0, s33, 114688
    s_waitcnt vmcnt(12) lgkmcnt(0)
    s_barrier
    v_mfma_f32_16x16x32_bf16 v[16:19], v[128:131], v[116:119], v[16:19]
    s_lshl_b32 s53, s48, 16
    v_mfma_f32_16x16x32_bf16 v[32:35], v[128:131], v[120:123], v[32:35]
    s_add_u32 s32, s52, s53
    ds_read_b128 v[80:83], v199 offset:32768
    ds_read_b128 v[84:87], v199 offset:34816
    v_mfma_f32_16x16x32_bf16 v[48:51], v[128:131], v[124:127], v[48:51]
    v_mfma_f32_16x16x32_bf16 v[52:55], v[132:135], v[124:127], v[52:55]
    ds_read_b128 v[88:91], v199 offset:36864
    ds_read_b128 v[92:95], v199 offset:38912
    v_mfma_f32_16x16x32_bf16 v[36:39], v[132:135], v[120:123], v[36:39]
    buffer_load_dwordx4 v201, s[4:7], s32 offen offset:0 lds
    v_mfma_f32_16x16x32_bf16 v[20:23], v[132:135], v[116:119], v[20:23]
    ds_read_b64_tr_b16 v[96:97], v144 offset:32768
    ds_read_b64_tr_b16 v[98:99], v144 offset:36864
    v_mfma_f32_16x16x32_bf16 v[4:7], v[132:135], v[112:115], v[4:7]
    s_waitcnt lgkmcnt(6)
    v_mfma_f32_16x16x32_bf16 v[8:11], v[136:139], v[112:115], v[8:11]
    ds_read_b64_tr_b16 v[100:101], v145 offset:32768
    ds_read_b64_tr_b16 v[102:103], v145 offset:36864
    v_mfma_f32_16x16x32_bf16 v[24:27], v[136:139], v[116:119], v[24:27]
    buffer_load_dwordx4 v202, s[4:7], s32 offen offset:1024 lds
    v_mfma_f32_16x16x32_bf16 v[40:43], v[136:139], v[120:123], v[40:43]
    ds_read_b64_tr_b16 v[104:105], v146 offset:32768
    ds_read_b64_tr_b16 v[106:107], v146 offset:36864
    v_mfma_f32_16x16x32_bf16 v[56:59], v[136:139], v[124:127], v[56:59]
    buffer_load_dwordx4 v203, s[4:7], s32 offen offset:2048 lds
    v_mfma_f32_16x16x32_bf16 v[60:63], v[140:143], v[124:127], v[60:63]
    ds_read_b64_tr_b16 v[108:109], v147 offset:32768
    ds_read_b64_tr_b16 v[110:111], v147 offset:36864
    v_mfma_f32_16x16x32_bf16 v[44:47], v[140:143], v[120:123], v[44:47]
    buffer_load_dwordx4 v204, s[4:7], s32 offen offset:3072 lds
    v_mfma_f32_16x16x32_bf16 v[28:31], v[140:143], v[116:119], v[28:31]
    s_add_u32 m0, s33, 131072
    s_nop 0
    v_mfma_f32_16x16x32_bf16 v[12:15], v[140:143], v[112:115], v[12:15]
    s_waitcnt lgkmcnt(4)
    v_mfma_f32_16x16x32_bf16 v[0:3], v[96:99], v[80:83], v[0:3]
    ds_read_b128 v[112:115], v199 offset:33792
    ds_read_b128 v[116:119], v199 offset:35840
    v_mfma_f32_16x16x32_bf16 v[16:19], v[96:99], v[84:87], v[16:19]
    buffer_load_dwordx4 v191, s[12:15], s39 offen offset:0 sc1 lds
    v_mfma_f32_16x16x32_bf16 v[32:35], v[96:99], v[88:91], v[32:35]
    ds_read_b128 v[120:123], v199 offset:37888
    ds_read_b128 v[124:127], v199 offset:39936
    v_mfma_f32_16x16x32_bf16 v[48:51], v[96:99], v[92:95], v[48:51]
    buffer_load_dwordx4 v191, s[12:15], s39 offen offset:1024 sc1 lds
    v_mfma_f32_16x16x32_bf16 v[52:55], v[100:103], v[92:95], v[52:55]
    ds_read_b64_tr_b16 v[128:129], v144 offset:40960
    ds_read_b64_tr_b16 v[130:131], v144 offset:45056
    v_mfma_f32_16x16x32_bf16 v[36:39], v[100:103], v[88:91], v[36:39]
    buffer_load_dwordx4 v191, s[12:15], s39 offen offset:2048 sc1 lds
    v_mfma_f32_16x16x32_bf16 v[20:23], v[100:103], v[84:87], v[20:23]
    ds_read_b64_tr_b16 v[132:133], v145 offset:40960
    ds_read_b64_tr_b16 v[134:135], v145 offset:45056
    v_mfma_f32_16x16x32_bf16 v[4:7], v[100:103], v[80:83], v[4:7]
    s_waitcnt lgkmcnt(8)
    v_mfma_f32_16x16x32_bf16 v[8:11], v[104:107], v[80:83], v[8:11]
    ds_read_b64_tr_b16 v[136:137], v146 offset:40960
    ds_read_b64_tr_b16 v[138:139], v146 offset:45056
    v_mfma_f32_16x16x32_bf16 v[24:27], v[104:107], v[84:87], v[24:27]
    buffer_load_dwordx4 v191, s[12:15], s39 offen offset:3072 sc1 lds
    v_mfma_f32_16x16x32_bf16 v[40:43], v[104:107], v[88:91], v[40:43]
    s_add_u32 m0, s33, 147456
    ds_read_b64_tr_b16 v[140:141], v147 offset:40960
    ds_read_b64_tr_b16 v[142:143], v147 offset:45056
    v_mfma_f32_16x16x32_bf16 v[56:59], v[104:107], v[92:95], v[56:59]
    s_add_u32 s39, s39, 4096
    v_mfma_f32_16x16x32_bf16 v[60:63], v[108:111], v[92:95], v[60:63]
    buffer_load_dwordx4 v152, s[8:11], s40 offen offset:0 lds
    v_mfma_f32_16x16x32_bf16 v[44:47], v[108:111], v[88:91], v[44:47]
    buffer_load_dwordx4 v153, s[8:11], s40 offen offset:1024 lds
    v_mfma_f32_16x16x32_bf16 v[28:31], v[108:111], v[84:87], v[28:31]
    v_mfma_f32_16x16x32_bf16 v[12:15], v[108:111], v[80:83], v[12:15]
    s_waitcnt lgkmcnt(4)
    v_mfma_f32_16x16x32_bf16 v[0:3], v[128:131], v[112:115], v[0:3]
    s_waitcnt vmcnt(14) lgkmcnt(0)
    s_barrier
    v_mfma_f32_16x16x32_bf16 v[16:19], v[128:131], v[116:119], v[16:19]
    buffer_load_dwordx4 v154, s[8:11], s40 offen offset:2048 lds
    v_mfma_f32_16x16x32_bf16 v[32:35], v[128:131], v[120:123], v[32:35]
    ds_read_b128 v[80:83], v200 offset:0
    ds_read_b128 v[84:87], v200 offset:2048
    v_mfma_f32_16x16x32_bf16 v[48:51], v[128:131], v[124:127], v[48:51]
    buffer_load_dwordx4 v155, s[8:11], s40 offen offset:3072 lds
    v_mfma_f32_16x16x32_bf16 v[52:55], v[132:135], v[124:127], v[52:55]
    s_add_u32 s40, s40, 0x20000
    ds_read_b128 v[88:91], v200 offset:4096
    ds_read_b128 v[92:95], v200 offset:6144
    v_mfma_f32_16x16x32_bf16 v[36:39], v[132:135], v[120:123], v[36:39]
    s_add_u32 m0, s33, 0
    v_mfma_f32_16x16x32_bf16 v[20:23], v[132:135], v[116:119], v[20:23]
    s_nop 0
    ds_read_b64_tr_b16 v[96:97], v148 offset:0
    ds_read_b64_tr_b16 v[98:99], v148 offset:4096
    v_mfma_f32_16x16x32_bf16 v[4:7], v[132:135], v[112:115], v[4:7]
    s_waitcnt lgkmcnt(6)
    v_mfma_f32_16x16x32_bf16 v[8:11], v[136:139], v[112:115], v[8:11]
    ds_read_b64_tr_b16 v[100:101], v149 offset:0
    ds_read_b64_tr_b16 v[102:103], v149 offset:4096
    v_mfma_f32_16x16x32_bf16 v[24:27], v[136:139], v[116:119], v[24:27]
    buffer_load_dwordx4 v191, s[12:15], s39 offen offset:0 sc1 lds
    v_mfma_f32_16x16x32_bf16 v[40:43], v[136:139], v[120:123], v[40:43]
    ds_read_b64_tr_b16 v[104:105], v150 offset:0
    ds_read_b64_tr_b16 v[106:107], v150 offset:4096
    v_mfma_f32_16x16x32_bf16 v[56:59], v[136:139], v[124:127], v[56:59]
    buffer_load_dwordx4 v191, s[12:15], s39 offen offset:1024 sc1 lds
    v_mfma_f32_16x16x32_bf16 v[60:63], v[140:143], v[124:127], v[60:63]
    ds_read_b64_tr_b16 v[108:109], v151 offset:0
    ds_read_b64_tr_b16 v[110:111], v151 offset:4096
    v_mfma_f32_16x16x32_bf16 v[44:47], v[140:143], v[120:123], v[44:47]
    buffer_load_dwordx4 v191, s[12:15], s39 offen offset:2048 sc1 lds
    v_mfma_f32_16x16x32_bf16 v[28:31], v[140:143], v[116:119], v[28:31]
    buffer_load_dwordx4 v191, s[12:15], s39 offen offset:3072 sc1 lds
    v_mfma_f32_16x16x32_bf16 v[12:15], v[140:143], v[112:115], v[12:15]
    s_waitcnt lgkmcnt(4)
    v_mfma_f32_16x16x32_bf16 v[0:3], v[96:99], v[80:83], v[0:3]
    s_add_u32 m0, s33, 16384
    ds_read_b128 v[112:115], v200 offset:1024
    ds_read_b128 v[116:119], v200 offset:3072
    v_mfma_f32_16x16x32_bf16 v[16:19], v[96:99], v[84:87], v[16:19]
    s_add_u32 s39, s39, 4096
    v_mfma_f32_16x16x32_bf16 v[32:35], v[96:99], v[88:91], v[32:35]
    ds_read_b128 v[120:123], v200 offset:5120
    ds_read_b128 v[124:127], v200 offset:7168
    v_mfma_f32_16x16x32_bf16 v[48:51], v[96:99], v[92:95], v[48:51]
    buffer_load_dwordx4 v152, s[8:11], s40 offen offset:0 lds
    v_mfma_f32_16x16x32_bf16 v[52:55], v[100:103], v[92:95], v[52:55]
    ds_read_b64_tr_b16 v[128:129], v148 offset:8192
    ds_read_b64_tr_b16 v[130:131], v148 offset:12288
    v_mfma_f32_16x16x32_bf16 v[36:39], v[100:103], v[88:91], v[36:39]
    buffer_load_dwordx4 v153, s[8:11], s40 offen offset:1024 lds
    v_mfma_f32_16x16x32_bf16 v[20:23], v[100:103], v[84:87], v[20:23]
    ds_read_b64_tr_b16 v[132:133], v149 offset:8192
    ds_read_b64_tr_b16 v[134:135], v149 offset:12288
    v_mfma_f32_16x16x32_bf16 v[4:7], v[100:103], v[80:83], v[4:7]
    s_waitcnt lgkmcnt(8)
    v_mfma_f32_16x16x32_bf16 v[8:11], v[104:107], v[80:83], v[8:11]
    ds_read_b64_tr_b16 v[136:137], v150 offset:8192
    ds_read_b64_tr_b16 v[138:139], v150 offset:12288
    v_mfma_f32_16x16x32_bf16 v[24:27], v[104:107], v[84:87], v[24:27]
    buffer_load_dwordx4 v154, s[8:11], s40 offen offset:2048 lds
    v_mfma_f32_16x16x32_bf16 v[40:43], v[104:107], v[88:91], v[40:43]
    ds_read_b64_tr_b16 v[140:141], v151 offset:8192
    ds_read_b64_tr_b16 v[142:143], v151 offset:12288
    v_mfma_f32_16x16x32_bf16 v[56:59], v[104:107], v[92:95], v[56:59]
    buffer_load_dwordx4 v155, s[8:11], s40 offen offset:3072 lds
    v_mfma_f32_16x16x32_bf16 v[60:63], v[108:111], v[92:95], v[60:63]
    s_add_u32 s40, s40, 0x20000
    s_add_u32 m0, s33, 32768
    s_nop 0
    v_mfma_f32_16x16x32_bf16 v[44:47], v[108:111], v[88:91], v[44:47]
    buffer_load_dwordx4 v191, s[12:15], s39 offen offset:0 sc1 lds
    v_mfma_f32_16x16x32_bf16 v[28:31], v[108:111], v[84:87], v[28:31]
    v_mfma_f32_16x16x32_bf16 v[12:15], v[108:111], v[80:83], v[12:15]
    s_waitcnt lgkmcnt(4)
    v_mfma_f32_16x16x32_bf16 v[0:3], v[128:131], v[112:115], v[0:3]
    s_waitcnt vmcnt(17) lgkmcnt(0)
    s_barrier
    v_mfma_f32_16x16x32_bf16 v[16:19], v[128:131], v[116:119], v[16:19]
    buffer_load_dwordx4 v191, s[12:15], s39 offen offset:1024 sc1 lds
    v_mfma_f32_16x16x32_bf16 v[32:35], v[128:131], v[120:123], v[32:35]
    ds_read_b128 v[80:83], v200 offset:32768
    ds_read_b128 v[84:87], v200 offset:34816
    v_mfma_f32_16x16x32_bf16 v[48:51], v[128:131], v[124:127], v[48:51]
    buffer_load_dwordx4 v191, s[12:15], s39 offen offset:2048 sc1 lds
    v_mfma_f32_16x16x32_bf16 v[52:55], v[132:135], v[124:127], v[52:55]
    ds_read_b128 v[88:91], v200 offset:36864
    ds_read_b128 v[92:95], v200 offset:38912
    v_mfma_f32_16x16x32_bf16 v[36:39], v[132:135], v[120:123], v[36:39]
    buffer_load_dwordx4 v191, s[12:15], s39 offen offset:3072 sc1 lds
    v_mfma_f32_16x16x32_bf16 v[20:23], v[132:135], v[116:119], v[20:23]
    s_add_u32 m0, s33, 49152
    ds_read_b64_tr_b16 v[96:97], v148 offset:32768
    ds_read_b64_tr_b16 v[98:99], v148 offset:36864
    v_mfma_f32_16x16x32_bf16 v[4:7], v[132:135], v[112:115], v[4:7]
    s_waitcnt lgkmcnt(6)
    s_add_u32 s39, s39, 4096
    v_mfma_f32_16x16x32_bf16 v[8:11], v[136:139], v[112:115], v[8:11]
    ds_read_b64_tr_b16 v[100:101], v149 offset:32768
    ds_read_b64_tr_b16 v[102:103], v149 offset:36864
    v_mfma_f32_16x16x32_bf16 v[24:27], v[136:139], v[116:119], v[24:27]
    buffer_load_dwordx4 v152, s[8:11], s40 offen offset:0 lds
    v_mfma_f32_16x16x32_bf16 v[40:43], v[136:139], v[120:123], v[40:43]
    ds_read_b64_tr_b16 v[104:105], v150 offset:32768
    ds_read_b64_tr_b16 v[106:107], v150 offset:36864
    v_mfma_f32_16x16x32_bf16 v[56:59], v[136:139], v[124:127], v[56:59]
    buffer_load_dwordx4 v153, s[8:11], s40 offen offset:1024 lds
    v_mfma_f32_16x16x32_bf16 v[60:63], v[140:143], v[124:127], v[60:63]
    ds_read_b64_tr_b16 v[108:109], v151 offset:32768
    ds_read_b64_tr_b16 v[110:111], v151 offset:36864
    v_mfma_f32_16x16x32_bf16 v[44:47], v[140:143], v[120:123], v[44:47]
    buffer_load_dwordx4 v154, s[8:11], s40 offen offset:2048 lds
    v_mfma_f32_16x16x32_bf16 v[28:31], v[140:143], v[116:119], v[28:31]
    buffer_load_dwordx4 v155, s[8:11], s40 offen offset:3072 lds
    v_mfma_f32_16x16x32_bf16 v[12:15], v[140:143], v[112:115], v[12:15]
    s_add_u32 s40, s40, 0x20000
    s_waitcnt lgkmcnt(4)
    v_mfma_f32_16x16x32_bf16 v[0:3], v[96:99], v[80:83], v[0:3]
    s_add_u32 m0, s33, 65536
    ds_read_b128 v[112:115], v200 offset:33792
    ds_read_b128 v[116:119], v200 offset:35840
    v_mfma_f32_16x16x32_bf16 v[16:19], v[96:99], v[84:87], v[16:19]
    s_nop 0
    ds_read_b128 v[120:123], v200 offset:37888
    ds_read_b128 v[124:127], v200 offset:39936
    v_mfma_f32_16x16x32_bf16 v[32:35], v[96:99], v[88:91], v[32:35]
    ds_read_b64_tr_b16 v[128:129], v148 offset:40960
    ds_read_b64_tr_b16 v[130:131], v148 offset:45056
    v_mfma_f32_16x16x32_bf16 v[48:51], v[96:99], v[92:95], v[48:51]
    ds_read_b64_tr_b16 v[132:133], v149 offset:40960
    ds_read_b64_tr_b16 v[134:135], v149 offset:45056
    v_mfma_f32_16x16x32_bf16 v[52:55], v[100:103], v[92:95], v[52:55]
    ds_read_b64_tr_b16 v[136:137], v150 offset:40960
    ds_read_b64_tr_b16 v[138:139], v150 offset:45056
    v_mfma_f32_16x16x32_bf16 v[36:39], v[100:103], v[88:91], v[36:39]
    ds_read_b64_tr_b16 v[140:141], v151 offset:40960
    ds_read_b64_tr_b16 v[142:143], v151 offset:45056
    v_mfma_f32_16x16x32_bf16 v[20:23], v[100:103], v[84:87], v[20:23]
    buffer_load_dwordx4 v191, s[12:15], s39 offen offset:0 sc1 lds
    v_mfma_f32_16x16x32_bf16 v[4:7], v[100:103], v[80:83], v[4:7]
    s_waitcnt lgkmcnt(12)
    v_mfma_f32_16x16x32_bf16 v[8:11], v[104:107], v[80:83], v[8:11]
    buffer_load_dwordx4 v191, s[12:15], s39 offen offset:1024 sc1 lds
    v_mfma_f32_16x16x32_bf16 v[24:27], v[104:107], v[84:87], v[24:27]
    buffer_load_dwordx4 v191, s[12:15], s39 offen offset:2048 sc1 lds
    v_mfma_f32_16x16x32_bf16 v[40:43], v[104:107], v[88:91], v[40:43]
    buffer_load_dwordx4 v191, s[12:15], s39 offen offset:3072 sc1 lds
    v_mfma_f32_16x16x32_bf16 v[56:59], v[104:107], v[92:95], v[56:59]
    v_mfma_f32_16x16x32_bf16 v[60:63], v[108:111], v[92:95], v[60:63]
    s_add_u32 m0, s33, 81920
    v_mfma_f32_16x16x32_bf16 v[44:47], v[108:111], v[88:91], v[44:47]
    s_add_u32 s39, s39, 4096
    v_mfma_f32_16x16x32_bf16 v[28:31], v[108:111], v[84:87], v[28:31]
    buffer_load_dwordx4 v152, s[8:11], s40 offen offset:0 lds
    v_mfma_f32_16x16x32_bf16 v[12:15], v[108:111], v[80:83], v[12:15]
    s_waitcnt lgkmcnt(0)
    v_mfma_f32_16x16x32_bf16 v[16:19], v[128:131], v[116:119], v[16:19]
    v_mfma_f32_16x16x32_bf16 v[20:23], v[132:135], v[116:119], v[20:23]
    buffer_load_dwordx4 v153, s[8:11], s40 offen offset:1024 lds
    v_mfma_f32_16x16x32_bf16 v[24:27], v[136:139], v[116:119], v[24:27]
    v_mfma_f32_16x16x32_bf16 v[28:31], v[140:143], v[116:119], v[28:31]
    buffer_load_dwordx4 v154, s[8:11], s40 offen offset:2048 lds
    v_mfma_f32_16x16x32_bf16 v[32:35], v[128:131], v[120:123], v[32:35]
    v_mfma_f32_16x16x32_bf16 v[36:39], v[132:135], v[120:123], v[36:39]
    v_mfma_f32_16x16x32_bf16 v[40:43], v[136:139], v[120:123], v[40:43]
    buffer_load_dwordx4 v155, s[8:11], s40 offen offset:3072 lds
    v_mfma_f32_16x16x32_bf16 v[44:47], v[140:143], v[120:123], v[44:47]
    v_mfma_f32_16x16x32_bf16 v[48:51], v[128:131], v[124:127], v[48:51]
    s_add_u32 s40, s40, 0x20000
    v_mfma_f32_16x16x32_bf16 v[52:55], v[132:135], v[124:127], v[52:55]
    v_mfma_f32_16x16x32_bf16 v[56:59], v[136:139], v[124:127], v[56:59]
    v_mfma_f32_16x16x32_bf16 v[60:63], v[140:143], v[124:127], v[60:63]
    v_cvt_pk_bf16_f32 v16, v16, v17
    v_cvt_pk_bf16_f32 v17, v18, v19
    v_mfma_f32_16x16x32_bf16 v[0:3], v[128:131], v[112:115], v[0:3]
    v_cvt_pk_bf16_f32 v18, v20, v21
    v_cvt_pk_bf16_f32 v19, v22, v23
    v_mfma_f32_16x16x32_bf16 v[4:7], v[132:135], v[112:115], v[4:7]
    buffer_store_dwordx4 v[16:19], v191, s[12:15], s35 offen offset:0 sc1
    v_mfma_f32_16x16x32_bf16 v[8:11], v[136:139], v[112:115], v[8:11]
    v_cvt_pk_bf16_f32 v20, v24, v25
    v_cvt_pk_bf16_f32 v21, v26, v27
    v_mfma_f32_16x16x32_bf16 v[12:15], v[140:143], v[112:115], v[12:15]
    v_cvt_pk_bf16_f32 v22, v28, v29
    v_cvt_pk_bf16_f32 v23, v30, v31
    buffer_store_dwordx4 v[20:23], v191, s[12:15], s35 offen offset:1024 sc1
    s_waitcnt vmcnt(10)
    s_barrier
    v_cvt_pk_bf16_f32 v32, v32, v33
    v_cvt_pk_bf16_f32 v33, v34, v35
    v_cvt_pk_bf16_f32 v34, v36, v37
    v_cvt_pk_bf16_f32 v35, v38, v39
    buffer_store_dwordx4 v[32:35], v191, s[12:15], s35 offen offset:2048 sc1
    v_cvt_pk_bf16_f32 v36, v40, v41
    v_cvt_pk_bf16_f32 v37, v42, v43
    v_cvt_pk_bf16_f32 v38, v44, v45
    v_cvt_pk_bf16_f32 v39, v46, v47
    buffer_store_dwordx4 v[36:39], v191, s[12:15], s35 offen offset:3072 sc1
    s_add_u32 s35, s35, 4096
    v_cvt_pk_bf16_f32 v48, v48, v49
    v_cvt_pk_bf16_f32 v49, v50, v51
    v_cvt_pk_bf16_f32 v50, v52, v53
    v_cvt_pk_bf16_f32 v51, v54, v55
    buffer_store_dwordx4 v[48:51], v191, s[12:15], s35 offen offset:0 sc1
    v_cvt_pk_bf16_f32 v52, v56, v57
    v_cvt_pk_bf16_f32 v53, v58, v59
    v_cvt_pk_bf16_f32 v54, v60, v61
    v_cvt_pk_bf16_f32 v55, v62, v63
    buffer_store_dwordx4 v[52:55], v191, s[12:15], s35 offen offset:1024 sc1
    ds_read_b128 v[80:83], v158 offset:0
    ds_read_b128 v[84:87], v158 offset:4096
    ds_read_b64_tr_b16 v[88:89], v163 offset:0
    ds_read_b64_tr_b16 v[90:91], v163 offset:2048
    ds_read_b64_tr_b16 v[92:93], v164 offset:0
    ds_read_b64_tr_b16 v[94:95], v164 offset:2048
    ds_read_b128 v[96:99], v158 offset:1024
    ds_read_b128 v[100:103], v158 offset:5120
    ds_read_b64_tr_b16 v[104:105], v163 offset:4096
    ds_read_b64_tr_b16 v[106:107], v163 offset:6144
    ds_read_b64_tr_b16 v[108:109], v164 offset:4096
    ds_read_b64_tr_b16 v[110:111], v164 offset:6144
    s_waitcnt lgkmcnt(6)
    v_mfma_f32_16x16x32_bf16 v[64:67], v[88:91], v[80:83], v[64:67]
    ds_read_b128 v[112:115], v158 offset:2048
    ds_read_b128 v[116:119], v158 offset:6144
    v_mfma_f32_16x16x32_bf16 v[68:71], v[88:91], v[84:87], v[68:71]
    ds_read_b64_tr_b16 v[120:121], v163 offset:8192
    ds_read_b64_tr_b16 v[122:123], v163 offset:10240
    v_mfma_f32_16x16x32_bf16 v[72:75], v[92:95], v[80:83], v[72:75]
    ds_read_b64_tr_b16 v[124:125], v164 offset:8192
    ds_read_b64_tr_b16 v[126:127], v164 offset:10240
    v_mfma_f32_16x16x32_bf16 v[76:79], v[92:95], v[84:87], v[76:79]
    s_waitcnt lgkmcnt(6)
    v_mfma_f32_16x16x32_bf16 v[64:67], v[104:107], v[96:99], v[64:67]
    ds_read_b128 v[128:131], v158 offset:3072
    ds_read_b128 v[132:135], v158 offset:7168
    v_mfma_f32_16x16x32_bf16 v[68:71], v[104:107], v[100:103], v[68:71]
    ds_read_b64_tr_b16 v[136:137], v163 offset:12288
    ds_read_b64_tr_b16 v[138:139], v163 offset:14336
    v_mfma_f32_16x16x32_bf16 v[72:75], v[108:111], v[96:99], v[72:75]
    ds_read_b64_tr_b16 v[140:141], v164 offset:12288
    ds_read_b64_tr_b16 v[142:143], v164 offset:14336
    v_mfma_f32_16x16x32_bf16 v[76:79], v[108:111], v[100:103], v[76:79]
    s_waitcnt lgkmcnt(6)
    v_mfma_f32_16x16x32_bf16 v[64:67], v[120:123], v[112:115], v[64:67]
    ds_read_b128 v[80:83], v156 offset:0
    ds_read_b128 v[84:87], v156 offset:4096
    v_mfma_f32_16x16x32_bf16 v[68:71], v[120:123], v[116:119], v[68:71]
    ds_read_b64_tr_b16 v[88:89], v159 offset:0
    ds_read_b64_tr_b16 v[90:91], v159 offset:2048
    v_mfma_f32_16x16x32_bf16 v[72:75], v[124:127], v[112:115], v[72:75]
    ds_read_b64_tr_b16 v[92:93], v160 offset:0
    ds_read_b64_tr_b16 v[94:95], v160 offset:2048
    v_mfma_f32_16x16x32_bf16 v[76:79], v[124:127], v[116:119], v[76:79]
    s_waitcnt lgkmcnt(6)
    v_mfma_f32_16x16x32_bf16 v[64:67], v[136:139], v[128:131], v[64:67]
    ds_read_b128 v[96:99], v156 offset:1024
    ds_read_b128 v[100:103], v156 offset:5120
    v_mfma_f32_16x16x32_bf16 v[68:71], v[136:139], v[132:135], v[68:71]
    ds_read_b64_tr_b16 v[104:105], v159 offset:4096
    ds_read_b64_tr_b16 v[106:107], v159 offset:6144
    v_mfma_f32_16x16x32_bf16 v[72:75], v[140:143], v[128:131], v[72:75]
    ds_read_b64_tr_b16 v[108:109], v160 offset:4096
    ds_read_b64_tr_b16 v[110:111], v160 offset:6144
    v_mfma_f32_16x16x32_bf16 v[76:79], v[140:143], v[132:135], v[76:79]
    s_waitcnt lgkmcnt(6)
    v_mfma_f32_16x16x32_bf16 v[64:67], v[88:91], v[80:83], v[64:67]
    ds_read_b128 v[112:115], v156 offset:2048
    ds_read_b128 v[116:119], v156 offset:6144
    v_mfma_f32_16x16x32_bf16 v[68:71], v[88:91], v[84:87], v[68:71]
    ds_read_b64_tr_b16 v[120:121], v159 offset:8192
    ds_read_b64_tr_b16 v[122:123], v159 offset:10240
    v_mfma_f32_16x16x32_bf16 v[72:75], v[92:95], v[80:83], v[72:75]
    ds_read_b64_tr_b16 v[124:125], v160 offset:8192
    ds_read_b64_tr_b16 v[126:127], v160 offset:10240
    v_mfma_f32_16x16x32_bf16 v[76:79], v[92:95], v[84:87], v[76:79]
    s_waitcnt lgkmcnt(6)
    v_mfma_f32_16x16x32_bf16 v[64:67], v[104:107], v[96:99], v[64:67]
    ds_read_b128 v[128:131], v156 offset:3072
    ds_read_b128 v[132:135], v156 offset:7168
    v_mfma_f32_16x16x32_bf16 v[68:71], v[104:107], v[100:103], v[68:71]
    ds_read_b64_tr_b16 v[136:137], v159 offset:12288
    ds_read_b64_tr_b16 v[138:139], v159 offset:14336
    v_mfma_f32_16x16x32_bf16 v[72:75], v[108:111], v[96:99], v[72:75]
    ds_read_b64_tr_b16 v[140:141], v160 offset:12288
    ds_read_b64_tr_b16 v[142:143], v160 offset:14336
    v_mfma_f32_16x16x32_bf16 v[76:79], v[108:111], v[100:103], v[76:79]
    s_waitcnt lgkmcnt(6)
    v_mfma_f32_16x16x32_bf16 v[64:67], v[120:123], v[112:115], v[64:67]
    ds_read_b128 v[80:83], v156 offset:32768
    ds_read_b128 v[84:87], v156 offset:36864
    v_mfma_f32_16x16x32_bf16 v[68:71], v[120:123], v[116:119], v[68:71]
    ds_read_b64_tr_b16 v[88:89], v159 offset:32768
    ds_read_b64_tr_b16 v[90:91], v159 offset:34816
    v_mfma_f32_16x16x32_bf16 v[72:75], v[124:127], v[112:115], v[72:75]
    ds_read_b64_tr_b16 v[92:93], v160 offset:32768
    ds_read_b64_tr_b16 v[94:95], v160 offset:34816
    v_mfma_f32_16x16x32_bf16 v[76:79], v[124:127], v[116:119], v[76:79]
    s_waitcnt lgkmcnt(6)
    v_mfma_f32_16x16x32_bf16 v[64:67], v[136:139], v[128:131], v[64:67]
    ds_read_b128 v[96:99], v156 offset:33792
    ds_read_b128 v[100:103], v156 offset:37888
    v_mfma_f32_16x16x32_bf16 v[68:71], v[136:139], v[132:135], v[68:71]
    ds_read_b64_tr_b16 v[104:105], v159 offset:36864
    ds_read_b64_tr_b16 v[106:107], v159 offset:38912
    v_mfma_f32_16x16x32_bf16 v[72:75], v[140:143], v[128:131], v[72:75]
    ds_read_b64_tr_b16 v[108:109], v160 offset:36864
    ds_read_b64_tr_b16 v[110:111], v160 offset:38912
    v_mfma_f32_16x16x32_bf16 v[76:79], v[140:143], v[132:135], v[76:79]
    s_waitcnt lgkmcnt(6)
    v_mfma_f32_16x16x32_bf16 v[64:67], v[88:91], v[80:83], v[64:67]
    ds_read_b128 v[112:115], v156 offset:34816
    ds_read_b128 v[116:119], v156 offset:38912
    v_mfma_f32_16x16x32_bf16 v[68:71], v[88:91], v[84:87], v[68:71]
    ds_read_b64_tr_b16 v[120:121], v159 offset:40960
    ds_read_b64_tr_b16 v[122:123], v159 offset:43008
    v_mfma_f32_16x16x32_bf16 v[72:75], v[92:95], v[80:83], v[72:75]
    ds_read_b64_tr_b16 v[124:125], v160 offset:40960
    ds_read_b64_tr_b16 v[126:127], v160 offset:43008
    v_mfma_f32_16x16x32_bf16 v[76:79], v[92:95], v[84:87], v[76:79]
    s_waitcnt lgkmcnt(6)
    v_mfma_f32_16x16x32_bf16 v[64:67], v[104:107], v[96:99], v[64:67]
    ds_read_b128 v[128:131], v156 offset:35840
    ds_read_b128 v[132:135], v156 offset:39936
    v_mfma_f32_16x16x32_bf16 v[68:71], v[104:107], v[100:103], v[68:71]
    ds_read_b64_tr_b16 v[136:137], v159 offset:45056
    ds_read_b64_tr_b16 v[138:139], v159 offset:47104
    v_mfma_f32_16x16x32_bf16 v[72:75], v[108:111], v[96:99], v[72:75]
    ds_read_b64_tr_b16 v[140:141], v160 offset:45056
    ds_read_b64_tr_b16 v[142:143], v160 offset:47104
    v_mfma_f32_16x16x32_bf16 v[76:79], v[108:111], v[100:103], v[76:79]
    s_waitcnt lgkmcnt(6)
    s_waitcnt vmcnt(6)
    s_barrier
    v_mfma_f32_16x16x32_bf16 v[64:67], v[120:123], v[112:115], v[64:67]
    ds_read_b128 v[80:83], v157 offset:0
    ds_read_b128 v[84:87], v157 offset:4096
    v_mfma_f32_16x16x32_bf16 v[68:71], v[120:123], v[116:119], v[68:71]
    ds_read_b64_tr_b16 v[88:89], v161 offset:0
    ds_read_b64_tr_b16 v[90:91], v161 offset:2048
    v_mfma_f32_16x16x32_bf16 v[72:75], v[124:127], v[112:115], v[72:75]
    ds_read_b64_tr_b16 v[92:93], v162 offset:0
    ds_read_b64_tr_b16 v[94:95], v162 offset:2048
    v_mfma_f32_16x16x32_bf16 v[76:79], v[124:127], v[116:119], v[76:79]
    s_waitcnt lgkmcnt(6)
    v_mfma_f32_16x16x32_bf16 v[64:67], v[136:139], v[128:131], v[64:67]
    ds_read_b128 v[96:99], v157 offset:1024
    ds_read_b128 v[100:103], v157 offset:5120
    v_mfma_f32_16x16x32_bf16 v[68:71], v[136:139], v[132:135], v[68:71]
    ds_read_b64_tr_b16 v[104:105], v161 offset:4096
    ds_read_b64_tr_b16 v[106:107], v161 offset:6144
    v_mfma_f32_16x16x32_bf16 v[72:75], v[140:143], v[128:131], v[72:75]
    ds_read_b64_tr_b16 v[108:109], v162 offset:4096
    ds_read_b64_tr_b16 v[110:111], v162 offset:6144
    v_mfma_f32_16x16x32_bf16 v[76:79], v[140:143], v[132:135], v[76:79]
    s_waitcnt lgkmcnt(6)
    v_mfma_f32_16x16x32_bf16 v[64:67], v[88:91], v[80:83], v[64:67]
    ds_read_b128 v[112:115], v157 offset:2048
    ds_read_b128 v[116:119], v157 offset:6144
    buffer_load_dwordx4 v[166:169], v191, s[12:15], s41 offen offset:0 sc1
    v_mfma_f32_16x16x32_bf16 v[68:71], v[88:91], v[84:87], v[68:71]
    ds_read_b64_tr_b16 v[120:121], v161 offset:8192
    ds_read_b64_tr_b16 v[122:123], v161 offset:10240
    buffer_load_dwordx4 v[170:173], v191, s[12:15], s41 offen offset:1024 sc1
    v_mfma_f32_16x16x32_bf16 v[72:75], v[92:95], v[80:83], v[72:75]
    ds_read_b64_tr_b16 v[124:125], v162 offset:8192
    ds_read_b64_tr_b16 v[126:127], v162 offset:10240
    buffer_load_dwordx4 v[174:177], v191, s[12:15], s42 offen offset:0 sc1
    v_mfma_f32_16x16x32_bf16 v[76:79], v[92:95], v[84:87], v[76:79]
    s_waitcnt lgkmcnt(6)
    buffer_load_dwordx4 v[178:181], v191, s[12:15], s42 offen offset:1024 sc1
    v_mfma_f32_16x16x32_bf16 v[64:67], v[104:107], v[96:99], v[64:67]
    ds_read_b128 v[128:131], v157 offset:3072
    ds_read_b128 v[132:135], v157 offset:7168
    buffer_load_dwordx4 v[182:185], v191, s[12:15], s43 offen offset:0 sc1
    v_mfma_f32_16x16x32_bf16 v[68:71], v[104:107], v[100:103], v[68:71]
    ds_read_b64_tr_b16 v[136:137], v161 offset:12288
    ds_read_b64_tr_b16 v[138:139], v161 offset:14336
    buffer_load_dwordx4 v[186:189], v191, s[12:15], s43 offen offset:1024 sc1
    v_mfma_f32_16x16x32_bf16 v[72:75], v[108:111], v[96:99], v[72:75]
    ds_read_b64_tr_b16 v[140:141], v162 offset:12288
    ds_read_b64_tr_b16 v[142:143], v162 offset:14336
    v_mfma_f32_16x16x32_bf16 v[76:79], v[108:111], v[100:103], v[76:79]
    s_waitcnt lgkmcnt(6)
    v_mfma_f32_16x16x32_bf16 v[64:67], v[120:123], v[112:115], v[64:67]
    v_mfma_f32_16x16x32_bf16 v[68:71], v[120:123], v[116:119], v[68:71]
    v_mfma_f32_16x16x32_bf16 v[72:75], v[124:127], v[112:115], v[72:75]
    v_mfma_f32_16x16x32_bf16 v[76:79], v[124:127], v[116:119], v[76:79]
    s_waitcnt lgkmcnt(0)
    v_mfma_f32_16x16x32_bf16 v[64:67], v[136:139], v[128:131], v[64:67]
    v_mfma_f32_16x16x32_bf16 v[68:71], v[136:139], v[132:135], v[68:71]
    v_mfma_f32_16x16x32_bf16 v[72:75], v[140:143], v[128:131], v[72:75]
    v_mfma_f32_16x16x32_bf16 v[76:79], v[140:143], v[132:135], v[76:79]
    s_nop 7
    v_cvt_pk_bf16_f32 v64, v64, v65
    v_cvt_pk_bf16_f32 v65, v66, v67
    v_cvt_pk_bf16_f32 v68, v68, v69
    v_cvt_pk_bf16_f32 v69, v70, v71
    v_cvt_pk_bf16_f32 v72, v72, v73
    v_cvt_pk_bf16_f32 v73, v74, v75
    v_cvt_pk_bf16_f32 v76, v76, v77
    v_cvt_pk_bf16_f32 v77, v78, v79
    s_add_u32 s28, s36, 32768
    buffer_store_dwordx2 v[64:65], v198, s[16:19], s36 offen offset:1024
    buffer_store_dwordx2 v[68:69], v198, s[16:19], s28 offen offset:1024
    buffer_store_dwordx2 v[72:73], v198, s[16:19], s36 offen offset:1056
    buffer_store_dwordx2 v[76:77], v198, s[16:19], s28 offen offset:1056
    s_mov_b32 s30, 0x40000
    s_waitcnt vmcnt(4)
K3_poll_63:
    v_max3_u32 v195, v166, v167, v168
    v_max3_u32 v196, v169, v170, v171
    v_max3_u32 v195, v195, v172, v173
    v_max3_u32 v196, v196, v174, v175
    v_max3_u32 v195, v195, v176, v177
    v_max3_u32 v196, v196, v178, v179
    v_max3_u32 v195, v195, v180, v181
    v_max3_u32 v196, v196, v182, v183
    v_max3_u32 v195, v195, v184, v185
    v_max3_u32 v196, v196, v186, v187
    v_max3_u32 v195, v195, v188, v189
    v_max_u32 v195, v195, v196
    v_cmp_eq_u32 vcc, -1, v195
    s_sub_u32 s30, s30, 1
    s_cmp_eq_u32 s30, 0
    s_cbranch_scc1 K3_polled_64
    s_cbranch_vccz K3_polled_64
    s_sleep 4
    buffer_load_dwordx4 v[166:169], v191, s[12:15], s41 offen offset:0 sc1
    buffer_load_dwordx4 v[170:173], v191, s[12:15], s41 offen offset:1024 sc1
    buffer_load_dwordx4 v[174:177], v191, s[12:15], s42 offen offset:0 sc1
    buffer_load_dwordx4 v[178:181], v191, s[12:15], s42 offen offset:1024 sc1
    buffer_load_dwordx4 v[182:185], v191, s[12:15], s43 offen offset:0 sc1
    buffer_load_dwordx4 v[186:189], v191, s[12:15], s43 offen offset:1024 sc1
    s_waitcnt vmcnt(0)
    s_branch K3_poll_63
K3_polled_64:
    v_lshlrev_b32 v32, 16, v166
    v_and_b32 v33, 0xffff0000, v166
    v_lshlrev_b32 v34, 16, v167
    v_and_b32 v35, 0xffff0000, v167
    v_lshlrev_b32 v36, 16, v168
    v_and_b32 v37, 0xffff0000, v168
    v_lshlrev_b32 v38, 16, v169
    v_and_b32 v39, 0xffff0000, v169
    v_lshlrev_b32 v40, 16, v170
    v_and_b32 v41, 0xffff0000, v170
    v_lshlrev_b32 v42, 16, v171
    v_and_b32 v43, 0xffff0000, v171
    v_lshlrev_b32 v44, 16, v172
    v_and_b32 v45, 0xffff0000, v172
    v_lshlrev_b32 v46, 16, v173
    v_and_b32 v47, 0xffff0000, v173
    v_pk_add_f32 v[0:1], v[0:1], v[32:33]
    v_pk_add_f32 v[2:3], v[2:3], v[34:35]
    v_pk_add_f32 v[4:5], v[4:5], v[36:37]
    v_pk_add_f32 v[6:7], v[6:7], v[38:39]
    v_pk_add_f32 v[8:9], v[8:9], v[40:41]
    v_pk_add_f32 v[10:11], v[10:11], v[42:43]
    v_pk_add_f32 v[12:13], v[12:13], v[44:45]
    v_pk_add_f32 v[14:15], v[14:15], v[46:47]
    v_lshlrev_b32 v32, 16, v174
    v_and_b32 v33, 0xffff0000, v174
    v_lshlrev_b32 v34, 16, v175
    v_and_b32 v35, 0xffff0000, v175
    v_lshlrev_b32 v36, 16, v176
    v_and_b32 v37, 0xffff0000, v176
    v_lshlrev_b32 v38, 16, v177
    v_and_b32 v39, 0xffff0000, v177
    v_lshlrev_b32 v40, 16, v178
    v_and_b32 v41, 0xffff0000, v178
    v_lshlrev_b32 v42, 16, v179
    v_and_b32 v43, 0xffff0000, v179
    v_lshlrev_b32 v44, 16, v180
    v_and_b32 v45, 0xffff0000, v180
    v_lshlrev_b32 v46, 16, v181
    v_and_b32 v47, 0xffff0000, v181
    v_pk_add_f32 v[0:1], v[0:1], v[32:33]
    v_pk_add_f32 v[2:3], v[2:3], v[34:35]
    v_pk_add_f32 v[4:5], v[4:5], v[36:37]
    v_pk_add_f32 v[6:7], v[6:7], v[38:39]
    v_pk_add_f32 v[8:9], v[8:9], v[40:41]
    v_pk_add_f32 v[10:11], v[10:11], v[42:43]
    v_pk_add_f32 v[12:13], v[12:13], v[44:45]
    v_pk_add_f32 v[14:15], v[14:15], v[46:47]
    v_lshlrev_b32 v32, 16, v182
    v_and_b32 v33, 0xffff0000, v182
    v_lshlrev_b32 v34, 16, v183
    v_and_b32 v35, 0xffff0000, v183
    v_lshlrev_b32 v36, 16, v184
    v_and_b32 v37, 0xffff0000, v184
    v_lshlrev_b32 v38, 16, v185
    v_and_b32 v39, 0xffff0000, v185
    v_lshlrev_b32 v40, 16, v186
    v_and_b32 v41, 0xffff0000, v186
    v_lshlrev_b32 v42, 16, v187
    v_and_b32 v43, 0xffff0000, v187
    v_lshlrev_b32 v44, 16, v188
    v_and_b32 v45, 0xffff0000, v188
    v_lshlrev_b32 v46, 16, v189
    v_and_b32 v47, 0xffff0000, v189
    v_pk_add_f32 v[0:1], v[0:1], v[32:33]
    v_pk_add_f32 v[2:3], v[2:3], v[34:35]
    v_pk_add_f32 v[4:5], v[4:5], v[36:37]
    v_pk_add_f32 v[6:7], v[6:7], v[38:39]
    v_pk_add_f32 v[8:9], v[8:9], v[40:41]
    v_pk_add_f32 v[10:11], v[10:11], v[42:43]
    v_pk_add_f32 v[12:13], v[12:13], v[44:45]
    v_pk_add_f32 v[14:15], v[14:15], v[46:47]
    v_cvt_pk_bf16_f32 v0, v0, v1
    v_cvt_pk_bf16_f32 v1, v2, v3
    buffer_store_dwordx2 v[0:1], v198, s[16:19], s34 offen offset:0
    v_cvt_pk_bf16_f32 v4, v4, v5
    v_cvt_pk_bf16_f32 v5, v6, v7
    buffer_store_dwordx2 v[4:5], v198, s[16:19], s34 offen offset:32
    v_cvt_pk_bf16_f32 v8, v8, v9
    v_cvt_pk_bf16_f32 v9, v10, v11
    buffer_store_dwordx2 v[8:9], v198, s[16:19], s34 offen offset:64
    v_cvt_pk_bf16_f32 v12, v12, v13
    v_cvt_pk_bf16_f32 v13, v14, v15
    buffer_store_dwordx2 v[12:13], v198, s[16:19], s34 offen offset:96
    s_endpgm
K3_sp_54:
    s_mov_b32 s45, 0x40000
K3_spl_55:
    buffer_load_dword v209, v206, s[12:15], s44 offen sc1
    s_waitcnt vmcnt(0)
    v_cmp_gt_u32 vcc, v210, v209
    s_sub_u32 s45, s45, 1
    s_cmp_eq_u32 s45, 0
    s_cbranch_scc1 K3_ok_53
    s_cbranch_vccz K3_ok_53
    s_sleep 1
    s_branch K3_spl_55
K3_sp_58:
    s_mov_b32 s45, 0x40000
K3_spl_59:
    buffer_load_dword v209, v206, s[12:15], s44 offen sc1
    s_waitcnt vmcnt(0)
    v_cmp_gt_u32 vcc, v210, v209
    s_sub_u32 s45, s45, 1
    s_cmp_eq_u32 s45, 0
    s_cbranch_scc1 K3_ok_57
    s_cbranch_vccz K3_ok_57
    s_sleep 1
    s_branch K3_spl_59
K3_sp_61:
    s_mov_b32 s45, 0x40000
K3_spl_62:
    buffer_load_dword v209, v206, s[12:15], s44 offen sc1
    s_waitcnt vmcnt(0)
    v_cmp_gt_u32 vcc, v210, v209
    s_sub_u32 s45, s45, 1
    s_cmp_eq_u32 s45, 0
    s_cbranch_scc1 K3_ok_60
    s_cbranch_vccz K3_ok_60
    s_sleep 1
    s_branch K3_spl_62
K3_code_end:
    s_endpgm
.section .rodata,"a"
.p2align 6
.amdhsa_kernel k1_kernel
  .amdhsa_next_free_vgpr 512
  .amdhsa_next_free_sgpr 102
  .amdhsa_accum_offset 256
  .amdhsa_group_segment_fixed_size 0
  .amdhsa_kernarg_size 104
  .amdhsa_user_sgpr_count 2
  .amdhsa_user_sgpr_kernarg_segment_ptr 1
  .amdhsa_system_sgpr_workgroup_id_x 1
  .amdhsa_float_denorm_mode_32 3
.end_amdhsa_kernel
```
